```python
import torch

def _softmax(x, axis=-1):
    return torch.softmax(x, dim=axis)
def _gelu(x):
    return torch.nn.functional.gelu(x, approximate="tanh")
def _silu(x):
    return torch.nn.functional.silu(x)
def _sigmoid(x):
    return torch.sigmoid(x)
def _layernorm(x, axis=-1, eps=1e-5):
    m = x.mean(dim=axis, keepdim=True)
    v = x.var(dim=axis, keepdim=True, unbiased=False)
    return (x - m) / torch.sqrt(v + eps)
def _scatter_add(tgt, idx, src, axis=0):
    return tgt.clone().index_add_(axis, idx, src)
def _segment_sum(src, seg, n):
    out = torch.zeros((n,) + src.shape[1:], dtype=src.dtype)
    return out.index_add_(0, seg, src)
def _pad(x, pw):
    flat = tuple(v for pair in reversed(pw) for v in pair)
    return torch.nn.functional.pad(x, flat)

kernel_name = 'standalone__gqa_softmax__near_ridge'

def setup_inputs():

    _w = (lambda a: (lambda t: t.to(torch.bfloat16) if t.is_floating_point() else t)(torch.as_tensor(a)))
    B, Hq, Hkv, Sq, Sk, D = 16, 32, 32, 288, 1024, 128
    return {
        "q": _w((lambda *s: torch.randn(*s, dtype=torch.bfloat16) * 0.8)(B, Hq, Sq, D)),
        "k": _w((lambda *s: torch.randn(*s, dtype=torch.bfloat16) * 0.8)(B, Hkv, Sk, D)),
        "v": _w((lambda *s: torch.randn(*s, dtype=torch.bfloat16) * 0.05)(B, Hkv, Sk, D)),
    }

def reference(q, k, v):
    B, Hq, Sq, D = q.shape
    Hkv = k.shape[1]
    rep = Hq // Hkv
    k = (lambda x, n, axis: torch.repeat_interleave(x, n, dim=axis))(k, rep, axis=1)
    v = (lambda x, n, axis: torch.repeat_interleave(x, n, dim=axis))(v, rep, axis=1)
    scale = D ** -0.5
    scores = torch.einsum("bhqd,bhkd->bhqk", q, k) * scale
    p = _softmax(scores, axis=-1)
    return torch.einsum("bhqk,bhkd->bhqd", p, v)
```

```asm
; @launch grid=(256,1,1) block=(256,1,1) lds=163840
.amdgcn_target "amdgcn-amd-amdhsa--gfx950"
.text
.globl standalone__gqa_softmax__near_ridge_kernel
.p2align 8
.type standalone__gqa_softmax__near_ridge_kernel,@function
standalone__gqa_softmax__near_ridge_kernel:
s_cmp_ge_u32 s2, 256
s_cbranch_scc1 L_end
s_load_dwordx4 s[4:7], s[0:1], 0
s_load_dwordx4 s[8:11], s[0:1], 16
v_lshrrev_b32 v16, 6, v0
v_and_b32 v17, 63, v0
v_readfirstlane_b32 s3, v16
v_lshlrev_b32 v3, 4, v17
s_mov_b32 s48, s2
s_mul_i32 s56, s48, 73728
s_lshl_b32 s57, s48, 18
s_mul_i32 s33, s3, 4224
s_mov_b32 s41, -1
s_getreg_b32 s44, hwreg(HW_REG_XCC_ID)
s_lshl_b32 s32, s3, 12
s_add_u32 s32, s32, s57
s_mov_b32 s14, 4096
s_mov_b32 s15, 0x20000
s_mov_b32 s18, 4096
s_mov_b32 s19, 0x20000
s_mov_b32 s30, 37748736
s_mov_b32 s31, 0x20000
s_mov_b32 s22, 73728
s_mov_b32 s23, 0x20000
s_mov_b32 s26, 18432
s_mov_b32 s27, 0x20000
v_accvgpr_write_b32 a232, 0
v_accvgpr_write_b32 a233, 0
v_accvgpr_write_b32 a234, 0
v_accvgpr_write_b32 a235, 0
v_accvgpr_write_b32 a236, 0
v_accvgpr_write_b32 a237, 0
v_accvgpr_write_b32 a238, 0
v_accvgpr_write_b32 a239, 0
v_accvgpr_write_b32 a240, 0
v_accvgpr_write_b32 a241, 0
s_mul_i32 s48, s3, 18432
s_add_u32 s48, s48, 18874368
s_waitcnt lgkmcnt(0)
s_mov_b64 s[28:29], s[10:11]
s_add_u32 s20, s4, s56
s_addc_u32 s21, s5, 0
s_add_u32 s24, s20, s48
s_addc_u32 s25, s21, 0
L_start:
s_add_u32 s12, s6, s32
s_addc_u32 s13, s7, 0
s_add_u32 s16, s8, s32
s_addc_u32 s17, s9, 0
s_lshl_b32 s46, s3, 14
s_lshl_b32 s47, s3, 11
s_add_u32 s47, s47, 65536
s_add_u32 m0, s33, 0
s_nop 0
buffer_load_dwordx4 v3, s[12:15], 0 offen nt lds
s_add_u32 m0, s33, 32
s_nop 0
buffer_load_dwordx4 v3, s[12:15], 0 offen offset:1024 nt lds
s_add_u32 m0, s33, 64
s_nop 0
buffer_load_dwordx4 v3, s[12:15], 0 offen offset:2048 nt lds
s_add_u32 m0, s33, 96
s_nop 0
buffer_load_dwordx4 v3, s[12:15], 0 offen offset:3072 nt lds
buffer_load_dwordx4 v[128:131], v3, s[20:23], s47 offen nt
buffer_load_dwordx4 v[132:135], v3, s[20:23], s47 offen offset:1024 nt
s_getpc_b64 s[48:49]
L_pc:
s_lshr_b32 s50, s2, 3
s_lshl_b32 s50, s50, 12
v_lshl_add_u32 v28, v0, 4, s50
v_min_u32 v28, L_end-L_pc, v28
v_mov_b32 v29, s49
v_add_co_u32 v28, vcc, s48, v28
s_nop 1
v_addc_co_u32 v29, vcc, 0, v29, vcc
global_load_dword v12, v[28:29], off
v_lshrrev_b32 v16, 6, v0
v_and_b32 v17, 63, v0
v_lshrrev_b32 v18, 4, v17
v_and_b32 v19, 7, v17
v_bfe_u32 v20, v17, 3, 1
v_bfe_u32 v24, v16, 1, 1
v_bfe_u32 v25, v16, 0, 1
v_mul_u32_u24 v21, 1056, v19
v_lshl_add_u32 v26, v20, 8, v21
v_lshlrev_b32 v21, 4, v18
v_accvgpr_write_b32 a243, v21
v_add_u32 v1, v26, v21
v_bfe_u32 v21, v17, 2, 3
v_mul_u32_u24 v21, 1056, v21
v_lshrrev_b32 v22, 5, v17
v_lshl_add_u32 v21, v22, 8, v21
v_and_b32 v23, 3, v17
v_lshl_add_u32 v21, v23, 3, v21
v_add_u32 v2, 33792, v21
v_mul_u32_u24 v27, 16896, v16
v_add_u32 v27, 67584, v27
v_add_u32 v6, v27, v1
v_add_u32 v10, v27, v3
v_mul_u32_u24 v21, 2112, v16
v_add_u32 v21, 135168, v21
v_add_u32 v11, v21, v3
v_mul_u32_u24 v21, 19008, v16
v_add_u32 v21, 67584, v21
v_add_u32 v4, v21, v3
v_lshl_add_u32 v21, v25, 9, v1
v_add_u32 v21, 135168, v21
v_accvgpr_write_b32 a242, v21
v_xor_b32 v21, v22, v20
v_lshl_add_u32 v21, v21, 4, v26
v_and_b32 v23, 1, v18
v_lshl_add_u32 v21, v23, 3, v21
v_add_u32 v7, v27, v21
v_lshl_add_u32 v21, v25, 9, v21
v_lshl_add_u32 v21, v24, 7, v21
v_add_u32 v21, 135168, v21
v_accvgpr_write_b32 a249, v21
v_and_b32 v21, 31, v17
v_lshlrev_b32 v21, 4, v21
v_lshl_add_u32 v9, v22, 12, v21
v_lshlrev_b32 v23, 4, v23
v_xor_b32 v28, v23, v10
v_accvgpr_write_b32 a253, v28
v_xor_b32 v21, v23, v21
v_mul_u32_u24 v23, 4224, v22
v_add3_u32 v8, v21, v23, v27
v_xor_b32 v21, v19, v20
v_lshlrev_b32 v21, 4, v21
v_lshl_add_u32 v21, v20, 8, v21
v_mul_u32_u24 v23, 1056, v18
v_add_u32 v21, v21, v23
v_lshl_add_u32 v21, v25, 9, v21
v_lshl_add_u32 v21, v24, 7, v21
v_add_u32 v21, 135168, v21
v_accvgpr_write_b32 a250, v21
v_lshlrev_b32 v21, 4, v19
v_lshl_add_u32 v21, v20, 8, v21
v_lshl_add_u32 v21, v18, 10, v21
v_lshl_add_u32 v21, v25, 9, v21
v_lshl_add_u32 v21, v24, 7, v21
v_accvgpr_write_b32 a251, v21
v_lshl_add_u32 v22, v16, 12, v3
v_add_u32 v21, 143616, v22
v_accvgpr_write_b32 a245, v21
v_xor_b32 v22, 8192, v22
v_add_u32 v21, 143616, v22
v_accvgpr_write_b32 a246, v21
v_lshlrev_b32 v21, 2, v0
v_add_u32 v21, 160768, v21
v_accvgpr_write_b32 a247, v21
v_xor_b32 v21, 512, v21
v_accvgpr_write_b32 a248, v21
v_lshlrev_b32 v21, 2, v16
v_add_u32 v21, 161792, v21
v_accvgpr_write_b32 a252, v21
v_mov_b32 v21, 0x80008000
v_accvgpr_write_b32 a244, v21
v_mov_b32 v21, 0x3f803f80
v_and_b32 v22, 3, v17
v_cmp_eq_u32 vcc, 0, v22
s_nop 1
v_cndmask_b32 v21, 0, v21, vcc
v_accvgpr_write_b32 a228, v21
v_accvgpr_write_b32 a229, v21
v_accvgpr_write_b32 a230, v21
v_accvgpr_write_b32 a231, v21
v_mov_b32 v5, 0
s_mov_b32 s38, 0x3e0293ee
s_mov_b32 s39, 0x3e0293ee
s_mov_b32 s40, 0x5f800000
s_mov_b32 s45, 0xffff0000
s_lshl_b32 s48, s3, 14
s_add_u32 s36, s48, s56
s_add_u32 s42, s36, 18874368
s_add_u32 s43, s56, 65536
s_mov_b32 s35, 0
v_accvgpr_read_b32 v36, a232
v_accvgpr_read_b32 v37, a232
v_accvgpr_read_b32 v38, a232
v_accvgpr_read_b32 v39, a232
v_accvgpr_read_b32 v40, a233
v_accvgpr_read_b32 v41, a233
v_accvgpr_read_b32 v42, a233
v_accvgpr_read_b32 v43, a233
v_accvgpr_read_b32 v44, a234
v_accvgpr_read_b32 v45, a234
v_accvgpr_read_b32 v46, a234
v_accvgpr_read_b32 v47, a234
v_accvgpr_read_b32 v48, a235
v_accvgpr_read_b32 v49, a235
v_accvgpr_read_b32 v50, a235
v_accvgpr_read_b32 v51, a235
v_accvgpr_read_b32 v52, a236
v_accvgpr_read_b32 v53, a236
v_accvgpr_read_b32 v54, a236
v_accvgpr_read_b32 v55, a236
s_waitcnt vmcnt(6)
buffer_load_dwordx4 v[160:163], v3, s[20:23], s46 offen nt
s_waitcnt vmcnt(6)
buffer_load_dwordx4 v[164:167], v3, s[20:23], s46 offen offset:1024 nt
s_waitcnt vmcnt(6)
buffer_load_dwordx4 v[168:171], v3, s[20:23], s46 offen offset:2048 nt
s_waitcnt vmcnt(6)
buffer_load_dwordx4 v[172:175], v3, s[20:23], s46 offen offset:3072 nt
s_waitcnt vmcnt(6)
s_add_u32 s46, s46, 4096
buffer_load_dwordx4 v[176:179], v3, s[20:23], s46 offen nt
v_lshlrev_b32 v56, 16, v128
v_and_b32 v57, s45, v128
v_lshlrev_b32 v58, 16, v129
v_and_b32 v59, s45, v129
v_lshlrev_b32 v60, 16, v130
v_and_b32 v61, s45, v130
v_lshlrev_b32 v62, 16, v131
v_and_b32 v63, s45, v131
v_pk_mul_f32 v[56:57], v[56:57], s[38:39]
v_pk_mul_f32 v[58:59], v[58:59], s[38:39]
v_pk_mul_f32 v[60:61], v[60:61], s[38:39]
v_pk_mul_f32 v[62:63], v[62:63], s[38:39]
v_cvt_pk_bf16_f32 v128, v56, v57
v_cvt_pk_bf16_f32 v129, v58, v59
v_cvt_pk_bf16_f32 v130, v60, v61
v_cvt_pk_bf16_f32 v131, v62, v63
ds_write_b128 v11, v[128:131]
s_waitcnt vmcnt(6)
buffer_load_dwordx4 v[180:183], v3, s[20:23], s46 offen offset:1024 nt
v_lshlrev_b32 v56, 16, v132
v_and_b32 v57, s45, v132
v_lshlrev_b32 v58, 16, v133
v_and_b32 v59, s45, v133
v_lshlrev_b32 v60, 16, v134
v_and_b32 v61, s45, v134
v_lshlrev_b32 v62, 16, v135
v_and_b32 v63, s45, v135
v_pk_mul_f32 v[56:57], v[56:57], s[38:39]
v_pk_mul_f32 v[58:59], v[58:59], s[38:39]
v_pk_mul_f32 v[60:61], v[60:61], s[38:39]
v_pk_mul_f32 v[62:63], v[62:63], s[38:39]
v_cvt_pk_bf16_f32 v132, v56, v57
v_cvt_pk_bf16_f32 v133, v58, v59
v_cvt_pk_bf16_f32 v134, v60, v61
v_cvt_pk_bf16_f32 v135, v62, v63
ds_write_b128 v11, v[132:135] offset:1056
s_waitcnt vmcnt(5)
buffer_load_dwordx4 v[184:187], v3, s[20:23], s46 offen offset:2048 nt
v_lshlrev_b32 v56, 16, v160
v_and_b32 v57, s45, v160
v_lshlrev_b32 v58, 16, v161
v_and_b32 v59, s45, v161
v_lshlrev_b32 v60, 16, v162
v_and_b32 v61, s45, v162
v_lshlrev_b32 v62, 16, v163
v_and_b32 v63, s45, v163
v_pk_mul_f32 v[56:57], v[56:57], s[38:39]
v_pk_mul_f32 v[58:59], v[58:59], s[38:39]
v_pk_mul_f32 v[60:61], v[60:61], s[38:39]
v_pk_mul_f32 v[62:63], v[62:63], s[38:39]
v_cvt_pk_bf16_f32 v160, v56, v57
v_cvt_pk_bf16_f32 v161, v58, v59
v_cvt_pk_bf16_f32 v162, v60, v61
v_cvt_pk_bf16_f32 v163, v62, v63
ds_write_b128 v10, v[160:163]
s_waitcnt lgkmcnt(1)
s_barrier
v_accvgpr_read_b32 v34, a243
v_accvgpr_read_b32 v35, a244
ds_read_b128 v[16:19], v34
ds_read_b128 v[20:23], v34 offset:64
ds_read_b128 v[24:27], v34 offset:128
ds_read_b128 v[28:31], v34 offset:192
v_accvgpr_read_b32 v32, a242
ds_read_b128 a[64:67], v32
ds_read_b128 a[68:71], v32 offset:64
ds_read_b128 a[72:75], v32 offset:128
ds_read_b128 a[76:79], v32 offset:192
s_bitcmp1_b32 s3, 1
s_cbranch_scc1 L_odd
ds_read_b128 a[80:83], v1
ds_read_b128 a[84:87], v1 offset:64
ds_read_b128 a[88:91], v1 offset:128
ds_read_b128 a[92:95], v1 offset:192
ds_read_b128 a[96:99], v1 offset:512
ds_read_b128 a[100:103], v1 offset:576
ds_read_b128 a[104:107], v1 offset:640
ds_read_b128 a[108:111], v1 offset:704
s_waitcnt vmcnt(5)
buffer_load_dwordx4 v[188:191], v3, s[20:23], s46 offen offset:3072 nt
v_lshlrev_b32 v56, 16, v164
v_and_b32 v57, s45, v164
v_lshlrev_b32 v58, 16, v165
v_and_b32 v59, s45, v165
v_lshlrev_b32 v60, 16, v166
v_and_b32 v61, s45, v166
v_lshlrev_b32 v62, 16, v167
v_and_b32 v63, s45, v167
v_pk_mul_f32 v[56:57], v[56:57], s[38:39]
v_pk_mul_f32 v[58:59], v[58:59], s[38:39]
v_pk_mul_f32 v[60:61], v[60:61], s[38:39]
v_pk_mul_f32 v[62:63], v[62:63], s[38:39]
v_cvt_pk_bf16_f32 v164, v56, v57
v_cvt_pk_bf16_f32 v165, v58, v59
v_cvt_pk_bf16_f32 v166, v60, v61
v_cvt_pk_bf16_f32 v167, v62, v63
ds_write_b128 v10, v[164:167] offset:1056
s_waitcnt lgkmcnt(13)
v_bitop3_b32 v16, v16, v35, s41 bitop3:0x28
v_bitop3_b32 v17, v17, v35, s41 bitop3:0x28
v_bitop3_b32 v18, v18, v35, s41 bitop3:0x28
v_bitop3_b32 v19, v19, v35, s41 bitop3:0x28
v_bitop3_b32 v20, v20, v35, s41 bitop3:0x28
v_bitop3_b32 v21, v21, v35, s41 bitop3:0x28
v_bitop3_b32 v22, v22, v35, s41 bitop3:0x28
v_bitop3_b32 v23, v23, v35, s41 bitop3:0x28
v_bitop3_b32 v24, v24, v35, s41 bitop3:0x28
v_bitop3_b32 v25, v25, v35, s41 bitop3:0x28
v_bitop3_b32 v26, v26, v35, s41 bitop3:0x28
v_bitop3_b32 v27, v27, v35, s41 bitop3:0x28
v_bitop3_b32 v28, v28, v35, s41 bitop3:0x28
v_bitop3_b32 v29, v29, v35, s41 bitop3:0x28
v_bitop3_b32 v30, v30, v35, s41 bitop3:0x28
v_bitop3_b32 v31, v31, v35, s41 bitop3:0x28
ds_read_b128 a[112:115], v1 offset:8448
ds_read_b128 a[116:119], v1 offset:8512
ds_read_b128 a[120:123], v1 offset:8576
ds_read_b128 a[124:127], v1 offset:8640
ds_read_b128 a[128:131], v1 offset:8960
ds_read_b128 a[132:135], v1 offset:9024
ds_read_b128 a[136:139], v1 offset:9088
ds_read_b128 a[140:143], v1 offset:9152
s_waitcnt vmcnt(5)
s_add_u32 m0, s33, 33792
s_nop 0
buffer_load_dwordx4 v3, s[16:19], 0 offen nt lds
v_lshlrev_b32 v56, 16, v168
v_and_b32 v57, s45, v168
v_lshlrev_b32 v58, 16, v169
v_and_b32 v59, s45, v169
v_lshlrev_b32 v60, 16, v170
v_and_b32 v61, s45, v170
v_lshlrev_b32 v62, 16, v171
v_and_b32 v63, s45, v171
v_pk_mul_f32 v[56:57], v[56:57], s[38:39]
v_pk_mul_f32 v[58:59], v[58:59], s[38:39]
v_pk_mul_f32 v[60:61], v[60:61], s[38:39]
v_pk_mul_f32 v[62:63], v[62:63], s[38:39]
v_cvt_pk_bf16_f32 v168, v56, v57
v_cvt_pk_bf16_f32 v169, v58, v59
v_cvt_pk_bf16_f32 v170, v60, v61
v_cvt_pk_bf16_f32 v171, v62, v63
ds_write_b128 v10, v[168:171] offset:2112
s_waitcnt vmcnt(5)
s_add_u32 m0, s33, 33824
s_nop 0
buffer_load_dwordx4 v3, s[16:19], 0 offen offset:1024 nt lds
v_lshlrev_b32 v56, 16, v172
v_and_b32 v57, s45, v172
v_lshlrev_b32 v58, 16, v173
v_and_b32 v59, s45, v173
v_lshlrev_b32 v60, 16, v174
v_and_b32 v61, s45, v174
v_lshlrev_b32 v62, 16, v175
v_and_b32 v63, s45, v175
v_pk_mul_f32 v[56:57], v[56:57], s[38:39]
v_pk_mul_f32 v[58:59], v[58:59], s[38:39]
v_pk_mul_f32 v[60:61], v[60:61], s[38:39]
v_pk_mul_f32 v[62:63], v[62:63], s[38:39]
v_cvt_pk_bf16_f32 v172, v56, v57
v_cvt_pk_bf16_f32 v173, v58, v59
v_cvt_pk_bf16_f32 v174, v60, v61
v_cvt_pk_bf16_f32 v175, v62, v63
ds_write_b128 v10, v[172:175] offset:3168
s_waitcnt vmcnt(5)
s_add_u32 m0, s33, 33856
s_nop 0
buffer_load_dwordx4 v3, s[16:19], 0 offen offset:2048 nt lds
v_lshlrev_b32 v56, 16, v176
v_and_b32 v57, s45, v176
v_lshlrev_b32 v58, 16, v177
v_and_b32 v59, s45, v177
v_lshlrev_b32 v60, 16, v178
v_and_b32 v61, s45, v178
v_lshlrev_b32 v62, 16, v179
v_and_b32 v63, s45, v179
v_pk_mul_f32 v[56:57], v[56:57], s[38:39]
v_pk_mul_f32 v[58:59], v[58:59], s[38:39]
v_pk_mul_f32 v[60:61], v[60:61], s[38:39]
v_pk_mul_f32 v[62:63], v[62:63], s[38:39]
v_cvt_pk_bf16_f32 v176, v56, v57
v_cvt_pk_bf16_f32 v177, v58, v59
v_cvt_pk_bf16_f32 v178, v60, v61
v_cvt_pk_bf16_f32 v179, v62, v63
ds_write_b128 v10, v[176:179] offset:4224
s_waitcnt vmcnt(5)
s_add_u32 m0, s33, 33888
s_nop 0
buffer_load_dwordx4 v3, s[16:19], 0 offen offset:3072 nt lds
v_lshlrev_b32 v56, 16, v180
v_and_b32 v57, s45, v180
v_lshlrev_b32 v58, 16, v181
v_and_b32 v59, s45, v181
v_lshlrev_b32 v60, 16, v182
v_and_b32 v61, s45, v182
v_lshlrev_b32 v62, 16, v183
v_and_b32 v63, s45, v183
v_pk_mul_f32 v[56:57], v[56:57], s[38:39]
v_pk_mul_f32 v[58:59], v[58:59], s[38:39]
v_pk_mul_f32 v[60:61], v[60:61], s[38:39]
v_pk_mul_f32 v[62:63], v[62:63], s[38:39]
v_cvt_pk_bf16_f32 v180, v56, v57
v_cvt_pk_bf16_f32 v181, v58, v59
v_cvt_pk_bf16_f32 v182, v60, v61
v_cvt_pk_bf16_f32 v183, v62, v63
ds_write_b128 v10, v[180:183] offset:5280
s_waitcnt vmcnt(5)
s_add_u32 s46, s46, 4096
buffer_load_dwordx4 v[192:195], v3, s[20:23], s46 offen nt
v_lshlrev_b32 v56, 16, v184
v_and_b32 v57, s45, v184
v_lshlrev_b32 v58, 16, v185
v_and_b32 v59, s45, v185
v_lshlrev_b32 v60, 16, v186
v_and_b32 v61, s45, v186
v_lshlrev_b32 v62, 16, v187
v_and_b32 v63, s45, v187
v_pk_mul_f32 v[56:57], v[56:57], s[38:39]
v_pk_mul_f32 v[58:59], v[58:59], s[38:39]
v_pk_mul_f32 v[60:61], v[60:61], s[38:39]
v_pk_mul_f32 v[62:63], v[62:63], s[38:39]
v_cvt_pk_bf16_f32 v184, v56, v57
v_cvt_pk_bf16_f32 v185, v58, v59
v_cvt_pk_bf16_f32 v186, v60, v61
v_cvt_pk_bf16_f32 v187, v62, v63
ds_write_b128 v10, v[184:187] offset:6336
s_waitcnt vmcnt(5)
buffer_load_dwordx4 v[196:199], v3, s[20:23], s46 offen offset:1024 nt
v_lshlrev_b32 v56, 16, v188
v_and_b32 v57, s45, v188
v_lshlrev_b32 v58, 16, v189
v_and_b32 v59, s45, v189
v_lshlrev_b32 v60, 16, v190
v_and_b32 v61, s45, v190
v_lshlrev_b32 v62, 16, v191
v_and_b32 v63, s45, v191
v_pk_mul_f32 v[56:57], v[56:57], s[38:39]
v_pk_mul_f32 v[58:59], v[58:59], s[38:39]
v_pk_mul_f32 v[60:61], v[60:61], s[38:39]
v_pk_mul_f32 v[62:63], v[62:63], s[38:39]
v_cvt_pk_bf16_f32 v188, v56, v57
v_cvt_pk_bf16_f32 v189, v58, v59
v_cvt_pk_bf16_f32 v190, v60, v61
v_cvt_pk_bf16_f32 v191, v62, v63
ds_write_b128 v10, v[188:191] offset:7392
ds_read_b128 a[0:3], v6
ds_read_b128 a[4:7], v6 offset:64
ds_read_b128 a[8:11], v6 offset:128
ds_read_b128 a[12:15], v6 offset:192
ds_read_b128 a[16:19], v6 offset:512
ds_read_b128 a[20:23], v6 offset:576
ds_read_b128 a[24:27], v6 offset:640
ds_read_b128 a[28:31], v6 offset:704
s_waitcnt lgkmcnt(14)
v_mfma_f32_16x16x32_bf16 v[52:55], v[16:19], a[64:67], v[52:55]
v_mfma_f32_16x16x32_bf16 v[52:55], v[20:23], a[68:71], v[52:55]
v_mfma_f32_16x16x32_bf16 v[52:55], v[24:27], a[72:75], v[52:55]
v_mfma_f32_16x16x32_bf16 v[52:55], v[28:31], a[76:79], v[52:55]
v_mfma_f32_16x16x32_bf16 v[56:59], a[80:83], a[64:67], v[52:55]
v_mfma_f32_16x16x32_bf16 v[56:59], a[84:87], a[68:71], v[56:59]
v_mfma_f32_16x16x32_bf16 v[56:59], a[88:91], a[72:75], v[56:59]
v_mfma_f32_16x16x32_bf16 v[56:59], a[92:95], a[76:79], v[56:59]
v_mfma_f32_16x16x32_bf16 v[60:63], a[108:111], a[76:79], v[52:55]
v_mfma_f32_16x16x32_bf16 v[60:63], a[104:107], a[72:75], v[60:63]
v_mfma_f32_16x16x32_bf16 v[60:63], a[100:103], a[68:71], v[60:63]
v_mfma_f32_16x16x32_bf16 v[60:63], a[96:99], a[64:67], v[60:63]
s_waitcnt lgkmcnt(4)
v_mfma_f32_16x16x32_bf16 v[36:39], v[16:19], a[0:3], v[36:39]
v_mfma_f32_16x16x32_bf16 v[36:39], v[20:23], a[4:7], v[36:39]
v_mfma_f32_16x16x32_bf16 v[36:39], v[24:27], a[8:11], v[36:39]
v_mfma_f32_16x16x32_bf16 v[36:39], v[28:31], a[12:15], v[36:39]
v_mfma_f32_16x16x32_bf16 v[64:67], a[80:83], a[0:3], v[36:39]
v_exp_f32 v56, v56
v_mfma_f32_16x16x32_bf16 v[64:67], a[84:87], a[4:7], v[64:67]
v_exp_f32 v57, v57
v_mfma_f32_16x16x32_bf16 v[64:67], a[88:91], a[8:11], v[64:67]
v_exp_f32 v58, v58
v_mfma_f32_16x16x32_bf16 v[64:67], a[92:95], a[12:15], v[64:67]
v_exp_f32 v59, v59
v_mfma_f32_16x16x32_bf16 v[68:71], a[108:111], a[12:15], v[36:39]
v_exp_f32 v60, v60
v_mfma_f32_16x16x32_bf16 v[68:71], a[104:107], a[8:11], v[68:71]
v_exp_f32 v61, v61
v_mfma_f32_16x16x32_bf16 v[68:71], a[100:103], a[4:7], v[68:71]
v_exp_f32 v62, v62
v_mfma_f32_16x16x32_bf16 v[68:71], a[96:99], a[0:3], v[68:71]
s_waitcnt lgkmcnt(14)
v_exp_f32 v63, v63
v_mfma_f32_16x16x32_bf16 v[72:75], a[112:115], a[0:3], v[36:39]
v_exp_f32 v64, v64
v_mfma_f32_16x16x32_bf16 v[72:75], a[116:119], a[4:7], v[72:75]
v_cvt_pk_bf16_f32 v80, v56, v57
v_cvt_pk_bf16_f32 v81, v58, v59
v_mfma_f32_16x16x32_bf16 v[72:75], a[120:123], a[8:11], v[72:75]
v_exp_f32 v65, v65
v_mfma_f32_16x16x32_bf16 v[72:75], a[124:127], a[12:15], v[72:75]
v_cvt_pk_bf16_f32 v88, v64, v65
v_mfma_f32_16x16x32_bf16 v[76:79], a[140:143], a[12:15], v[36:39]
v_exp_f32 v66, v66
v_mfma_f32_16x16x32_bf16 v[76:79], a[136:139], a[8:11], v[76:79]
v_cvt_pk_bf16_f32 v82, v60, v61
v_cvt_pk_bf16_f32 v83, v62, v63
v_mfma_f32_16x16x32_bf16 v[76:79], a[132:135], a[4:7], v[76:79]
v_exp_f32 v67, v67
v_mfma_f32_16x16x32_bf16 v[76:79], a[128:131], a[0:3], v[76:79]
v_cvt_pk_bf16_f32 v89, v66, v67
s_waitcnt vmcnt(5)
buffer_load_dwordx4 v[200:203], v3, s[20:23], s46 offen offset:2048 nt
s_waitcnt vmcnt(5)
buffer_load_dwordx4 v[204:207], v3, s[20:23], s46 offen offset:3072 nt
s_waitcnt vmcnt(5)
s_add_u32 s46, s46, 4096
buffer_load_dwordx4 v[208:211], v3, s[20:23], s46 offen nt
s_waitcnt vmcnt(5)
buffer_load_dwordx4 v[212:215], v3, s[20:23], s46 offen offset:1024 nt
s_waitcnt lgkmcnt(14)
s_barrier
ds_read_b64_tr_b16 a[144:145], v2
ds_read_b64_tr_b16 a[146:147], v2 offset:512
ds_read_b64_tr_b16 a[148:149], v2 offset:32
ds_read_b64_tr_b16 a[150:151], v2 offset:544
ds_read_b64_tr_b16 a[152:153], v2 offset:64
ds_read_b64_tr_b16 a[154:155], v2 offset:576
ds_read_b64_tr_b16 a[156:157], v2 offset:96
ds_read_b64_tr_b16 a[158:159], v2 offset:608
ds_read_b64_tr_b16 a[160:161], v2 offset:128
ds_read_b64_tr_b16 a[162:163], v2 offset:640
ds_read_b64_tr_b16 a[164:165], v2 offset:160
ds_read_b64_tr_b16 a[166:167], v2 offset:672
ds_read_b64_tr_b16 a[168:169], v2 offset:192
ds_read_b64_tr_b16 a[170:171], v2 offset:704
ds_read_b64_tr_b16 a[172:173], v2 offset:224
ds_read_b64_tr_b16 a[174:175], v2 offset:736
s_waitcnt lgkmcnt(8)
v_mfma_f32_16x16x32_bf16 v[224:227], a[144:147], v[80:83], 0
v_exp_f32 v68, v68
v_mfma_f32_16x16x32_bf16 v[228:231], a[148:151], v[80:83], 0
ds_read_b64_tr_b16 a[176:177], v2 offset:8448
ds_read_b64_tr_b16 a[178:179], v2 offset:8960
v_mfma_f32_16x16x32_bf16 v[232:235], a[152:155], v[80:83], 0
v_exp_f32 v69, v69
v_mfma_f32_16x16x32_bf16 v[236:239], a[156:159], v[80:83], 0
s_waitcnt lgkmcnt(2)
v_cvt_pk_bf16_f32 v90, v68, v69
v_mfma_f32_16x16x32_bf16 v[240:243], a[160:163], v[80:83], 0
v_exp_f32 v70, v70
v_mfma_f32_16x16x32_bf16 v[244:247], a[164:167], v[80:83], 0
ds_read_b64_tr_b16 a[180:181], v2 offset:8480
ds_read_b64_tr_b16 a[182:183], v2 offset:8992
v_mfma_f32_16x16x32_bf16 v[248:251], a[168:171], v[80:83], 0
v_exp_f32 v71, v71
v_mfma_f32_16x16x32_bf16 v[252:255], a[172:175], v[80:83], 0
ds_read_b64_tr_b16 a[184:185], v2 offset:8512
v_cvt_pk_bf16_f32 v91, v70, v71
v_mfma_f32_16x16x32_bf16 a[224:227], a[228:231], v[80:83], 0
v_exp_f32 v72, v72
v_mfma_f32_16x16x32_bf16 v[40:43], v[16:19], a[16:19], v[40:43]
s_waitcnt vmcnt(5)
buffer_load_dwordx4 v[216:219], v3, s[20:23], s46 offen offset:2048 nt
v_lshlrev_b32 v160, 16, v192
v_and_b32 v161, s45, v192
v_lshlrev_b32 v162, 16, v193
v_and_b32 v163, s45, v193
v_lshlrev_b32 v164, 16, v194
v_and_b32 v165, s45, v194
v_lshlrev_b32 v166, 16, v195
v_and_b32 v167, s45, v195
v_pk_mul_f32 v[160:161], v[160:161], s[38:39]
v_pk_mul_f32 v[162:163], v[162:163], s[38:39]
v_pk_mul_f32 v[164:165], v[164:165], s[38:39]
v_pk_mul_f32 v[166:167], v[166:167], s[38:39]
v_cvt_pk_bf16_f32 v192, v160, v161
v_cvt_pk_bf16_f32 v193, v162, v163
v_cvt_pk_bf16_f32 v194, v164, v165
v_cvt_pk_bf16_f32 v195, v166, v167
ds_write_b128 v10, v[192:195] offset:8448
v_mfma_f32_16x16x32_bf16 v[40:43], v[20:23], a[20:23], v[40:43]
ds_read_b64_tr_b16 a[186:187], v2 offset:9024
ds_read_b64_tr_b16 a[188:189], v2 offset:8544
v_mfma_f32_16x16x32_bf16 v[40:43], v[24:27], a[24:27], v[40:43]
ds_read_b64_tr_b16 a[190:191], v2 offset:9056
ds_read_b64_tr_b16 a[192:193], v2 offset:8576
v_mfma_f32_16x16x32_bf16 v[40:43], v[28:31], a[28:31], v[40:43]
s_waitcnt vmcnt(5)
buffer_load_dwordx4 v[220:223], v3, s[20:23], s46 offen offset:3072 nt
v_lshlrev_b32 v160, 16, v196
v_and_b32 v161, s45, v196
v_lshlrev_b32 v162, 16, v197
v_and_b32 v163, s45, v197
v_lshlrev_b32 v164, 16, v198
v_and_b32 v165, s45, v198
v_lshlrev_b32 v166, 16, v199
v_and_b32 v167, s45, v199
v_pk_mul_f32 v[160:161], v[160:161], s[38:39]
v_pk_mul_f32 v[162:163], v[162:163], s[38:39]
v_pk_mul_f32 v[164:165], v[164:165], s[38:39]
v_pk_mul_f32 v[166:167], v[166:167], s[38:39]
v_cvt_pk_bf16_f32 v196, v160, v161
v_cvt_pk_bf16_f32 v197, v162, v163
v_cvt_pk_bf16_f32 v198, v164, v165
v_cvt_pk_bf16_f32 v199, v166, v167
ds_write_b128 v10, v[196:199] offset:9504
v_mfma_f32_16x16x32_bf16 v[56:59], a[80:83], a[16:19], v[40:43]
ds_read_b64_tr_b16 a[194:195], v2 offset:9088
ds_read_b64_tr_b16 a[196:197], v2 offset:8608
v_mfma_f32_16x16x32_bf16 v[56:59], a[84:87], a[20:23], v[56:59]
v_exp_f32 v73, v73
v_mfma_f32_16x16x32_bf16 v[56:59], a[88:91], a[24:27], v[56:59]
ds_read_b64_tr_b16 a[198:199], v2 offset:9120
v_cvt_pk_bf16_f32 v92, v72, v73
v_mfma_f32_16x16x32_bf16 v[56:59], a[92:95], a[28:31], v[56:59]
v_exp_f32 v74, v74
v_mfma_f32_16x16x32_bf16 v[60:63], a[108:111], a[28:31], v[40:43]
s_waitcnt vmcnt(5)
s_add_u32 s12, s12, 16384
s_addc_u32 s13, s13, 0
s_add_u32 m0, s33, 16896
s_nop 0
buffer_load_dwordx4 v3, s[12:15], 0 offen nt lds
v_lshlrev_b32 v160, 16, v200
v_and_b32 v161, s45, v200
v_lshlrev_b32 v162, 16, v201
v_and_b32 v163, s45, v201
v_lshlrev_b32 v164, 16, v202
v_and_b32 v165, s45, v202
v_lshlrev_b32 v166, 16, v203
v_and_b32 v167, s45, v203
v_pk_mul_f32 v[160:161], v[160:161], s[38:39]
v_pk_mul_f32 v[162:163], v[162:163], s[38:39]
v_pk_mul_f32 v[164:165], v[164:165], s[38:39]
v_pk_mul_f32 v[166:167], v[166:167], s[38:39]
v_cvt_pk_bf16_f32 v200, v160, v161
v_cvt_pk_bf16_f32 v201, v162, v163
v_cvt_pk_bf16_f32 v202, v164, v165
v_cvt_pk_bf16_f32 v203, v166, v167
ds_write_b128 v10, v[200:203] offset:10560
v_mfma_f32_16x16x32_bf16 v[60:63], a[104:107], a[24:27], v[60:63]
v_exp_f32 v75, v75
v_mfma_f32_16x16x32_bf16 v[60:63], a[100:103], a[20:23], v[60:63]
ds_read_b64_tr_b16 a[200:201], v2 offset:8640
v_cvt_pk_bf16_f32 v93, v74, v75
v_mfma_f32_16x16x32_bf16 v[60:63], a[96:99], a[16:19], v[60:63]
v_exp_f32 v76, v76
v_mfma_f32_16x16x32_bf16 v[64:67], a[112:115], a[16:19], v[40:43]
ds_read_b64_tr_b16 a[202:203], v2 offset:9152
v_mfma_f32_16x16x32_bf16 v[64:67], a[116:119], a[20:23], v[64:67]
v_exp_f32 v77, v77
v_mfma_f32_16x16x32_bf16 v[64:67], a[120:123], a[24:27], v[64:67]
ds_read_b64_tr_b16 a[204:205], v2 offset:8672
v_cvt_pk_bf16_f32 v94, v76, v77
v_mfma_f32_16x16x32_bf16 v[64:67], a[124:127], a[28:31], v[64:67]
v_exp_f32 v78, v78
v_mfma_f32_16x16x32_bf16 v[68:71], a[140:143], a[28:31], v[40:43]
s_waitcnt vmcnt(5)
s_add_u32 m0, s33, 16928
s_nop 0
buffer_load_dwordx4 v3, s[12:15], 0 offen offset:1024 nt lds
v_lshlrev_b32 v160, 16, v204
v_and_b32 v161, s45, v204
v_lshlrev_b32 v162, 16, v205
v_and_b32 v163, s45, v205
v_lshlrev_b32 v164, 16, v206
v_and_b32 v165, s45, v206
v_lshlrev_b32 v166, 16, v207
v_and_b32 v167, s45, v207
v_pk_mul_f32 v[160:161], v[160:161], s[38:39]
v_pk_mul_f32 v[162:163], v[162:163], s[38:39]
v_pk_mul_f32 v[164:165], v[164:165], s[38:39]
v_pk_mul_f32 v[166:167], v[166:167], s[38:39]
v_cvt_pk_bf16_f32 v204, v160, v161
v_cvt_pk_bf16_f32 v205, v162, v163
v_cvt_pk_bf16_f32 v206, v164, v165
v_cvt_pk_bf16_f32 v207, v166, v167
ds_write_b128 v10, v[204:207] offset:11616
v_mfma_f32_16x16x32_bf16 v[68:71], a[136:139], a[24:27], v[68:71]
v_exp_f32 v79, v79
v_mfma_f32_16x16x32_bf16 v[68:71], a[132:135], a[20:23], v[68:71]
ds_read_b64_tr_b16 a[206:207], v2 offset:9184
v_cvt_pk_bf16_f32 v95, v78, v79
v_mfma_f32_16x16x32_bf16 v[68:71], a[128:131], a[16:19], v[68:71]
s_waitcnt lgkmcnt(11)
v_exp_f32 v56, v56
v_mfma_f32_16x16x32_bf16 v[96:99], a[144:147], v[88:91], 0
s_waitcnt vmcnt(5)
s_add_u32 m0, s33, 16960
s_nop 0
buffer_load_dwordx4 v3, s[12:15], 0 offen offset:2048 nt lds
v_lshlrev_b32 v160, 16, v208
v_and_b32 v161, s45, v208
v_lshlrev_b32 v162, 16, v209
v_and_b32 v163, s45, v209
v_lshlrev_b32 v164, 16, v210
v_and_b32 v165, s45, v210
v_lshlrev_b32 v166, 16, v211
v_and_b32 v167, s45, v211
v_pk_mul_f32 v[160:161], v[160:161], s[38:39]
v_pk_mul_f32 v[162:163], v[162:163], s[38:39]
v_pk_mul_f32 v[164:165], v[164:165], s[38:39]
v_pk_mul_f32 v[166:167], v[166:167], s[38:39]
v_cvt_pk_bf16_f32 v208, v160, v161
v_cvt_pk_bf16_f32 v209, v162, v163
v_cvt_pk_bf16_f32 v210, v164, v165
v_cvt_pk_bf16_f32 v211, v166, v167
ds_write_b128 v10, v[208:211] offset:12672
v_mfma_f32_16x16x32_bf16 v[96:99], a[176:179], v[92:95], v[96:99]
v_exp_f32 v57, v57
v_mfma_f32_16x16x32_bf16 v[100:103], a[180:183], v[92:95], 0
v_cvt_pk_bf16_f32 v80, v56, v57
v_mfma_f32_16x16x32_bf16 v[100:103], a[148:151], v[88:91], v[100:103]
v_exp_f32 v58, v58
v_mfma_f32_16x16x32_bf16 v[104:107], a[152:155], v[88:91], 0
v_mfma_f32_16x16x32_bf16 v[104:107], a[184:187], v[92:95], v[104:107]
v_exp_f32 v59, v59
v_mfma_f32_16x16x32_bf16 v[108:111], a[188:191], v[92:95], 0
v_cvt_pk_bf16_f32 v81, v58, v59
v_mfma_f32_16x16x32_bf16 v[108:111], a[156:159], v[88:91], v[108:111]
s_waitcnt lgkmcnt(1)
v_exp_f32 v60, v60
v_mfma_f32_16x16x32_bf16 v[112:115], a[160:163], v[88:91], 0
s_waitcnt vmcnt(5)
s_add_u32 m0, s33, 16992
s_nop 0
buffer_load_dwordx4 v3, s[12:15], 0 offen offset:3072 nt lds
v_lshlrev_b32 v160, 16, v212
v_and_b32 v161, s45, v212
v_lshlrev_b32 v162, 16, v213
v_and_b32 v163, s45, v213
v_lshlrev_b32 v164, 16, v214
v_and_b32 v165, s45, v214
v_lshlrev_b32 v166, 16, v215
v_and_b32 v167, s45, v215
v_pk_mul_f32 v[160:161], v[160:161], s[38:39]
v_pk_mul_f32 v[162:163], v[162:163], s[38:39]
v_pk_mul_f32 v[164:165], v[164:165], s[38:39]
v_pk_mul_f32 v[166:167], v[166:167], s[38:39]
v_cvt_pk_bf16_f32 v212, v160, v161
v_cvt_pk_bf16_f32 v213, v162, v163
v_cvt_pk_bf16_f32 v214, v164, v165
v_cvt_pk_bf16_f32 v215, v166, v167
ds_write_b128 v10, v[212:215] offset:13728
v_mfma_f32_16x16x32_bf16 v[112:115], a[192:195], v[92:95], v[112:115]
v_exp_f32 v61, v61
v_mfma_f32_16x16x32_bf16 v[116:119], a[196:199], v[92:95], 0
v_cvt_pk_bf16_f32 v82, v60, v61
v_mfma_f32_16x16x32_bf16 v[116:119], a[164:167], v[88:91], v[116:119]
v_exp_f32 v62, v62
v_mfma_f32_16x16x32_bf16 v[120:123], a[168:171], v[88:91], 0
s_waitcnt vmcnt(5)
s_add_u32 s16, s16, 16384
s_addc_u32 s17, s17, 0
s_add_u32 m0, s33, 50688
s_nop 0
buffer_load_dwordx4 v3, s[16:19], 0 offen nt lds
v_lshlrev_b32 v160, 16, v216
v_and_b32 v161, s45, v216
v_lshlrev_b32 v162, 16, v217
v_and_b32 v163, s45, v217
v_lshlrev_b32 v164, 16, v218
v_and_b32 v165, s45, v218
v_lshlrev_b32 v166, 16, v219
v_and_b32 v167, s45, v219
v_pk_mul_f32 v[160:161], v[160:161], s[38:39]
v_pk_mul_f32 v[162:163], v[162:163], s[38:39]
v_pk_mul_f32 v[164:165], v[164:165], s[38:39]
v_pk_mul_f32 v[166:167], v[166:167], s[38:39]
v_cvt_pk_bf16_f32 v216, v160, v161
v_cvt_pk_bf16_f32 v217, v162, v163
v_cvt_pk_bf16_f32 v218, v164, v165
v_cvt_pk_bf16_f32 v219, v166, v167
ds_write_b128 v10, v[216:219] offset:14784
v_mfma_f32_16x16x32_bf16 v[120:123], a[200:203], v[92:95], v[120:123]
v_exp_f32 v63, v63
v_mfma_f32_16x16x32_bf16 v[124:127], a[204:207], v[92:95], 0
v_cvt_pk_bf16_f32 v83, v62, v63
v_mfma_f32_16x16x32_bf16 v[124:127], a[172:175], v[88:91], v[124:127]
v_exp_f32 v64, v64
v_mfma_f32_16x16x32_bf16 a[208:211], a[228:231], v[88:91], 0
v_mfma_f32_16x16x32_bf16 a[208:211], a[228:231], v[92:95], a[208:211]
v_exp_f32 v65, v65
s_waitcnt vmcnt(5)
s_add_u32 m0, s33, 50720
s_nop 0
buffer_load_dwordx4 v3, s[16:19], 0 offen offset:1024 nt lds
v_lshlrev_b32 v160, 16, v220
v_and_b32 v161, s45, v220
v_lshlrev_b32 v162, 16, v221
v_and_b32 v163, s45, v221
v_lshlrev_b32 v164, 16, v222
v_and_b32 v165, s45, v222
v_lshlrev_b32 v166, 16, v223
v_and_b32 v167, s45, v223
v_pk_mul_f32 v[160:161], v[160:161], s[38:39]
v_pk_mul_f32 v[162:163], v[162:163], s[38:39]
v_pk_mul_f32 v[164:165], v[164:165], s[38:39]
v_pk_mul_f32 v[166:167], v[166:167], s[38:39]
v_cvt_pk_bf16_f32 v220, v160, v161
v_cvt_pk_bf16_f32 v221, v162, v163
v_cvt_pk_bf16_f32 v222, v164, v165
v_cvt_pk_bf16_f32 v223, v166, v167
ds_write_b128 v10, v[220:223] offset:15840
ds_read_b128 a[32:35], v6 offset:8448
ds_read_b128 a[36:39], v6 offset:8512
ds_read_b128 a[40:43], v6 offset:8576
ds_read_b128 a[44:47], v6 offset:8640
ds_read_b128 a[48:51], v6 offset:8960
ds_read_b128 a[52:55], v6 offset:9024
ds_read_b128 a[56:59], v6 offset:9088
ds_read_b128 a[60:63], v6 offset:9152
s_add_u32 m0, s33, 50752
s_nop 0
buffer_load_dwordx4 v3, s[16:19], 0 offen offset:2048 nt lds
s_add_u32 m0, s33, 50784
s_nop 0
buffer_load_dwordx4 v3, s[16:19], 0 offen offset:3072 nt lds
s_waitcnt lgkmcnt(4)
v_mfma_f32_16x16x32_bf16 v[44:47], v[16:19], a[32:35], v[44:47]
v_mfma_f32_16x16x32_bf16 v[44:47], v[20:23], a[36:39], v[44:47]
v_mfma_f32_16x16x32_bf16 v[44:47], v[24:27], a[40:43], v[44:47]
v_mfma_f32_16x16x32_bf16 v[44:47], v[28:31], a[44:47], v[44:47]
v_mfma_f32_16x16x32_bf16 v[72:75], a[80:83], a[32:35], v[44:47]
v_cvt_pk_bf16_f32 v84, v64, v65
v_mfma_f32_16x16x32_bf16 v[72:75], a[84:87], a[36:39], v[72:75]
v_exp_f32 v66, v66
v_mfma_f32_16x16x32_bf16 v[72:75], a[88:91], a[40:43], v[72:75]
v_mfma_f32_16x16x32_bf16 v[72:75], a[92:95], a[44:47], v[72:75]
v_exp_f32 v67, v67
v_mfma_f32_16x16x32_bf16 v[76:79], a[108:111], a[44:47], v[44:47]
v_cvt_pk_bf16_f32 v85, v66, v67
v_mfma_f32_16x16x32_bf16 v[76:79], a[104:107], a[40:43], v[76:79]
v_mfma_f32_16x16x32_bf16 v[76:79], a[100:103], a[36:39], v[76:79]
v_mfma_f32_16x16x32_bf16 v[76:79], a[96:99], a[32:35], v[76:79]
v_mfma_f32_16x16x32_bf16 v[56:59], a[112:115], a[32:35], v[44:47]
v_mfma_f32_16x16x32_bf16 v[56:59], a[116:119], a[36:39], v[56:59]
v_mfma_f32_16x16x32_bf16 v[56:59], a[120:123], a[40:43], v[56:59]
v_mfma_f32_16x16x32_bf16 v[56:59], a[124:127], a[44:47], v[56:59]
v_exp_f32 v68, v68
v_exp_f32 v69, v69
v_exp_f32 v70, v70
v_exp_f32 v71, v71
v_cvt_pk_bf16_f32 v86, v68, v69
v_cvt_pk_bf16_f32 v87, v70, v71
v_mfma_f32_16x16x32_bf16 v[60:63], a[140:143], a[44:47], v[44:47]
v_mfma_f32_16x16x32_bf16 v[60:63], a[136:139], a[40:43], v[60:63]
v_mfma_f32_16x16x32_bf16 v[60:63], a[132:135], a[36:39], v[60:63]
v_mfma_f32_16x16x32_bf16 v[60:63], a[128:131], a[32:35], v[60:63]
s_add_u32 s12, s12, 16384
s_addc_u32 s13, s13, 0
v_mfma_f32_16x16x32_bf16 v[128:131], a[144:147], v[80:83], 0
s_add_u32 m0, s33, 0
v_mfma_f32_16x16x32_bf16 v[128:131], a[176:179], v[84:87], v[128:131]
buffer_load_dwordx4 v3, s[12:15], 0 offen nt lds
v_exp_f32 v72, v72
v_exp_f32 v73, v73
v_exp_f32 v74, v74
v_exp_f32 v75, v75
v_cvt_pk_bf16_f32 v88, v72, v73
v_cvt_pk_bf16_f32 v89, v74, v75
v_mfma_f32_16x16x32_bf16 v[132:135], a[180:183], v[84:87], 0
v_mfma_f32_16x16x32_bf16 v[132:135], a[148:151], v[80:83], v[132:135]
v_mfma_f32_16x16x32_bf16 v[136:139], a[152:155], v[80:83], 0
s_add_u32 m0, s33, 32
v_mfma_f32_16x16x32_bf16 v[136:139], a[184:187], v[84:87], v[136:139]
buffer_load_dwordx4 v3, s[12:15], 0 offen offset:1024 nt lds
v_mfma_f32_16x16x32_bf16 v[140:143], a[188:191], v[84:87], 0
v_mfma_f32_16x16x32_bf16 v[140:143], a[156:159], v[80:83], v[140:143]
v_mfma_f32_16x16x32_bf16 v[144:147], a[160:163], v[80:83], 0
s_add_u32 m0, s33, 64
v_mfma_f32_16x16x32_bf16 v[144:147], a[192:195], v[84:87], v[144:147]
buffer_load_dwordx4 v3, s[12:15], 0 offen offset:2048 nt lds
v_exp_f32 v76, v76
v_exp_f32 v77, v77
v_exp_f32 v78, v78
v_exp_f32 v79, v79
v_cvt_pk_bf16_f32 v90, v76, v77
v_cvt_pk_bf16_f32 v91, v78, v79
v_mfma_f32_16x16x32_bf16 v[148:151], a[196:199], v[84:87], 0
v_mfma_f32_16x16x32_bf16 v[148:151], a[164:167], v[80:83], v[148:151]
v_mfma_f32_16x16x32_bf16 v[152:155], a[168:171], v[80:83], 0
s_add_u32 m0, s33, 96
v_mfma_f32_16x16x32_bf16 v[152:155], a[200:203], v[84:87], v[152:155]
buffer_load_dwordx4 v3, s[12:15], 0 offen offset:3072 nt lds
v_mfma_f32_16x16x32_bf16 v[156:159], a[204:207], v[84:87], 0
s_waitcnt vmcnt(8) lgkmcnt(12)
v_mfma_f32_16x16x32_bf16 v[156:159], a[172:175], v[80:83], v[156:159]
v_mfma_f32_16x16x32_bf16 a[212:215], a[228:231], v[80:83], 0
s_barrier
v_mfma_f32_16x16x32_bf16 a[212:215], a[228:231], v[84:87], a[212:215]
s_waitcnt lgkmcnt(0)
v_exp_f32 v56, v56
v_exp_f32 v57, v57
v_exp_f32 v58, v58
v_exp_f32 v59, v59
v_cvt_pk_bf16_f32 v92, v56, v57
v_cvt_pk_bf16_f32 v93, v58, v59
v_mfma_f32_16x16x32_bf16 v[48:51], v[16:19], a[48:51], v[48:51]
v_mfma_f32_16x16x32_bf16 v[48:51], v[20:23], a[52:55], v[48:51]
v_mfma_f32_16x16x32_bf16 v[48:51], v[24:27], a[56:59], v[48:51]
v_mfma_f32_16x16x32_bf16 v[48:51], v[28:31], a[60:63], v[48:51]
v_mfma_f32_16x16x32_bf16 v[64:67], a[80:83], a[48:51], v[48:51]
v_mfma_f32_16x16x32_bf16 v[64:67], a[84:87], a[52:55], v[64:67]
ds_read_b128 a[80:83], v1 offset:16896
v_mfma_f32_16x16x32_bf16 v[64:67], a[88:91], a[56:59], v[64:67]
v_mfma_f32_16x16x32_bf16 v[64:67], a[92:95], a[60:63], v[64:67]
ds_read_b128 a[84:87], v1 offset:16960
ds_read_b128 a[88:91], v1 offset:17024
v_mfma_f32_16x16x32_bf16 v[68:71], a[108:111], a[60:63], v[48:51]
v_mfma_f32_16x16x32_bf16 v[68:71], a[104:107], a[56:59], v[68:71]
ds_read_b128 a[92:95], v1 offset:17088
v_mfma_f32_16x16x32_bf16 v[68:71], a[100:103], a[52:55], v[68:71]
v_mfma_f32_16x16x32_bf16 v[68:71], a[96:99], a[48:51], v[68:71]
ds_read_b128 a[108:111], v1 offset:17600
v_exp_f32 v60, v60
v_exp_f32 v61, v61
v_exp_f32 v62, v62
v_exp_f32 v63, v63
v_cvt_pk_bf16_f32 v94, v60, v61
v_cvt_pk_bf16_f32 v95, v62, v63
v_mfma_f32_16x16x32_bf16 v[72:75], a[112:115], a[48:51], v[48:51]
v_mfma_f32_16x16x32_bf16 v[72:75], a[116:119], a[52:55], v[72:75]
v_mfma_f32_16x16x32_bf16 v[72:75], a[120:123], a[56:59], v[72:75]
ds_read_b128 a[104:107], v1 offset:17536
v_mfma_f32_16x16x32_bf16 v[72:75], a[124:127], a[60:63], v[72:75]
v_mfma_f32_16x16x32_bf16 v[76:79], a[140:143], a[60:63], v[48:51]
ds_read_b128 a[100:103], v1 offset:17472
v_mfma_f32_16x16x32_bf16 v[76:79], a[136:139], a[56:59], v[76:79]
v_mfma_f32_16x16x32_bf16 v[76:79], a[132:135], a[52:55], v[76:79]
ds_read_b128 a[96:99], v1 offset:17408
v_mfma_f32_16x16x32_bf16 v[76:79], a[128:131], a[48:51], v[76:79]
v_exp_f32 v64, v64
v_exp_f32 v65, v65
v_exp_f32 v66, v66
v_exp_f32 v67, v67
v_cvt_pk_bf16_f32 v80, v64, v65
v_cvt_pk_bf16_f32 v81, v66, v67
v_mfma_f32_16x16x32_bf16 v[160:163], a[144:147], v[88:91], 0
ds_read_b128 a[112:115], v1 offset:25344
v_mfma_f32_16x16x32_bf16 v[160:163], a[176:179], v[92:95], v[160:163]
v_mfma_f32_16x16x32_bf16 v[164:167], a[180:183], v[92:95], 0
ds_read_b128 a[116:119], v1 offset:25408
v_mfma_f32_16x16x32_bf16 v[164:167], a[148:151], v[88:91], v[164:167]
v_mfma_f32_16x16x32_bf16 v[168:171], a[152:155], v[88:91], 0
ds_read_b128 a[120:123], v1 offset:25472
v_mfma_f32_16x16x32_bf16 v[168:171], a[184:187], v[92:95], v[168:171]
v_mfma_f32_16x16x32_bf16 v[172:175], a[188:191], v[92:95], 0
ds_read_b128 a[124:127], v1 offset:25536
v_mfma_f32_16x16x32_bf16 v[172:175], a[156:159], v[88:91], v[172:175]
v_exp_f32 v68, v68
v_exp_f32 v69, v69
v_exp_f32 v70, v70
v_exp_f32 v71, v71
v_cvt_pk_bf16_f32 v82, v68, v69
v_cvt_pk_bf16_f32 v83, v70, v71
v_mfma_f32_16x16x32_bf16 v[176:179], a[160:163], v[88:91], 0
ds_read_b128 a[140:143], v1 offset:26048
v_mfma_f32_16x16x32_bf16 v[176:179], a[192:195], v[92:95], v[176:179]
v_mfma_f32_16x16x32_bf16 v[180:183], a[196:199], v[92:95], 0
ds_read_b128 a[136:139], v1 offset:25984
v_mfma_f32_16x16x32_bf16 v[180:183], a[164:167], v[88:91], v[180:183]
v_mfma_f32_16x16x32_bf16 v[184:187], a[168:171], v[88:91], 0
ds_read_b128 a[132:135], v1 offset:25920
v_mfma_f32_16x16x32_bf16 v[184:187], a[200:203], v[92:95], v[184:187]
v_mfma_f32_16x16x32_bf16 v[188:191], a[204:207], v[92:95], 0
ds_read_b128 a[128:131], v1 offset:25856
v_mfma_f32_16x16x32_bf16 v[188:191], a[172:175], v[88:91], v[188:191]
v_exp_f32 v72, v72
v_exp_f32 v73, v73
v_exp_f32 v74, v74
v_exp_f32 v75, v75
v_cvt_pk_bf16_f32 v84, v72, v73
v_cvt_pk_bf16_f32 v85, v74, v75
v_mfma_f32_16x16x32_bf16 a[216:219], a[228:231], v[88:91], 0
s_waitcnt lgkmcnt(8)
v_mfma_f32_16x16x32_bf16 a[216:219], a[228:231], v[92:95], a[216:219]
v_mfma_f32_16x16x32_bf16 v[56:59], a[80:83], a[64:67], v[52:55]
v_mfma_f32_16x16x32_bf16 v[56:59], a[84:87], a[68:71], v[56:59]
v_mfma_f32_16x16x32_bf16 v[56:59], a[88:91], a[72:75], v[56:59]
v_mfma_f32_16x16x32_bf16 v[56:59], a[92:95], a[76:79], v[56:59]
v_exp_f32 v76, v76
v_exp_f32 v77, v77
v_exp_f32 v78, v78
v_exp_f32 v79, v79
v_cvt_pk_bf16_f32 v86, v76, v77
v_cvt_pk_bf16_f32 v87, v78, v79
v_mfma_f32_16x16x32_bf16 v[60:63], a[108:111], a[76:79], v[52:55]
v_mfma_f32_16x16x32_bf16 v[60:63], a[104:107], a[72:75], v[60:63]
s_waitcnt vmcnt(4) lgkmcnt(0)
v_mfma_f32_16x16x32_bf16 v[60:63], a[100:103], a[68:71], v[60:63]
v_mfma_f32_16x16x32_bf16 v[60:63], a[96:99], a[64:67], v[60:63]
s_barrier
s_add_u32 s16, s16, 16384
s_addc_u32 s17, s17, 0
v_mfma_f32_16x16x32_bf16 v[192:195], a[144:147], v[80:83], 0
ds_read_b64_tr_b16 a[144:145], v2 offset:16896
v_mfma_f32_16x16x32_bf16 v[192:195], a[176:179], v[84:87], v[192:195]
v_mfma_f32_16x16x32_bf16 v[196:199], a[180:183], v[84:87], 0
ds_read_b64_tr_b16 a[146:147], v2 offset:17408
v_mfma_f32_16x16x32_bf16 v[196:199], a[148:151], v[80:83], v[196:199]
ds_read_b64_tr_b16 a[148:149], v2 offset:16928
v_mfma_f32_16x16x32_bf16 v[200:203], a[152:155], v[80:83], 0
v_mfma_f32_16x16x32_bf16 v[200:203], a[184:187], v[84:87], v[200:203]
ds_read_b64_tr_b16 a[150:151], v2 offset:17440
v_mfma_f32_16x16x32_bf16 v[204:207], a[188:191], v[84:87], 0
ds_read_b64_tr_b16 a[152:153], v2 offset:16960
v_mfma_f32_16x16x32_bf16 v[204:207], a[156:159], v[80:83], v[204:207]
v_mfma_f32_16x16x32_bf16 v[208:211], a[160:163], v[80:83], 0
ds_read_b64_tr_b16 a[154:155], v2 offset:17472
v_mfma_f32_16x16x32_bf16 v[208:211], a[192:195], v[84:87], v[208:211]
ds_read_b64_tr_b16 a[156:157], v2 offset:16992
v_exp_f32 v56, v56
v_exp_f32 v57, v57
v_exp_f32 v58, v58
v_exp_f32 v59, v59
v_cvt_pk_bf16_f32 v88, v56, v57
v_cvt_pk_bf16_f32 v89, v58, v59
v_mfma_f32_16x16x32_bf16 v[212:215], a[196:199], v[84:87], 0
v_mfma_f32_16x16x32_bf16 v[212:215], a[164:167], v[80:83], v[212:215]
ds_read_b64_tr_b16 a[158:159], v2 offset:17504
v_mfma_f32_16x16x32_bf16 v[216:219], a[168:171], v[80:83], 0
ds_read_b64_tr_b16 a[160:161], v2 offset:17024
v_mfma_f32_16x16x32_bf16 v[216:219], a[200:203], v[84:87], v[216:219]
v_mfma_f32_16x16x32_bf16 v[220:223], a[204:207], v[84:87], 0
ds_read_b64_tr_b16 a[162:163], v2 offset:17536
v_mfma_f32_16x16x32_bf16 v[220:223], a[172:175], v[80:83], v[220:223]
ds_read_b64_tr_b16 a[164:165], v2 offset:17056
v_mfma_f32_16x16x32_bf16 a[220:223], a[228:231], v[80:83], 0
v_mfma_f32_16x16x32_bf16 a[220:223], a[228:231], v[84:87], a[220:223]
ds_read_b64_tr_b16 a[166:167], v2 offset:17568
v_mfma_f32_16x16x32_bf16 v[64:67], a[80:83], a[0:3], v[36:39]
ds_read_b64_tr_b16 a[168:169], v2 offset:17088
v_mfma_f32_16x16x32_bf16 v[64:67], a[84:87], a[4:7], v[64:67]
v_mfma_f32_16x16x32_bf16 v[64:67], a[88:91], a[8:11], v[64:67]
ds_read_b64_tr_b16 a[170:171], v2 offset:17600
v_mfma_f32_16x16x32_bf16 v[64:67], a[92:95], a[12:15], v[64:67]
ds_read_b64_tr_b16 a[172:173], v2 offset:17120
v_exp_f32 v60, v60
v_exp_f32 v61, v61
v_exp_f32 v62, v62
v_exp_f32 v63, v63
v_cvt_pk_bf16_f32 v90, v60, v61
v_cvt_pk_bf16_f32 v91, v62, v63
v_mfma_f32_16x16x32_bf16 v[68:71], a[108:111], a[12:15], v[36:39]
v_mfma_f32_16x16x32_bf16 v[68:71], a[104:107], a[8:11], v[68:71]
ds_read_b64_tr_b16 a[174:175], v2 offset:17632
v_mfma_f32_16x16x32_bf16 v[68:71], a[100:103], a[4:7], v[68:71]
ds_read_b64_tr_b16 a[176:177], v2 offset:25344
v_mfma_f32_16x16x32_bf16 v[68:71], a[96:99], a[0:3], v[68:71]
ds_read_b64_tr_b16 a[178:179], v2 offset:25856
v_mfma_f32_16x16x32_bf16 v[72:75], a[112:115], a[0:3], v[36:39]
v_mfma_f32_16x16x32_bf16 v[72:75], a[116:119], a[4:7], v[72:75]
ds_read_b64_tr_b16 a[180:181], v2 offset:25376
v_mfma_f32_16x16x32_bf16 v[72:75], a[120:123], a[8:11], v[72:75]
v_mfma_f32_16x16x32_bf16 v[72:75], a[124:127], a[12:15], v[72:75]
ds_read_b64_tr_b16 a[182:183], v2 offset:25888
v_exp_f32 v64, v64
v_exp_f32 v65, v65
v_exp_f32 v66, v66
v_exp_f32 v67, v67
v_cvt_pk_bf16_f32 v80, v64, v65
v_cvt_pk_bf16_f32 v81, v66, v67
v_mfma_f32_16x16x32_bf16 v[76:79], a[140:143], a[12:15], v[36:39]
v_mfma_f32_16x16x32_bf16 v[76:79], a[136:139], a[8:11], v[76:79]
ds_read_b64_tr_b16 a[184:185], v2 offset:25408
v_mfma_f32_16x16x32_bf16 v[76:79], a[132:135], a[4:7], v[76:79]
s_waitcnt lgkmcnt(13)
v_mfma_f32_16x16x32_bf16 v[76:79], a[128:131], a[0:3], v[76:79]
ds_read_b64_tr_b16 a[186:187], v2 offset:25920
v_mfma_f32_16x16x32_bf16 v[224:227], a[144:147], v[88:91], v[224:227]
v_mfma_f32_16x16x32_bf16 v[228:231], a[148:151], v[88:91], v[228:231]
ds_read_b64_tr_b16 a[188:189], v2 offset:25440
v_mfma_f32_16x16x32_bf16 v[232:235], a[152:155], v[88:91], v[232:235]
s_waitcnt lgkmcnt(7)
v_mfma_f32_16x16x32_bf16 v[236:239], a[156:159], v[88:91], v[236:239]
ds_read_b64_tr_b16 a[190:191], v2 offset:25952
v_mfma_f32_16x16x32_bf16 v[240:243], a[160:163], v[88:91], v[240:243]
v_mfma_f32_16x16x32_bf16 v[244:247], a[164:167], v[88:91], v[244:247]
ds_read_b64_tr_b16 a[192:193], v2 offset:25472
v_mfma_f32_16x16x32_bf16 v[248:251], a[168:171], v[88:91], v[248:251]
v_exp_f32 v68, v68
v_exp_f32 v69, v69
v_exp_f32 v70, v70
v_exp_f32 v71, v71
v_cvt_pk_bf16_f32 v82, v68, v69
v_cvt_pk_bf16_f32 v83, v70, v71
v_mfma_f32_16x16x32_bf16 v[252:255], a[172:175], v[88:91], v[252:255]
ds_read_b64_tr_b16 a[194:195], v2 offset:25984
v_mfma_f32_16x16x32_bf16 a[224:227], a[228:231], v[88:91], a[224:227]
s_add_u32 m0, s33, 33792
v_mfma_f32_16x16x32_bf16 v[56:59], a[80:83], a[16:19], v[40:43]
buffer_load_dwordx4 v3, s[16:19], 0 offen nt lds
v_mfma_f32_16x16x32_bf16 v[56:59], a[84:87], a[20:23], v[56:59]
v_mfma_f32_16x16x32_bf16 v[56:59], a[88:91], a[24:27], v[56:59]
ds_read_b64_tr_b16 a[196:197], v2 offset:25504
v_mfma_f32_16x16x32_bf16 v[56:59], a[92:95], a[28:31], v[56:59]
v_exp_f32 v72, v72
v_exp_f32 v73, v73
v_exp_f32 v74, v74
v_exp_f32 v75, v75
v_cvt_pk_bf16_f32 v84, v72, v73
v_cvt_pk_bf16_f32 v85, v74, v75
v_mfma_f32_16x16x32_bf16 v[60:63], a[108:111], a[28:31], v[40:43]
ds_read_b64_tr_b16 a[198:199], v2 offset:26016
v_mfma_f32_16x16x32_bf16 v[60:63], a[104:107], a[24:27], v[60:63]
v_mfma_f32_16x16x32_bf16 v[60:63], a[100:103], a[20:23], v[60:63]
ds_read_b64_tr_b16 a[200:201], v2 offset:25536
v_mfma_f32_16x16x32_bf16 v[60:63], a[96:99], a[16:19], v[60:63]
s_add_u32 m0, s33, 33824
v_mfma_f32_16x16x32_bf16 v[64:67], a[112:115], a[16:19], v[40:43]
buffer_load_dwordx4 v3, s[16:19], 0 offen offset:1024 nt lds
v_mfma_f32_16x16x32_bf16 v[64:67], a[116:119], a[20:23], v[64:67]
v_mfma_f32_16x16x32_bf16 v[64:67], a[120:123], a[24:27], v[64:67]
ds_read_b64_tr_b16 a[202:203], v2 offset:26048
v_mfma_f32_16x16x32_bf16 v[64:67], a[124:127], a[28:31], v[64:67]
v_exp_f32 v76, v76
v_exp_f32 v77, v77
v_exp_f32 v78, v78
v_exp_f32 v79, v79
v_cvt_pk_bf16_f32 v86, v76, v77
v_cvt_pk_bf16_f32 v87, v78, v79
v_mfma_f32_16x16x32_bf16 v[68:71], a[140:143], a[28:31], v[40:43]
ds_read_b64_tr_b16 a[204:205], v2 offset:25568
v_mfma_f32_16x16x32_bf16 v[68:71], a[136:139], a[24:27], v[68:71]
s_waitcnt lgkmcnt(7)
v_mfma_f32_16x16x32_bf16 v[68:71], a[132:135], a[20:23], v[68:71]
ds_read_b64_tr_b16 a[206:207], v2 offset:26080
v_mfma_f32_16x16x32_bf16 v[68:71], a[128:131], a[16:19], v[68:71]
s_add_u32 m0, s33, 33856
v_mfma_f32_16x16x32_bf16 v[96:99], a[144:147], v[80:83], v[96:99]
buffer_load_dwordx4 v3, s[16:19], 0 offen offset:2048 nt lds
v_mfma_f32_16x16x32_bf16 v[96:99], a[176:179], v[84:87], v[96:99]
v_mfma_f32_16x16x32_bf16 v[100:103], a[180:183], v[84:87], v[100:103]
v_mfma_f32_16x16x32_bf16 v[100:103], a[148:151], v[80:83], v[100:103]
v_mfma_f32_16x16x32_bf16 v[104:107], a[152:155], v[80:83], v[104:107]
buffer_load_dwordx4 v[16:19], v3, s[24:27], s35 offen nt
v_mfma_f32_16x16x32_bf16 v[104:107], a[184:187], v[84:87], v[104:107]
v_exp_f32 v56, v56
v_exp_f32 v57, v57
v_exp_f32 v58, v58
v_exp_f32 v59, v59
v_cvt_pk_bf16_f32 v88, v56, v57
v_cvt_pk_bf16_f32 v89, v58, v59
v_mfma_f32_16x16x32_bf16 v[108:111], a[188:191], v[84:87], v[108:111]
s_waitcnt lgkmcnt(0)
v_mfma_f32_16x16x32_bf16 v[108:111], a[156:159], v[80:83], v[108:111]
s_add_u32 m0, s33, 33888
v_mfma_f32_16x16x32_bf16 v[112:115], a[160:163], v[80:83], v[112:115]
buffer_load_dwordx4 v3, s[16:19], 0 offen offset:3072 nt lds
v_mfma_f32_16x16x32_bf16 v[112:115], a[192:195], v[84:87], v[112:115]
v_mfma_f32_16x16x32_bf16 v[116:119], a[196:199], v[84:87], v[116:119]
s_add_u32 s12, s12, 16384
s_addc_u32 s13, s13, 0
v_mfma_f32_16x16x32_bf16 v[116:119], a[164:167], v[80:83], v[116:119]
v_mfma_f32_16x16x32_bf16 v[120:123], a[168:171], v[80:83], v[120:123]
v_mfma_f32_16x16x32_bf16 v[120:123], a[200:203], v[84:87], v[120:123]
s_add_u32 m0, s33, 16896
v_exp_f32 v60, v60
v_exp_f32 v61, v61
v_exp_f32 v62, v62
v_exp_f32 v63, v63
v_cvt_pk_bf16_f32 v90, v60, v61
v_cvt_pk_bf16_f32 v91, v62, v63
v_mfma_f32_16x16x32_bf16 v[124:127], a[204:207], v[84:87], v[124:127]
v_mfma_f32_16x16x32_bf16 v[124:127], a[172:175], v[80:83], v[124:127]
v_mfma_f32_16x16x32_bf16 a[208:211], a[228:231], v[80:83], a[208:211]
buffer_load_dwordx4 v3, s[12:15], 0 offen nt lds
v_mfma_f32_16x16x32_bf16 a[208:211], a[228:231], v[84:87], a[208:211]
v_mfma_f32_16x16x32_bf16 v[72:75], a[80:83], a[32:35], v[44:47]
v_mfma_f32_16x16x32_bf16 v[72:75], a[84:87], a[36:39], v[72:75]
v_mfma_f32_16x16x32_bf16 v[72:75], a[88:91], a[40:43], v[72:75]
v_mfma_f32_16x16x32_bf16 v[72:75], a[92:95], a[44:47], v[72:75]
s_add_u32 m0, s33, 16928
v_exp_f32 v64, v64
v_exp_f32 v65, v65
v_exp_f32 v66, v66
v_exp_f32 v67, v67
v_cvt_pk_bf16_f32 v92, v64, v65
v_cvt_pk_bf16_f32 v93, v66, v67
v_mfma_f32_16x16x32_bf16 v[76:79], a[108:111], a[44:47], v[44:47]
v_mfma_f32_16x16x32_bf16 v[76:79], a[104:107], a[40:43], v[76:79]
v_mfma_f32_16x16x32_bf16 v[76:79], a[100:103], a[36:39], v[76:79]
buffer_load_dwordx4 v3, s[12:15], 0 offen offset:1024 nt lds
v_mfma_f32_16x16x32_bf16 v[76:79], a[96:99], a[32:35], v[76:79]
v_mfma_f32_16x16x32_bf16 v[56:59], a[112:115], a[32:35], v[44:47]
v_mfma_f32_16x16x32_bf16 v[56:59], a[116:119], a[36:39], v[56:59]
v_mfma_f32_16x16x32_bf16 v[56:59], a[120:123], a[40:43], v[56:59]
v_mfma_f32_16x16x32_bf16 v[56:59], a[124:127], a[44:47], v[56:59]
s_add_u32 m0, s33, 16960
v_exp_f32 v68, v68
v_exp_f32 v69, v69
v_exp_f32 v70, v70
v_exp_f32 v71, v71
v_cvt_pk_bf16_f32 v94, v68, v69
v_cvt_pk_bf16_f32 v95, v70, v71
v_mfma_f32_16x16x32_bf16 v[60:63], a[140:143], a[44:47], v[44:47]
v_mfma_f32_16x16x32_bf16 v[60:63], a[136:139], a[40:43], v[60:63]
v_mfma_f32_16x16x32_bf16 v[60:63], a[132:135], a[36:39], v[60:63]
v_mfma_f32_16x16x32_bf16 v[60:63], a[128:131], a[32:35], v[60:63]
v_mfma_f32_16x16x32_bf16 v[128:131], a[144:147], v[88:91], v[128:131]
v_mfma_f32_16x16x32_bf16 v[128:131], a[176:179], v[92:95], v[128:131]
buffer_load_dwordx4 v3, s[12:15], 0 offen offset:2048 nt lds
v_exp_f32 v72, v72
v_exp_f32 v73, v73
v_exp_f32 v74, v74
v_exp_f32 v75, v75
v_cvt_pk_bf16_f32 v80, v72, v73
v_cvt_pk_bf16_f32 v81, v74, v75
v_mfma_f32_16x16x32_bf16 v[132:135], a[180:183], v[92:95], v[132:135]
v_mfma_f32_16x16x32_bf16 v[132:135], a[148:151], v[88:91], v[132:135]
v_mfma_f32_16x16x32_bf16 v[136:139], a[152:155], v[88:91], v[136:139]
s_add_u32 m0, s33, 16992
v_mfma_f32_16x16x32_bf16 v[136:139], a[184:187], v[92:95], v[136:139]
buffer_load_dwordx4 v3, s[12:15], 0 offen offset:3072 nt lds
v_mfma_f32_16x16x32_bf16 v[140:143], a[188:191], v[92:95], v[140:143]
v_mfma_f32_16x16x32_bf16 v[140:143], a[156:159], v[88:91], v[140:143]
v_mfma_f32_16x16x32_bf16 v[144:147], a[160:163], v[88:91], v[144:147]
v_mfma_f32_16x16x32_bf16 v[144:147], a[192:195], v[92:95], v[144:147]
v_exp_f32 v76, v76
v_exp_f32 v77, v77
v_exp_f32 v78, v78
v_exp_f32 v79, v79
v_cvt_pk_bf16_f32 v82, v76, v77
v_cvt_pk_bf16_f32 v83, v78, v79
v_mfma_f32_16x16x32_bf16 v[148:151], a[196:199], v[92:95], v[148:151]
v_mfma_f32_16x16x32_bf16 v[148:151], a[164:167], v[88:91], v[148:151]
v_mfma_f32_16x16x32_bf16 v[152:155], a[168:171], v[88:91], v[152:155]
v_mfma_f32_16x16x32_bf16 v[152:155], a[200:203], v[92:95], v[152:155]
v_mfma_f32_16x16x32_bf16 v[156:159], a[204:207], v[92:95], v[156:159]
s_waitcnt vmcnt(9) lgkmcnt(0)
v_mfma_f32_16x16x32_bf16 v[156:159], a[172:175], v[88:91], v[156:159]
v_mfma_f32_16x16x32_bf16 a[212:215], a[228:231], v[88:91], a[212:215]
s_barrier
v_mfma_f32_16x16x32_bf16 a[212:215], a[228:231], v[92:95], a[212:215]
v_exp_f32 v56, v56
v_exp_f32 v57, v57
v_exp_f32 v58, v58
v_exp_f32 v59, v59
v_cvt_pk_bf16_f32 v84, v56, v57
v_cvt_pk_bf16_f32 v85, v58, v59
v_mfma_f32_16x16x32_bf16 v[64:67], a[80:83], a[48:51], v[48:51]
v_mfma_f32_16x16x32_bf16 v[64:67], a[84:87], a[52:55], v[64:67]
ds_read_b128 a[80:83], v1
v_mfma_f32_16x16x32_bf16 v[64:67], a[88:91], a[56:59], v[64:67]
v_mfma_f32_16x16x32_bf16 v[64:67], a[92:95], a[60:63], v[64:67]
ds_read_b128 a[84:87], v1 offset:64
ds_read_b128 a[88:91], v1 offset:128
v_mfma_f32_16x16x32_bf16 v[68:71], a[108:111], a[60:63], v[48:51]
v_mfma_f32_16x16x32_bf16 v[68:71], a[104:107], a[56:59], v[68:71]
ds_read_b128 a[92:95], v1 offset:192
v_mfma_f32_16x16x32_bf16 v[68:71], a[100:103], a[52:55], v[68:71]
v_mfma_f32_16x16x32_bf16 v[68:71], a[96:99], a[48:51], v[68:71]
ds_read_b128 a[108:111], v1 offset:704
v_exp_f32 v60, v60
v_exp_f32 v61, v61
v_exp_f32 v62, v62
v_exp_f32 v63, v63
v_cvt_pk_bf16_f32 v86, v60, v61
v_cvt_pk_bf16_f32 v87, v62, v63
v_mfma_f32_16x16x32_bf16 v[72:75], a[112:115], a[48:51], v[48:51]
v_mfma_f32_16x16x32_bf16 v[72:75], a[116:119], a[52:55], v[72:75]
v_mfma_f32_16x16x32_bf16 v[72:75], a[120:123], a[56:59], v[72:75]
ds_read_b128 a[104:107], v1 offset:640
v_mfma_f32_16x16x32_bf16 v[72:75], a[124:127], a[60:63], v[72:75]
v_mfma_f32_16x16x32_bf16 v[76:79], a[140:143], a[60:63], v[48:51]
ds_read_b128 a[100:103], v1 offset:576
v_mfma_f32_16x16x32_bf16 v[76:79], a[136:139], a[56:59], v[76:79]
v_mfma_f32_16x16x32_bf16 v[76:79], a[132:135], a[52:55], v[76:79]
ds_read_b128 a[96:99], v1 offset:512
v_mfma_f32_16x16x32_bf16 v[76:79], a[128:131], a[48:51], v[76:79]
v_exp_f32 v64, v64
v_exp_f32 v65, v65
v_exp_f32 v66, v66
v_exp_f32 v67, v67
v_cvt_pk_bf16_f32 v88, v64, v65
v_cvt_pk_bf16_f32 v89, v66, v67
v_mfma_f32_16x16x32_bf16 v[160:163], a[144:147], v[80:83], v[160:163]
ds_read_b128 a[112:115], v1 offset:8448
v_mfma_f32_16x16x32_bf16 v[160:163], a[176:179], v[84:87], v[160:163]
v_mfma_f32_16x16x32_bf16 v[164:167], a[180:183], v[84:87], v[164:167]
ds_read_b128 a[116:119], v1 offset:8512
v_mfma_f32_16x16x32_bf16 v[164:167], a[148:151], v[80:83], v[164:167]
v_mfma_f32_16x16x32_bf16 v[168:171], a[152:155], v[80:83], v[168:171]
ds_read_b128 a[120:123], v1 offset:8576
v_mfma_f32_16x16x32_bf16 v[168:171], a[184:187], v[84:87], v[168:171]
v_mfma_f32_16x16x32_bf16 v[172:175], a[188:191], v[84:87], v[172:175]
ds_read_b128 a[124:127], v1 offset:8640
v_mfma_f32_16x16x32_bf16 v[172:175], a[156:159], v[80:83], v[172:175]
v_exp_f32 v68, v68
v_exp_f32 v69, v69
v_exp_f32 v70, v70
v_exp_f32 v71, v71
v_cvt_pk_bf16_f32 v90, v68, v69
v_cvt_pk_bf16_f32 v91, v70, v71
v_mfma_f32_16x16x32_bf16 v[176:179], a[160:163], v[80:83], v[176:179]
ds_read_b128 a[140:143], v1 offset:9152
v_mfma_f32_16x16x32_bf16 v[176:179], a[192:195], v[84:87], v[176:179]
v_mfma_f32_16x16x32_bf16 v[180:183], a[196:199], v[84:87], v[180:183]
ds_read_b128 a[136:139], v1 offset:9088
v_mfma_f32_16x16x32_bf16 v[180:183], a[164:167], v[80:83], v[180:183]
v_mfma_f32_16x16x32_bf16 v[184:187], a[168:171], v[80:83], v[184:187]
ds_read_b128 a[132:135], v1 offset:9024
v_mfma_f32_16x16x32_bf16 v[184:187], a[200:203], v[84:87], v[184:187]
s_mov_b32 s34, 6
v_mfma_f32_16x16x32_bf16 v[188:191], a[204:207], v[84:87], v[188:191]
ds_read_b128 a[128:131], v1 offset:8960
v_mfma_f32_16x16x32_bf16 v[188:191], a[172:175], v[80:83], v[188:191]
s_bitcmp0_b32 s44, 0
v_exp_f32 v72, v72
v_exp_f32 v73, v73
v_exp_f32 v74, v74
v_exp_f32 v75, v75
v_cvt_pk_bf16_f32 v92, v72, v73
v_cvt_pk_bf16_f32 v93, v74, v75
v_mfma_f32_16x16x32_bf16 a[216:219], a[228:231], v[80:83], a[216:219]
s_waitcnt lgkmcnt(8)
v_mfma_f32_16x16x32_bf16 a[216:219], a[228:231], v[84:87], a[216:219]
s_cbranch_scc1 L_n010
L_m010:
v_exp_f32 v76, v76
v_mfma_f32_16x16x32_bf16 v[56:59], a[80:83], a[64:67], v[52:55]
buffer_load_dwordx4 v[20:23], v3, s[24:27], s35 offen offset:1024 nt
v_mfma_f32_16x16x32_bf16 v[56:59], a[84:87], a[68:71], v[56:59]
v_exp_f32 v77, v77
v_mfma_f32_16x16x32_bf16 v[56:59], a[88:91], a[72:75], v[56:59]
v_cvt_pk_bf16_f32 v94, v76, v77
v_mfma_f32_16x16x32_bf16 v[56:59], a[92:95], a[76:79], v[56:59]
v_exp_f32 v78, v78
v_mfma_f32_16x16x32_bf16 v[60:63], a[108:111], a[76:79], v[52:55]
v_mfma_f32_16x16x32_bf16 v[60:63], a[104:107], a[72:75], v[60:63]
s_waitcnt vmcnt(5) lgkmcnt(0)
v_exp_f32 v79, v79
v_mfma_f32_16x16x32_bf16 v[60:63], a[100:103], a[68:71], v[60:63]
v_cvt_pk_bf16_f32 v95, v78, v79
v_mfma_f32_16x16x32_bf16 v[60:63], a[96:99], a[64:67], v[60:63]
s_barrier
s_add_u32 s16, s16, 16384
s_addc_u32 s17, s17, 0
v_mfma_f32_16x16x32_bf16 v[192:195], a[144:147], v[88:91], v[192:195]
ds_read_b64_tr_b16 a[144:145], v2
v_mfma_f32_16x16x32_bf16 v[192:195], a[176:179], v[92:95], v[192:195]
v_exp_f32 v56, v56
v_mfma_f32_16x16x32_bf16 v[196:199], a[180:183], v[92:95], v[196:199]
ds_read_b64_tr_b16 a[146:147], v2 offset:512
v_mfma_f32_16x16x32_bf16 v[196:199], a[148:151], v[88:91], v[196:199]
ds_read_b64_tr_b16 a[148:149], v2 offset:32
v_mfma_f32_16x16x32_bf16 v[200:203], a[152:155], v[88:91], v[200:203]
v_exp_f32 v57, v57
v_mfma_f32_16x16x32_bf16 v[200:203], a[184:187], v[92:95], v[200:203]
ds_read_b64_tr_b16 a[150:151], v2 offset:544
v_cvt_pk_bf16_f32 v80, v56, v57
v_mfma_f32_16x16x32_bf16 v[204:207], a[188:191], v[92:95], v[204:207]
ds_read_b64_tr_b16 a[152:153], v2 offset:64
v_mfma_f32_16x16x32_bf16 v[204:207], a[156:159], v[88:91], v[204:207]
v_exp_f32 v58, v58
v_mfma_f32_16x16x32_bf16 v[208:211], a[160:163], v[88:91], v[208:211]
ds_read_b64_tr_b16 a[154:155], v2 offset:576
v_mfma_f32_16x16x32_bf16 v[208:211], a[192:195], v[92:95], v[208:211]
ds_read_b64_tr_b16 a[156:157], v2 offset:96
v_mfma_f32_16x16x32_bf16 v[212:215], a[196:199], v[92:95], v[212:215]
v_exp_f32 v59, v59
v_mfma_f32_16x16x32_bf16 v[212:215], a[164:167], v[88:91], v[212:215]
ds_read_b64_tr_b16 a[158:159], v2 offset:608
v_cvt_pk_bf16_f32 v81, v58, v59
v_mfma_f32_16x16x32_bf16 v[216:219], a[168:171], v[88:91], v[216:219]
ds_read_b64_tr_b16 a[160:161], v2 offset:128
v_mfma_f32_16x16x32_bf16 v[216:219], a[200:203], v[92:95], v[216:219]
v_exp_f32 v60, v60
v_mfma_f32_16x16x32_bf16 v[220:223], a[204:207], v[92:95], v[220:223]
ds_read_b64_tr_b16 a[162:163], v2 offset:640
v_mfma_f32_16x16x32_bf16 v[220:223], a[172:175], v[88:91], v[220:223]
ds_read_b64_tr_b16 a[164:165], v2 offset:160
v_mfma_f32_16x16x32_bf16 a[220:223], a[228:231], v[88:91], a[220:223]
v_exp_f32 v61, v61
v_mfma_f32_16x16x32_bf16 a[220:223], a[228:231], v[92:95], a[220:223]
ds_read_b64_tr_b16 a[166:167], v2 offset:672
v_cvt_pk_bf16_f32 v82, v60, v61
v_mfma_f32_16x16x32_bf16 v[64:67], a[80:83], a[0:3], v[36:39]
s_waitcnt vmcnt(6)
ds_read_b64_tr_b16 a[168:169], v2 offset:192
v_mfma_f32_16x16x32_bf16 v[64:67], a[84:87], a[4:7], v[64:67]
v_exp_f32 v62, v62
v_mfma_f32_16x16x32_bf16 v[64:67], a[88:91], a[8:11], v[64:67]
ds_read_b64_tr_b16 a[170:171], v2 offset:704
v_lshlrev_b32 v32, 16, v16
v_mfma_f32_16x16x32_bf16 v[64:67], a[92:95], a[12:15], v[64:67]
ds_read_b64_tr_b16 a[172:173], v2 offset:224
v_and_b32 v33, s45, v16
v_mfma_f32_16x16x32_bf16 v[68:71], a[108:111], a[12:15], v[36:39]
v_exp_f32 v63, v63
v_mfma_f32_16x16x32_bf16 v[68:71], a[104:107], a[8:11], v[68:71]
ds_read_b64_tr_b16 a[174:175], v2 offset:736
v_cvt_pk_bf16_f32 v83, v62, v63
v_mfma_f32_16x16x32_bf16 v[68:71], a[100:103], a[4:7], v[68:71]
ds_read_b64_tr_b16 a[176:177], v2 offset:8448
v_mul_f32 v32, s38, v32
v_mfma_f32_16x16x32_bf16 v[68:71], a[96:99], a[0:3], v[68:71]
ds_read_b64_tr_b16 a[178:179], v2 offset:8960
v_mul_f32 v33, s38, v33
v_mfma_f32_16x16x32_bf16 v[72:75], a[112:115], a[0:3], v[36:39]
v_exp_f32 v64, v64
v_mfma_f32_16x16x32_bf16 v[72:75], a[116:119], a[4:7], v[72:75]
ds_read_b64_tr_b16 a[180:181], v2 offset:8480
v_cvt_pk_bf16_f32 v16, v32, v33
v_mfma_f32_16x16x32_bf16 v[72:75], a[120:123], a[8:11], v[72:75]
v_exp_f32 v65, v65
v_mfma_f32_16x16x32_bf16 v[72:75], a[124:127], a[12:15], v[72:75]
ds_read_b64_tr_b16 a[182:183], v2 offset:8992
v_cvt_pk_bf16_f32 v88, v64, v65
v_mfma_f32_16x16x32_bf16 v[76:79], a[140:143], a[12:15], v[36:39]
v_exp_f32 v66, v66
v_mfma_f32_16x16x32_bf16 v[76:79], a[136:139], a[8:11], v[76:79]
ds_read_b64_tr_b16 a[184:185], v2 offset:8512
v_lshlrev_b32 v34, 16, v17
v_mfma_f32_16x16x32_bf16 v[76:79], a[132:135], a[4:7], v[76:79]
s_waitcnt lgkmcnt(13)
v_exp_f32 v67, v67
v_mfma_f32_16x16x32_bf16 v[76:79], a[128:131], a[0:3], v[76:79]
ds_read_b64_tr_b16 a[186:187], v2 offset:9024
v_cvt_pk_bf16_f32 v89, v66, v67
v_mfma_f32_16x16x32_bf16 v[224:227], a[144:147], v[80:83], v[224:227]
v_exp_f32 v68, v68
v_mfma_f32_16x16x32_bf16 v[228:231], a[148:151], v[80:83], v[228:231]
ds_read_b64_tr_b16 a[188:189], v2 offset:8544
v_and_b32 v35, s45, v17
v_mfma_f32_16x16x32_bf16 v[232:235], a[152:155], v[80:83], v[232:235]
s_waitcnt lgkmcnt(7)
v_exp_f32 v69, v69
v_mfma_f32_16x16x32_bf16 v[236:239], a[156:159], v[80:83], v[236:239]
ds_read_b64_tr_b16 a[190:191], v2 offset:9056
v_cvt_pk_bf16_f32 v90, v68, v69
v_mfma_f32_16x16x32_bf16 v[240:243], a[160:163], v[80:83], v[240:243]
v_exp_f32 v70, v70
v_mfma_f32_16x16x32_bf16 v[244:247], a[164:167], v[80:83], v[244:247]
ds_read_b64_tr_b16 a[192:193], v2 offset:8576
v_mul_f32 v34, s38, v34
v_mfma_f32_16x16x32_bf16 v[248:251], a[168:171], v[80:83], v[248:251]
v_exp_f32 v71, v71
v_mfma_f32_16x16x32_bf16 v[252:255], a[172:175], v[80:83], v[252:255]
ds_read_b64_tr_b16 a[194:195], v2 offset:9088
v_cvt_pk_bf16_f32 v91, v70, v71
v_mfma_f32_16x16x32_bf16 a[224:227], a[228:231], v[80:83], a[224:227]
s_add_u32 m0, s33, 50688
v_mfma_f32_16x16x32_bf16 v[56:59], a[80:83], a[16:19], v[40:43]
buffer_load_dwordx4 v3, s[16:19], 0 offen nt lds
v_mfma_f32_16x16x32_bf16 v[56:59], a[84:87], a[20:23], v[56:59]
v_mfma_f32_16x16x32_bf16 v[56:59], a[88:91], a[24:27], v[56:59]
ds_read_b64_tr_b16 a[196:197], v2 offset:8608
v_mfma_f32_16x16x32_bf16 v[56:59], a[92:95], a[28:31], v[56:59]
v_exp_f32 v72, v72
v_exp_f32 v73, v73
v_exp_f32 v74, v74
v_exp_f32 v75, v75
v_cvt_pk_bf16_f32 v92, v72, v73
v_cvt_pk_bf16_f32 v93, v74, v75
v_mfma_f32_16x16x32_bf16 v[60:63], a[108:111], a[28:31], v[40:43]
ds_read_b64_tr_b16 a[198:199], v2 offset:9120
v_mul_f32 v35, s38, v35
v_mfma_f32_16x16x32_bf16 v[60:63], a[104:107], a[24:27], v[60:63]
v_mfma_f32_16x16x32_bf16 v[60:63], a[100:103], a[20:23], v[60:63]
ds_read_b64_tr_b16 a[200:201], v2 offset:8640
v_mfma_f32_16x16x32_bf16 v[60:63], a[96:99], a[16:19], v[60:63]
s_add_u32 m0, s33, 50720
v_exp_f32 v76, v76
v_mfma_f32_16x16x32_bf16 v[64:67], a[112:115], a[16:19], v[40:43]
buffer_load_dwordx4 v3, s[16:19], 0 offen offset:1024 nt lds
v_mfma_f32_16x16x32_bf16 v[64:67], a[116:119], a[20:23], v[64:67]
v_exp_f32 v77, v77
v_mfma_f32_16x16x32_bf16 v[64:67], a[120:123], a[24:27], v[64:67]
ds_read_b64_tr_b16 a[202:203], v2 offset:9152
v_cvt_pk_bf16_f32 v94, v76, v77
v_mfma_f32_16x16x32_bf16 v[64:67], a[124:127], a[28:31], v[64:67]
v_exp_f32 v78, v78
v_mfma_f32_16x16x32_bf16 v[68:71], a[140:143], a[28:31], v[40:43]
ds_read_b64_tr_b16 a[204:205], v2 offset:8672
v_cvt_pk_bf16_f32 v17, v34, v35
v_mfma_f32_16x16x32_bf16 v[68:71], a[136:139], a[24:27], v[68:71]
s_waitcnt lgkmcnt(7)
v_exp_f32 v79, v79
v_mfma_f32_16x16x32_bf16 v[68:71], a[132:135], a[20:23], v[68:71]
ds_read_b64_tr_b16 a[206:207], v2 offset:9184
v_cvt_pk_bf16_f32 v95, v78, v79
v_mfma_f32_16x16x32_bf16 v[68:71], a[128:131], a[16:19], v[68:71]
s_add_u32 m0, s33, 50752
v_exp_f32 v56, v56
v_mfma_f32_16x16x32_bf16 v[96:99], a[144:147], v[88:91], v[96:99]
buffer_load_dwordx4 v3, s[16:19], 0 offen offset:2048 nt lds
v_mfma_f32_16x16x32_bf16 v[96:99], a[176:179], v[92:95], v[96:99]
v_exp_f32 v57, v57
v_mfma_f32_16x16x32_bf16 v[100:103], a[180:183], v[92:95], v[100:103]
v_cvt_pk_bf16_f32 v80, v56, v57
v_lshlrev_b32 v32, 16, v18
v_mfma_f32_16x16x32_bf16 v[100:103], a[148:151], v[88:91], v[100:103]
v_exp_f32 v58, v58
v_mfma_f32_16x16x32_bf16 v[104:107], a[152:155], v[88:91], v[104:107]
buffer_load_dwordx4 v[24:27], v3, s[24:27], s35 offen offset:2048 nt
v_mfma_f32_16x16x32_bf16 v[104:107], a[184:187], v[92:95], v[104:107]
v_exp_f32 v59, v59
v_mfma_f32_16x16x32_bf16 v[108:111], a[188:191], v[92:95], v[108:111]
s_waitcnt lgkmcnt(0)
v_cvt_pk_bf16_f32 v81, v58, v59
v_and_b32 v33, s45, v18
v_mfma_f32_16x16x32_bf16 v[108:111], a[156:159], v[88:91], v[108:111]
s_add_u32 m0, s33, 50784
v_exp_f32 v60, v60
v_mfma_f32_16x16x32_bf16 v[112:115], a[160:163], v[88:91], v[112:115]
buffer_load_dwordx4 v3, s[16:19], 0 offen offset:3072 nt lds
v_mfma_f32_16x16x32_bf16 v[112:115], a[192:195], v[92:95], v[112:115]
v_exp_f32 v61, v61
v_mfma_f32_16x16x32_bf16 v[116:119], a[196:199], v[92:95], v[116:119]
s_add_u32 s12, s12, 16384
s_addc_u32 s13, s13, 0
v_cvt_pk_bf16_f32 v82, v60, v61
v_mfma_f32_16x16x32_bf16 v[116:119], a[164:167], v[88:91], v[116:119]
v_exp_f32 v62, v62
v_mfma_f32_16x16x32_bf16 v[120:123], a[168:171], v[88:91], v[120:123]
v_mul_f32 v32, s38, v32
v_mul_f32 v33, s38, v33
v_mfma_f32_16x16x32_bf16 v[120:123], a[200:203], v[92:95], v[120:123]
s_add_u32 m0, s33, 0
v_exp_f32 v63, v63
v_mfma_f32_16x16x32_bf16 v[124:127], a[204:207], v[92:95], v[124:127]
v_cvt_pk_bf16_f32 v83, v62, v63
v_cvt_pk_bf16_f32 v18, v32, v33
v_mfma_f32_16x16x32_bf16 v[124:127], a[172:175], v[88:91], v[124:127]
v_mfma_f32_16x16x32_bf16 a[208:211], a[228:231], v[88:91], a[208:211]
buffer_load_dwordx4 v3, s[12:15], 0 offen nt lds
v_mfma_f32_16x16x32_bf16 a[208:211], a[228:231], v[92:95], a[208:211]
v_mfma_f32_16x16x32_bf16 v[72:75], a[80:83], a[32:35], v[44:47]
v_lshlrev_b32 v34, 16, v19
v_mfma_f32_16x16x32_bf16 v[72:75], a[84:87], a[36:39], v[72:75]
v_mfma_f32_16x16x32_bf16 v[72:75], a[88:91], a[40:43], v[72:75]
v_and_b32 v35, s45, v19
v_mul_f32 v34, s38, v34
v_mfma_f32_16x16x32_bf16 v[72:75], a[92:95], a[44:47], v[72:75]
s_add_u32 m0, s33, 32
v_exp_f32 v64, v64
v_exp_f32 v65, v65
v_exp_f32 v66, v66
v_exp_f32 v67, v67
v_cvt_pk_bf16_f32 v84, v64, v65
v_cvt_pk_bf16_f32 v85, v66, v67
v_mfma_f32_16x16x32_bf16 v[76:79], a[108:111], a[44:47], v[44:47]
v_mul_f32 v35, s38, v35
v_mfma_f32_16x16x32_bf16 v[76:79], a[104:107], a[40:43], v[76:79]
v_exp_f32 v68, v68
v_mfma_f32_16x16x32_bf16 v[76:79], a[100:103], a[36:39], v[76:79]
buffer_load_dwordx4 v3, s[12:15], 0 offen offset:1024 nt lds
v_mfma_f32_16x16x32_bf16 v[76:79], a[96:99], a[32:35], v[76:79]
v_exp_f32 v69, v69
v_mfma_f32_16x16x32_bf16 v[56:59], a[112:115], a[32:35], v[44:47]
v_cvt_pk_bf16_f32 v86, v68, v69
v_cvt_pk_bf16_f32 v19, v34, v35
v_mfma_f32_16x16x32_bf16 v[56:59], a[116:119], a[36:39], v[56:59]
v_exp_f32 v70, v70
v_mfma_f32_16x16x32_bf16 v[56:59], a[120:123], a[40:43], v[56:59]
v_mfma_f32_16x16x32_bf16 v[56:59], a[124:127], a[44:47], v[56:59]
s_add_u32 m0, s33, 64
v_exp_f32 v71, v71
v_mfma_f32_16x16x32_bf16 v[60:63], a[140:143], a[44:47], v[44:47]
v_exp_f32 v72, v72
v_mfma_f32_16x16x32_bf16 v[60:63], a[136:139], a[40:43], v[60:63]
v_cvt_pk_bf16_f32 v87, v70, v71
v_mfma_f32_16x16x32_bf16 v[60:63], a[132:135], a[36:39], v[60:63]
v_exp_f32 v73, v73
v_mfma_f32_16x16x32_bf16 v[60:63], a[128:131], a[32:35], v[60:63]
v_cvt_pk_bf16_f32 v88, v72, v73
v_mfma_f32_16x16x32_bf16 v[128:131], a[144:147], v[80:83], v[128:131]
v_exp_f32 v74, v74
v_mfma_f32_16x16x32_bf16 v[128:131], a[176:179], v[84:87], v[128:131]
buffer_load_dwordx4 v3, s[12:15], 0 offen offset:2048 nt lds
v_mfma_f32_16x16x32_bf16 v[132:135], a[180:183], v[84:87], v[132:135]
v_exp_f32 v75, v75
v_mfma_f32_16x16x32_bf16 v[132:135], a[148:151], v[80:83], v[132:135]
v_cvt_pk_bf16_f32 v89, v74, v75
v_mfma_f32_16x16x32_bf16 v[136:139], a[152:155], v[80:83], v[136:139]
s_add_u32 m0, s33, 96
v_exp_f32 v76, v76
v_mfma_f32_16x16x32_bf16 v[136:139], a[184:187], v[84:87], v[136:139]
buffer_load_dwordx4 v3, s[12:15], 0 offen offset:3072 nt lds
v_mfma_f32_16x16x32_bf16 v[140:143], a[188:191], v[84:87], v[140:143]
v_exp_f32 v77, v77
v_mfma_f32_16x16x32_bf16 v[140:143], a[156:159], v[80:83], v[140:143]
v_cvt_pk_bf16_f32 v90, v76, v77
v_mfma_f32_16x16x32_bf16 v[144:147], a[160:163], v[80:83], v[144:147]
v_exp_f32 v78, v78
v_mfma_f32_16x16x32_bf16 v[144:147], a[192:195], v[84:87], v[144:147]
ds_write_b128 v4, v[16:19]
v_mfma_f32_16x16x32_bf16 v[148:151], a[196:199], v[84:87], v[148:151]
v_exp_f32 v79, v79
v_mfma_f32_16x16x32_bf16 v[148:151], a[164:167], v[80:83], v[148:151]
v_cvt_pk_bf16_f32 v91, v78, v79
v_mfma_f32_16x16x32_bf16 v[152:155], a[168:171], v[80:83], v[152:155]
v_exp_f32 v56, v56
v_mfma_f32_16x16x32_bf16 v[152:155], a[200:203], v[84:87], v[152:155]
v_mfma_f32_16x16x32_bf16 v[156:159], a[204:207], v[84:87], v[156:159]
s_waitcnt vmcnt(10) lgkmcnt(1)
v_exp_f32 v57, v57
v_mfma_f32_16x16x32_bf16 v[156:159], a[172:175], v[80:83], v[156:159]
v_cvt_pk_bf16_f32 v92, v56, v57
v_mfma_f32_16x16x32_bf16 a[212:215], a[228:231], v[80:83], a[212:215]
s_barrier
v_exp_f32 v58, v58
v_mfma_f32_16x16x32_bf16 a[212:215], a[228:231], v[84:87], a[212:215]
v_mfma_f32_16x16x32_bf16 v[64:67], a[80:83], a[48:51], v[48:51]
v_exp_f32 v59, v59
v_mfma_f32_16x16x32_bf16 v[64:67], a[84:87], a[52:55], v[64:67]
ds_read_b128 a[80:83], v1 offset:16896
v_cvt_pk_bf16_f32 v93, v58, v59
v_mfma_f32_16x16x32_bf16 v[64:67], a[88:91], a[56:59], v[64:67]
v_mfma_f32_16x16x32_bf16 v[64:67], a[92:95], a[60:63], v[64:67]
ds_read_b128 a[84:87], v1 offset:16960
ds_read_b128 a[88:91], v1 offset:17024
v_mfma_f32_16x16x32_bf16 v[68:71], a[108:111], a[60:63], v[48:51]
v_mfma_f32_16x16x32_bf16 v[68:71], a[104:107], a[56:59], v[68:71]
ds_read_b128 a[92:95], v1 offset:17088
v_mfma_f32_16x16x32_bf16 v[68:71], a[100:103], a[52:55], v[68:71]
v_mfma_f32_16x16x32_bf16 v[68:71], a[96:99], a[48:51], v[68:71]
ds_read_b128 a[108:111], v1 offset:17600
v_exp_f32 v60, v60
v_exp_f32 v61, v61
v_exp_f32 v62, v62
v_exp_f32 v63, v63
v_cvt_pk_bf16_f32 v94, v60, v61
v_cvt_pk_bf16_f32 v95, v62, v63
v_mfma_f32_16x16x32_bf16 v[72:75], a[112:115], a[48:51], v[48:51]
v_mfma_f32_16x16x32_bf16 v[72:75], a[116:119], a[52:55], v[72:75]
v_exp_f32 v64, v64
v_mfma_f32_16x16x32_bf16 v[72:75], a[120:123], a[56:59], v[72:75]
ds_read_b128 a[104:107], v1 offset:17536
v_mfma_f32_16x16x32_bf16 v[72:75], a[124:127], a[60:63], v[72:75]
v_exp_f32 v65, v65
v_mfma_f32_16x16x32_bf16 v[76:79], a[140:143], a[60:63], v[48:51]
ds_read_b128 a[100:103], v1 offset:17472
v_cvt_pk_bf16_f32 v80, v64, v65
v_mfma_f32_16x16x32_bf16 v[76:79], a[136:139], a[56:59], v[76:79]
v_exp_f32 v66, v66
v_mfma_f32_16x16x32_bf16 v[76:79], a[132:135], a[52:55], v[76:79]
ds_read_b128 a[96:99], v1 offset:17408
v_mfma_f32_16x16x32_bf16 v[76:79], a[128:131], a[48:51], v[76:79]
v_exp_f32 v67, v67
v_mfma_f32_16x16x32_bf16 v[160:163], a[144:147], v[88:91], v[160:163]
ds_read_b128 a[112:115], v1 offset:25344
v_cvt_pk_bf16_f32 v81, v66, v67
v_mfma_f32_16x16x32_bf16 v[160:163], a[176:179], v[92:95], v[160:163]
v_exp_f32 v68, v68
v_mfma_f32_16x16x32_bf16 v[164:167], a[180:183], v[92:95], v[164:167]
ds_read_b128 a[116:119], v1 offset:25408
v_mfma_f32_16x16x32_bf16 v[164:167], a[148:151], v[88:91], v[164:167]
v_exp_f32 v69, v69
v_mfma_f32_16x16x32_bf16 v[168:171], a[152:155], v[88:91], v[168:171]
ds_read_b128 a[120:123], v1 offset:25472
v_cvt_pk_bf16_f32 v82, v68, v69
v_mfma_f32_16x16x32_bf16 v[168:171], a[184:187], v[92:95], v[168:171]
v_exp_f32 v70, v70
v_mfma_f32_16x16x32_bf16 v[172:175], a[188:191], v[92:95], v[172:175]
ds_read_b128 a[124:127], v1 offset:25536
v_mfma_f32_16x16x32_bf16 v[172:175], a[156:159], v[88:91], v[172:175]
v_exp_f32 v71, v71
v_mfma_f32_16x16x32_bf16 v[176:179], a[160:163], v[88:91], v[176:179]
ds_read_b128 a[140:143], v1 offset:26048
v_cvt_pk_bf16_f32 v83, v70, v71
v_mfma_f32_16x16x32_bf16 v[176:179], a[192:195], v[92:95], v[176:179]
v_exp_f32 v72, v72
v_mfma_f32_16x16x32_bf16 v[180:183], a[196:199], v[92:95], v[180:183]
ds_read_b128 a[136:139], v1 offset:25984
v_mfma_f32_16x16x32_bf16 v[180:183], a[164:167], v[88:91], v[180:183]
v_exp_f32 v73, v73
v_mfma_f32_16x16x32_bf16 v[184:187], a[168:171], v[88:91], v[184:187]
ds_read_b128 a[132:135], v1 offset:25920
v_cvt_pk_bf16_f32 v84, v72, v73
v_mfma_f32_16x16x32_bf16 v[184:187], a[200:203], v[92:95], v[184:187]
v_exp_f32 v74, v74
v_mfma_f32_16x16x32_bf16 v[188:191], a[204:207], v[92:95], v[188:191]
ds_read_b128 a[128:131], v1 offset:25856
v_mfma_f32_16x16x32_bf16 v[188:191], a[172:175], v[88:91], v[188:191]
v_exp_f32 v75, v75
v_mfma_f32_16x16x32_bf16 a[216:219], a[228:231], v[88:91], a[216:219]
s_waitcnt lgkmcnt(8)
v_cvt_pk_bf16_f32 v85, v74, v75
v_mfma_f32_16x16x32_bf16 a[216:219], a[228:231], v[92:95], a[216:219]
v_mfma_f32_16x16x32_bf16 v[56:59], a[80:83], a[64:67], v[52:55]
buffer_load_dwordx4 v[16:19], v3, s[24:27], s35 offen offset:3072 nt
v_mfma_f32_16x16x32_bf16 v[56:59], a[84:87], a[68:71], v[56:59]
s_add_u32 s35, s35, 3072
v_mfma_f32_16x16x32_bf16 v[56:59], a[88:91], a[72:75], v[56:59]
v_mfma_f32_16x16x32_bf16 v[56:59], a[92:95], a[76:79], v[56:59]
v_exp_f32 v76, v76
v_exp_f32 v77, v77
v_exp_f32 v78, v78
v_exp_f32 v79, v79
v_cvt_pk_bf16_f32 v86, v76, v77
v_cvt_pk_bf16_f32 v87, v78, v79
v_mfma_f32_16x16x32_bf16 v[60:63], a[108:111], a[76:79], v[52:55]
v_mfma_f32_16x16x32_bf16 v[60:63], a[104:107], a[72:75], v[60:63]
s_waitcnt vmcnt(5) lgkmcnt(0)
v_mfma_f32_16x16x32_bf16 v[60:63], a[100:103], a[68:71], v[60:63]
s_waitcnt vmcnt(10)
v_lshlrev_b32 v32, 16, v20
v_mfma_f32_16x16x32_bf16 v[60:63], a[96:99], a[64:67], v[60:63]
s_barrier
s_add_u32 s16, s16, 16384
s_addc_u32 s17, s17, 0
v_mfma_f32_16x16x32_bf16 v[192:195], a[144:147], v[80:83], v[192:195]
ds_read_b64_tr_b16 a[144:145], v2 offset:16896
v_and_b32 v33, s45, v20
v_mfma_f32_16x16x32_bf16 v[192:195], a[176:179], v[84:87], v[192:195]
v_exp_f32 v56, v56
v_mfma_f32_16x16x32_bf16 v[196:199], a[180:183], v[84:87], v[196:199]
ds_read_b64_tr_b16 a[146:147], v2 offset:17408
v_mul_f32 v32, s38, v32
v_mfma_f32_16x16x32_bf16 v[196:199], a[148:151], v[80:83], v[196:199]
ds_read_b64_tr_b16 a[148:149], v2 offset:16928
v_mul_f32 v33, s38, v33
v_mfma_f32_16x16x32_bf16 v[200:203], a[152:155], v[80:83], v[200:203]
v_exp_f32 v57, v57
v_mfma_f32_16x16x32_bf16 v[200:203], a[184:187], v[84:87], v[200:203]
ds_read_b64_tr_b16 a[150:151], v2 offset:17440
v_cvt_pk_bf16_f32 v88, v56, v57
v_mfma_f32_16x16x32_bf16 v[204:207], a[188:191], v[84:87], v[204:207]
ds_read_b64_tr_b16 a[152:153], v2 offset:16960
v_cvt_pk_bf16_f32 v20, v32, v33
v_mfma_f32_16x16x32_bf16 v[204:207], a[156:159], v[80:83], v[204:207]
v_exp_f32 v58, v58
v_mfma_f32_16x16x32_bf16 v[208:211], a[160:163], v[80:83], v[208:211]
ds_read_b64_tr_b16 a[154:155], v2 offset:17472
v_lshlrev_b32 v34, 16, v21
v_mfma_f32_16x16x32_bf16 v[208:211], a[192:195], v[84:87], v[208:211]
ds_read_b64_tr_b16 a[156:157], v2 offset:16992
v_and_b32 v35, s45, v21
v_mfma_f32_16x16x32_bf16 v[212:215], a[196:199], v[84:87], v[212:215]
v_exp_f32 v59, v59
v_mfma_f32_16x16x32_bf16 v[212:215], a[164:167], v[80:83], v[212:215]
ds_read_b64_tr_b16 a[158:159], v2 offset:17504
v_cvt_pk_bf16_f32 v89, v58, v59
v_mfma_f32_16x16x32_bf16 v[216:219], a[168:171], v[80:83], v[216:219]
ds_read_b64_tr_b16 a[160:161], v2 offset:17024
v_mul_f32 v34, s38, v34
v_mfma_f32_16x16x32_bf16 v[216:219], a[200:203], v[84:87], v[216:219]
v_exp_f32 v60, v60
v_mfma_f32_16x16x32_bf16 v[220:223], a[204:207], v[84:87], v[220:223]
ds_read_b64_tr_b16 a[162:163], v2 offset:17536
v_mul_f32 v35, s38, v35
v_mfma_f32_16x16x32_bf16 v[220:223], a[172:175], v[80:83], v[220:223]
ds_read_b64_tr_b16 a[164:165], v2 offset:17056
v_cvt_pk_bf16_f32 v21, v34, v35
v_mfma_f32_16x16x32_bf16 a[220:223], a[228:231], v[80:83], a[220:223]
v_exp_f32 v61, v61
v_mfma_f32_16x16x32_bf16 a[220:223], a[228:231], v[84:87], a[220:223]
ds_read_b64_tr_b16 a[166:167], v2 offset:17568
v_cvt_pk_bf16_f32 v90, v60, v61
v_mfma_f32_16x16x32_bf16 v[64:67], a[80:83], a[0:3], v[36:39]
ds_read_b64_tr_b16 a[168:169], v2 offset:17088
v_lshlrev_b32 v32, 16, v22
v_mfma_f32_16x16x32_bf16 v[64:67], a[84:87], a[4:7], v[64:67]
v_exp_f32 v62, v62
v_mfma_f32_16x16x32_bf16 v[64:67], a[88:91], a[8:11], v[64:67]
ds_read_b64_tr_b16 a[170:171], v2 offset:17600
v_and_b32 v33, s45, v22
v_mfma_f32_16x16x32_bf16 v[64:67], a[92:95], a[12:15], v[64:67]
ds_read_b64_tr_b16 a[172:173], v2 offset:17120
v_mul_f32 v32, s38, v32
v_mfma_f32_16x16x32_bf16 v[68:71], a[108:111], a[12:15], v[36:39]
v_exp_f32 v63, v63
v_mfma_f32_16x16x32_bf16 v[68:71], a[104:107], a[8:11], v[68:71]
ds_read_b64_tr_b16 a[174:175], v2 offset:17632
v_cvt_pk_bf16_f32 v91, v62, v63
v_mfma_f32_16x16x32_bf16 v[68:71], a[100:103], a[4:7], v[68:71]
ds_read_b64_tr_b16 a[176:177], v2 offset:25344
v_mul_f32 v33, s38, v33
v_mfma_f32_16x16x32_bf16 v[68:71], a[96:99], a[0:3], v[68:71]
ds_read_b64_tr_b16 a[178:179], v2 offset:25856
v_cvt_pk_bf16_f32 v22, v32, v33
v_mfma_f32_16x16x32_bf16 v[72:75], a[112:115], a[0:3], v[36:39]
v_exp_f32 v64, v64
v_mfma_f32_16x16x32_bf16 v[72:75], a[116:119], a[4:7], v[72:75]
ds_read_b64_tr_b16 a[180:181], v2 offset:25376
v_lshlrev_b32 v34, 16, v23
v_mfma_f32_16x16x32_bf16 v[72:75], a[120:123], a[8:11], v[72:75]
v_exp_f32 v65, v65
v_mfma_f32_16x16x32_bf16 v[72:75], a[124:127], a[12:15], v[72:75]
ds_read_b64_tr_b16 a[182:183], v2 offset:25888
v_cvt_pk_bf16_f32 v80, v64, v65
v_mfma_f32_16x16x32_bf16 v[76:79], a[140:143], a[12:15], v[36:39]
v_exp_f32 v66, v66
v_mfma_f32_16x16x32_bf16 v[76:79], a[136:139], a[8:11], v[76:79]
ds_read_b64_tr_b16 a[184:185], v2 offset:25408
v_and_b32 v35, s45, v23
v_mfma_f32_16x16x32_bf16 v[76:79], a[132:135], a[4:7], v[76:79]
s_waitcnt lgkmcnt(13)
v_exp_f32 v67, v67
v_mfma_f32_16x16x32_bf16 v[76:79], a[128:131], a[0:3], v[76:79]
ds_read_b64_tr_b16 a[186:187], v2 offset:25920
v_cvt_pk_bf16_f32 v81, v66, v67
v_mfma_f32_16x16x32_bf16 v[224:227], a[144:147], v[88:91], v[224:227]
v_exp_f32 v68, v68
v_mfma_f32_16x16x32_bf16 v[228:231], a[148:151], v[88:91], v[228:231]
ds_read_b64_tr_b16 a[188:189], v2 offset:25440
v_mul_f32 v34, s38, v34
v_mfma_f32_16x16x32_bf16 v[232:235], a[152:155], v[88:91], v[232:235]
s_waitcnt lgkmcnt(7)
v_exp_f32 v69, v69
v_mfma_f32_16x16x32_bf16 v[236:239], a[156:159], v[88:91], v[236:239]
ds_read_b64_tr_b16 a[190:191], v2 offset:25952
v_cvt_pk_bf16_f32 v82, v68, v69
v_mfma_f32_16x16x32_bf16 v[240:243], a[160:163], v[88:91], v[240:243]
v_exp_f32 v70, v70
v_mfma_f32_16x16x32_bf16 v[244:247], a[164:167], v[88:91], v[244:247]
ds_read_b64_tr_b16 a[192:193], v2 offset:25472
v_mul_f32 v35, s38, v35
v_mfma_f32_16x16x32_bf16 v[248:251], a[168:171], v[88:91], v[248:251]
v_exp_f32 v71, v71
v_mfma_f32_16x16x32_bf16 v[252:255], a[172:175], v[88:91], v[252:255]
ds_read_b64_tr_b16 a[194:195], v2 offset:25984
v_cvt_pk_bf16_f32 v83, v70, v71
v_mfma_f32_16x16x32_bf16 a[224:227], a[228:231], v[88:91], a[224:227]
s_add_u32 m0, s33, 33792
v_mfma_f32_16x16x32_bf16 v[56:59], a[80:83], a[16:19], v[40:43]
buffer_load_dwordx4 v3, s[16:19], 0 offen nt lds
v_mfma_f32_16x16x32_bf16 v[56:59], a[84:87], a[20:23], v[56:59]
v_mfma_f32_16x16x32_bf16 v[56:59], a[88:91], a[24:27], v[56:59]
ds_read_b64_tr_b16 a[196:197], v2 offset:25504
v_mfma_f32_16x16x32_bf16 v[56:59], a[92:95], a[28:31], v[56:59]
v_exp_f32 v72, v72
v_exp_f32 v73, v73
v_exp_f32 v74, v74
v_exp_f32 v75, v75
v_cvt_pk_bf16_f32 v84, v72, v73
v_cvt_pk_bf16_f32 v85, v74, v75
v_mfma_f32_16x16x32_bf16 v[60:63], a[108:111], a[28:31], v[40:43]
ds_read_b64_tr_b16 a[198:199], v2 offset:26016
v_cvt_pk_bf16_f32 v23, v34, v35
v_mfma_f32_16x16x32_bf16 v[60:63], a[104:107], a[24:27], v[60:63]
v_mfma_f32_16x16x32_bf16 v[60:63], a[100:103], a[20:23], v[60:63]
ds_read_b64_tr_b16 a[200:201], v2 offset:25536
v_mfma_f32_16x16x32_bf16 v[60:63], a[96:99], a[16:19], v[60:63]
s_add_u32 m0, s33, 33824
v_exp_f32 v76, v76
v_mfma_f32_16x16x32_bf16 v[64:67], a[112:115], a[16:19], v[40:43]
buffer_load_dwordx4 v3, s[16:19], 0 offen offset:1024 nt lds
v_mfma_f32_16x16x32_bf16 v[64:67], a[116:119], a[20:23], v[64:67]
v_exp_f32 v77, v77
v_mfma_f32_16x16x32_bf16 v[64:67], a[120:123], a[24:27], v[64:67]
ds_read_b64_tr_b16 a[202:203], v2 offset:26048
v_cvt_pk_bf16_f32 v86, v76, v77
v_mfma_f32_16x16x32_bf16 v[64:67], a[124:127], a[28:31], v[64:67]
s_waitcnt vmcnt(8)
v_exp_f32 v78, v78
v_mfma_f32_16x16x32_bf16 v[68:71], a[140:143], a[28:31], v[40:43]
ds_read_b64_tr_b16 a[204:205], v2 offset:25568
v_lshlrev_b32 v32, 16, v24
v_mfma_f32_16x16x32_bf16 v[68:71], a[136:139], a[24:27], v[68:71]
s_waitcnt lgkmcnt(7)
v_exp_f32 v79, v79
v_mfma_f32_16x16x32_bf16 v[68:71], a[132:135], a[20:23], v[68:71]
ds_read_b64_tr_b16 a[206:207], v2 offset:26080
v_cvt_pk_bf16_f32 v87, v78, v79
v_mfma_f32_16x16x32_bf16 v[68:71], a[128:131], a[16:19], v[68:71]
s_add_u32 m0, s33, 33856
v_exp_f32 v56, v56
v_mfma_f32_16x16x32_bf16 v[96:99], a[144:147], v[80:83], v[96:99]
buffer_load_dwordx4 v3, s[16:19], 0 offen offset:2048 nt lds
v_mfma_f32_16x16x32_bf16 v[96:99], a[176:179], v[84:87], v[96:99]
v_exp_f32 v57, v57
v_mfma_f32_16x16x32_bf16 v[100:103], a[180:183], v[84:87], v[100:103]
v_cvt_pk_bf16_f32 v88, v56, v57
v_and_b32 v33, s45, v24
v_mfma_f32_16x16x32_bf16 v[100:103], a[148:151], v[80:83], v[100:103]
v_exp_f32 v58, v58
v_mfma_f32_16x16x32_bf16 v[104:107], a[152:155], v[80:83], v[104:107]
ds_write_b128 v4, v[20:23] offset:1056
v_mfma_f32_16x16x32_bf16 v[104:107], a[184:187], v[84:87], v[104:107]
v_exp_f32 v59, v59
v_mfma_f32_16x16x32_bf16 v[108:111], a[188:191], v[84:87], v[108:111]
s_waitcnt lgkmcnt(1)
v_cvt_pk_bf16_f32 v89, v58, v59
v_mul_f32 v32, s38, v32
v_mfma_f32_16x16x32_bf16 v[108:111], a[156:159], v[80:83], v[108:111]
s_add_u32 m0, s33, 33888
v_exp_f32 v60, v60
v_mfma_f32_16x16x32_bf16 v[112:115], a[160:163], v[80:83], v[112:115]
buffer_load_dwordx4 v3, s[16:19], 0 offen offset:3072 nt lds
v_mfma_f32_16x16x32_bf16 v[112:115], a[192:195], v[84:87], v[112:115]
v_exp_f32 v61, v61
v_mfma_f32_16x16x32_bf16 v[116:119], a[196:199], v[84:87], v[116:119]
s_add_u32 s12, s12, 16384
s_addc_u32 s13, s13, 0
v_cvt_pk_bf16_f32 v90, v60, v61
v_mfma_f32_16x16x32_bf16 v[116:119], a[164:167], v[80:83], v[116:119]
v_exp_f32 v62, v62
v_mfma_f32_16x16x32_bf16 v[120:123], a[168:171], v[80:83], v[120:123]
v_mul_f32 v33, s38, v33
v_cvt_pk_bf16_f32 v24, v32, v33
v_mfma_f32_16x16x32_bf16 v[120:123], a[200:203], v[84:87], v[120:123]
s_add_u32 m0, s33, 16896
v_exp_f32 v63, v63
v_mfma_f32_16x16x32_bf16 v[124:127], a[204:207], v[84:87], v[124:127]
v_cvt_pk_bf16_f32 v91, v62, v63
v_lshlrev_b32 v34, 16, v25
v_mfma_f32_16x16x32_bf16 v[124:127], a[172:175], v[80:83], v[124:127]
v_mfma_f32_16x16x32_bf16 a[208:211], a[228:231], v[80:83], a[208:211]
buffer_load_dwordx4 v3, s[12:15], 0 offen nt lds
v_mfma_f32_16x16x32_bf16 a[208:211], a[228:231], v[84:87], a[208:211]
v_mfma_f32_16x16x32_bf16 v[72:75], a[80:83], a[32:35], v[44:47]
v_and_b32 v35, s45, v25
v_mfma_f32_16x16x32_bf16 v[72:75], a[84:87], a[36:39], v[72:75]
v_mfma_f32_16x16x32_bf16 v[72:75], a[88:91], a[40:43], v[72:75]
v_mul_f32 v34, s38, v34
v_mul_f32 v35, s38, v35
v_mfma_f32_16x16x32_bf16 v[72:75], a[92:95], a[44:47], v[72:75]
s_add_u32 m0, s33, 16928
v_exp_f32 v64, v64
v_exp_f32 v65, v65
v_exp_f32 v66, v66
v_exp_f32 v67, v67
v_cvt_pk_bf16_f32 v92, v64, v65
v_cvt_pk_bf16_f32 v93, v66, v67
v_mfma_f32_16x16x32_bf16 v[76:79], a[108:111], a[44:47], v[44:47]
v_cvt_pk_bf16_f32 v25, v34, v35
v_mfma_f32_16x16x32_bf16 v[76:79], a[104:107], a[40:43], v[76:79]
v_exp_f32 v68, v68
v_mfma_f32_16x16x32_bf16 v[76:79], a[100:103], a[36:39], v[76:79]
buffer_load_dwordx4 v3, s[12:15], 0 offen offset:1024 nt lds
v_mfma_f32_16x16x32_bf16 v[76:79], a[96:99], a[32:35], v[76:79]
v_exp_f32 v69, v69
v_mfma_f32_16x16x32_bf16 v[56:59], a[112:115], a[32:35], v[44:47]
v_cvt_pk_bf16_f32 v94, v68, v69
v_lshlrev_b32 v32, 16, v26
v_mfma_f32_16x16x32_bf16 v[56:59], a[116:119], a[36:39], v[56:59]
v_exp_f32 v70, v70
v_mfma_f32_16x16x32_bf16 v[56:59], a[120:123], a[40:43], v[56:59]
v_and_b32 v33, s45, v26
v_mul_f32 v32, s38, v32
v_mfma_f32_16x16x32_bf16 v[56:59], a[124:127], a[44:47], v[56:59]
s_add_u32 m0, s33, 16960
v_exp_f32 v71, v71
v_mfma_f32_16x16x32_bf16 v[60:63], a[140:143], a[44:47], v[44:47]
v_exp_f32 v72, v72
v_mfma_f32_16x16x32_bf16 v[60:63], a[136:139], a[40:43], v[60:63]
v_cvt_pk_bf16_f32 v95, v70, v71
v_mul_f32 v33, s38, v33
v_mfma_f32_16x16x32_bf16 v[60:63], a[132:135], a[36:39], v[60:63]
v_exp_f32 v73, v73
v_mfma_f32_16x16x32_bf16 v[60:63], a[128:131], a[32:35], v[60:63]
v_cvt_pk_bf16_f32 v80, v72, v73
v_cvt_pk_bf16_f32 v26, v32, v33
v_mfma_f32_16x16x32_bf16 v[128:131], a[144:147], v[88:91], v[128:131]
v_exp_f32 v74, v74
v_mfma_f32_16x16x32_bf16 v[128:131], a[176:179], v[92:95], v[128:131]
buffer_load_dwordx4 v3, s[12:15], 0 offen offset:2048 nt lds
v_mfma_f32_16x16x32_bf16 v[132:135], a[180:183], v[92:95], v[132:135]
v_exp_f32 v75, v75
v_mfma_f32_16x16x32_bf16 v[132:135], a[148:151], v[88:91], v[132:135]
v_cvt_pk_bf16_f32 v81, v74, v75
v_lshlrev_b32 v34, 16, v27
v_mfma_f32_16x16x32_bf16 v[136:139], a[152:155], v[88:91], v[136:139]
s_add_u32 m0, s33, 16992
v_exp_f32 v76, v76
v_mfma_f32_16x16x32_bf16 v[136:139], a[184:187], v[92:95], v[136:139]
buffer_load_dwordx4 v3, s[12:15], 0 offen offset:3072 nt lds
v_mfma_f32_16x16x32_bf16 v[140:143], a[188:191], v[92:95], v[140:143]
v_exp_f32 v77, v77
v_mfma_f32_16x16x32_bf16 v[140:143], a[156:159], v[88:91], v[140:143]
v_cvt_pk_bf16_f32 v82, v76, v77
v_and_b32 v35, s45, v27
v_mfma_f32_16x16x32_bf16 v[144:147], a[160:163], v[88:91], v[144:147]
v_exp_f32 v78, v78
v_mul_f32 v34, s38, v34
v_mul_f32 v35, s38, v35
v_cvt_pk_bf16_f32 v27, v34, v35
v_mfma_f32_16x16x32_bf16 v[144:147], a[192:195], v[92:95], v[144:147]
ds_write_b128 v4, v[24:27] offset:2112
v_mfma_f32_16x16x32_bf16 v[148:151], a[196:199], v[92:95], v[148:151]
v_exp_f32 v79, v79
v_mfma_f32_16x16x32_bf16 v[148:151], a[164:167], v[88:91], v[148:151]
v_cvt_pk_bf16_f32 v83, v78, v79
v_add_u32 v4, 3168, v4
v_mfma_f32_16x16x32_bf16 v[152:155], a[168:171], v[88:91], v[152:155]
v_exp_f32 v56, v56
v_mfma_f32_16x16x32_bf16 v[152:155], a[200:203], v[92:95], v[152:155]
v_mfma_f32_16x16x32_bf16 v[156:159], a[204:207], v[92:95], v[156:159]
s_waitcnt vmcnt(9) lgkmcnt(2)
v_exp_f32 v57, v57
v_mfma_f32_16x16x32_bf16 v[156:159], a[172:175], v[88:91], v[156:159]
v_cvt_pk_bf16_f32 v84, v56, v57
v_mfma_f32_16x16x32_bf16 a[212:215], a[228:231], v[88:91], a[212:215]
s_barrier
v_exp_f32 v58, v58
v_mfma_f32_16x16x32_bf16 a[212:215], a[228:231], v[92:95], a[212:215]
v_mfma_f32_16x16x32_bf16 v[64:67], a[80:83], a[48:51], v[48:51]
v_exp_f32 v59, v59
v_mfma_f32_16x16x32_bf16 v[64:67], a[84:87], a[52:55], v[64:67]
ds_read_b128 a[80:83], v1
v_cvt_pk_bf16_f32 v85, v58, v59
v_mfma_f32_16x16x32_bf16 v[64:67], a[88:91], a[56:59], v[64:67]
v_mfma_f32_16x16x32_bf16 v[64:67], a[92:95], a[60:63], v[64:67]
ds_read_b128 a[84:87], v1 offset:64
ds_read_b128 a[88:91], v1 offset:128
v_mfma_f32_16x16x32_bf16 v[68:71], a[108:111], a[60:63], v[48:51]
v_mfma_f32_16x16x32_bf16 v[68:71], a[104:107], a[56:59], v[68:71]
ds_read_b128 a[92:95], v1 offset:192
v_mfma_f32_16x16x32_bf16 v[68:71], a[100:103], a[52:55], v[68:71]
v_mfma_f32_16x16x32_bf16 v[68:71], a[96:99], a[48:51], v[68:71]
ds_read_b128 a[108:111], v1 offset:704
v_exp_f32 v60, v60
v_exp_f32 v61, v61
v_exp_f32 v62, v62
v_exp_f32 v63, v63
v_cvt_pk_bf16_f32 v86, v60, v61
v_cvt_pk_bf16_f32 v87, v62, v63
v_mfma_f32_16x16x32_bf16 v[72:75], a[112:115], a[48:51], v[48:51]
v_mfma_f32_16x16x32_bf16 v[72:75], a[116:119], a[52:55], v[72:75]
v_exp_f32 v64, v64
v_mfma_f32_16x16x32_bf16 v[72:75], a[120:123], a[56:59], v[72:75]
ds_read_b128 a[104:107], v1 offset:640
v_mfma_f32_16x16x32_bf16 v[72:75], a[124:127], a[60:63], v[72:75]
v_exp_f32 v65, v65
v_mfma_f32_16x16x32_bf16 v[76:79], a[140:143], a[60:63], v[48:51]
ds_read_b128 a[100:103], v1 offset:576
v_cvt_pk_bf16_f32 v88, v64, v65
v_mfma_f32_16x16x32_bf16 v[76:79], a[136:139], a[56:59], v[76:79]
v_exp_f32 v66, v66
v_mfma_f32_16x16x32_bf16 v[76:79], a[132:135], a[52:55], v[76:79]
ds_read_b128 a[96:99], v1 offset:512
v_mfma_f32_16x16x32_bf16 v[76:79], a[128:131], a[48:51], v[76:79]
v_exp_f32 v67, v67
v_mfma_f32_16x16x32_bf16 v[160:163], a[144:147], v[80:83], v[160:163]
ds_read_b128 a[112:115], v1 offset:8448
v_cvt_pk_bf16_f32 v89, v66, v67
v_mfma_f32_16x16x32_bf16 v[160:163], a[176:179], v[84:87], v[160:163]
v_exp_f32 v68, v68
v_mfma_f32_16x16x32_bf16 v[164:167], a[180:183], v[84:87], v[164:167]
ds_read_b128 a[116:119], v1 offset:8512
v_mfma_f32_16x16x32_bf16 v[164:167], a[148:151], v[80:83], v[164:167]
v_exp_f32 v69, v69
v_mfma_f32_16x16x32_bf16 v[168:171], a[152:155], v[80:83], v[168:171]
ds_read_b128 a[120:123], v1 offset:8576
v_cvt_pk_bf16_f32 v90, v68, v69
v_mfma_f32_16x16x32_bf16 v[168:171], a[184:187], v[84:87], v[168:171]
v_exp_f32 v70, v70
v_mfma_f32_16x16x32_bf16 v[172:175], a[188:191], v[84:87], v[172:175]
ds_read_b128 a[124:127], v1 offset:8640
v_mfma_f32_16x16x32_bf16 v[172:175], a[156:159], v[80:83], v[172:175]
v_exp_f32 v71, v71
v_mfma_f32_16x16x32_bf16 v[176:179], a[160:163], v[80:83], v[176:179]
ds_read_b128 a[140:143], v1 offset:9152
v_cvt_pk_bf16_f32 v91, v70, v71
v_mfma_f32_16x16x32_bf16 v[176:179], a[192:195], v[84:87], v[176:179]
v_exp_f32 v72, v72
v_mfma_f32_16x16x32_bf16 v[180:183], a[196:199], v[84:87], v[180:183]
ds_read_b128 a[136:139], v1 offset:9088
v_mfma_f32_16x16x32_bf16 v[180:183], a[164:167], v[80:83], v[180:183]
v_exp_f32 v73, v73
v_mfma_f32_16x16x32_bf16 v[184:187], a[168:171], v[80:83], v[184:187]
ds_read_b128 a[132:135], v1 offset:9024
v_cvt_pk_bf16_f32 v92, v72, v73
v_mfma_f32_16x16x32_bf16 v[184:187], a[200:203], v[84:87], v[184:187]
s_sub_u32 s34, s34, 1
v_exp_f32 v74, v74
v_mfma_f32_16x16x32_bf16 v[188:191], a[204:207], v[84:87], v[188:191]
ds_read_b128 a[128:131], v1 offset:8960
v_mfma_f32_16x16x32_bf16 v[188:191], a[172:175], v[80:83], v[188:191]
s_cmp_lg_u32 s34, 0
v_exp_f32 v75, v75
v_mfma_f32_16x16x32_bf16 a[216:219], a[228:231], v[80:83], a[216:219]
s_waitcnt lgkmcnt(8)
v_cvt_pk_bf16_f32 v93, v74, v75
v_mfma_f32_16x16x32_bf16 a[216:219], a[228:231], v[84:87], a[216:219]
s_cbranch_scc1 L_m010
L_x00:
v_exp_f32 v76, v76
v_mfma_f32_16x16x32_bf16 v[56:59], a[80:83], a[64:67], v[52:55]
v_mfma_f32_16x16x32_bf16 v[56:59], a[84:87], a[68:71], v[56:59]
v_exp_f32 v77, v77
v_mfma_f32_16x16x32_bf16 v[56:59], a[88:91], a[72:75], v[56:59]
v_cvt_pk_bf16_f32 v94, v76, v77
v_mfma_f32_16x16x32_bf16 v[56:59], a[92:95], a[76:79], v[56:59]
v_exp_f32 v78, v78
v_mfma_f32_16x16x32_bf16 v[60:63], a[108:111], a[76:79], v[52:55]
v_mfma_f32_16x16x32_bf16 v[60:63], a[104:107], a[72:75], v[60:63]
s_waitcnt vmcnt(4) lgkmcnt(0)
v_exp_f32 v79, v79
v_mfma_f32_16x16x32_bf16 v[60:63], a[100:103], a[68:71], v[60:63]
s_add_u32 s12, s12, 66863104
s_addc_u32 s13, s13, 0
v_cvt_pk_bf16_f32 v95, v78, v79
v_mfma_f32_16x16x32_bf16 v[60:63], a[96:99], a[64:67], v[60:63]
s_barrier
s_add_u32 s16, s16, 16384
s_addc_u32 s17, s17, 0
v_mfma_f32_16x16x32_bf16 v[192:195], a[144:147], v[88:91], v[192:195]
ds_read_b64_tr_b16 a[144:145], v2
ds_read_b64_tr_b16 a[146:147], v2 offset:512
v_mfma_f32_16x16x32_bf16 v[192:195], a[176:179], v[92:95], v[192:195]
v_exp_f32 v56, v56
v_mfma_f32_16x16x32_bf16 v[196:199], a[180:183], v[92:95], v[196:199]
v_mfma_f32_16x16x32_bf16 v[196:199], a[148:151], v[88:91], v[196:199]
ds_read_b64_tr_b16 a[148:149], v2 offset:32
ds_read_b64_tr_b16 a[150:151], v2 offset:544
v_mfma_f32_16x16x32_bf16 v[200:203], a[152:155], v[88:91], v[200:203]
v_exp_f32 v57, v57
v_mfma_f32_16x16x32_bf16 v[200:203], a[184:187], v[92:95], v[200:203]
ds_read_b64_tr_b16 a[152:153], v2 offset:64
v_cvt_pk_bf16_f32 v80, v56, v57
v_mfma_f32_16x16x32_bf16 v[204:207], a[188:191], v[92:95], v[204:207]
ds_read_b64_tr_b16 a[154:155], v2 offset:576
v_mfma_f32_16x16x32_bf16 v[204:207], a[156:159], v[88:91], v[204:207]
v_exp_f32 v58, v58
v_mfma_f32_16x16x32_bf16 v[208:211], a[160:163], v[88:91], v[208:211]
ds_read_b64_tr_b16 a[156:157], v2 offset:96
ds_read_b64_tr_b16 a[158:159], v2 offset:608
v_mfma_f32_16x16x32_bf16 v[208:211], a[192:195], v[92:95], v[208:211]
ds_read_b64_tr_b16 a[160:161], v2 offset:128
v_mfma_f32_16x16x32_bf16 v[212:215], a[196:199], v[92:95], v[212:215]
v_exp_f32 v59, v59
v_mfma_f32_16x16x32_bf16 v[212:215], a[164:167], v[88:91], v[212:215]
ds_read_b64_tr_b16 a[162:163], v2 offset:640
v_cvt_pk_bf16_f32 v81, v58, v59
v_mfma_f32_16x16x32_bf16 v[216:219], a[168:171], v[88:91], v[216:219]
ds_read_b64_tr_b16 a[164:165], v2 offset:160
v_mfma_f32_16x16x32_bf16 v[216:219], a[200:203], v[92:95], v[216:219]
v_exp_f32 v60, v60
v_mfma_f32_16x16x32_bf16 v[220:223], a[204:207], v[92:95], v[220:223]
ds_read_b64_tr_b16 a[166:167], v2 offset:672
v_mfma_f32_16x16x32_bf16 v[220:223], a[172:175], v[88:91], v[220:223]
ds_read_b64_tr_b16 a[168:169], v2 offset:192
v_mfma_f32_16x16x32_bf16 a[220:223], a[228:231], v[88:91], a[220:223]
v_exp_f32 v61, v61
v_mfma_f32_16x16x32_bf16 a[220:223], a[228:231], v[92:95], a[220:223]
ds_read_b64_tr_b16 a[170:171], v2 offset:704
v_cvt_pk_bf16_f32 v82, v60, v61
v_mfma_f32_16x16x32_bf16 v[64:67], a[80:83], a[0:3], v[36:39]
ds_read_b64_tr_b16 a[172:173], v2 offset:224
v_mfma_f32_16x16x32_bf16 v[64:67], a[84:87], a[4:7], v[64:67]
v_exp_f32 v62, v62
v_mfma_f32_16x16x32_bf16 v[64:67], a[88:91], a[8:11], v[64:67]
ds_read_b64_tr_b16 a[174:175], v2 offset:736
v_mfma_f32_16x16x32_bf16 v[64:67], a[92:95], a[12:15], v[64:67]
ds_read_b64_tr_b16 a[176:177], v2 offset:8448
v_mfma_f32_16x16x32_bf16 v[68:71], a[108:111], a[12:15], v[36:39]
v_exp_f32 v63, v63
v_mfma_f32_16x16x32_bf16 v[68:71], a[104:107], a[8:11], v[68:71]
ds_read_b64_tr_b16 a[178:179], v2 offset:8960
v_cvt_pk_bf16_f32 v83, v62, v63
v_mfma_f32_16x16x32_bf16 v[68:71], a[100:103], a[4:7], v[68:71]
ds_read_b64_tr_b16 a[180:181], v2 offset:8480
v_mfma_f32_16x16x32_bf16 v[68:71], a[96:99], a[0:3], v[68:71]
ds_read_b64_tr_b16 a[182:183], v2 offset:8992
v_mfma_f32_16x16x32_bf16 v[72:75], a[112:115], a[0:3], v[36:39]
v_exp_f32 v64, v64
v_mfma_f32_16x16x32_bf16 v[72:75], a[116:119], a[4:7], v[72:75]
ds_read_b64_tr_b16 a[184:185], v2 offset:8512
v_mfma_f32_16x16x32_bf16 v[72:75], a[120:123], a[8:11], v[72:75]
v_exp_f32 v65, v65
v_mfma_f32_16x16x32_bf16 v[72:75], a[124:127], a[12:15], v[72:75]
ds_read_b64_tr_b16 a[186:187], v2 offset:9024
v_cvt_pk_bf16_f32 v88, v64, v65
v_mfma_f32_16x16x32_bf16 v[76:79], a[140:143], a[12:15], v[36:39]
v_exp_f32 v66, v66
v_mfma_f32_16x16x32_bf16 v[76:79], a[136:139], a[8:11], v[76:79]
ds_read_b64_tr_b16 a[188:189], v2 offset:8544
v_mfma_f32_16x16x32_bf16 v[76:79], a[132:135], a[4:7], v[76:79]
s_waitcnt lgkmcnt(14)
v_exp_f32 v67, v67
v_mfma_f32_16x16x32_bf16 v[76:79], a[128:131], a[0:3], v[76:79]
ds_read_b64_tr_b16 a[190:191], v2 offset:9056
v_cvt_pk_bf16_f32 v89, v66, v67
v_mfma_f32_16x16x32_bf16 v[224:227], a[144:147], v[80:83], v[224:227]
v_exp_f32 v68, v68
v_mfma_f32_16x16x32_bf16 v[228:231], a[148:151], v[80:83], v[228:231]
ds_read_b64_tr_b16 a[192:193], v2 offset:8576
v_mfma_f32_16x16x32_bf16 v[232:235], a[152:155], v[80:83], v[232:235]
s_waitcnt lgkmcnt(9)
v_exp_f32 v69, v69
v_mfma_f32_16x16x32_bf16 v[236:239], a[156:159], v[80:83], v[236:239]
ds_read_b64_tr_b16 a[194:195], v2 offset:9088
v_cvt_pk_bf16_f32 v90, v68, v69
v_mfma_f32_16x16x32_bf16 v[240:243], a[160:163], v[80:83], v[240:243]
s_add_u32 m0, s33, 50688
v_exp_f32 v70, v70
v_mfma_f32_16x16x32_bf16 v[244:247], a[164:167], v[80:83], v[244:247]
buffer_load_dwordx4 v3, s[16:19], 0 offen nt lds
v_mfma_f32_16x16x32_bf16 v[248:251], a[168:171], v[80:83], v[248:251]
v_exp_f32 v71, v71
v_mfma_f32_16x16x32_bf16 v[252:255], a[172:175], v[80:83], v[252:255]
ds_read_b64_tr_b16 a[196:197], v2 offset:8608
v_cvt_pk_bf16_f32 v91, v70, v71
v_mfma_f32_16x16x32_bf16 a[224:227], a[228:231], v[80:83], a[224:227]
v_mfma_f32_16x16x32_bf16 v[56:59], a[80:83], a[16:19], v[40:43]
ds_read_b64_tr_b16 a[198:199], v2 offset:9120
v_mfma_f32_16x16x32_bf16 v[56:59], a[84:87], a[20:23], v[56:59]
s_add_u32 m0, s33, 50720
v_mfma_f32_16x16x32_bf16 v[56:59], a[88:91], a[24:27], v[56:59]
ds_read_b64_tr_b16 a[200:201], v2 offset:8640
v_mfma_f32_16x16x32_bf16 v[56:59], a[92:95], a[28:31], v[56:59]
v_exp_f32 v72, v72
v_exp_f32 v73, v73
v_exp_f32 v74, v74
v_exp_f32 v75, v75
v_cvt_pk_bf16_f32 v92, v72, v73
v_cvt_pk_bf16_f32 v93, v74, v75
v_mfma_f32_16x16x32_bf16 v[60:63], a[108:111], a[28:31], v[40:43]
buffer_load_dwordx4 v3, s[16:19], 0 offen offset:1024 nt lds
v_mfma_f32_16x16x32_bf16 v[60:63], a[104:107], a[24:27], v[60:63]
s_add_u32 m0, s33, 50752
v_mfma_f32_16x16x32_bf16 v[60:63], a[100:103], a[20:23], v[60:63]
ds_read_b64_tr_b16 a[202:203], v2 offset:9152
v_mfma_f32_16x16x32_bf16 v[60:63], a[96:99], a[16:19], v[60:63]
v_exp_f32 v76, v76
v_mfma_f32_16x16x32_bf16 v[64:67], a[112:115], a[16:19], v[40:43]
buffer_load_dwordx4 v3, s[16:19], 0 offen offset:2048 nt lds
v_mfma_f32_16x16x32_bf16 v[64:67], a[116:119], a[20:23], v[64:67]
v_exp_f32 v77, v77
v_mfma_f32_16x16x32_bf16 v[64:67], a[120:123], a[24:27], v[64:67]
ds_read_b64_tr_b16 a[204:205], v2 offset:8672
v_cvt_pk_bf16_f32 v94, v76, v77
v_mfma_f32_16x16x32_bf16 v[64:67], a[124:127], a[28:31], v[64:67]
s_add_u32 m0, s33, 50784
v_exp_f32 v78, v78
v_mfma_f32_16x16x32_bf16 v[68:71], a[140:143], a[28:31], v[40:43]
buffer_load_dwordx4 v3, s[16:19], 0 offen offset:3072 nt lds
v_mfma_f32_16x16x32_bf16 v[68:71], a[136:139], a[24:27], v[68:71]
s_waitcnt lgkmcnt(7)
v_exp_f32 v79, v79
v_mfma_f32_16x16x32_bf16 v[68:71], a[132:135], a[20:23], v[68:71]
ds_read_b64_tr_b16 a[206:207], v2 offset:9184
v_cvt_pk_bf16_f32 v95, v78, v79
v_mfma_f32_16x16x32_bf16 v[68:71], a[128:131], a[16:19], v[68:71]
s_add_u32 m0, s33, 0
v_exp_f32 v56, v56
v_mfma_f32_16x16x32_bf16 v[96:99], a[144:147], v[88:91], v[96:99]
buffer_load_dwordx4 v3, s[12:15], 0 offen nt lds
v_mfma_f32_16x16x32_bf16 v[96:99], a[176:179], v[92:95], v[96:99]
v_exp_f32 v57, v57
v_mfma_f32_16x16x32_bf16 v[100:103], a[180:183], v[92:95], v[100:103]
v_cvt_pk_bf16_f32 v80, v56, v57
v_accvgpr_read_b32 v4, a253
v_mfma_f32_16x16x32_bf16 v[100:103], a[148:151], v[88:91], v[100:103]
v_exp_f32 v58, v58
v_mfma_f32_16x16x32_bf16 v[104:107], a[152:155], v[88:91], v[104:107]
v_mfma_f32_16x16x32_bf16 v[104:107], a[184:187], v[92:95], v[104:107]
s_add_u32 m0, s33, 32
v_exp_f32 v59, v59
v_mfma_f32_16x16x32_bf16 v[108:111], a[188:191], v[92:95], v[108:111]
s_waitcnt lgkmcnt(0)
v_cvt_pk_bf16_f32 v81, v58, v59
v_mfma_f32_16x16x32_bf16 v[108:111], a[156:159], v[88:91], v[108:111]
s_waitcnt lgkmcnt(0)
v_exp_f32 v60, v60
v_mfma_f32_16x16x32_bf16 v[112:115], a[160:163], v[88:91], v[112:115]
buffer_load_dwordx4 v3, s[12:15], 0 offen offset:1024 nt lds
v_mfma_f32_16x16x32_bf16 v[112:115], a[192:195], v[92:95], v[112:115]
s_barrier
v_exp_f32 v61, v61
v_mfma_f32_16x16x32_bf16 v[116:119], a[196:199], v[92:95], v[116:119]
v_cvt_pk_bf16_f32 v82, v60, v61
v_mfma_f32_16x16x32_bf16 v[116:119], a[164:167], v[88:91], v[116:119]
s_add_u32 m0, s33, 64
v_exp_f32 v62, v62
v_mfma_f32_16x16x32_bf16 v[120:123], a[168:171], v[88:91], v[120:123]
buffer_load_dwordx4 v3, s[12:15], 0 offen offset:2048 nt lds
v_mfma_f32_16x16x32_bf16 v[120:123], a[200:203], v[92:95], v[120:123]
v_exp_f32 v63, v63
v_mfma_f32_16x16x32_bf16 v[124:127], a[204:207], v[92:95], v[124:127]
v_cvt_pk_bf16_f32 v83, v62, v63
v_mfma_f32_16x16x32_bf16 v[124:127], a[172:175], v[88:91], v[124:127]
v_mfma_f32_16x16x32_bf16 a[208:211], a[228:231], v[88:91], a[208:211]
v_mfma_f32_16x16x32_bf16 a[208:211], a[228:231], v[92:95], a[208:211]
s_add_u32 m0, s33, 96
v_mfma_f32_16x16x32_bf16 v[72:75], a[80:83], a[32:35], v[44:47]
v_mfma_f32_16x16x32_bf16 v[72:75], a[84:87], a[36:39], v[72:75]
v_mfma_f32_16x16x32_bf16 v[72:75], a[88:91], a[40:43], v[72:75]
buffer_load_dwordx4 v3, s[12:15], 0 offen offset:3072 nt lds
v_mfma_f32_16x16x32_bf16 v[72:75], a[92:95], a[44:47], v[72:75]
v_exp_f32 v64, v64
v_exp_f32 v65, v65
v_exp_f32 v66, v66
v_exp_f32 v67, v67
v_cvt_pk_bf16_f32 v84, v64, v65
v_cvt_pk_bf16_f32 v85, v66, v67
v_mfma_f32_16x16x32_bf16 v[76:79], a[108:111], a[44:47], v[44:47]
s_add_u32 s16, s16, 66863104
s_addc_u32 s17, s17, 0
v_mfma_f32_16x16x32_bf16 v[76:79], a[104:107], a[40:43], v[76:79]
s_add_u32 m0, s33, 33792
v_exp_f32 v68, v68
v_mfma_f32_16x16x32_bf16 v[76:79], a[100:103], a[36:39], v[76:79]
buffer_load_dwordx4 v3, s[16:19], 0 offen nt lds
v_mfma_f32_16x16x32_bf16 v[76:79], a[96:99], a[32:35], v[76:79]
v_exp_f32 v69, v69
v_mfma_f32_16x16x32_bf16 v[56:59], a[112:115], a[32:35], v[44:47]
v_cvt_pk_bf16_f32 v86, v68, v69
v_mfma_f32_16x16x32_bf16 v[56:59], a[116:119], a[36:39], v[56:59]
v_exp_f32 v70, v70
v_mfma_f32_16x16x32_bf16 v[56:59], a[120:123], a[40:43], v[56:59]
v_mfma_f32_16x16x32_bf16 v[56:59], a[124:127], a[44:47], v[56:59]
s_add_u32 m0, s33, 33824
v_exp_f32 v71, v71
v_mfma_f32_16x16x32_bf16 v[60:63], a[140:143], a[44:47], v[44:47]
v_exp_f32 v72, v72
v_mfma_f32_16x16x32_bf16 v[60:63], a[136:139], a[40:43], v[60:63]
v_cvt_pk_bf16_f32 v87, v70, v71
v_mfma_f32_16x16x32_bf16 v[60:63], a[132:135], a[36:39], v[60:63]
v_exp_f32 v73, v73
v_mfma_f32_16x16x32_bf16 v[60:63], a[128:131], a[32:35], v[60:63]
v_cvt_pk_bf16_f32 v88, v72, v73
v_mfma_f32_16x16x32_bf16 v[128:131], a[144:147], v[80:83], v[128:131]
v_exp_f32 v74, v74
v_mfma_f32_16x16x32_bf16 v[128:131], a[176:179], v[84:87], v[128:131]
buffer_load_dwordx4 v3, s[16:19], 0 offen offset:1024 nt lds
v_mfma_f32_16x16x32_bf16 v[132:135], a[180:183], v[84:87], v[132:135]
s_add_u32 m0, s33, 33856
v_exp_f32 v75, v75
v_mfma_f32_16x16x32_bf16 v[132:135], a[148:151], v[80:83], v[132:135]
v_cvt_pk_bf16_f32 v89, v74, v75
v_mfma_f32_16x16x32_bf16 v[136:139], a[152:155], v[80:83], v[136:139]
v_exp_f32 v76, v76
v_mfma_f32_16x16x32_bf16 v[136:139], a[184:187], v[84:87], v[136:139]
buffer_load_dwordx4 v3, s[16:19], 0 offen offset:2048 nt lds
v_mfma_f32_16x16x32_bf16 v[140:143], a[188:191], v[84:87], v[140:143]
v_exp_f32 v77, v77
v_mfma_f32_16x16x32_bf16 v[140:143], a[156:159], v[80:83], v[140:143]
v_cvt_pk_bf16_f32 v90, v76, v77
v_mfma_f32_16x16x32_bf16 v[144:147], a[160:163], v[80:83], v[144:147]
s_add_u32 m0, s33, 33888
v_exp_f32 v78, v78
v_mfma_f32_16x16x32_bf16 v[144:147], a[192:195], v[84:87], v[144:147]
buffer_load_dwordx4 v3, s[16:19], 0 offen offset:3072 nt lds
v_mfma_f32_16x16x32_bf16 v[148:151], a[196:199], v[84:87], v[148:151]
v_exp_f32 v79, v79
v_mfma_f32_16x16x32_bf16 v[148:151], a[164:167], v[80:83], v[148:151]
v_cvt_pk_bf16_f32 v91, v78, v79
v_mfma_f32_16x16x32_bf16 v[152:155], a[168:171], v[80:83], v[152:155]
v_exp_f32 v56, v56
v_mfma_f32_16x16x32_bf16 v[152:155], a[200:203], v[84:87], v[152:155]
v_mfma_f32_16x16x32_bf16 v[156:159], a[204:207], v[84:87], v[156:159]
s_waitcnt vmcnt(12) lgkmcnt(0)
v_exp_f32 v57, v57
v_mfma_f32_16x16x32_bf16 v[156:159], a[172:175], v[80:83], v[156:159]
v_cvt_pk_bf16_f32 v92, v56, v57
v_mfma_f32_16x16x32_bf16 a[212:215], a[228:231], v[80:83], a[212:215]
s_barrier
v_exp_f32 v58, v58
v_mfma_f32_16x16x32_bf16 a[212:215], a[228:231], v[84:87], a[212:215]
v_mfma_f32_16x16x32_bf16 v[64:67], a[80:83], a[48:51], v[48:51]
v_exp_f32 v59, v59
v_mfma_f32_16x16x32_bf16 v[64:67], a[84:87], a[52:55], v[64:67]
ds_read_b128 a[80:83], v1 offset:16896
v_cvt_pk_bf16_f32 v93, v58, v59
v_mfma_f32_16x16x32_bf16 v[64:67], a[88:91], a[56:59], v[64:67]
v_mfma_f32_16x16x32_bf16 v[64:67], a[92:95], a[60:63], v[64:67]
ds_read_b128 a[84:87], v1 offset:16960
ds_read_b128 a[88:91], v1 offset:17024
v_mfma_f32_16x16x32_bf16 v[68:71], a[108:111], a[60:63], v[48:51]
v_mfma_f32_16x16x32_bf16 v[68:71], a[104:107], a[56:59], v[68:71]
ds_read_b128 a[92:95], v1 offset:17088
v_mfma_f32_16x16x32_bf16 v[68:71], a[100:103], a[52:55], v[68:71]
v_mfma_f32_16x16x32_bf16 v[68:71], a[96:99], a[48:51], v[68:71]
ds_read_b128 a[108:111], v1 offset:17600
v_exp_f32 v60, v60
v_exp_f32 v61, v61
v_exp_f32 v62, v62
v_exp_f32 v63, v63
v_cvt_pk_bf16_f32 v94, v60, v61
v_cvt_pk_bf16_f32 v95, v62, v63
v_mfma_f32_16x16x32_bf16 v[72:75], a[112:115], a[48:51], v[48:51]
v_mfma_f32_16x16x32_bf16 v[72:75], a[116:119], a[52:55], v[72:75]
v_exp_f32 v64, v64
v_mfma_f32_16x16x32_bf16 v[72:75], a[120:123], a[56:59], v[72:75]
ds_read_b128 a[104:107], v1 offset:17536
v_mfma_f32_16x16x32_bf16 v[72:75], a[124:127], a[60:63], v[72:75]
v_exp_f32 v65, v65
v_mfma_f32_16x16x32_bf16 v[76:79], a[140:143], a[60:63], v[48:51]
ds_read_b128 a[100:103], v1 offset:17472
v_cvt_pk_bf16_f32 v80, v64, v65
v_mfma_f32_16x16x32_bf16 v[76:79], a[136:139], a[56:59], v[76:79]
v_exp_f32 v66, v66
v_mfma_f32_16x16x32_bf16 v[76:79], a[132:135], a[52:55], v[76:79]
ds_read_b128 a[96:99], v1 offset:17408
v_mfma_f32_16x16x32_bf16 v[76:79], a[128:131], a[48:51], v[76:79]
v_exp_f32 v67, v67
v_mfma_f32_16x16x32_bf16 v[160:163], a[144:147], v[88:91], v[160:163]
ds_read_b128 a[112:115], v1 offset:25344
v_cvt_pk_bf16_f32 v81, v66, v67
v_mfma_f32_16x16x32_bf16 v[160:163], a[176:179], v[92:95], v[160:163]
v_exp_f32 v68, v68
v_mfma_f32_16x16x32_bf16 v[164:167], a[180:183], v[92:95], v[164:167]
ds_read_b128 a[116:119], v1 offset:25408
v_mfma_f32_16x16x32_bf16 v[164:167], a[148:151], v[88:91], v[164:167]
v_exp_f32 v69, v69
v_mfma_f32_16x16x32_bf16 v[168:171], a[152:155], v[88:91], v[168:171]
ds_read_b128 a[120:123], v1 offset:25472
v_cvt_pk_bf16_f32 v82, v68, v69
v_mfma_f32_16x16x32_bf16 v[168:171], a[184:187], v[92:95], v[168:171]
v_exp_f32 v70, v70
v_mfma_f32_16x16x32_bf16 v[172:175], a[188:191], v[92:95], v[172:175]
ds_read_b128 a[124:127], v1 offset:25536
v_mfma_f32_16x16x32_bf16 v[172:175], a[156:159], v[88:91], v[172:175]
v_exp_f32 v71, v71
v_mfma_f32_16x16x32_bf16 v[176:179], a[160:163], v[88:91], v[176:179]
ds_read_b128 a[140:143], v1 offset:26048
v_cvt_pk_bf16_f32 v83, v70, v71
v_mfma_f32_16x16x32_bf16 v[176:179], a[192:195], v[92:95], v[176:179]
v_exp_f32 v72, v72
v_mfma_f32_16x16x32_bf16 v[180:183], a[196:199], v[92:95], v[180:183]
ds_read_b128 a[136:139], v1 offset:25984
v_mfma_f32_16x16x32_bf16 v[180:183], a[164:167], v[88:91], v[180:183]
v_exp_f32 v73, v73
v_mfma_f32_16x16x32_bf16 v[184:187], a[168:171], v[88:91], v[184:187]
ds_read_b128 a[132:135], v1 offset:25920
v_cvt_pk_bf16_f32 v84, v72, v73
v_mfma_f32_16x16x32_bf16 v[184:187], a[200:203], v[92:95], v[184:187]
v_exp_f32 v74, v74
v_mfma_f32_16x16x32_bf16 v[188:191], a[204:207], v[92:95], v[188:191]
ds_read_b128 a[128:131], v1 offset:25856
v_mfma_f32_16x16x32_bf16 v[188:191], a[172:175], v[88:91], v[188:191]
v_exp_f32 v75, v75
v_mfma_f32_16x16x32_bf16 a[216:219], a[228:231], v[88:91], a[216:219]
s_waitcnt lgkmcnt(8)
v_cvt_pk_bf16_f32 v85, v74, v75
v_mfma_f32_16x16x32_bf16 a[216:219], a[228:231], v[92:95], a[216:219]
v_mfma_f32_16x16x32_bf16 v[56:59], a[80:83], a[64:67], v[52:55]
v_mfma_f32_16x16x32_bf16 v[56:59], a[84:87], a[68:71], v[56:59]
v_mfma_f32_16x16x32_bf16 v[56:59], a[88:91], a[72:75], v[56:59]
v_mfma_f32_16x16x32_bf16 v[56:59], a[92:95], a[76:79], v[56:59]
v_exp_f32 v76, v76
v_exp_f32 v77, v77
v_exp_f32 v78, v78
v_exp_f32 v79, v79
v_cvt_pk_bf16_f32 v86, v76, v77
v_cvt_pk_bf16_f32 v87, v78, v79
v_mfma_f32_16x16x32_bf16 v[60:63], a[108:111], a[76:79], v[52:55]
v_mfma_f32_16x16x32_bf16 v[60:63], a[104:107], a[72:75], v[60:63]
s_waitcnt vmcnt(8) lgkmcnt(0)
v_mfma_f32_16x16x32_bf16 v[60:63], a[100:103], a[68:71], v[60:63]
v_mfma_f32_16x16x32_bf16 v[60:63], a[96:99], a[64:67], v[60:63]
s_barrier
s_add_u32 s12, s12, 16384
s_addc_u32 s13, s13, 0
v_mfma_f32_16x16x32_bf16 v[192:195], a[144:147], v[80:83], v[192:195]
ds_read_b64_tr_b16 a[144:145], v2 offset:16896
ds_read_b64_tr_b16 a[146:147], v2 offset:17408
v_mfma_f32_16x16x32_bf16 v[192:195], a[176:179], v[84:87], v[192:195]
v_exp_f32 v56, v56
v_mfma_f32_16x16x32_bf16 v[196:199], a[180:183], v[84:87], v[196:199]
v_mfma_f32_16x16x32_bf16 v[196:199], a[148:151], v[80:83], v[196:199]
ds_read_b64_tr_b16 a[148:149], v2 offset:16928
ds_read_b64_tr_b16 a[150:151], v2 offset:17440
v_mfma_f32_16x16x32_bf16 v[200:203], a[152:155], v[80:83], v[200:203]
s_add_u32 m0, s33, 16896
v_exp_f32 v57, v57
v_mfma_f32_16x16x32_bf16 v[200:203], a[184:187], v[84:87], v[200:203]
ds_read_b64_tr_b16 a[152:153], v2 offset:16960
v_cvt_pk_bf16_f32 v88, v56, v57
v_mfma_f32_16x16x32_bf16 v[204:207], a[188:191], v[84:87], v[204:207]
buffer_load_dwordx4 v3, s[12:15], 0 offen nt lds
v_mfma_f32_16x16x32_bf16 v[204:207], a[156:159], v[80:83], v[204:207]
v_exp_f32 v58, v58
v_mfma_f32_16x16x32_bf16 v[208:211], a[160:163], v[80:83], v[208:211]
ds_read_b64_tr_b16 a[154:155], v2 offset:17472
ds_read_b64_tr_b16 a[156:157], v2 offset:16992
v_mfma_f32_16x16x32_bf16 v[208:211], a[192:195], v[84:87], v[208:211]
ds_read_b64_tr_b16 a[158:159], v2 offset:17504
v_accvgpr_read_b32 v32, a242
v_mfma_f32_16x16x32_bf16 v[212:215], a[196:199], v[84:87], v[212:215]
v_exp_f32 v59, v59
v_mfma_f32_16x16x32_bf16 v[212:215], a[164:167], v[80:83], v[212:215]
ds_read_b64_tr_b16 a[160:161], v2 offset:17024
v_cvt_pk_bf16_f32 v89, v58, v59
v_mfma_f32_16x16x32_bf16 v[216:219], a[168:171], v[80:83], v[216:219]
ds_read_b64_tr_b16 a[162:163], v2 offset:17536
ds_read_b128 a[64:67], v32
v_mfma_f32_16x16x32_bf16 v[216:219], a[200:203], v[84:87], v[216:219]
s_add_u32 m0, s33, 16928
v_exp_f32 v60, v60
v_mfma_f32_16x16x32_bf16 v[220:223], a[204:207], v[84:87], v[220:223]
buffer_load_dwordx4 v3, s[12:15], 0 offen offset:1024 nt lds
v_mfma_f32_16x16x32_bf16 v[220:223], a[172:175], v[80:83], v[220:223]
ds_read_b64_tr_b16 a[164:165], v2 offset:17056
ds_read_b128 a[68:71], v32 offset:64
v_mfma_f32_16x16x32_bf16 a[220:223], a[228:231], v[80:83], a[220:223]
v_exp_f32 v61, v61
v_mfma_f32_16x16x32_bf16 a[220:223], a[228:231], v[84:87], a[220:223]
ds_read_b64_tr_b16 a[166:167], v2 offset:17568
v_cvt_pk_bf16_f32 v90, v60, v61
v_mfma_f32_16x16x32_bf16 v[64:67], a[80:83], a[0:3], v[36:39]
ds_read_b64_tr_b16 a[168:169], v2 offset:17088
ds_read_b128 a[72:75], v32 offset:128
v_mfma_f32_16x16x32_bf16 v[64:67], a[84:87], a[4:7], v[64:67]
v_exp_f32 v62, v62
v_mfma_f32_16x16x32_bf16 v[64:67], a[88:91], a[8:11], v[64:67]
ds_read_b64_tr_b16 a[170:171], v2 offset:17600
ds_read_b128 a[76:79], v32 offset:192
v_mfma_f32_16x16x32_bf16 v[64:67], a[92:95], a[12:15], v[64:67]
ds_read_b64_tr_b16 a[172:173], v2 offset:17120
v_accvgpr_read_b32 v52, a241
v_mfma_f32_16x16x32_bf16 v[68:71], a[108:111], a[12:15], v[36:39]
s_add_u32 m0, s33, 16960
v_exp_f32 v63, v63
v_mfma_f32_16x16x32_bf16 v[68:71], a[104:107], a[8:11], v[68:71]
ds_read_b64_tr_b16 a[174:175], v2 offset:17632
v_cvt_pk_bf16_f32 v91, v62, v63
v_mfma_f32_16x16x32_bf16 v[68:71], a[100:103], a[4:7], v[68:71]
buffer_load_dwordx4 v3, s[12:15], 0 offen offset:2048 nt lds
v_mfma_f32_16x16x32_bf16 v[68:71], a[96:99], a[0:3], v[68:71]
ds_read_b64_tr_b16 a[176:177], v2 offset:25344
v_accvgpr_read_b32 v53, a241
v_mfma_f32_16x16x32_bf16 v[72:75], a[112:115], a[0:3], v[36:39]
v_exp_f32 v64, v64
v_mfma_f32_16x16x32_bf16 v[72:75], a[116:119], a[4:7], v[72:75]
ds_read_b64_tr_b16 a[178:179], v2 offset:25856
v_accvgpr_read_b32 v54, a241
v_mfma_f32_16x16x32_bf16 v[72:75], a[120:123], a[8:11], v[72:75]
v_exp_f32 v65, v65
v_mfma_f32_16x16x32_bf16 v[72:75], a[124:127], a[12:15], v[72:75]
ds_read_b64_tr_b16 a[180:181], v2 offset:25376
v_cvt_pk_bf16_f32 v80, v64, v65
v_mfma_f32_16x16x32_bf16 v[76:79], a[140:143], a[12:15], v[36:39]
v_exp_f32 v66, v66
v_mfma_f32_16x16x32_bf16 v[76:79], a[136:139], a[8:11], v[76:79]
s_waitcnt lgkmcnt(14)
ds_read_b64_tr_b16 a[182:183], v2 offset:25888
v_mfma_f32_16x16x32_bf16 v[76:79], a[132:135], a[4:7], v[76:79]
s_add_u32 m0, s33, 16992
v_exp_f32 v67, v67
v_mfma_f32_16x16x32_bf16 v[76:79], a[128:131], a[0:3], v[76:79]
ds_read_b64_tr_b16 a[184:185], v2 offset:25408
v_cvt_pk_bf16_f32 v81, v66, v67
v_mfma_f32_16x16x32_bf16 v[224:227], a[144:147], v[88:91], v[224:227]
v_exp_f32 v68, v68
v_mfma_f32_16x16x32_bf16 v[228:231], a[148:151], v[88:91], v[228:231]
buffer_load_dwordx4 v3, s[12:15], 0 offen offset:3072 nt lds
v_mfma_f32_16x16x32_bf16 v[232:235], a[152:155], v[88:91], v[232:235]
s_waitcnt lgkmcnt(5)
v_exp_f32 v69, v69
v_mfma_f32_16x16x32_bf16 v[236:239], a[156:159], v[88:91], v[236:239]
ds_read_b64_tr_b16 a[186:187], v2 offset:25920
v_cvt_pk_bf16_f32 v82, v68, v69
v_mfma_f32_16x16x32_bf16 v[240:243], a[160:163], v[88:91], v[240:243]
v_exp_f32 v70, v70
v_mfma_f32_16x16x32_bf16 v[244:247], a[164:167], v[88:91], v[244:247]
ds_read_b64_tr_b16 a[188:189], v2 offset:25440
ds_read_b128 a[0:3], v6
v_mfma_f32_16x16x32_bf16 v[248:251], a[168:171], v[88:91], v[248:251]
v_exp_f32 v71, v71
v_mfma_f32_16x16x32_bf16 v[252:255], a[172:175], v[88:91], v[252:255]
ds_read_b64_tr_b16 a[190:191], v2 offset:25952
v_cvt_pk_bf16_f32 v83, v70, v71
v_mfma_f32_16x16x32_bf16 a[224:227], a[228:231], v[88:91], a[224:227]
v_exp_f32 v72, v72
v_mfma_f32_16x16x32_bf16 v[56:59], a[80:83], a[16:19], v[40:43]
ds_read_b64_tr_b16 a[192:193], v2 offset:25472
ds_read_b128 a[4:7], v6 offset:64
v_mfma_f32_16x16x32_bf16 v[56:59], a[84:87], a[20:23], v[56:59]
v_exp_f32 v73, v73
v_mfma_f32_16x16x32_bf16 v[56:59], a[88:91], a[24:27], v[56:59]
ds_read_b64_tr_b16 a[194:195], v2 offset:25984
v_cvt_pk_bf16_f32 v84, v72, v73
v_mfma_f32_16x16x32_bf16 v[56:59], a[92:95], a[28:31], v[56:59]
v_exp_f32 v74, v74
v_mfma_f32_16x16x32_bf16 v[60:63], a[108:111], a[28:31], v[40:43]
ds_read_b64_tr_b16 a[196:197], v2 offset:25504
ds_read_b128 a[8:11], v6 offset:128
v_mfma_f32_16x16x32_bf16 v[60:63], a[104:107], a[24:27], v[60:63]
v_exp_f32 v75, v75
v_mfma_f32_16x16x32_bf16 v[60:63], a[100:103], a[20:23], v[60:63]
ds_read_b64_tr_b16 a[198:199], v2 offset:26016
v_cvt_pk_bf16_f32 v85, v74, v75
v_mfma_f32_16x16x32_bf16 v[60:63], a[96:99], a[16:19], v[60:63]
v_exp_f32 v76, v76
v_accvgpr_read_b32 v32, a245
v_accvgpr_read_b32 v33, a247
v_accvgpr_read_b32 v11, a224
v_mfma_f32_16x16x32_bf16 v[64:67], a[112:115], a[16:19], v[40:43]
ds_read_b64_tr_b16 a[200:201], v2 offset:25536
ds_read_b128 a[12:15], v6 offset:192
v_mfma_f32_16x16x32_bf16 v[64:67], a[116:119], a[20:23], v[64:67]
v_exp_f32 v77, v77
v_mfma_f32_16x16x32_bf16 v[64:67], a[120:123], a[24:27], v[64:67]
ds_read_b64_tr_b16 a[202:203], v2 offset:26048
v_cvt_pk_bf16_f32 v86, v76, v77
v_mfma_f32_16x16x32_bf16 v[64:67], a[124:127], a[28:31], v[64:67]
ds_write_b128 v32, v[240:243]
v_exp_f32 v78, v78
v_mfma_f32_16x16x32_bf16 v[68:71], a[140:143], a[28:31], v[40:43]
ds_read_b64_tr_b16 a[204:205], v2 offset:25568
ds_write_b128 v32, v[244:247] offset:1024
v_mfma_f32_16x16x32_bf16 v[68:71], a[136:139], a[24:27], v[68:71]
v_exp_f32 v79, v79
v_mfma_f32_16x16x32_bf16 v[68:71], a[132:135], a[20:23], v[68:71]
ds_read_b64_tr_b16 a[206:207], v2 offset:26080
v_cvt_pk_bf16_f32 v87, v78, v79
v_mfma_f32_16x16x32_bf16 v[68:71], a[128:131], a[16:19], v[68:71]
ds_write_b128 v32, v[248:251] offset:2048
v_exp_f32 v56, v56
v_mfma_f32_16x16x32_bf16 v[96:99], a[144:147], v[80:83], v[96:99]
s_waitcnt lgkmcnt(14)
ds_read_b128 a[16:19], v6 offset:512
v_mfma_f32_16x16x32_bf16 v[96:99], a[176:179], v[84:87], v[96:99]
ds_write_b128 v32, v[252:255] offset:3072
v_exp_f32 v57, v57
v_accvgpr_read_b32 v40, a238
v_accvgpr_read_b32 v41, a238
v_accvgpr_read_b32 v42, a238
v_mfma_f32_16x16x32_bf16 v[100:103], a[180:183], v[84:87], v[100:103]
ds_read_b128 a[20:23], v6 offset:576
v_cvt_pk_bf16_f32 v88, v56, v57
v_mfma_f32_16x16x32_bf16 v[100:103], a[148:151], v[80:83], v[100:103]
ds_write_b32 v33, v11
v_exp_f32 v58, v58
v_accvgpr_read_b32 v32, a246
v_accvgpr_read_b32 v33, a248
v_mfma_f32_16x16x32_bf16 v[104:107], a[152:155], v[80:83], v[104:107]
ds_read_b128 a[24:27], v6 offset:640
ds_read_b128 a[28:31], v6 offset:704
v_mfma_f32_16x16x32_bf16 v[104:107], a[184:187], v[84:87], v[104:107]
v_exp_f32 v59, v59
v_mfma_f32_16x16x32_bf16 v[108:111], a[188:191], v[84:87], v[108:111]
v_cvt_pk_bf16_f32 v89, v58, v59
v_accvgpr_read_b32 v55, a241
v_mfma_f32_16x16x32_bf16 v[108:111], a[156:159], v[80:83], v[108:111]
s_waitcnt lgkmcnt(2)
v_exp_f32 v60, v60
v_mfma_f32_16x16x32_bf16 v[112:115], a[160:163], v[80:83], v[112:115]
s_waitcnt lgkmcnt(7)
v_accvgpr_read_b32 v36, a237
v_accvgpr_read_b32 v37, a237
v_mfma_f32_16x16x32_bf16 v[112:115], a[192:195], v[84:87], v[112:115]
s_barrier
v_exp_f32 v61, v61
v_mfma_f32_16x16x32_bf16 v[116:119], a[196:199], v[84:87], v[116:119]
s_add_u32 s16, s16, 16384
s_addc_u32 s17, s17, 0
v_cvt_pk_bf16_f32 v90, v60, v61
v_mfma_f32_16x16x32_bf16 v[116:119], a[164:167], v[80:83], v[116:119]
s_add_u32 m0, s33, 50688
v_exp_f32 v62, v62
v_mfma_f32_16x16x32_bf16 v[120:123], a[168:171], v[80:83], v[120:123]
ds_read_b32 v12, v33
ds_read_b128 v[240:243], v32
ds_read_b128 v[244:247], v32 offset:1024
ds_read_b128 v[248:251], v32 offset:2048
ds_read_b128 v[252:255], v32 offset:3072
buffer_load_dwordx4 v3, s[16:19], 0 offen nt lds
v_accvgpr_read_b32 v32, a249
v_mfma_f32_16x16x32_bf16 v[120:123], a[200:203], v[84:87], v[120:123]
s_waitcnt vmcnt(25)
v_exp_f32 v63, v63
v_mfma_f32_16x16x32_bf16 v[124:127], a[204:207], v[84:87], v[124:127]
v_cvt_pk_bf16_f32 v91, v62, v63
v_accvgpr_read_b32 v34, a243
v_mfma_f32_16x16x32_bf16 v[124:127], a[172:175], v[80:83], v[124:127]
s_add_u32 m0, s33, 50720
v_exp_f32 v64, v64
v_mfma_f32_16x16x32_bf16 a[208:211], a[228:231], v[80:83], a[208:211]
buffer_load_dwordx4 v3, s[16:19], 0 offen offset:1024 nt lds
v_mfma_f32_16x16x32_bf16 a[208:211], a[228:231], v[84:87], a[208:211]
v_exp_f32 v65, v65
v_mfma_f32_16x16x32_bf16 v[72:75], a[80:83], a[32:35], v[44:47]
v_cvt_pk_bf16_f32 v92, v64, v65
v_accvgpr_read_b32 v35, a244
v_mfma_f32_16x16x32_bf16 v[72:75], a[84:87], a[36:39], v[72:75]
s_add_u32 m0, s33, 50752
v_exp_f32 v66, v66
v_mfma_f32_16x16x32_bf16 v[72:75], a[88:91], a[40:43], v[72:75]
buffer_load_dwordx4 v3, s[16:19], 0 offen offset:2048 nt lds
v_mfma_f32_16x16x32_bf16 v[72:75], a[92:95], a[44:47], v[72:75]
v_exp_f32 v67, v67
v_mfma_f32_16x16x32_bf16 v[76:79], a[108:111], a[44:47], v[44:47]
v_cvt_pk_bf16_f32 v93, v66, v67
v_accvgpr_read_b32 v38, a237
v_mfma_f32_16x16x32_bf16 v[76:79], a[104:107], a[40:43], v[76:79]
v_exp_f32 v68, v68
v_mfma_f32_16x16x32_bf16 v[76:79], a[100:103], a[36:39], v[76:79]
v_accvgpr_read_b32 v39, a237
v_accvgpr_read_b32 v43, a238
v_mfma_f32_16x16x32_bf16 v[76:79], a[96:99], a[32:35], v[76:79]
s_add_u32 m0, s33, 50784
v_exp_f32 v69, v69
v_mfma_f32_16x16x32_bf16 v[56:59], a[112:115], a[32:35], v[44:47]
s_waitcnt lgkmcnt(0)
v_cvt_pk_bf16_f32 v94, v68, v69
v_add_f32 v11, v11, v12
v_mfma_f32_16x16x32_bf16 v[56:59], a[116:119], a[36:39], v[56:59]
v_exp_f32 v70, v70
v_mfma_f32_16x16x32_bf16 v[56:59], a[120:123], a[40:43], v[56:59]
buffer_load_dwordx4 v3, s[16:19], 0 offen offset:3072 nt lds
v_rcp_f32 v14, v11
v_add_f32 v5, v5, v11
v_add_f32 v5, v5, v14
v_pk_add_f32 v[224:225], v[224:225], v[240:241]
v_pk_add_f32 v[226:227], v[226:227], v[242:243]
v_pk_add_f32 v[228:229], v[228:229], v[244:245]
v_pk_add_f32 v[230:231], v[230:231], v[246:247]
v_pk_add_f32 v[232:233], v[232:233], v[248:249]
v_pk_add_f32 v[234:235], v[234:235], v[250:251]
v_pk_add_f32 v[236:237], v[236:237], v[252:253]
v_pk_add_f32 v[238:239], v[238:239], v[254:255]
v_pk_mul_f32 v[224:225], v[224:225], v[14:15] op_sel_hi:[1,0]
v_pk_mul_f32 v[226:227], v[226:227], v[14:15] op_sel_hi:[1,0]
v_pk_mul_f32 v[228:229], v[228:229], v[14:15] op_sel_hi:[1,0]
v_pk_mul_f32 v[230:231], v[230:231], v[14:15] op_sel_hi:[1,0]
v_pk_mul_f32 v[232:233], v[232:233], v[14:15] op_sel_hi:[1,0]
v_pk_mul_f32 v[234:235], v[234:235], v[14:15] op_sel_hi:[1,0]
v_pk_mul_f32 v[236:237], v[236:237], v[14:15] op_sel_hi:[1,0]
v_pk_mul_f32 v[238:239], v[238:239], v[14:15] op_sel_hi:[1,0]
v_mfma_f32_16x16x32_bf16 v[56:59], a[124:127], a[44:47], v[56:59]
v_exp_f32 v71, v71
v_mfma_f32_16x16x32_bf16 v[60:63], a[140:143], a[44:47], v[44:47]
v_exp_f32 v72, v72
v_mfma_f32_16x16x32_bf16 v[60:63], a[136:139], a[40:43], v[60:63]
v_cvt_pk_bf16_f32 v95, v70, v71
v_cvt_pk_bf16_f32 v224, v224, v225
v_mfma_f32_16x16x32_bf16 v[60:63], a[132:135], a[36:39], v[60:63]
v_exp_f32 v73, v73
v_mfma_f32_16x16x32_bf16 v[60:63], a[128:131], a[32:35], v[60:63]
ds_read_b128 a[32:35], v6 offset:8448
v_cvt_pk_bf16_f32 v80, v72, v73
v_mfma_f32_16x16x32_bf16 v[128:131], a[144:147], v[88:91], v[128:131]
v_exp_f32 v74, v74
v_mfma_f32_16x16x32_bf16 v[128:131], a[176:179], v[92:95], v[128:131]
ds_read_b128 a[36:39], v6 offset:8512
ds_read_b128 a[40:43], v6 offset:8576
v_accvgpr_read_b32 v44, a239
v_accvgpr_read_b32 v45, a239
v_accvgpr_read_b32 v46, a239
v_accvgpr_read_b32 v47, a239
v_mfma_f32_16x16x32_bf16 v[132:135], a[180:183], v[92:95], v[132:135]
v_exp_f32 v75, v75
v_mfma_f32_16x16x32_bf16 v[132:135], a[148:151], v[88:91], v[132:135]
ds_read_b128 a[44:47], v6 offset:8640
v_cvt_pk_bf16_f32 v81, v74, v75
v_mfma_f32_16x16x32_bf16 v[136:139], a[152:155], v[88:91], v[136:139]
v_exp_f32 v76, v76
v_mfma_f32_16x16x32_bf16 v[136:139], a[184:187], v[92:95], v[136:139]
v_cvt_pk_bf16_f32 v225, v226, v227
v_cvt_pk_bf16_f32 v228, v228, v229
v_mfma_f32_16x16x32_bf16 v[140:143], a[188:191], v[92:95], v[140:143]
v_exp_f32 v77, v77
v_mfma_f32_16x16x32_bf16 v[140:143], a[156:159], v[88:91], v[140:143]
ds_write_b64 v32, v[224:225]
v_cvt_pk_bf16_f32 v82, v76, v77
v_cvt_pk_bf16_f32 v229, v230, v231
v_mfma_f32_16x16x32_bf16 v[144:147], a[160:163], v[88:91], v[144:147]
v_exp_f32 v78, v78
v_mfma_f32_16x16x32_bf16 v[144:147], a[192:195], v[92:95], v[144:147]
ds_write_b64 v32, v[228:229] offset:32
v_cvt_pk_bf16_f32 v232, v232, v233
v_cvt_pk_bf16_f32 v233, v234, v235
v_mfma_f32_16x16x32_bf16 v[148:151], a[196:199], v[92:95], v[148:151]
v_exp_f32 v79, v79
v_mfma_f32_16x16x32_bf16 v[148:151], a[164:167], v[88:91], v[148:151]
ds_write_b64 v32, v[232:233] offset:64
v_cvt_pk_bf16_f32 v83, v78, v79
v_cvt_pk_bf16_f32 v236, v236, v237
v_mfma_f32_16x16x32_bf16 v[152:155], a[168:171], v[88:91], v[152:155]
v_exp_f32 v56, v56
v_mfma_f32_16x16x32_bf16 v[152:155], a[200:203], v[92:95], v[152:155]
v_cvt_pk_bf16_f32 v237, v238, v239
v_accvgpr_read_b32 v10, a208
v_mfma_f32_16x16x32_bf16 v[156:159], a[204:207], v[92:95], v[156:159]
s_waitcnt vmcnt(12) lgkmcnt(14)
v_exp_f32 v57, v57
v_mfma_f32_16x16x32_bf16 v[156:159], a[172:175], v[88:91], v[156:159]
ds_write_b64 v32, v[236:237] offset:96
v_cvt_pk_bf16_f32 v84, v56, v57
v_rcp_f32 v14, v10
v_add_f32 v5, v5, v10
v_add_f32 v5, v5, v14
v_pk_mul_f32 v[96:97], v[96:97], v[14:15] op_sel_hi:[1,0]
v_pk_mul_f32 v[98:99], v[98:99], v[14:15] op_sel_hi:[1,0]
v_pk_mul_f32 v[100:101], v[100:101], v[14:15] op_sel_hi:[1,0]
v_pk_mul_f32 v[102:103], v[102:103], v[14:15] op_sel_hi:[1,0]
v_pk_mul_f32 v[104:105], v[104:105], v[14:15] op_sel_hi:[1,0]
v_pk_mul_f32 v[106:107], v[106:107], v[14:15] op_sel_hi:[1,0]
v_pk_mul_f32 v[108:109], v[108:109], v[14:15] op_sel_hi:[1,0]
v_pk_mul_f32 v[110:111], v[110:111], v[14:15] op_sel_hi:[1,0]
v_pk_mul_f32 v[112:113], v[112:113], v[14:15] op_sel_hi:[1,0]
v_pk_mul_f32 v[114:115], v[114:115], v[14:15] op_sel_hi:[1,0]
v_pk_mul_f32 v[116:117], v[116:117], v[14:15] op_sel_hi:[1,0]
v_pk_mul_f32 v[118:119], v[118:119], v[14:15] op_sel_hi:[1,0]
v_pk_mul_f32 v[120:121], v[120:121], v[14:15] op_sel_hi:[1,0]
v_pk_mul_f32 v[122:123], v[122:123], v[14:15] op_sel_hi:[1,0]
v_pk_mul_f32 v[124:125], v[124:125], v[14:15] op_sel_hi:[1,0]
v_pk_mul_f32 v[126:127], v[126:127], v[14:15] op_sel_hi:[1,0]
v_mfma_f32_16x16x32_bf16 a[212:215], a[228:231], v[88:91], a[212:215]
s_barrier
v_exp_f32 v58, v58
v_mfma_f32_16x16x32_bf16 a[212:215], a[228:231], v[92:95], a[212:215]
ds_read_b128 v[16:19], v34
ds_read_b128 v[20:23], v34 offset:64
v_accvgpr_read_b32 v32, a250
v_accvgpr_read_b32 v33, a251
v_mfma_f32_16x16x32_bf16 v[64:67], a[80:83], a[48:51], v[48:51]
v_exp_f32 v59, v59
v_mfma_f32_16x16x32_bf16 v[64:67], a[84:87], a[52:55], v[64:67]
ds_read_b128 a[80:83], v1
v_cvt_pk_bf16_f32 v85, v58, v59
v_mfma_f32_16x16x32_bf16 v[64:67], a[88:91], a[56:59], v[64:67]
v_exp_f32 v60, v60
v_mfma_f32_16x16x32_bf16 v[64:67], a[92:95], a[60:63], v[64:67]
ds_read_b128 a[84:87], v1 offset:64
ds_read_b128 a[88:91], v1 offset:128
ds_read_b128 v[240:243], v32
ds_read_b128 v[244:247], v32 offset:4224
v_mfma_f32_16x16x32_bf16 v[68:71], a[108:111], a[60:63], v[48:51]
v_exp_f32 v61, v61
v_mfma_f32_16x16x32_bf16 v[68:71], a[104:107], a[56:59], v[68:71]
ds_read_b128 a[92:95], v1 offset:192
v_cvt_pk_bf16_f32 v86, v60, v61
v_mfma_f32_16x16x32_bf16 v[68:71], a[100:103], a[52:55], v[68:71]
v_exp_f32 v62, v62
v_mfma_f32_16x16x32_bf16 v[68:71], a[96:99], a[48:51], v[68:71]
ds_read_b128 a[108:111], v1 offset:704
ds_read_b128 v[24:27], v34 offset:128
v_mfma_f32_16x16x32_bf16 v[72:75], a[112:115], a[48:51], v[48:51]
v_exp_f32 v63, v63
v_mfma_f32_16x16x32_bf16 v[72:75], a[116:119], a[52:55], v[72:75]
s_waitcnt lgkmcnt(4)
v_exp_f32 v64, v64
v_mfma_f32_16x16x32_bf16 v[72:75], a[120:123], a[56:59], v[72:75]
ds_read_b128 a[104:107], v1 offset:640
v_cvt_pk_bf16_f32 v87, v62, v63
v_mfma_f32_16x16x32_bf16 v[72:75], a[124:127], a[60:63], v[72:75]
v_exp_f32 v65, v65
v_mfma_f32_16x16x32_bf16 v[76:79], a[140:143], a[60:63], v[48:51]
ds_read_b128 a[100:103], v1 offset:576
v_cvt_pk_bf16_f32 v88, v64, v65
v_mfma_f32_16x16x32_bf16 v[76:79], a[136:139], a[56:59], v[76:79]
v_exp_f32 v66, v66
v_mfma_f32_16x16x32_bf16 v[76:79], a[132:135], a[52:55], v[76:79]
ds_read_b128 a[96:99], v1 offset:512
ds_read_b128 v[28:31], v34 offset:192
v_mfma_f32_16x16x32_bf16 v[76:79], a[128:131], a[48:51], v[76:79]
v_exp_f32 v67, v67
v_mfma_f32_16x16x32_bf16 v[160:163], a[144:147], v[80:83], v[160:163]
ds_read_b128 a[112:115], v1 offset:8448
v_cvt_pk_bf16_f32 v89, v66, v67
v_mfma_f32_16x16x32_bf16 v[160:163], a[176:179], v[84:87], v[160:163]
buffer_store_dwordx4 v[240:243], v33, s[28:31], s43 offen sc0 sc1
v_exp_f32 v68, v68
v_accvgpr_read_b32 v48, a240
v_accvgpr_read_b32 v49, a240
v_accvgpr_read_b32 v50, a240
v_accvgpr_read_b32 v51, a240
v_mfma_f32_16x16x32_bf16 v[164:167], a[180:183], v[84:87], v[164:167]
ds_read_b128 a[116:119], v1 offset:8512
ds_read_b128 a[48:51], v6 offset:8960
v_mfma_f32_16x16x32_bf16 v[164:167], a[148:151], v[80:83], v[164:167]
s_add_u32 s43, s43, 4096
v_exp_f32 v69, v69
v_mfma_f32_16x16x32_bf16 v[168:171], a[152:155], v[80:83], v[168:171]
ds_read_b128 a[120:123], v1 offset:8576
v_cvt_pk_bf16_f32 v90, v68, v69
v_mfma_f32_16x16x32_bf16 v[168:171], a[184:187], v[84:87], v[168:171]
s_waitcnt lgkmcnt(11)
v_exp_f32 v70, v70
v_mfma_f32_16x16x32_bf16 v[172:175], a[188:191], v[84:87], v[172:175]
ds_read_b128 a[124:127], v1 offset:8640
ds_read_b128 a[52:55], v6 offset:9024
v_mfma_f32_16x16x32_bf16 v[172:175], a[156:159], v[80:83], v[172:175]
s_waitcnt lgkmcnt(6)
buffer_store_dwordx4 v[244:247], v33, s[28:31], s43 offen sc0 sc1
v_exp_f32 v71, v71
v_bitop3_b32 v16, v16, v35, s41 bitop3:0x28
v_bitop3_b32 v17, v17, v35, s41 bitop3:0x28
v_bitop3_b32 v18, v18, v35, s41 bitop3:0x28
v_bitop3_b32 v19, v19, v35, s41 bitop3:0x28
v_bitop3_b32 v20, v20, v35, s41 bitop3:0x28
v_bitop3_b32 v21, v21, v35, s41 bitop3:0x28
v_bitop3_b32 v22, v22, v35, s41 bitop3:0x28
v_bitop3_b32 v23, v23, v35, s41 bitop3:0x28
v_bitop3_b32 v24, v24, v35, s41 bitop3:0x28
v_bitop3_b32 v25, v25, v35, s41 bitop3:0x28
v_bitop3_b32 v26, v26, v35, s41 bitop3:0x28
v_bitop3_b32 v27, v27, v35, s41 bitop3:0x28
v_bitop3_b32 v28, v28, v35, s41 bitop3:0x28
v_bitop3_b32 v29, v29, v35, s41 bitop3:0x28
v_bitop3_b32 v30, v30, v35, s41 bitop3:0x28
v_bitop3_b32 v31, v31, v35, s41 bitop3:0x28
v_mfma_f32_16x16x32_bf16 v[176:179], a[160:163], v[80:83], v[176:179]
ds_read_b128 a[140:143], v1 offset:9152
v_cvt_pk_bf16_f32 v91, v70, v71
v_mfma_f32_16x16x32_bf16 v[176:179], a[192:195], v[84:87], v[176:179]
s_add_u32 s43, s43, 18870272
v_exp_f32 v72, v72
v_mfma_f32_16x16x32_bf16 v[180:183], a[196:199], v[84:87], v[180:183]
ds_read_b128 a[136:139], v1 offset:9088
ds_read_b128 a[56:59], v6 offset:9088
v_mfma_f32_16x16x32_bf16 v[180:183], a[164:167], v[80:83], v[180:183]
v_exp_f32 v73, v73
v_mfma_f32_16x16x32_bf16 v[184:187], a[168:171], v[80:83], v[184:187]
ds_read_b128 a[132:135], v1 offset:9024
v_cvt_pk_bf16_f32 v92, v72, v73
v_mfma_f32_16x16x32_bf16 v[184:187], a[200:203], v[84:87], v[184:187]
v_exp_f32 v74, v74
v_mfma_f32_16x16x32_bf16 v[188:191], a[204:207], v[84:87], v[188:191]
ds_read_b128 a[128:131], v1 offset:8960
ds_read_b128 a[60:63], v6 offset:9152
v_mfma_f32_16x16x32_bf16 v[188:191], a[172:175], v[80:83], v[188:191]
v_exp_f32 v75, v75
v_mfma_f32_16x16x32_bf16 a[216:219], a[228:231], v[80:83], a[216:219]
s_waitcnt lgkmcnt(13)
v_cvt_pk_bf16_f32 v93, v74, v75
v_cvt_pk_bf16_f32 v96, v96, v97
v_mfma_f32_16x16x32_bf16 a[216:219], a[228:231], v[84:87], a[216:219]
s_waitcnt lgkmcnt(14)
v_exp_f32 v76, v76
v_mfma_f32_16x16x32_bf16 v[52:55], v[16:19], a[64:67], v[52:55]
v_cvt_pk_bf16_f32 v97, v98, v99
v_cvt_pk_bf16_f32 v100, v100, v101
v_mfma_f32_16x16x32_bf16 v[52:55], v[20:23], a[68:71], v[52:55]
v_cvt_pk_bf16_f32 v101, v102, v103
v_cvt_pk_bf16_f32 v104, v104, v105
v_mfma_f32_16x16x32_bf16 v[52:55], v[24:27], a[72:75], v[52:55]
v_cvt_pk_bf16_f32 v105, v106, v107
v_cvt_pk_bf16_f32 v108, v108, v109
v_mfma_f32_16x16x32_bf16 v[52:55], v[28:31], a[76:79], v[52:55]
v_cvt_pk_bf16_f32 v109, v110, v111
v_cvt_pk_bf16_f32 v112, v112, v113
v_mfma_f32_16x16x32_bf16 v[56:59], a[80:83], a[64:67], v[52:55]
v_cvt_pk_bf16_f32 v113, v114, v115
v_cvt_pk_bf16_f32 v116, v116, v117
v_mfma_f32_16x16x32_bf16 v[56:59], a[84:87], a[68:71], v[56:59]
v_exp_f32 v77, v77
v_mfma_f32_16x16x32_bf16 v[56:59], a[88:91], a[72:75], v[56:59]
v_cvt_pk_bf16_f32 v94, v76, v77
v_cvt_pk_bf16_f32 v117, v118, v119
v_mfma_f32_16x16x32_bf16 v[56:59], a[92:95], a[76:79], v[56:59]
ds_write_b64 v7, v[96:97]
v_exp_f32 v78, v78
v_mfma_f32_16x16x32_bf16 v[60:63], a[108:111], a[76:79], v[52:55]
ds_write_b64 v7, v[100:101] offset:32
v_mfma_f32_16x16x32_bf16 v[60:63], a[104:107], a[72:75], v[60:63]
s_waitcnt vmcnt(10) lgkmcnt(3)
v_exp_f32 v79, v79
v_mfma_f32_16x16x32_bf16 v[60:63], a[100:103], a[68:71], v[60:63]
v_cvt_pk_bf16_f32 v95, v78, v79
v_cvt_pk_bf16_f32 v120, v120, v121
v_mfma_f32_16x16x32_bf16 v[60:63], a[96:99], a[64:67], v[60:63]
s_barrier
s_add_u32 s12, s12, 16384
s_addc_u32 s13, s13, 0
v_mfma_f32_16x16x32_bf16 v[192:195], a[144:147], v[88:91], v[192:195]
ds_read_b64_tr_b16 a[144:145], v2
v_cvt_pk_bf16_f32 v121, v122, v123
v_mfma_f32_16x16x32_bf16 v[192:195], a[176:179], v[92:95], v[192:195]
ds_write_b64 v7, v[104:105] offset:64
v_exp_f32 v56, v56
v_mfma_f32_16x16x32_bf16 v[196:199], a[180:183], v[92:95], v[196:199]
ds_read_b64_tr_b16 a[146:147], v2 offset:512
v_cvt_pk_bf16_f32 v124, v124, v125
v_mfma_f32_16x16x32_bf16 v[196:199], a[148:151], v[88:91], v[196:199]
ds_read_b64_tr_b16 a[148:149], v2 offset:32
ds_write_b64 v7, v[108:109] offset:96
v_cvt_pk_bf16_f32 v125, v126, v127
v_mfma_f32_16x16x32_bf16 v[200:203], a[152:155], v[88:91], v[200:203]
s_add_u32 m0, s33, 0
v_exp_f32 v57, v57
v_mfma_f32_16x16x32_bf16 v[200:203], a[184:187], v[92:95], v[200:203]
ds_read_b64_tr_b16 a[150:151], v2 offset:544
ds_write_b64 v7, v[112:113] offset:128
v_cvt_pk_bf16_f32 v80, v56, v57
v_mfma_f32_16x16x32_bf16 v[204:207], a[188:191], v[92:95], v[204:207]
buffer_load_dwordx4 v3, s[12:15], 0 offen nt lds
ds_write_b64 v7, v[116:117] offset:160
v_mfma_f32_16x16x32_bf16 v[204:207], a[156:159], v[88:91], v[204:207]
ds_write_b64 v7, v[120:121] offset:192
v_exp_f32 v58, v58
v_mfma_f32_16x16x32_bf16 v[208:211], a[160:163], v[88:91], v[208:211]
ds_read_b64_tr_b16 a[152:153], v2 offset:64
v_accvgpr_read_b32 v10, a212
v_mfma_f32_16x16x32_bf16 v[208:211], a[192:195], v[92:95], v[208:211]
ds_read_b64_tr_b16 a[154:155], v2 offset:576
ds_write_b64 v7, v[124:125] offset:224
v_rcp_f32 v14, v10
v_add_f32 v5, v5, v10
v_add_f32 v5, v5, v14
v_pk_mul_f32 v[128:129], v[128:129], v[14:15] op_sel_hi:[1,0]
v_pk_mul_f32 v[130:131], v[130:131], v[14:15] op_sel_hi:[1,0]
v_pk_mul_f32 v[132:133], v[132:133], v[14:15] op_sel_hi:[1,0]
v_pk_mul_f32 v[134:135], v[134:135], v[14:15] op_sel_hi:[1,0]
v_pk_mul_f32 v[136:137], v[136:137], v[14:15] op_sel_hi:[1,0]
v_pk_mul_f32 v[138:139], v[138:139], v[14:15] op_sel_hi:[1,0]
v_pk_mul_f32 v[140:141], v[140:141], v[14:15] op_sel_hi:[1,0]
v_pk_mul_f32 v[142:143], v[142:143], v[14:15] op_sel_hi:[1,0]
v_pk_mul_f32 v[144:145], v[144:145], v[14:15] op_sel_hi:[1,0]
v_pk_mul_f32 v[146:147], v[146:147], v[14:15] op_sel_hi:[1,0]
v_pk_mul_f32 v[148:149], v[148:149], v[14:15] op_sel_hi:[1,0]
v_pk_mul_f32 v[150:151], v[150:151], v[14:15] op_sel_hi:[1,0]
v_pk_mul_f32 v[152:153], v[152:153], v[14:15] op_sel_hi:[1,0]
v_pk_mul_f32 v[154:155], v[154:155], v[14:15] op_sel_hi:[1,0]
v_pk_mul_f32 v[156:157], v[156:157], v[14:15] op_sel_hi:[1,0]
v_pk_mul_f32 v[158:159], v[158:159], v[14:15] op_sel_hi:[1,0]
v_mfma_f32_16x16x32_bf16 v[212:215], a[196:199], v[92:95], v[212:215]
v_exp_f32 v59, v59
v_mfma_f32_16x16x32_bf16 v[212:215], a[164:167], v[88:91], v[212:215]
ds_read_b64_tr_b16 a[156:157], v2 offset:96
v_cvt_pk_bf16_f32 v81, v58, v59
v_mfma_f32_16x16x32_bf16 v[216:219], a[168:171], v[88:91], v[216:219]
ds_read_b64_tr_b16 a[158:159], v2 offset:608
v_cvt_pk_bf16_f32 v128, v128, v129
v_mfma_f32_16x16x32_bf16 v[216:219], a[200:203], v[92:95], v[216:219]
s_add_u32 m0, s33, 32
v_exp_f32 v60, v60
v_mfma_f32_16x16x32_bf16 v[220:223], a[204:207], v[92:95], v[220:223]
buffer_load_dwordx4 v3, s[12:15], 0 offen offset:1024 nt lds
v_mfma_f32_16x16x32_bf16 v[220:223], a[172:175], v[88:91], v[220:223]
ds_read_b64_tr_b16 a[160:161], v2 offset:128
v_cvt_pk_bf16_f32 v129, v130, v131
v_mfma_f32_16x16x32_bf16 a[220:223], a[228:231], v[88:91], a[220:223]
s_waitcnt lgkmcnt(14)
v_exp_f32 v61, v61
v_mfma_f32_16x16x32_bf16 a[220:223], a[228:231], v[92:95], a[220:223]
ds_read_b64_tr_b16 a[162:163], v2 offset:640
v_cvt_pk_bf16_f32 v82, v60, v61
v_mfma_f32_16x16x32_bf16 v[36:39], v[16:19], a[0:3], v[36:39]
ds_read_b64_tr_b16 a[164:165], v2 offset:160
v_cvt_pk_bf16_f32 v132, v132, v133
v_mfma_f32_16x16x32_bf16 v[36:39], v[20:23], a[4:7], v[36:39]
ds_read_b64_tr_b16 a[166:167], v2 offset:672
v_cvt_pk_bf16_f32 v133, v134, v135
v_mfma_f32_16x16x32_bf16 v[36:39], v[24:27], a[8:11], v[36:39]
ds_read_b64_tr_b16 a[168:169], v2 offset:192
v_cvt_pk_bf16_f32 v136, v136, v137
v_mfma_f32_16x16x32_bf16 v[36:39], v[28:31], a[12:15], v[36:39]
ds_read_b64_tr_b16 a[170:171], v2 offset:704
v_cvt_pk_bf16_f32 v137, v138, v139
v_mfma_f32_16x16x32_bf16 v[64:67], a[80:83], a[0:3], v[36:39]
ds_read_b64_tr_b16 a[172:173], v2 offset:224
v_cvt_pk_bf16_f32 v140, v140, v141
v_mfma_f32_16x16x32_bf16 v[64:67], a[84:87], a[4:7], v[64:67]
v_exp_f32 v62, v62
v_mfma_f32_16x16x32_bf16 v[64:67], a[88:91], a[8:11], v[64:67]
ds_read_b64_tr_b16 a[174:175], v2 offset:736
v_cvt_pk_bf16_f32 v141, v142, v143
v_mfma_f32_16x16x32_bf16 v[64:67], a[92:95], a[12:15], v[64:67]
ds_read_b64_tr_b16 a[176:177], v2 offset:8448
v_cvt_pk_bf16_f32 v144, v144, v145
v_mfma_f32_16x16x32_bf16 v[68:71], a[108:111], a[12:15], v[36:39]
s_add_u32 m0, s33, 64
v_exp_f32 v63, v63
v_mfma_f32_16x16x32_bf16 v[68:71], a[104:107], a[8:11], v[68:71]
ds_read_b64_tr_b16 a[178:179], v2 offset:8960
v_cvt_pk_bf16_f32 v83, v62, v63
v_mfma_f32_16x16x32_bf16 v[68:71], a[100:103], a[4:7], v[68:71]
buffer_load_dwordx4 v3, s[12:15], 0 offen offset:2048 nt lds
v_mfma_f32_16x16x32_bf16 v[68:71], a[96:99], a[0:3], v[68:71]
ds_read_b64_tr_b16 a[180:181], v2 offset:8480
v_cvt_pk_bf16_f32 v145, v146, v147
v_mfma_f32_16x16x32_bf16 v[72:75], a[112:115], a[0:3], v[36:39]
v_exp_f32 v64, v64
v_mfma_f32_16x16x32_bf16 v[72:75], a[116:119], a[4:7], v[72:75]
ds_read_b64_tr_b16 a[182:183], v2 offset:8992
v_cvt_pk_bf16_f32 v148, v148, v149
v_mfma_f32_16x16x32_bf16 v[72:75], a[120:123], a[8:11], v[72:75]
v_exp_f32 v65, v65
v_mfma_f32_16x16x32_bf16 v[72:75], a[124:127], a[12:15], v[72:75]
ds_read_b64_tr_b16 a[184:185], v2 offset:8512
v_cvt_pk_bf16_f32 v88, v64, v65
v_mfma_f32_16x16x32_bf16 v[76:79], a[140:143], a[12:15], v[36:39]
v_exp_f32 v66, v66
v_mfma_f32_16x16x32_bf16 v[76:79], a[136:139], a[8:11], v[76:79]
s_waitcnt lgkmcnt(13)
ds_read_b64_tr_b16 a[186:187], v2 offset:9024
v_mfma_f32_16x16x32_bf16 v[76:79], a[132:135], a[4:7], v[76:79]
s_add_u32 m0, s33, 96
v_exp_f32 v67, v67
v_mfma_f32_16x16x32_bf16 v[76:79], a[128:131], a[0:3], v[76:79]
ds_read_b64_tr_b16 a[188:189], v2 offset:8544
v_cvt_pk_bf16_f32 v89, v66, v67
v_mfma_f32_16x16x32_bf16 v[224:227], a[144:147], v[80:83], 0
v_exp_f32 v68, v68
v_mfma_f32_16x16x32_bf16 v[228:231], a[148:151], v[80:83], 0
buffer_load_dwordx4 v3, s[12:15], 0 offen offset:3072 nt lds
v_mfma_f32_16x16x32_bf16 v[232:235], a[152:155], v[80:83], 0
s_waitcnt lgkmcnt(7)
v_exp_f32 v69, v69
v_mfma_f32_16x16x32_bf16 v[236:239], a[156:159], v[80:83], 0
ds_read_b64_tr_b16 a[190:191], v2 offset:9056
v_cvt_pk_bf16_f32 v90, v68, v69
v_mfma_f32_16x16x32_bf16 v[240:243], a[160:163], v[80:83], 0
v_exp_f32 v70, v70
v_mfma_f32_16x16x32_bf16 v[244:247], a[164:167], v[80:83], 0
ds_read_b64_tr_b16 a[192:193], v2 offset:8576
v_cvt_pk_bf16_f32 v149, v150, v151
v_mfma_f32_16x16x32_bf16 v[248:251], a[168:171], v[80:83], 0
v_exp_f32 v71, v71
v_mfma_f32_16x16x32_bf16 v[252:255], a[172:175], v[80:83], 0
ds_read_b64_tr_b16 a[194:195], v2 offset:9088
v_cvt_pk_bf16_f32 v91, v70, v71
v_mfma_f32_16x16x32_bf16 a[224:227], a[228:231], v[80:83], 0
s_waitcnt lgkmcnt(14)
v_exp_f32 v72, v72
v_mfma_f32_16x16x32_bf16 v[40:43], v[16:19], a[16:19], v[40:43]
ds_read_b64_tr_b16 a[196:197], v2 offset:8608
v_cvt_pk_bf16_f32 v152, v152, v153
v_mfma_f32_16x16x32_bf16 v[40:43], v[20:23], a[20:23], v[40:43]
ds_read_b64_tr_b16 a[198:199], v2 offset:9120
v_cvt_pk_bf16_f32 v153, v154, v155
v_mfma_f32_16x16x32_bf16 v[40:43], v[24:27], a[24:27], v[40:43]
ds_write_b64 v7, v[128:129] offset:512
v_mfma_f32_16x16x32_bf16 v[40:43], v[28:31], a[28:31], v[40:43]
ds_write_b64 v7, v[132:133] offset:544
v_mfma_f32_16x16x32_bf16 v[56:59], a[80:83], a[16:19], v[40:43]
ds_write_b64 v7, v[136:137] offset:576
v_mfma_f32_16x16x32_bf16 v[56:59], a[84:87], a[20:23], v[56:59]
v_exp_f32 v73, v73
v_mfma_f32_16x16x32_bf16 v[56:59], a[88:91], a[24:27], v[56:59]
ds_read_b64_tr_b16 a[200:201], v2 offset:8640
v_cvt_pk_bf16_f32 v92, v72, v73
v_mfma_f32_16x16x32_bf16 v[56:59], a[92:95], a[28:31], v[56:59]
v_exp_f32 v74, v74
v_mfma_f32_16x16x32_bf16 v[60:63], a[108:111], a[28:31], v[40:43]
ds_write_b64 v7, v[140:141] offset:608
v_mfma_f32_16x16x32_bf16 v[60:63], a[104:107], a[24:27], v[60:63]
v_exp_f32 v75, v75
v_mfma_f32_16x16x32_bf16 v[60:63], a[100:103], a[20:23], v[60:63]
ds_read_b64_tr_b16 a[202:203], v2 offset:9152
v_cvt_pk_bf16_f32 v93, v74, v75
v_mfma_f32_16x16x32_bf16 v[60:63], a[96:99], a[16:19], v[60:63]
v_exp_f32 v76, v76
v_mfma_f32_16x16x32_bf16 v[64:67], a[112:115], a[16:19], v[40:43]
ds_write_b64 v7, v[144:145] offset:640
v_mfma_f32_16x16x32_bf16 v[64:67], a[116:119], a[20:23], v[64:67]
v_exp_f32 v77, v77
v_mfma_f32_16x16x32_bf16 v[64:67], a[120:123], a[24:27], v[64:67]
ds_read_b64_tr_b16 a[204:205], v2 offset:8672
v_cvt_pk_bf16_f32 v94, v76, v77
v_mfma_f32_16x16x32_bf16 v[64:67], a[124:127], a[28:31], v[64:67]
v_exp_f32 v78, v78
v_mfma_f32_16x16x32_bf16 v[68:71], a[140:143], a[28:31], v[40:43]
ds_write_b64 v7, v[148:149] offset:672
v_mfma_f32_16x16x32_bf16 v[68:71], a[136:139], a[24:27], v[68:71]
v_exp_f32 v79, v79
v_mfma_f32_16x16x32_bf16 v[68:71], a[132:135], a[20:23], v[68:71]
ds_read_b64_tr_b16 a[206:207], v2 offset:9184
v_cvt_pk_bf16_f32 v95, v78, v79
v_mfma_f32_16x16x32_bf16 v[68:71], a[128:131], a[16:19], v[68:71]
v_exp_f32 v56, v56
v_mfma_f32_16x16x32_bf16 v[96:99], a[144:147], v[88:91], 0
s_waitcnt lgkmcnt(14)
v_cvt_pk_bf16_f32 v156, v156, v157
v_cvt_pk_bf16_f32 v157, v158, v159
v_mfma_f32_16x16x32_bf16 v[96:99], a[176:179], v[92:95], v[96:99]
v_exp_f32 v57, v57
v_mfma_f32_16x16x32_bf16 v[100:103], a[180:183], v[92:95], 0
v_cvt_pk_bf16_f32 v80, v56, v57
v_accvgpr_read_b32 v10, a216
v_mfma_f32_16x16x32_bf16 v[100:103], a[148:151], v[88:91], v[100:103]
v_exp_f32 v58, v58
v_mfma_f32_16x16x32_bf16 v[104:107], a[152:155], v[88:91], 0
ds_write_b64 v7, v[152:153] offset:704
v_mfma_f32_16x16x32_bf16 v[104:107], a[184:187], v[92:95], v[104:107]
v_exp_f32 v59, v59
v_mfma_f32_16x16x32_bf16 v[108:111], a[188:191], v[92:95], 0
ds_write_b64 v7, v[156:157] offset:736
v_cvt_pk_bf16_f32 v81, v58, v59
v_mfma_f32_16x16x32_bf16 v[108:111], a[156:159], v[88:91], v[108:111]
s_waitcnt lgkmcnt(2)
v_exp_f32 v60, v60
v_mfma_f32_16x16x32_bf16 v[112:115], a[160:163], v[88:91], 0
s_waitcnt lgkmcnt(2)
v_rcp_f32 v14, v10
v_mfma_f32_16x16x32_bf16 v[112:115], a[192:195], v[92:95], v[112:115]
s_barrier
v_exp_f32 v61, v61
v_mfma_f32_16x16x32_bf16 v[116:119], a[196:199], v[92:95], 0
s_add_u32 s16, s16, 16384
s_addc_u32 s17, s17, 0
v_cvt_pk_bf16_f32 v82, v60, v61
v_mfma_f32_16x16x32_bf16 v[116:119], a[164:167], v[88:91], v[116:119]
s_add_u32 m0, s33, 33792
v_exp_f32 v62, v62
v_mfma_f32_16x16x32_bf16 v[120:123], a[168:171], v[88:91], 0
buffer_load_dwordx4 v3, s[16:19], 0 offen nt lds
v_add_f32 v5, v5, v10
v_add_f32 v5, v5, v14
v_pk_mul_f32 v[160:161], v[160:161], v[14:15] op_sel_hi:[1,0]
v_pk_mul_f32 v[162:163], v[162:163], v[14:15] op_sel_hi:[1,0]
v_pk_mul_f32 v[164:165], v[164:165], v[14:15] op_sel_hi:[1,0]
v_pk_mul_f32 v[166:167], v[166:167], v[14:15] op_sel_hi:[1,0]
v_pk_mul_f32 v[168:169], v[168:169], v[14:15] op_sel_hi:[1,0]
v_pk_mul_f32 v[170:171], v[170:171], v[14:15] op_sel_hi:[1,0]
v_pk_mul_f32 v[172:173], v[172:173], v[14:15] op_sel_hi:[1,0]
v_pk_mul_f32 v[174:175], v[174:175], v[14:15] op_sel_hi:[1,0]
v_pk_mul_f32 v[176:177], v[176:177], v[14:15] op_sel_hi:[1,0]
v_pk_mul_f32 v[178:179], v[178:179], v[14:15] op_sel_hi:[1,0]
v_pk_mul_f32 v[180:181], v[180:181], v[14:15] op_sel_hi:[1,0]
v_pk_mul_f32 v[182:183], v[182:183], v[14:15] op_sel_hi:[1,0]
v_pk_mul_f32 v[184:185], v[184:185], v[14:15] op_sel_hi:[1,0]
v_pk_mul_f32 v[186:187], v[186:187], v[14:15] op_sel_hi:[1,0]
v_pk_mul_f32 v[188:189], v[188:189], v[14:15] op_sel_hi:[1,0]
v_pk_mul_f32 v[190:191], v[190:191], v[14:15] op_sel_hi:[1,0]
v_mfma_f32_16x16x32_bf16 v[120:123], a[200:203], v[92:95], v[120:123]
v_exp_f32 v63, v63
v_mfma_f32_16x16x32_bf16 v[124:127], a[204:207], v[92:95], 0
v_cvt_pk_bf16_f32 v83, v62, v63
v_cvt_pk_bf16_f32 v160, v160, v161
v_mfma_f32_16x16x32_bf16 v[124:127], a[172:175], v[88:91], v[124:127]
s_add_u32 m0, s33, 33824
v_exp_f32 v64, v64
v_mfma_f32_16x16x32_bf16 a[208:211], a[228:231], v[88:91], 0
buffer_load_dwordx4 v3, s[16:19], 0 offen offset:1024 nt lds
v_mfma_f32_16x16x32_bf16 a[208:211], a[228:231], v[92:95], a[208:211]
s_waitcnt lgkmcnt(14)
v_exp_f32 v65, v65
v_mfma_f32_16x16x32_bf16 v[44:47], v[16:19], a[32:35], v[44:47]
v_cvt_pk_bf16_f32 v161, v162, v163
v_cvt_pk_bf16_f32 v164, v164, v165
v_mfma_f32_16x16x32_bf16 v[44:47], v[20:23], a[36:39], v[44:47]
v_cvt_pk_bf16_f32 v165, v166, v167
v_cvt_pk_bf16_f32 v168, v168, v169
v_mfma_f32_16x16x32_bf16 v[44:47], v[24:27], a[40:43], v[44:47]
v_cvt_pk_bf16_f32 v169, v170, v171
v_cvt_pk_bf16_f32 v172, v172, v173
v_mfma_f32_16x16x32_bf16 v[44:47], v[28:31], a[44:47], v[44:47]
v_cvt_pk_bf16_f32 v173, v174, v175
v_cvt_pk_bf16_f32 v176, v176, v177
v_mfma_f32_16x16x32_bf16 v[72:75], a[80:83], a[32:35], v[44:47]
v_cvt_pk_bf16_f32 v84, v64, v65
v_cvt_pk_bf16_f32 v177, v178, v179
v_mfma_f32_16x16x32_bf16 v[72:75], a[84:87], a[36:39], v[72:75]
s_add_u32 m0, s33, 33856
v_exp_f32 v66, v66
v_mfma_f32_16x16x32_bf16 v[72:75], a[88:91], a[40:43], v[72:75]
buffer_load_dwordx4 v3, s[16:19], 0 offen offset:2048 nt lds
ds_write_b64 v7, v[160:161] offset:8448
v_mfma_f32_16x16x32_bf16 v[72:75], a[92:95], a[44:47], v[72:75]
ds_write_b64 v7, v[164:165] offset:8480
v_exp_f32 v67, v67
v_mfma_f32_16x16x32_bf16 v[76:79], a[108:111], a[44:47], v[44:47]
v_cvt_pk_bf16_f32 v85, v66, v67
v_cvt_pk_bf16_f32 v180, v180, v181
v_mfma_f32_16x16x32_bf16 v[76:79], a[104:107], a[40:43], v[76:79]
v_exp_f32 v68, v68
v_mfma_f32_16x16x32_bf16 v[76:79], a[100:103], a[36:39], v[76:79]
v_cvt_pk_bf16_f32 v181, v182, v183
v_cvt_pk_bf16_f32 v184, v184, v185
v_mfma_f32_16x16x32_bf16 v[76:79], a[96:99], a[32:35], v[76:79]
s_add_u32 m0, s33, 33888
v_exp_f32 v69, v69
v_mfma_f32_16x16x32_bf16 v[56:59], a[112:115], a[32:35], v[44:47]
v_cvt_pk_bf16_f32 v86, v68, v69
v_cvt_pk_bf16_f32 v185, v186, v187
v_mfma_f32_16x16x32_bf16 v[56:59], a[116:119], a[36:39], v[56:59]
v_exp_f32 v70, v70
v_mfma_f32_16x16x32_bf16 v[56:59], a[120:123], a[40:43], v[56:59]
buffer_load_dwordx4 v3, s[16:19], 0 offen offset:3072 nt lds
v_mfma_f32_16x16x32_bf16 v[56:59], a[124:127], a[44:47], v[56:59]
v_exp_f32 v71, v71
v_mfma_f32_16x16x32_bf16 v[60:63], a[140:143], a[44:47], v[44:47]
v_exp_f32 v72, v72
v_mfma_f32_16x16x32_bf16 v[60:63], a[136:139], a[40:43], v[60:63]
v_cvt_pk_bf16_f32 v87, v70, v71
v_cvt_pk_bf16_f32 v188, v188, v189
v_mfma_f32_16x16x32_bf16 v[60:63], a[132:135], a[36:39], v[60:63]
v_exp_f32 v73, v73
v_mfma_f32_16x16x32_bf16 v[60:63], a[128:131], a[32:35], v[60:63]
v_cvt_pk_bf16_f32 v88, v72, v73
v_cvt_pk_bf16_f32 v189, v190, v191
v_mfma_f32_16x16x32_bf16 v[128:131], a[144:147], v[80:83], 0
v_exp_f32 v74, v74
v_mfma_f32_16x16x32_bf16 v[128:131], a[176:179], v[84:87], v[128:131]
ds_write_b64 v7, v[168:169] offset:8512
v_mfma_f32_16x16x32_bf16 v[132:135], a[180:183], v[84:87], 0
v_exp_f32 v75, v75
v_mfma_f32_16x16x32_bf16 v[132:135], a[148:151], v[80:83], v[132:135]
v_cvt_pk_bf16_f32 v89, v74, v75
v_accvgpr_read_b32 v10, a220
v_mfma_f32_16x16x32_bf16 v[136:139], a[152:155], v[80:83], 0
v_exp_f32 v76, v76
v_mfma_f32_16x16x32_bf16 v[136:139], a[184:187], v[84:87], v[136:139]
ds_write_b64 v7, v[172:173] offset:8544
v_mfma_f32_16x16x32_bf16 v[140:143], a[188:191], v[84:87], 0
v_exp_f32 v77, v77
v_mfma_f32_16x16x32_bf16 v[140:143], a[156:159], v[80:83], v[140:143]
v_cvt_pk_bf16_f32 v90, v76, v77
v_rcp_f32 v14, v10
v_add_f32 v5, v5, v10
v_add_f32 v5, v5, v14
v_pk_mul_f32 v[192:193], v[192:193], v[14:15] op_sel_hi:[1,0]
v_pk_mul_f32 v[194:195], v[194:195], v[14:15] op_sel_hi:[1,0]
v_pk_mul_f32 v[196:197], v[196:197], v[14:15] op_sel_hi:[1,0]
v_pk_mul_f32 v[198:199], v[198:199], v[14:15] op_sel_hi:[1,0]
v_pk_mul_f32 v[200:201], v[200:201], v[14:15] op_sel_hi:[1,0]
v_pk_mul_f32 v[202:203], v[202:203], v[14:15] op_sel_hi:[1,0]
v_pk_mul_f32 v[204:205], v[204:205], v[14:15] op_sel_hi:[1,0]
v_pk_mul_f32 v[206:207], v[206:207], v[14:15] op_sel_hi:[1,0]
v_pk_mul_f32 v[208:209], v[208:209], v[14:15] op_sel_hi:[1,0]
v_pk_mul_f32 v[210:211], v[210:211], v[14:15] op_sel_hi:[1,0]
v_pk_mul_f32 v[212:213], v[212:213], v[14:15] op_sel_hi:[1,0]
v_pk_mul_f32 v[214:215], v[214:215], v[14:15] op_sel_hi:[1,0]
v_pk_mul_f32 v[216:217], v[216:217], v[14:15] op_sel_hi:[1,0]
v_pk_mul_f32 v[218:219], v[218:219], v[14:15] op_sel_hi:[1,0]
v_pk_mul_f32 v[220:221], v[220:221], v[14:15] op_sel_hi:[1,0]
v_pk_mul_f32 v[222:223], v[222:223], v[14:15] op_sel_hi:[1,0]
v_mfma_f32_16x16x32_bf16 v[144:147], a[160:163], v[80:83], 0
v_exp_f32 v78, v78
v_mfma_f32_16x16x32_bf16 v[144:147], a[192:195], v[84:87], v[144:147]
ds_write_b64 v7, v[176:177] offset:8576
v_mfma_f32_16x16x32_bf16 v[148:151], a[196:199], v[84:87], 0
v_exp_f32 v79, v79
v_mfma_f32_16x16x32_bf16 v[148:151], a[164:167], v[80:83], v[148:151]
v_cvt_pk_bf16_f32 v91, v78, v79
v_cvt_pk_bf16_f32 v192, v192, v193
v_mfma_f32_16x16x32_bf16 v[152:155], a[168:171], v[80:83], 0
v_exp_f32 v56, v56
v_mfma_f32_16x16x32_bf16 v[152:155], a[200:203], v[84:87], v[152:155]
ds_write_b64 v7, v[180:181] offset:8608
v_mfma_f32_16x16x32_bf16 v[156:159], a[204:207], v[84:87], 0
s_waitcnt vmcnt(14) lgkmcnt(8)
v_exp_f32 v57, v57
v_mfma_f32_16x16x32_bf16 v[156:159], a[172:175], v[80:83], v[156:159]
v_cvt_pk_bf16_f32 v92, v56, v57
v_cvt_pk_bf16_f32 v193, v194, v195
v_mfma_f32_16x16x32_bf16 a[212:215], a[228:231], v[80:83], 0
s_barrier
v_exp_f32 v58, v58
v_mfma_f32_16x16x32_bf16 a[212:215], a[228:231], v[84:87], a[212:215]
s_waitcnt lgkmcnt(14)
v_cvt_pk_bf16_f32 v196, v196, v197
v_cvt_pk_bf16_f32 v197, v198, v199
v_mfma_f32_16x16x32_bf16 v[48:51], v[16:19], a[48:51], v[48:51]
ds_write_b64 v7, v[184:185] offset:8640
v_mfma_f32_16x16x32_bf16 v[48:51], v[20:23], a[52:55], v[48:51]
ds_write_b64 v7, v[188:189] offset:8672
v_mfma_f32_16x16x32_bf16 v[48:51], v[24:27], a[56:59], v[48:51]
ds_write_b64 v7, v[192:193] offset:8960
v_mfma_f32_16x16x32_bf16 v[48:51], v[28:31], a[60:63], v[48:51]
ds_write_b64 v7, v[196:197] offset:8992
v_mfma_f32_16x16x32_bf16 v[64:67], a[80:83], a[48:51], v[48:51]
v_exp_f32 v59, v59
v_mfma_f32_16x16x32_bf16 v[64:67], a[84:87], a[52:55], v[64:67]
ds_read_b128 a[80:83], v1 offset:16896
v_cvt_pk_bf16_f32 v93, v58, v59
v_mfma_f32_16x16x32_bf16 v[64:67], a[88:91], a[56:59], v[64:67]
v_exp_f32 v60, v60
v_mfma_f32_16x16x32_bf16 v[64:67], a[92:95], a[60:63], v[64:67]
ds_read_b128 a[84:87], v1 offset:16960
ds_read_b128 a[88:91], v1 offset:17024
v_mfma_f32_16x16x32_bf16 v[68:71], a[108:111], a[60:63], v[48:51]
v_exp_f32 v61, v61
v_mfma_f32_16x16x32_bf16 v[68:71], a[104:107], a[56:59], v[68:71]
ds_read_b128 a[92:95], v1 offset:17088
v_cvt_pk_bf16_f32 v94, v60, v61
v_mfma_f32_16x16x32_bf16 v[68:71], a[100:103], a[52:55], v[68:71]
v_exp_f32 v62, v62
v_mfma_f32_16x16x32_bf16 v[68:71], a[96:99], a[48:51], v[68:71]
ds_read_b128 a[108:111], v1 offset:17600
v_cvt_pk_bf16_f32 v200, v200, v201
v_mfma_f32_16x16x32_bf16 v[72:75], a[112:115], a[48:51], v[48:51]
v_exp_f32 v63, v63
v_mfma_f32_16x16x32_bf16 v[72:75], a[116:119], a[52:55], v[72:75]
v_exp_f32 v64, v64
v_mfma_f32_16x16x32_bf16 v[72:75], a[120:123], a[56:59], v[72:75]
ds_read_b128 a[104:107], v1 offset:17536
v_cvt_pk_bf16_f32 v95, v62, v63
v_mfma_f32_16x16x32_bf16 v[72:75], a[124:127], a[60:63], v[72:75]
v_exp_f32 v65, v65
v_mfma_f32_16x16x32_bf16 v[76:79], a[140:143], a[60:63], v[48:51]
ds_read_b128 a[100:103], v1 offset:17472
v_cvt_pk_bf16_f32 v80, v64, v65
v_mfma_f32_16x16x32_bf16 v[76:79], a[136:139], a[56:59], v[76:79]
v_exp_f32 v66, v66
v_mfma_f32_16x16x32_bf16 v[76:79], a[132:135], a[52:55], v[76:79]
ds_read_b128 a[96:99], v1 offset:17408
v_cvt_pk_bf16_f32 v201, v202, v203
v_mfma_f32_16x16x32_bf16 v[76:79], a[128:131], a[48:51], v[76:79]
ds_write_b64 v7, v[200:201] offset:9024
v_exp_f32 v67, v67
v_mfma_f32_16x16x32_bf16 v[160:163], a[144:147], v[88:91], 0
ds_read_b128 a[112:115], v1 offset:25344
v_cvt_pk_bf16_f32 v81, v66, v67
v_mfma_f32_16x16x32_bf16 v[160:163], a[176:179], v[92:95], v[160:163]
v_exp_f32 v68, v68
v_mfma_f32_16x16x32_bf16 v[164:167], a[180:183], v[92:95], 0
ds_read_b128 a[116:119], v1 offset:25408
v_cvt_pk_bf16_f32 v204, v204, v205
v_mfma_f32_16x16x32_bf16 v[164:167], a[148:151], v[88:91], v[164:167]
v_exp_f32 v69, v69
v_mfma_f32_16x16x32_bf16 v[168:171], a[152:155], v[88:91], 0
ds_read_b128 a[120:123], v1 offset:25472
v_cvt_pk_bf16_f32 v82, v68, v69
v_mfma_f32_16x16x32_bf16 v[168:171], a[184:187], v[92:95], v[168:171]
v_exp_f32 v70, v70
v_mfma_f32_16x16x32_bf16 v[172:175], a[188:191], v[92:95], 0
ds_read_b128 a[124:127], v1 offset:25536
v_cvt_pk_bf16_f32 v205, v206, v207
v_mfma_f32_16x16x32_bf16 v[172:175], a[156:159], v[88:91], v[172:175]
ds_write_b64 v7, v[204:205] offset:9056
v_exp_f32 v71, v71
v_mfma_f32_16x16x32_bf16 v[176:179], a[160:163], v[88:91], 0
ds_read_b128 a[140:143], v1 offset:26048
ds_read_b128 v[16:19], v4
v_cvt_pk_bf16_f32 v83, v70, v71
v_mfma_f32_16x16x32_bf16 v[176:179], a[192:195], v[92:95], v[176:179]
v_exp_f32 v72, v72
v_mfma_f32_16x16x32_bf16 v[180:183], a[196:199], v[92:95], 0
ds_read_b128 a[136:139], v1 offset:25984
v_cvt_pk_bf16_f32 v208, v208, v209
v_mfma_f32_16x16x32_bf16 v[180:183], a[164:167], v[88:91], v[180:183]
v_exp_f32 v73, v73
v_mfma_f32_16x16x32_bf16 v[184:187], a[168:171], v[88:91], 0
ds_read_b128 a[132:135], v1 offset:25920
v_cvt_pk_bf16_f32 v84, v72, v73
v_mfma_f32_16x16x32_bf16 v[184:187], a[200:203], v[92:95], v[184:187]
v_exp_f32 v74, v74
v_mfma_f32_16x16x32_bf16 v[188:191], a[204:207], v[92:95], 0
ds_read_b128 a[128:131], v1 offset:25856
v_cvt_pk_bf16_f32 v209, v210, v211
v_mfma_f32_16x16x32_bf16 v[188:191], a[172:175], v[88:91], v[188:191]
v_exp_f32 v75, v75
v_mfma_f32_16x16x32_bf16 a[216:219], a[228:231], v[88:91], 0
s_waitcnt lgkmcnt(11)
v_cvt_pk_bf16_f32 v85, v74, v75
v_cvt_pk_bf16_f32 v212, v212, v213
v_mfma_f32_16x16x32_bf16 a[216:219], a[228:231], v[92:95], a[216:219]
s_waitcnt lgkmcnt(3)
v_exp_f32 v76, v76
v_mfma_f32_16x16x32_bf16 v[56:59], a[80:83], a[64:67], v[52:55]
buffer_store_dwordx4 v[16:19], v3, s[28:31], s36 offen sc0 sc1
v_cvt_pk_bf16_f32 v213, v214, v215
v_cvt_pk_bf16_f32 v216, v216, v217
v_cvt_pk_bf16_f32 v217, v218, v219
v_mfma_f32_16x16x32_bf16 v[56:59], a[84:87], a[68:71], v[56:59]
v_exp_f32 v77, v77
v_mfma_f32_16x16x32_bf16 v[56:59], a[88:91], a[72:75], v[56:59]
v_cvt_pk_bf16_f32 v86, v76, v77
v_cvt_pk_bf16_f32 v220, v220, v221
v_mfma_f32_16x16x32_bf16 v[56:59], a[92:95], a[76:79], v[56:59]
v_exp_f32 v78, v78
v_mfma_f32_16x16x32_bf16 v[60:63], a[108:111], a[76:79], v[52:55]
ds_write_b64 v7, v[208:209] offset:9088
v_mfma_f32_16x16x32_bf16 v[60:63], a[104:107], a[72:75], v[60:63]
s_waitcnt vmcnt(11) lgkmcnt(1)
v_exp_f32 v79, v79
v_mfma_f32_16x16x32_bf16 v[60:63], a[100:103], a[68:71], v[60:63]
v_cvt_pk_bf16_f32 v87, v78, v79
v_cvt_pk_bf16_f32 v221, v222, v223
v_mfma_f32_16x16x32_bf16 v[60:63], a[96:99], a[64:67], v[60:63]
s_barrier
s_add_u32 s12, s12, 16384
s_addc_u32 s13, s13, 0
v_mfma_f32_16x16x32_bf16 v[192:195], a[144:147], v[80:83], 0
ds_read_b64_tr_b16 a[144:145], v2 offset:16896
ds_read_b64_tr_b16 a[146:147], v2 offset:17408
v_mfma_f32_16x16x32_bf16 v[192:195], a[176:179], v[84:87], v[192:195]
v_exp_f32 v56, v56
v_mfma_f32_16x16x32_bf16 v[196:199], a[180:183], v[84:87], 0
ds_write_b64 v7, v[212:213] offset:9120
v_mfma_f32_16x16x32_bf16 v[196:199], a[148:151], v[80:83], v[196:199]
ds_read_b64_tr_b16 a[148:149], v2 offset:16928
ds_read_b64_tr_b16 a[150:151], v2 offset:17440
v_mfma_f32_16x16x32_bf16 v[200:203], a[152:155], v[80:83], 0
s_add_u32 m0, s33, 16896
v_exp_f32 v57, v57
v_mfma_f32_16x16x32_bf16 v[200:203], a[184:187], v[84:87], v[200:203]
ds_read_b64_tr_b16 a[152:153], v2 offset:16960
v_cvt_pk_bf16_f32 v88, v56, v57
v_mfma_f32_16x16x32_bf16 v[204:207], a[188:191], v[84:87], 0
buffer_load_dwordx4 v3, s[12:15], 0 offen nt lds
v_mfma_f32_16x16x32_bf16 v[204:207], a[156:159], v[80:83], v[204:207]
v_exp_f32 v58, v58
v_mfma_f32_16x16x32_bf16 v[208:211], a[160:163], v[80:83], 0
ds_read_b64_tr_b16 a[154:155], v2 offset:17472
ds_read_b64_tr_b16 a[156:157], v2 offset:16992
v_mfma_f32_16x16x32_bf16 v[208:211], a[192:195], v[84:87], v[208:211]
ds_read_b64_tr_b16 a[158:159], v2 offset:17504
ds_write_b64 v7, v[216:217] offset:9152
v_mfma_f32_16x16x32_bf16 v[212:215], a[196:199], v[84:87], 0
v_exp_f32 v59, v59
v_mfma_f32_16x16x32_bf16 v[212:215], a[164:167], v[80:83], v[212:215]
ds_read_b64_tr_b16 a[160:161], v2 offset:17024
v_cvt_pk_bf16_f32 v89, v58, v59
v_mfma_f32_16x16x32_bf16 v[216:219], a[168:171], v[80:83], 0
ds_read_b64_tr_b16 a[162:163], v2 offset:17536
ds_write_b64 v7, v[220:221] offset:9184
v_mfma_f32_16x16x32_bf16 v[216:219], a[200:203], v[84:87], v[216:219]
s_add_u32 m0, s33, 16928
v_exp_f32 v60, v60
v_mfma_f32_16x16x32_bf16 v[220:223], a[204:207], v[84:87], 0
buffer_load_dwordx4 v3, s[12:15], 0 offen offset:1024 nt lds
v_mfma_f32_16x16x32_bf16 v[220:223], a[172:175], v[80:83], v[220:223]
ds_read_b64_tr_b16 a[164:165], v2 offset:17056
v_mfma_f32_16x16x32_bf16 a[220:223], a[228:231], v[80:83], 0
v_exp_f32 v61, v61
v_mfma_f32_16x16x32_bf16 a[220:223], a[228:231], v[84:87], a[220:223]
ds_read_b64_tr_b16 a[166:167], v2 offset:17568
v_cvt_pk_bf16_f32 v90, v60, v61
v_mfma_f32_16x16x32_bf16 v[64:67], a[80:83], a[0:3], v[36:39]
ds_read_b64_tr_b16 a[168:169], v2 offset:17088
v_mfma_f32_16x16x32_bf16 v[64:67], a[84:87], a[4:7], v[64:67]
v_exp_f32 v62, v62
v_mfma_f32_16x16x32_bf16 v[64:67], a[88:91], a[8:11], v[64:67]
ds_read_b64_tr_b16 a[170:171], v2 offset:17600
v_mfma_f32_16x16x32_bf16 v[64:67], a[92:95], a[12:15], v[64:67]
ds_read_b64_tr_b16 a[172:173], v2 offset:17120
v_mfma_f32_16x16x32_bf16 v[68:71], a[108:111], a[12:15], v[36:39]
s_add_u32 m0, s33, 16960
v_exp_f32 v63, v63
v_mfma_f32_16x16x32_bf16 v[68:71], a[104:107], a[8:11], v[68:71]
ds_read_b64_tr_b16 a[174:175], v2 offset:17632
v_cvt_pk_bf16_f32 v91, v62, v63
v_mfma_f32_16x16x32_bf16 v[68:71], a[100:103], a[4:7], v[68:71]
buffer_load_dwordx4 v3, s[12:15], 0 offen offset:2048 nt lds
v_mfma_f32_16x16x32_bf16 v[68:71], a[96:99], a[0:3], v[68:71]
ds_read_b64_tr_b16 a[176:177], v2 offset:25344
v_mfma_f32_16x16x32_bf16 v[72:75], a[112:115], a[0:3], v[36:39]
v_exp_f32 v64, v64
v_mfma_f32_16x16x32_bf16 v[72:75], a[116:119], a[4:7], v[72:75]
ds_read_b64_tr_b16 a[178:179], v2 offset:25856
v_mfma_f32_16x16x32_bf16 v[72:75], a[120:123], a[8:11], v[72:75]
v_exp_f32 v65, v65
v_mfma_f32_16x16x32_bf16 v[72:75], a[124:127], a[12:15], v[72:75]
ds_read_b64_tr_b16 a[180:181], v2 offset:25376
v_cvt_pk_bf16_f32 v80, v64, v65
v_mfma_f32_16x16x32_bf16 v[76:79], a[140:143], a[12:15], v[36:39]
v_exp_f32 v66, v66
v_mfma_f32_16x16x32_bf16 v[76:79], a[136:139], a[8:11], v[76:79]
s_waitcnt lgkmcnt(13)
ds_read_b64_tr_b16 a[182:183], v2 offset:25888
v_mfma_f32_16x16x32_bf16 v[76:79], a[132:135], a[4:7], v[76:79]
s_add_u32 m0, s33, 16992
v_exp_f32 v67, v67
v_mfma_f32_16x16x32_bf16 v[76:79], a[128:131], a[0:3], v[76:79]
ds_read_b64_tr_b16 a[184:185], v2 offset:25408
v_cvt_pk_bf16_f32 v81, v66, v67
v_mfma_f32_16x16x32_bf16 v[224:227], a[144:147], v[88:91], v[224:227]
v_exp_f32 v68, v68
v_mfma_f32_16x16x32_bf16 v[228:231], a[148:151], v[88:91], v[228:231]
buffer_load_dwordx4 v3, s[12:15], 0 offen offset:3072 nt lds
v_mfma_f32_16x16x32_bf16 v[232:235], a[152:155], v[88:91], v[232:235]
s_waitcnt lgkmcnt(5)
v_exp_f32 v69, v69
v_mfma_f32_16x16x32_bf16 v[236:239], a[156:159], v[88:91], v[236:239]
ds_read_b64_tr_b16 a[186:187], v2 offset:25920
v_cvt_pk_bf16_f32 v82, v68, v69
v_mfma_f32_16x16x32_bf16 v[240:243], a[160:163], v[88:91], v[240:243]
v_exp_f32 v70, v70
v_mfma_f32_16x16x32_bf16 v[244:247], a[164:167], v[88:91], v[244:247]
ds_read_b64_tr_b16 a[188:189], v2 offset:25440
v_mfma_f32_16x16x32_bf16 v[248:251], a[168:171], v[88:91], v[248:251]
v_exp_f32 v71, v71
v_mfma_f32_16x16x32_bf16 v[252:255], a[172:175], v[88:91], v[252:255]
ds_read_b64_tr_b16 a[190:191], v2 offset:25952
v_cvt_pk_bf16_f32 v83, v70, v71
v_mfma_f32_16x16x32_bf16 a[224:227], a[228:231], v[88:91], a[224:227]
v_exp_f32 v72, v72
v_mfma_f32_16x16x32_bf16 v[56:59], a[80:83], a[16:19], v[40:43]
ds_read_b64_tr_b16 a[192:193], v2 offset:25472
v_mfma_f32_16x16x32_bf16 v[56:59], a[84:87], a[20:23], v[56:59]
v_exp_f32 v73, v73
v_mfma_f32_16x16x32_bf16 v[56:59], a[88:91], a[24:27], v[56:59]
ds_read_b64_tr_b16 a[194:195], v2 offset:25984
v_cvt_pk_bf16_f32 v84, v72, v73
v_mfma_f32_16x16x32_bf16 v[56:59], a[92:95], a[28:31], v[56:59]
v_exp_f32 v74, v74
v_mfma_f32_16x16x32_bf16 v[60:63], a[108:111], a[28:31], v[40:43]
ds_read_b64_tr_b16 a[196:197], v2 offset:25504
v_mfma_f32_16x16x32_bf16 v[60:63], a[104:107], a[24:27], v[60:63]
v_exp_f32 v75, v75
v_mfma_f32_16x16x32_bf16 v[60:63], a[100:103], a[20:23], v[60:63]
ds_read_b64_tr_b16 a[198:199], v2 offset:26016
v_cvt_pk_bf16_f32 v85, v74, v75
v_mfma_f32_16x16x32_bf16 v[60:63], a[96:99], a[16:19], v[60:63]
v_exp_f32 v76, v76
v_mfma_f32_16x16x32_bf16 v[64:67], a[112:115], a[16:19], v[40:43]
ds_read_b64_tr_b16 a[200:201], v2 offset:25536
v_mfma_f32_16x16x32_bf16 v[64:67], a[116:119], a[20:23], v[64:67]
v_exp_f32 v77, v77
v_mfma_f32_16x16x32_bf16 v[64:67], a[120:123], a[24:27], v[64:67]
ds_read_b64_tr_b16 a[202:203], v2 offset:26048
v_cvt_pk_bf16_f32 v86, v76, v77
v_mfma_f32_16x16x32_bf16 v[64:67], a[124:127], a[28:31], v[64:67]
v_exp_f32 v78, v78
v_mfma_f32_16x16x32_bf16 v[68:71], a[140:143], a[28:31], v[40:43]
ds_read_b64_tr_b16 a[204:205], v2 offset:25568
v_mfma_f32_16x16x32_bf16 v[68:71], a[136:139], a[24:27], v[68:71]
v_exp_f32 v79, v79
v_mfma_f32_16x16x32_bf16 v[68:71], a[132:135], a[20:23], v[68:71]
ds_read_b64_tr_b16 a[206:207], v2 offset:26080
v_cvt_pk_bf16_f32 v87, v78, v79
v_mfma_f32_16x16x32_bf16 v[68:71], a[128:131], a[16:19], v[68:71]
v_exp_f32 v56, v56
v_mfma_f32_16x16x32_bf16 v[96:99], a[144:147], v[80:83], v[96:99]
s_waitcnt lgkmcnt(8)
v_mfma_f32_16x16x32_bf16 v[96:99], a[176:179], v[84:87], v[96:99]
v_exp_f32 v57, v57
v_mfma_f32_16x16x32_bf16 v[100:103], a[180:183], v[84:87], v[100:103]
v_cvt_pk_bf16_f32 v88, v56, v57
v_mfma_f32_16x16x32_bf16 v[100:103], a[148:151], v[80:83], v[100:103]
v_exp_f32 v58, v58
v_mfma_f32_16x16x32_bf16 v[104:107], a[152:155], v[80:83], v[104:107]
v_mfma_f32_16x16x32_bf16 v[104:107], a[184:187], v[84:87], v[104:107]
v_exp_f32 v59, v59
v_mfma_f32_16x16x32_bf16 v[108:111], a[188:191], v[84:87], v[108:111]
v_cvt_pk_bf16_f32 v89, v58, v59
v_mfma_f32_16x16x32_bf16 v[108:111], a[156:159], v[80:83], v[108:111]
s_waitcnt lgkmcnt(0)
v_exp_f32 v60, v60
v_mfma_f32_16x16x32_bf16 v[112:115], a[160:163], v[80:83], v[112:115]
s_waitcnt lgkmcnt(0)
v_mfma_f32_16x16x32_bf16 v[112:115], a[192:195], v[84:87], v[112:115]
s_barrier
v_exp_f32 v61, v61
v_mfma_f32_16x16x32_bf16 v[116:119], a[196:199], v[84:87], v[116:119]
s_add_u32 s16, s16, 16384
s_addc_u32 s17, s17, 0
v_cvt_pk_bf16_f32 v90, v60, v61
v_mfma_f32_16x16x32_bf16 v[116:119], a[164:167], v[80:83], v[116:119]
s_add_u32 m0, s33, 50688
v_exp_f32 v62, v62
v_mfma_f32_16x16x32_bf16 v[120:123], a[168:171], v[80:83], v[120:123]
buffer_load_dwordx4 v3, s[16:19], 0 offen nt lds
v_mfma_f32_16x16x32_bf16 v[120:123], a[200:203], v[84:87], v[120:123]
v_exp_f32 v63, v63
v_mfma_f32_16x16x32_bf16 v[124:127], a[204:207], v[84:87], v[124:127]
ds_read_b128 v[20:23], v4 offset:1056
v_cvt_pk_bf16_f32 v91, v62, v63
v_mfma_f32_16x16x32_bf16 v[124:127], a[172:175], v[80:83], v[124:127]
s_add_u32 m0, s33, 50720
v_exp_f32 v64, v64
v_mfma_f32_16x16x32_bf16 a[208:211], a[228:231], v[80:83], a[208:211]
buffer_load_dwordx4 v3, s[16:19], 0 offen offset:1024 nt lds
v_mfma_f32_16x16x32_bf16 a[208:211], a[228:231], v[84:87], a[208:211]
v_exp_f32 v65, v65
v_mfma_f32_16x16x32_bf16 v[72:75], a[80:83], a[32:35], v[44:47]
v_cvt_pk_bf16_f32 v92, v64, v65
v_add_u32 v4, 2112, v4
v_mfma_f32_16x16x32_bf16 v[72:75], a[84:87], a[36:39], v[72:75]
s_add_u32 m0, s33, 50752
v_exp_f32 v66, v66
v_mfma_f32_16x16x32_bf16 v[72:75], a[88:91], a[40:43], v[72:75]
buffer_load_dwordx4 v3, s[16:19], 0 offen offset:2048 nt lds
v_mfma_f32_16x16x32_bf16 v[72:75], a[92:95], a[44:47], v[72:75]
v_exp_f32 v67, v67
v_mfma_f32_16x16x32_bf16 v[76:79], a[108:111], a[44:47], v[44:47]
v_cvt_pk_bf16_f32 v93, v66, v67
v_mfma_f32_16x16x32_bf16 v[76:79], a[104:107], a[40:43], v[76:79]
v_exp_f32 v68, v68
v_mfma_f32_16x16x32_bf16 v[76:79], a[100:103], a[36:39], v[76:79]
v_mfma_f32_16x16x32_bf16 v[76:79], a[96:99], a[32:35], v[76:79]
s_add_u32 m0, s33, 50784
v_exp_f32 v69, v69
v_mfma_f32_16x16x32_bf16 v[56:59], a[112:115], a[32:35], v[44:47]
v_cvt_pk_bf16_f32 v94, v68, v69
v_mfma_f32_16x16x32_bf16 v[56:59], a[116:119], a[36:39], v[56:59]
v_exp_f32 v70, v70
v_mfma_f32_16x16x32_bf16 v[56:59], a[120:123], a[40:43], v[56:59]
buffer_load_dwordx4 v3, s[16:19], 0 offen offset:3072 nt lds
v_mfma_f32_16x16x32_bf16 v[56:59], a[124:127], a[44:47], v[56:59]
v_exp_f32 v71, v71
v_mfma_f32_16x16x32_bf16 v[60:63], a[140:143], a[44:47], v[44:47]
v_exp_f32 v72, v72
v_mfma_f32_16x16x32_bf16 v[60:63], a[136:139], a[40:43], v[60:63]
v_cvt_pk_bf16_f32 v95, v70, v71
v_mfma_f32_16x16x32_bf16 v[60:63], a[132:135], a[36:39], v[60:63]
v_exp_f32 v73, v73
v_mfma_f32_16x16x32_bf16 v[60:63], a[128:131], a[32:35], v[60:63]
v_cvt_pk_bf16_f32 v80, v72, v73
v_mfma_f32_16x16x32_bf16 v[128:131], a[144:147], v[88:91], v[128:131]
v_exp_f32 v74, v74
v_mfma_f32_16x16x32_bf16 v[128:131], a[176:179], v[92:95], v[128:131]
v_mfma_f32_16x16x32_bf16 v[132:135], a[180:183], v[92:95], v[132:135]
v_exp_f32 v75, v75
v_mfma_f32_16x16x32_bf16 v[132:135], a[148:151], v[88:91], v[132:135]
v_cvt_pk_bf16_f32 v81, v74, v75
v_mfma_f32_16x16x32_bf16 v[136:139], a[152:155], v[88:91], v[136:139]
v_exp_f32 v76, v76
v_mfma_f32_16x16x32_bf16 v[136:139], a[184:187], v[92:95], v[136:139]
v_mfma_f32_16x16x32_bf16 v[140:143], a[188:191], v[92:95], v[140:143]
v_exp_f32 v77, v77
v_mfma_f32_16x16x32_bf16 v[140:143], a[156:159], v[88:91], v[140:143]
v_cvt_pk_bf16_f32 v82, v76, v77
v_mfma_f32_16x16x32_bf16 v[144:147], a[160:163], v[88:91], v[144:147]
s_waitcnt lgkmcnt(0)
v_exp_f32 v78, v78
v_mfma_f32_16x16x32_bf16 v[144:147], a[192:195], v[92:95], v[144:147]
buffer_store_dwordx4 v[20:23], v3, s[28:31], s36 offen offset:1024 sc0 sc1
v_mfma_f32_16x16x32_bf16 v[148:151], a[196:199], v[92:95], v[148:151]
s_add_u32 s36, s36, 2048
v_exp_f32 v79, v79
v_mfma_f32_16x16x32_bf16 v[148:151], a[164:167], v[88:91], v[148:151]
v_cvt_pk_bf16_f32 v83, v78, v79
v_mfma_f32_16x16x32_bf16 v[152:155], a[168:171], v[88:91], v[152:155]
v_exp_f32 v56, v56
v_mfma_f32_16x16x32_bf16 v[152:155], a[200:203], v[92:95], v[152:155]
v_mfma_f32_16x16x32_bf16 v[156:159], a[204:207], v[92:95], v[156:159]
s_waitcnt vmcnt(14) lgkmcnt(1)
v_exp_f32 v57, v57
v_mfma_f32_16x16x32_bf16 v[156:159], a[172:175], v[88:91], v[156:159]
v_cvt_pk_bf16_f32 v84, v56, v57
v_mfma_f32_16x16x32_bf16 a[212:215], a[228:231], v[88:91], a[212:215]
s_barrier
v_exp_f32 v58, v58
v_mfma_f32_16x16x32_bf16 a[212:215], a[228:231], v[92:95], a[212:215]
v_mfma_f32_16x16x32_bf16 v[64:67], a[80:83], a[48:51], v[48:51]
v_exp_f32 v59, v59
v_mfma_f32_16x16x32_bf16 v[64:67], a[84:87], a[52:55], v[64:67]
ds_read_b128 a[80:83], v1
v_cvt_pk_bf16_f32 v85, v58, v59
v_mfma_f32_16x16x32_bf16 v[64:67], a[88:91], a[56:59], v[64:67]
v_exp_f32 v60, v60
v_mfma_f32_16x16x32_bf16 v[64:67], a[92:95], a[60:63], v[64:67]
ds_read_b128 a[84:87], v1 offset:64
ds_read_b128 a[88:91], v1 offset:128
v_mfma_f32_16x16x32_bf16 v[68:71], a[108:111], a[60:63], v[48:51]
v_exp_f32 v61, v61
v_mfma_f32_16x16x32_bf16 v[68:71], a[104:107], a[56:59], v[68:71]
ds_read_b128 a[92:95], v1 offset:192
v_cvt_pk_bf16_f32 v86, v60, v61
v_mfma_f32_16x16x32_bf16 v[68:71], a[100:103], a[52:55], v[68:71]
v_exp_f32 v62, v62
v_mfma_f32_16x16x32_bf16 v[68:71], a[96:99], a[48:51], v[68:71]
ds_read_b128 a[108:111], v1 offset:704
v_mfma_f32_16x16x32_bf16 v[72:75], a[112:115], a[48:51], v[48:51]
v_exp_f32 v63, v63
v_mfma_f32_16x16x32_bf16 v[72:75], a[116:119], a[52:55], v[72:75]
v_exp_f32 v64, v64
v_mfma_f32_16x16x32_bf16 v[72:75], a[120:123], a[56:59], v[72:75]
ds_read_b128 a[104:107], v1 offset:640
v_cvt_pk_bf16_f32 v87, v62, v63
v_mfma_f32_16x16x32_bf16 v[72:75], a[124:127], a[60:63], v[72:75]
v_exp_f32 v65, v65
v_mfma_f32_16x16x32_bf16 v[76:79], a[140:143], a[60:63], v[48:51]
ds_read_b128 a[100:103], v1 offset:576
v_cvt_pk_bf16_f32 v88, v64, v65
v_mfma_f32_16x16x32_bf16 v[76:79], a[136:139], a[56:59], v[76:79]
v_exp_f32 v66, v66
v_mfma_f32_16x16x32_bf16 v[76:79], a[132:135], a[52:55], v[76:79]
ds_read_b128 a[96:99], v1 offset:512
v_mfma_f32_16x16x32_bf16 v[76:79], a[128:131], a[48:51], v[76:79]
v_exp_f32 v67, v67
v_mfma_f32_16x16x32_bf16 v[160:163], a[144:147], v[80:83], v[160:163]
ds_read_b128 a[112:115], v1 offset:8448
v_cvt_pk_bf16_f32 v89, v66, v67
v_mfma_f32_16x16x32_bf16 v[160:163], a[176:179], v[84:87], v[160:163]
v_exp_f32 v68, v68
v_mfma_f32_16x16x32_bf16 v[164:167], a[180:183], v[84:87], v[164:167]
ds_read_b128 a[116:119], v1 offset:8512
v_mfma_f32_16x16x32_bf16 v[164:167], a[148:151], v[80:83], v[164:167]
v_exp_f32 v69, v69
v_mfma_f32_16x16x32_bf16 v[168:171], a[152:155], v[80:83], v[168:171]
ds_read_b128 a[120:123], v1 offset:8576
v_cvt_pk_bf16_f32 v90, v68, v69
v_mfma_f32_16x16x32_bf16 v[168:171], a[184:187], v[84:87], v[168:171]
v_exp_f32 v70, v70
v_mfma_f32_16x16x32_bf16 v[172:175], a[188:191], v[84:87], v[172:175]
ds_read_b128 a[124:127], v1 offset:8640
v_mfma_f32_16x16x32_bf16 v[172:175], a[156:159], v[80:83], v[172:175]
v_exp_f32 v71, v71
v_mfma_f32_16x16x32_bf16 v[176:179], a[160:163], v[80:83], v[176:179]
ds_read_b128 a[140:143], v1 offset:9152
v_cvt_pk_bf16_f32 v91, v70, v71
v_mfma_f32_16x16x32_bf16 v[176:179], a[192:195], v[84:87], v[176:179]
v_exp_f32 v72, v72
v_mfma_f32_16x16x32_bf16 v[180:183], a[196:199], v[84:87], v[180:183]
ds_read_b128 a[136:139], v1 offset:9088
v_mfma_f32_16x16x32_bf16 v[180:183], a[164:167], v[80:83], v[180:183]
v_exp_f32 v73, v73
v_mfma_f32_16x16x32_bf16 v[184:187], a[168:171], v[80:83], v[184:187]
ds_read_b128 a[132:135], v1 offset:9024
v_cvt_pk_bf16_f32 v92, v72, v73
v_mfma_f32_16x16x32_bf16 v[184:187], a[200:203], v[84:87], v[184:187]
s_mov_b32 s34, 6
v_exp_f32 v74, v74
v_mfma_f32_16x16x32_bf16 v[188:191], a[204:207], v[84:87], v[188:191]
ds_read_b128 a[128:131], v1 offset:8960
v_mfma_f32_16x16x32_bf16 v[188:191], a[172:175], v[80:83], v[188:191]
s_bitcmp0_b32 s44, 0
v_exp_f32 v75, v75
v_mfma_f32_16x16x32_bf16 a[216:219], a[228:231], v[80:83], a[216:219]
s_waitcnt lgkmcnt(8)
v_cvt_pk_bf16_f32 v93, v74, v75
v_mfma_f32_16x16x32_bf16 a[216:219], a[228:231], v[84:87], a[216:219]
s_cbranch_scc1 L_n110
L_m110:
v_exp_f32 v76, v76
v_mfma_f32_16x16x32_bf16 v[56:59], a[80:83], a[64:67], v[52:55]
v_mfma_f32_16x16x32_bf16 v[56:59], a[84:87], a[68:71], v[56:59]
v_exp_f32 v77, v77
v_mfma_f32_16x16x32_bf16 v[56:59], a[88:91], a[72:75], v[56:59]
v_cvt_pk_bf16_f32 v94, v76, v77
v_mfma_f32_16x16x32_bf16 v[56:59], a[92:95], a[76:79], v[56:59]
v_exp_f32 v78, v78
v_mfma_f32_16x16x32_bf16 v[60:63], a[108:111], a[76:79], v[52:55]
v_mfma_f32_16x16x32_bf16 v[60:63], a[104:107], a[72:75], v[60:63]
s_waitcnt vmcnt(10) lgkmcnt(0)
v_exp_f32 v79, v79
v_mfma_f32_16x16x32_bf16 v[60:63], a[100:103], a[68:71], v[60:63]
v_cvt_pk_bf16_f32 v95, v78, v79
v_mfma_f32_16x16x32_bf16 v[60:63], a[96:99], a[64:67], v[60:63]
s_barrier
s_add_u32 s12, s12, 16384
s_addc_u32 s13, s13, 0
v_mfma_f32_16x16x32_bf16 v[192:195], a[144:147], v[88:91], v[192:195]
ds_read_b64_tr_b16 a[144:145], v2
ds_read_b64_tr_b16 a[146:147], v2 offset:512
v_mfma_f32_16x16x32_bf16 v[192:195], a[176:179], v[92:95], v[192:195]
v_exp_f32 v56, v56
v_mfma_f32_16x16x32_bf16 v[196:199], a[180:183], v[92:95], v[196:199]
v_mfma_f32_16x16x32_bf16 v[196:199], a[148:151], v[88:91], v[196:199]
ds_read_b64_tr_b16 a[148:149], v2 offset:32
ds_read_b64_tr_b16 a[150:151], v2 offset:544
v_mfma_f32_16x16x32_bf16 v[200:203], a[152:155], v[88:91], v[200:203]
s_add_u32 m0, s33, 0
v_exp_f32 v57, v57
v_mfma_f32_16x16x32_bf16 v[200:203], a[184:187], v[92:95], v[200:203]
ds_read_b64_tr_b16 a[152:153], v2 offset:64
v_cvt_pk_bf16_f32 v80, v56, v57
v_mfma_f32_16x16x32_bf16 v[204:207], a[188:191], v[92:95], v[204:207]
buffer_load_dwordx4 v3, s[12:15], 0 offen nt lds
v_mfma_f32_16x16x32_bf16 v[204:207], a[156:159], v[88:91], v[204:207]
v_exp_f32 v58, v58
v_mfma_f32_16x16x32_bf16 v[208:211], a[160:163], v[88:91], v[208:211]
ds_read_b64_tr_b16 a[154:155], v2 offset:576
ds_read_b64_tr_b16 a[156:157], v2 offset:96
v_mfma_f32_16x16x32_bf16 v[208:211], a[192:195], v[92:95], v[208:211]
ds_read_b64_tr_b16 a[158:159], v2 offset:608
v_mfma_f32_16x16x32_bf16 v[212:215], a[196:199], v[92:95], v[212:215]
v_exp_f32 v59, v59
v_mfma_f32_16x16x32_bf16 v[212:215], a[164:167], v[88:91], v[212:215]
ds_read_b64_tr_b16 a[160:161], v2 offset:128
v_cvt_pk_bf16_f32 v81, v58, v59
v_mfma_f32_16x16x32_bf16 v[216:219], a[168:171], v[88:91], v[216:219]
ds_read_b64_tr_b16 a[162:163], v2 offset:640
v_mfma_f32_16x16x32_bf16 v[216:219], a[200:203], v[92:95], v[216:219]
s_add_u32 m0, s33, 32
v_exp_f32 v60, v60
v_mfma_f32_16x16x32_bf16 v[220:223], a[204:207], v[92:95], v[220:223]
buffer_load_dwordx4 v3, s[12:15], 0 offen offset:1024 nt lds
v_mfma_f32_16x16x32_bf16 v[220:223], a[172:175], v[88:91], v[220:223]
ds_read_b64_tr_b16 a[164:165], v2 offset:160
v_mfma_f32_16x16x32_bf16 a[220:223], a[228:231], v[88:91], a[220:223]
v_exp_f32 v61, v61
v_mfma_f32_16x16x32_bf16 a[220:223], a[228:231], v[92:95], a[220:223]
ds_read_b64_tr_b16 a[166:167], v2 offset:672
v_cvt_pk_bf16_f32 v82, v60, v61
v_mfma_f32_16x16x32_bf16 v[64:67], a[80:83], a[0:3], v[36:39]
ds_read_b64_tr_b16 a[168:169], v2 offset:192
v_mfma_f32_16x16x32_bf16 v[64:67], a[84:87], a[4:7], v[64:67]
v_exp_f32 v62, v62
v_mfma_f32_16x16x32_bf16 v[64:67], a[88:91], a[8:11], v[64:67]
ds_read_b64_tr_b16 a[170:171], v2 offset:704
v_mfma_f32_16x16x32_bf16 v[64:67], a[92:95], a[12:15], v[64:67]
ds_read_b64_tr_b16 a[172:173], v2 offset:224
v_mfma_f32_16x16x32_bf16 v[68:71], a[108:111], a[12:15], v[36:39]
s_add_u32 m0, s33, 64
v_exp_f32 v63, v63
v_mfma_f32_16x16x32_bf16 v[68:71], a[104:107], a[8:11], v[68:71]
ds_read_b64_tr_b16 a[174:175], v2 offset:736
v_cvt_pk_bf16_f32 v83, v62, v63
v_mfma_f32_16x16x32_bf16 v[68:71], a[100:103], a[4:7], v[68:71]
buffer_load_dwordx4 v3, s[12:15], 0 offen offset:2048 nt lds
v_mfma_f32_16x16x32_bf16 v[68:71], a[96:99], a[0:3], v[68:71]
ds_read_b64_tr_b16 a[176:177], v2 offset:8448
v_mfma_f32_16x16x32_bf16 v[72:75], a[112:115], a[0:3], v[36:39]
v_exp_f32 v64, v64
v_mfma_f32_16x16x32_bf16 v[72:75], a[116:119], a[4:7], v[72:75]
ds_read_b64_tr_b16 a[178:179], v2 offset:8960
v_mfma_f32_16x16x32_bf16 v[72:75], a[120:123], a[8:11], v[72:75]
v_exp_f32 v65, v65
v_mfma_f32_16x16x32_bf16 v[72:75], a[124:127], a[12:15], v[72:75]
ds_read_b64_tr_b16 a[180:181], v2 offset:8480
v_cvt_pk_bf16_f32 v88, v64, v65
v_mfma_f32_16x16x32_bf16 v[76:79], a[140:143], a[12:15], v[36:39]
v_exp_f32 v66, v66
v_mfma_f32_16x16x32_bf16 v[76:79], a[136:139], a[8:11], v[76:79]
s_waitcnt lgkmcnt(11)
ds_read_b64_tr_b16 a[182:183], v2 offset:8992
v_mfma_f32_16x16x32_bf16 v[76:79], a[132:135], a[4:7], v[76:79]
s_add_u32 m0, s33, 96
v_exp_f32 v67, v67
v_mfma_f32_16x16x32_bf16 v[76:79], a[128:131], a[0:3], v[76:79]
ds_read_b64_tr_b16 a[184:185], v2 offset:8512
v_cvt_pk_bf16_f32 v89, v66, v67
v_mfma_f32_16x16x32_bf16 v[224:227], a[144:147], v[80:83], v[224:227]
v_exp_f32 v68, v68
v_mfma_f32_16x16x32_bf16 v[228:231], a[148:151], v[80:83], v[228:231]
buffer_load_dwordx4 v3, s[12:15], 0 offen offset:3072 nt lds
v_mfma_f32_16x16x32_bf16 v[232:235], a[152:155], v[80:83], v[232:235]
s_waitcnt lgkmcnt(5)
v_exp_f32 v69, v69
v_mfma_f32_16x16x32_bf16 v[236:239], a[156:159], v[80:83], v[236:239]
ds_read_b64_tr_b16 a[186:187], v2 offset:9024
v_cvt_pk_bf16_f32 v90, v68, v69
v_mfma_f32_16x16x32_bf16 v[240:243], a[160:163], v[80:83], v[240:243]
v_exp_f32 v70, v70
v_mfma_f32_16x16x32_bf16 v[244:247], a[164:167], v[80:83], v[244:247]
ds_read_b64_tr_b16 a[188:189], v2 offset:8544
v_mfma_f32_16x16x32_bf16 v[248:251], a[168:171], v[80:83], v[248:251]
v_exp_f32 v71, v71
v_mfma_f32_16x16x32_bf16 v[252:255], a[172:175], v[80:83], v[252:255]
ds_read_b64_tr_b16 a[190:191], v2 offset:9056
v_cvt_pk_bf16_f32 v91, v70, v71
v_mfma_f32_16x16x32_bf16 a[224:227], a[228:231], v[80:83], a[224:227]
v_exp_f32 v72, v72
v_mfma_f32_16x16x32_bf16 v[56:59], a[80:83], a[16:19], v[40:43]
ds_read_b64_tr_b16 a[192:193], v2 offset:8576
v_mfma_f32_16x16x32_bf16 v[56:59], a[84:87], a[20:23], v[56:59]
v_exp_f32 v73, v73
v_mfma_f32_16x16x32_bf16 v[56:59], a[88:91], a[24:27], v[56:59]
ds_read_b64_tr_b16 a[194:195], v2 offset:9088
v_cvt_pk_bf16_f32 v92, v72, v73
v_mfma_f32_16x16x32_bf16 v[56:59], a[92:95], a[28:31], v[56:59]
v_exp_f32 v74, v74
v_mfma_f32_16x16x32_bf16 v[60:63], a[108:111], a[28:31], v[40:43]
ds_read_b64_tr_b16 a[196:197], v2 offset:8608
v_mfma_f32_16x16x32_bf16 v[60:63], a[104:107], a[24:27], v[60:63]
v_exp_f32 v75, v75
v_mfma_f32_16x16x32_bf16 v[60:63], a[100:103], a[20:23], v[60:63]
ds_read_b64_tr_b16 a[198:199], v2 offset:9120
v_cvt_pk_bf16_f32 v93, v74, v75
v_mfma_f32_16x16x32_bf16 v[60:63], a[96:99], a[16:19], v[60:63]
v_exp_f32 v76, v76
v_mfma_f32_16x16x32_bf16 v[64:67], a[112:115], a[16:19], v[40:43]
ds_read_b64_tr_b16 a[200:201], v2 offset:8640
v_mfma_f32_16x16x32_bf16 v[64:67], a[116:119], a[20:23], v[64:67]
v_exp_f32 v77, v77
v_mfma_f32_16x16x32_bf16 v[64:67], a[120:123], a[24:27], v[64:67]
ds_read_b64_tr_b16 a[202:203], v2 offset:9152
v_cvt_pk_bf16_f32 v94, v76, v77
v_mfma_f32_16x16x32_bf16 v[64:67], a[124:127], a[28:31], v[64:67]
v_exp_f32 v78, v78
v_mfma_f32_16x16x32_bf16 v[68:71], a[140:143], a[28:31], v[40:43]
ds_read_b64_tr_b16 a[204:205], v2 offset:8672
v_mfma_f32_16x16x32_bf16 v[68:71], a[136:139], a[24:27], v[68:71]
v_exp_f32 v79, v79
v_mfma_f32_16x16x32_bf16 v[68:71], a[132:135], a[20:23], v[68:71]
ds_read_b64_tr_b16 a[206:207], v2 offset:9184
v_cvt_pk_bf16_f32 v95, v78, v79
v_mfma_f32_16x16x32_bf16 v[68:71], a[128:131], a[16:19], v[68:71]
v_exp_f32 v56, v56
v_mfma_f32_16x16x32_bf16 v[96:99], a[144:147], v[88:91], v[96:99]
s_waitcnt lgkmcnt(8)
v_mfma_f32_16x16x32_bf16 v[96:99], a[176:179], v[92:95], v[96:99]
v_exp_f32 v57, v57
v_mfma_f32_16x16x32_bf16 v[100:103], a[180:183], v[92:95], v[100:103]
v_cvt_pk_bf16_f32 v80, v56, v57
v_mfma_f32_16x16x32_bf16 v[100:103], a[148:151], v[88:91], v[100:103]
v_exp_f32 v58, v58
v_mfma_f32_16x16x32_bf16 v[104:107], a[152:155], v[88:91], v[104:107]
v_mfma_f32_16x16x32_bf16 v[104:107], a[184:187], v[92:95], v[104:107]
v_exp_f32 v59, v59
v_mfma_f32_16x16x32_bf16 v[108:111], a[188:191], v[92:95], v[108:111]
v_cvt_pk_bf16_f32 v81, v58, v59
v_mfma_f32_16x16x32_bf16 v[108:111], a[156:159], v[88:91], v[108:111]
s_waitcnt lgkmcnt(0)
v_exp_f32 v60, v60
v_mfma_f32_16x16x32_bf16 v[112:115], a[160:163], v[88:91], v[112:115]
s_waitcnt lgkmcnt(0)
v_mfma_f32_16x16x32_bf16 v[112:115], a[192:195], v[92:95], v[112:115]
s_barrier
v_exp_f32 v61, v61
v_mfma_f32_16x16x32_bf16 v[116:119], a[196:199], v[92:95], v[116:119]
s_add_u32 s16, s16, 16384
s_addc_u32 s17, s17, 0
v_cvt_pk_bf16_f32 v82, v60, v61
v_mfma_f32_16x16x32_bf16 v[116:119], a[164:167], v[88:91], v[116:119]
s_add_u32 m0, s33, 33792
v_exp_f32 v62, v62
v_mfma_f32_16x16x32_bf16 v[120:123], a[168:171], v[88:91], v[120:123]
buffer_load_dwordx4 v3, s[16:19], 0 offen nt lds
v_mfma_f32_16x16x32_bf16 v[120:123], a[200:203], v[92:95], v[120:123]
v_exp_f32 v63, v63
v_mfma_f32_16x16x32_bf16 v[124:127], a[204:207], v[92:95], v[124:127]
ds_read_b128 v[16:19], v4
v_cvt_pk_bf16_f32 v83, v62, v63
v_mfma_f32_16x16x32_bf16 v[124:127], a[172:175], v[88:91], v[124:127]
s_add_u32 m0, s33, 33824
v_mfma_f32_16x16x32_bf16 a[208:211], a[228:231], v[88:91], a[208:211]
buffer_load_dwordx4 v3, s[16:19], 0 offen offset:1024 nt lds
v_mfma_f32_16x16x32_bf16 a[208:211], a[228:231], v[92:95], a[208:211]
v_mfma_f32_16x16x32_bf16 v[72:75], a[80:83], a[32:35], v[44:47]
v_mfma_f32_16x16x32_bf16 v[72:75], a[84:87], a[36:39], v[72:75]
s_add_u32 m0, s33, 33856
v_mfma_f32_16x16x32_bf16 v[72:75], a[88:91], a[40:43], v[72:75]
buffer_load_dwordx4 v3, s[16:19], 0 offen offset:2048 nt lds
v_mfma_f32_16x16x32_bf16 v[72:75], a[92:95], a[44:47], v[72:75]
v_exp_f32 v64, v64
v_exp_f32 v65, v65
v_exp_f32 v66, v66
v_exp_f32 v67, v67
v_cvt_pk_bf16_f32 v84, v64, v65
v_cvt_pk_bf16_f32 v85, v66, v67
v_mfma_f32_16x16x32_bf16 v[76:79], a[108:111], a[44:47], v[44:47]
v_mfma_f32_16x16x32_bf16 v[76:79], a[104:107], a[40:43], v[76:79]
v_exp_f32 v68, v68
v_mfma_f32_16x16x32_bf16 v[76:79], a[100:103], a[36:39], v[76:79]
v_mfma_f32_16x16x32_bf16 v[76:79], a[96:99], a[32:35], v[76:79]
s_add_u32 m0, s33, 33888
v_exp_f32 v69, v69
v_mfma_f32_16x16x32_bf16 v[56:59], a[112:115], a[32:35], v[44:47]
v_cvt_pk_bf16_f32 v86, v68, v69
v_mfma_f32_16x16x32_bf16 v[56:59], a[116:119], a[36:39], v[56:59]
v_exp_f32 v70, v70
v_mfma_f32_16x16x32_bf16 v[56:59], a[120:123], a[40:43], v[56:59]
buffer_load_dwordx4 v3, s[16:19], 0 offen offset:3072 nt lds
v_mfma_f32_16x16x32_bf16 v[56:59], a[124:127], a[44:47], v[56:59]
v_exp_f32 v71, v71
v_mfma_f32_16x16x32_bf16 v[60:63], a[140:143], a[44:47], v[44:47]
v_exp_f32 v72, v72
v_mfma_f32_16x16x32_bf16 v[60:63], a[136:139], a[40:43], v[60:63]
v_cvt_pk_bf16_f32 v87, v70, v71
v_mfma_f32_16x16x32_bf16 v[60:63], a[132:135], a[36:39], v[60:63]
v_exp_f32 v73, v73
v_mfma_f32_16x16x32_bf16 v[60:63], a[128:131], a[32:35], v[60:63]
v_cvt_pk_bf16_f32 v88, v72, v73
v_mfma_f32_16x16x32_bf16 v[128:131], a[144:147], v[80:83], v[128:131]
v_exp_f32 v74, v74
v_mfma_f32_16x16x32_bf16 v[128:131], a[176:179], v[84:87], v[128:131]
v_mfma_f32_16x16x32_bf16 v[132:135], a[180:183], v[84:87], v[132:135]
v_exp_f32 v75, v75
v_mfma_f32_16x16x32_bf16 v[132:135], a[148:151], v[80:83], v[132:135]
v_cvt_pk_bf16_f32 v89, v74, v75
v_mfma_f32_16x16x32_bf16 v[136:139], a[152:155], v[80:83], v[136:139]
v_exp_f32 v76, v76
v_mfma_f32_16x16x32_bf16 v[136:139], a[184:187], v[84:87], v[136:139]
v_mfma_f32_16x16x32_bf16 v[140:143], a[188:191], v[84:87], v[140:143]
v_exp_f32 v77, v77
v_mfma_f32_16x16x32_bf16 v[140:143], a[156:159], v[80:83], v[140:143]
v_cvt_pk_bf16_f32 v90, v76, v77
v_mfma_f32_16x16x32_bf16 v[144:147], a[160:163], v[80:83], v[144:147]
s_waitcnt lgkmcnt(0)
v_exp_f32 v78, v78
v_mfma_f32_16x16x32_bf16 v[144:147], a[192:195], v[84:87], v[144:147]
buffer_store_dwordx4 v[16:19], v3, s[28:31], s36 offen sc0 sc1
v_mfma_f32_16x16x32_bf16 v[148:151], a[196:199], v[84:87], v[148:151]
v_exp_f32 v79, v79
v_mfma_f32_16x16x32_bf16 v[148:151], a[164:167], v[80:83], v[148:151]
v_cvt_pk_bf16_f32 v91, v78, v79
v_mfma_f32_16x16x32_bf16 v[152:155], a[168:171], v[80:83], v[152:155]
v_exp_f32 v56, v56
v_mfma_f32_16x16x32_bf16 v[152:155], a[200:203], v[84:87], v[152:155]
v_mfma_f32_16x16x32_bf16 v[156:159], a[204:207], v[84:87], v[156:159]
s_waitcnt vmcnt(14) lgkmcnt(1)
v_exp_f32 v57, v57
v_mfma_f32_16x16x32_bf16 v[156:159], a[172:175], v[80:83], v[156:159]
v_cvt_pk_bf16_f32 v92, v56, v57
v_mfma_f32_16x16x32_bf16 a[212:215], a[228:231], v[80:83], a[212:215]
s_barrier
v_exp_f32 v58, v58
v_mfma_f32_16x16x32_bf16 a[212:215], a[228:231], v[84:87], a[212:215]
v_mfma_f32_16x16x32_bf16 v[64:67], a[80:83], a[48:51], v[48:51]
v_exp_f32 v59, v59
v_mfma_f32_16x16x32_bf16 v[64:67], a[84:87], a[52:55], v[64:67]
ds_read_b128 a[80:83], v1 offset:16896
v_cvt_pk_bf16_f32 v93, v58, v59
v_mfma_f32_16x16x32_bf16 v[64:67], a[88:91], a[56:59], v[64:67]
v_exp_f32 v60, v60
v_mfma_f32_16x16x32_bf16 v[64:67], a[92:95], a[60:63], v[64:67]
ds_read_b128 a[84:87], v1 offset:16960
ds_read_b128 a[88:91], v1 offset:17024
v_mfma_f32_16x16x32_bf16 v[68:71], a[108:111], a[60:63], v[48:51]
v_exp_f32 v61, v61
v_mfma_f32_16x16x32_bf16 v[68:71], a[104:107], a[56:59], v[68:71]
ds_read_b128 a[92:95], v1 offset:17088
v_cvt_pk_bf16_f32 v94, v60, v61
v_mfma_f32_16x16x32_bf16 v[68:71], a[100:103], a[52:55], v[68:71]
v_exp_f32 v62, v62
v_mfma_f32_16x16x32_bf16 v[68:71], a[96:99], a[48:51], v[68:71]
ds_read_b128 a[108:111], v1 offset:17600
v_mfma_f32_16x16x32_bf16 v[72:75], a[112:115], a[48:51], v[48:51]
v_exp_f32 v63, v63
v_mfma_f32_16x16x32_bf16 v[72:75], a[116:119], a[52:55], v[72:75]
v_exp_f32 v64, v64
v_mfma_f32_16x16x32_bf16 v[72:75], a[120:123], a[56:59], v[72:75]
ds_read_b128 a[104:107], v1 offset:17536
v_cvt_pk_bf16_f32 v95, v62, v63
v_mfma_f32_16x16x32_bf16 v[72:75], a[124:127], a[60:63], v[72:75]
v_exp_f32 v65, v65
v_mfma_f32_16x16x32_bf16 v[76:79], a[140:143], a[60:63], v[48:51]
ds_read_b128 a[100:103], v1 offset:17472
v_cvt_pk_bf16_f32 v80, v64, v65
v_mfma_f32_16x16x32_bf16 v[76:79], a[136:139], a[56:59], v[76:79]
v_exp_f32 v66, v66
v_mfma_f32_16x16x32_bf16 v[76:79], a[132:135], a[52:55], v[76:79]
ds_read_b128 a[96:99], v1 offset:17408
v_mfma_f32_16x16x32_bf16 v[76:79], a[128:131], a[48:51], v[76:79]
v_exp_f32 v67, v67
v_mfma_f32_16x16x32_bf16 v[160:163], a[144:147], v[88:91], v[160:163]
ds_read_b128 a[112:115], v1 offset:25344
v_cvt_pk_bf16_f32 v81, v66, v67
v_mfma_f32_16x16x32_bf16 v[160:163], a[176:179], v[92:95], v[160:163]
v_exp_f32 v68, v68
v_mfma_f32_16x16x32_bf16 v[164:167], a[180:183], v[92:95], v[164:167]
ds_read_b128 a[116:119], v1 offset:25408
v_mfma_f32_16x16x32_bf16 v[164:167], a[148:151], v[88:91], v[164:167]
v_exp_f32 v69, v69
v_mfma_f32_16x16x32_bf16 v[168:171], a[152:155], v[88:91], v[168:171]
ds_read_b128 a[120:123], v1 offset:25472
v_cvt_pk_bf16_f32 v82, v68, v69
v_mfma_f32_16x16x32_bf16 v[168:171], a[184:187], v[92:95], v[168:171]
v_exp_f32 v70, v70
v_mfma_f32_16x16x32_bf16 v[172:175], a[188:191], v[92:95], v[172:175]
ds_read_b128 a[124:127], v1 offset:25536
v_mfma_f32_16x16x32_bf16 v[172:175], a[156:159], v[88:91], v[172:175]
v_exp_f32 v71, v71
v_mfma_f32_16x16x32_bf16 v[176:179], a[160:163], v[88:91], v[176:179]
ds_read_b128 a[140:143], v1 offset:26048
v_cvt_pk_bf16_f32 v83, v70, v71
v_mfma_f32_16x16x32_bf16 v[176:179], a[192:195], v[92:95], v[176:179]
v_exp_f32 v72, v72
v_mfma_f32_16x16x32_bf16 v[180:183], a[196:199], v[92:95], v[180:183]
ds_read_b128 a[136:139], v1 offset:25984
v_mfma_f32_16x16x32_bf16 v[180:183], a[164:167], v[88:91], v[180:183]
v_exp_f32 v73, v73
v_mfma_f32_16x16x32_bf16 v[184:187], a[168:171], v[88:91], v[184:187]
ds_read_b128 a[132:135], v1 offset:25920
v_cvt_pk_bf16_f32 v84, v72, v73
v_mfma_f32_16x16x32_bf16 v[184:187], a[200:203], v[92:95], v[184:187]
v_exp_f32 v74, v74
v_mfma_f32_16x16x32_bf16 v[188:191], a[204:207], v[92:95], v[188:191]
ds_read_b128 a[128:131], v1 offset:25856
v_mfma_f32_16x16x32_bf16 v[188:191], a[172:175], v[88:91], v[188:191]
v_exp_f32 v75, v75
v_mfma_f32_16x16x32_bf16 a[216:219], a[228:231], v[88:91], a[216:219]
s_waitcnt lgkmcnt(8)
v_cvt_pk_bf16_f32 v85, v74, v75
v_mfma_f32_16x16x32_bf16 a[216:219], a[228:231], v[92:95], a[216:219]
v_mfma_f32_16x16x32_bf16 v[56:59], a[80:83], a[64:67], v[52:55]
v_mfma_f32_16x16x32_bf16 v[56:59], a[84:87], a[68:71], v[56:59]
v_mfma_f32_16x16x32_bf16 v[56:59], a[88:91], a[72:75], v[56:59]
v_mfma_f32_16x16x32_bf16 v[56:59], a[92:95], a[76:79], v[56:59]
v_exp_f32 v76, v76
v_exp_f32 v77, v77
v_exp_f32 v78, v78
v_exp_f32 v79, v79
v_cvt_pk_bf16_f32 v86, v76, v77
v_cvt_pk_bf16_f32 v87, v78, v79
v_mfma_f32_16x16x32_bf16 v[60:63], a[108:111], a[76:79], v[52:55]
v_mfma_f32_16x16x32_bf16 v[60:63], a[104:107], a[72:75], v[60:63]
s_waitcnt vmcnt(10) lgkmcnt(0)
v_mfma_f32_16x16x32_bf16 v[60:63], a[100:103], a[68:71], v[60:63]
v_mfma_f32_16x16x32_bf16 v[60:63], a[96:99], a[64:67], v[60:63]
s_barrier
s_add_u32 s12, s12, 16384
s_addc_u32 s13, s13, 0
v_mfma_f32_16x16x32_bf16 v[192:195], a[144:147], v[80:83], v[192:195]
ds_read_b64_tr_b16 a[144:145], v2 offset:16896
ds_read_b64_tr_b16 a[146:147], v2 offset:17408
v_mfma_f32_16x16x32_bf16 v[192:195], a[176:179], v[84:87], v[192:195]
v_exp_f32 v56, v56
v_mfma_f32_16x16x32_bf16 v[196:199], a[180:183], v[84:87], v[196:199]
v_mfma_f32_16x16x32_bf16 v[196:199], a[148:151], v[80:83], v[196:199]
ds_read_b64_tr_b16 a[148:149], v2 offset:16928
ds_read_b64_tr_b16 a[150:151], v2 offset:17440
v_mfma_f32_16x16x32_bf16 v[200:203], a[152:155], v[80:83], v[200:203]
s_add_u32 m0, s33, 16896
v_exp_f32 v57, v57
v_mfma_f32_16x16x32_bf16 v[200:203], a[184:187], v[84:87], v[200:203]
ds_read_b64_tr_b16 a[152:153], v2 offset:16960
v_cvt_pk_bf16_f32 v88, v56, v57
v_mfma_f32_16x16x32_bf16 v[204:207], a[188:191], v[84:87], v[204:207]
buffer_load_dwordx4 v3, s[12:15], 0 offen nt lds
v_mfma_f32_16x16x32_bf16 v[204:207], a[156:159], v[80:83], v[204:207]
v_exp_f32 v58, v58
v_mfma_f32_16x16x32_bf16 v[208:211], a[160:163], v[80:83], v[208:211]
ds_read_b64_tr_b16 a[154:155], v2 offset:17472
ds_read_b64_tr_b16 a[156:157], v2 offset:16992
v_mfma_f32_16x16x32_bf16 v[208:211], a[192:195], v[84:87], v[208:211]
ds_read_b64_tr_b16 a[158:159], v2 offset:17504
v_mfma_f32_16x16x32_bf16 v[212:215], a[196:199], v[84:87], v[212:215]
v_exp_f32 v59, v59
v_mfma_f32_16x16x32_bf16 v[212:215], a[164:167], v[80:83], v[212:215]
ds_read_b64_tr_b16 a[160:161], v2 offset:17024
v_cvt_pk_bf16_f32 v89, v58, v59
v_mfma_f32_16x16x32_bf16 v[216:219], a[168:171], v[80:83], v[216:219]
ds_read_b64_tr_b16 a[162:163], v2 offset:17536
v_mfma_f32_16x16x32_bf16 v[216:219], a[200:203], v[84:87], v[216:219]
s_add_u32 m0, s33, 16928
v_exp_f32 v60, v60
v_mfma_f32_16x16x32_bf16 v[220:223], a[204:207], v[84:87], v[220:223]
buffer_load_dwordx4 v3, s[12:15], 0 offen offset:1024 nt lds
v_mfma_f32_16x16x32_bf16 v[220:223], a[172:175], v[80:83], v[220:223]
ds_read_b64_tr_b16 a[164:165], v2 offset:17056
v_mfma_f32_16x16x32_bf16 a[220:223], a[228:231], v[80:83], a[220:223]
v_exp_f32 v61, v61
v_mfma_f32_16x16x32_bf16 a[220:223], a[228:231], v[84:87], a[220:223]
ds_read_b64_tr_b16 a[166:167], v2 offset:17568
v_cvt_pk_bf16_f32 v90, v60, v61
v_mfma_f32_16x16x32_bf16 v[64:67], a[80:83], a[0:3], v[36:39]
ds_read_b64_tr_b16 a[168:169], v2 offset:17088
v_mfma_f32_16x16x32_bf16 v[64:67], a[84:87], a[4:7], v[64:67]
v_exp_f32 v62, v62
v_mfma_f32_16x16x32_bf16 v[64:67], a[88:91], a[8:11], v[64:67]
ds_read_b64_tr_b16 a[170:171], v2 offset:17600
v_mfma_f32_16x16x32_bf16 v[64:67], a[92:95], a[12:15], v[64:67]
ds_read_b64_tr_b16 a[172:173], v2 offset:17120
v_mfma_f32_16x16x32_bf16 v[68:71], a[108:111], a[12:15], v[36:39]
s_add_u32 m0, s33, 16960
v_exp_f32 v63, v63
v_mfma_f32_16x16x32_bf16 v[68:71], a[104:107], a[8:11], v[68:71]
ds_read_b64_tr_b16 a[174:175], v2 offset:17632
v_cvt_pk_bf16_f32 v91, v62, v63
v_mfma_f32_16x16x32_bf16 v[68:71], a[100:103], a[4:7], v[68:71]
buffer_load_dwordx4 v3, s[12:15], 0 offen offset:2048 nt lds
v_mfma_f32_16x16x32_bf16 v[68:71], a[96:99], a[0:3], v[68:71]
ds_read_b64_tr_b16 a[176:177], v2 offset:25344
v_mfma_f32_16x16x32_bf16 v[72:75], a[112:115], a[0:3], v[36:39]
v_exp_f32 v64, v64
v_mfma_f32_16x16x32_bf16 v[72:75], a[116:119], a[4:7], v[72:75]
ds_read_b64_tr_b16 a[178:179], v2 offset:25856
v_mfma_f32_16x16x32_bf16 v[72:75], a[120:123], a[8:11], v[72:75]
v_exp_f32 v65, v65
v_mfma_f32_16x16x32_bf16 v[72:75], a[124:127], a[12:15], v[72:75]
ds_read_b64_tr_b16 a[180:181], v2 offset:25376
v_cvt_pk_bf16_f32 v80, v64, v65
v_mfma_f32_16x16x32_bf16 v[76:79], a[140:143], a[12:15], v[36:39]
v_exp_f32 v66, v66
v_mfma_f32_16x16x32_bf16 v[76:79], a[136:139], a[8:11], v[76:79]
s_waitcnt lgkmcnt(11)
ds_read_b64_tr_b16 a[182:183], v2 offset:25888
v_mfma_f32_16x16x32_bf16 v[76:79], a[132:135], a[4:7], v[76:79]
s_add_u32 m0, s33, 16992
v_exp_f32 v67, v67
v_mfma_f32_16x16x32_bf16 v[76:79], a[128:131], a[0:3], v[76:79]
ds_read_b64_tr_b16 a[184:185], v2 offset:25408
v_cvt_pk_bf16_f32 v81, v66, v67
v_mfma_f32_16x16x32_bf16 v[224:227], a[144:147], v[88:91], v[224:227]
v_exp_f32 v68, v68
v_mfma_f32_16x16x32_bf16 v[228:231], a[148:151], v[88:91], v[228:231]
buffer_load_dwordx4 v3, s[12:15], 0 offen offset:3072 nt lds
v_mfma_f32_16x16x32_bf16 v[232:235], a[152:155], v[88:91], v[232:235]
s_waitcnt lgkmcnt(5)
v_exp_f32 v69, v69
v_mfma_f32_16x16x32_bf16 v[236:239], a[156:159], v[88:91], v[236:239]
ds_read_b64_tr_b16 a[186:187], v2 offset:25920
v_cvt_pk_bf16_f32 v82, v68, v69
v_mfma_f32_16x16x32_bf16 v[240:243], a[160:163], v[88:91], v[240:243]
v_exp_f32 v70, v70
v_mfma_f32_16x16x32_bf16 v[244:247], a[164:167], v[88:91], v[244:247]
ds_read_b64_tr_b16 a[188:189], v2 offset:25440
v_mfma_f32_16x16x32_bf16 v[248:251], a[168:171], v[88:91], v[248:251]
v_exp_f32 v71, v71
v_mfma_f32_16x16x32_bf16 v[252:255], a[172:175], v[88:91], v[252:255]
ds_read_b64_tr_b16 a[190:191], v2 offset:25952
v_cvt_pk_bf16_f32 v83, v70, v71
v_mfma_f32_16x16x32_bf16 a[224:227], a[228:231], v[88:91], a[224:227]
v_exp_f32 v72, v72
v_mfma_f32_16x16x32_bf16 v[56:59], a[80:83], a[16:19], v[40:43]
ds_read_b64_tr_b16 a[192:193], v2 offset:25472
v_mfma_f32_16x16x32_bf16 v[56:59], a[84:87], a[20:23], v[56:59]
v_exp_f32 v73, v73
v_mfma_f32_16x16x32_bf16 v[56:59], a[88:91], a[24:27], v[56:59]
ds_read_b64_tr_b16 a[194:195], v2 offset:25984
v_cvt_pk_bf16_f32 v84, v72, v73
v_mfma_f32_16x16x32_bf16 v[56:59], a[92:95], a[28:31], v[56:59]
v_exp_f32 v74, v74
v_mfma_f32_16x16x32_bf16 v[60:63], a[108:111], a[28:31], v[40:43]
ds_read_b64_tr_b16 a[196:197], v2 offset:25504
v_mfma_f32_16x16x32_bf16 v[60:63], a[104:107], a[24:27], v[60:63]
v_exp_f32 v75, v75
v_mfma_f32_16x16x32_bf16 v[60:63], a[100:103], a[20:23], v[60:63]
ds_read_b64_tr_b16 a[198:199], v2 offset:26016
v_cvt_pk_bf16_f32 v85, v74, v75
v_mfma_f32_16x16x32_bf16 v[60:63], a[96:99], a[16:19], v[60:63]
v_exp_f32 v76, v76
v_mfma_f32_16x16x32_bf16 v[64:67], a[112:115], a[16:19], v[40:43]
ds_read_b64_tr_b16 a[200:201], v2 offset:25536
v_mfma_f32_16x16x32_bf16 v[64:67], a[116:119], a[20:23], v[64:67]
v_exp_f32 v77, v77
v_mfma_f32_16x16x32_bf16 v[64:67], a[120:123], a[24:27], v[64:67]
ds_read_b64_tr_b16 a[202:203], v2 offset:26048
v_cvt_pk_bf16_f32 v86, v76, v77
v_mfma_f32_16x16x32_bf16 v[64:67], a[124:127], a[28:31], v[64:67]
v_exp_f32 v78, v78
v_mfma_f32_16x16x32_bf16 v[68:71], a[140:143], a[28:31], v[40:43]
ds_read_b64_tr_b16 a[204:205], v2 offset:25568
v_mfma_f32_16x16x32_bf16 v[68:71], a[136:139], a[24:27], v[68:71]
v_exp_f32 v79, v79
v_mfma_f32_16x16x32_bf16 v[68:71], a[132:135], a[20:23], v[68:71]
ds_read_b64_tr_b16 a[206:207], v2 offset:26080
v_cvt_pk_bf16_f32 v87, v78, v79
v_mfma_f32_16x16x32_bf16 v[68:71], a[128:131], a[16:19], v[68:71]
v_exp_f32 v56, v56
v_mfma_f32_16x16x32_bf16 v[96:99], a[144:147], v[80:83], v[96:99]
s_waitcnt lgkmcnt(8)
v_mfma_f32_16x16x32_bf16 v[96:99], a[176:179], v[84:87], v[96:99]
v_exp_f32 v57, v57
v_mfma_f32_16x16x32_bf16 v[100:103], a[180:183], v[84:87], v[100:103]
v_cvt_pk_bf16_f32 v88, v56, v57
v_mfma_f32_16x16x32_bf16 v[100:103], a[148:151], v[80:83], v[100:103]
v_exp_f32 v58, v58
v_mfma_f32_16x16x32_bf16 v[104:107], a[152:155], v[80:83], v[104:107]
v_mfma_f32_16x16x32_bf16 v[104:107], a[184:187], v[84:87], v[104:107]
v_exp_f32 v59, v59
v_mfma_f32_16x16x32_bf16 v[108:111], a[188:191], v[84:87], v[108:111]
v_cvt_pk_bf16_f32 v89, v58, v59
v_mfma_f32_16x16x32_bf16 v[108:111], a[156:159], v[80:83], v[108:111]
s_waitcnt lgkmcnt(0)
v_exp_f32 v60, v60
v_mfma_f32_16x16x32_bf16 v[112:115], a[160:163], v[80:83], v[112:115]
s_waitcnt lgkmcnt(0)
v_mfma_f32_16x16x32_bf16 v[112:115], a[192:195], v[84:87], v[112:115]
s_barrier
v_exp_f32 v61, v61
v_mfma_f32_16x16x32_bf16 v[116:119], a[196:199], v[84:87], v[116:119]
s_add_u32 s16, s16, 16384
s_addc_u32 s17, s17, 0
v_cvt_pk_bf16_f32 v90, v60, v61
v_mfma_f32_16x16x32_bf16 v[116:119], a[164:167], v[80:83], v[116:119]
s_add_u32 m0, s33, 50688
v_exp_f32 v62, v62
v_mfma_f32_16x16x32_bf16 v[120:123], a[168:171], v[80:83], v[120:123]
buffer_load_dwordx4 v3, s[16:19], 0 offen nt lds
v_mfma_f32_16x16x32_bf16 v[120:123], a[200:203], v[84:87], v[120:123]
v_exp_f32 v63, v63
v_mfma_f32_16x16x32_bf16 v[124:127], a[204:207], v[84:87], v[124:127]
ds_read_b128 v[20:23], v4 offset:1056
v_cvt_pk_bf16_f32 v91, v62, v63
v_mfma_f32_16x16x32_bf16 v[124:127], a[172:175], v[80:83], v[124:127]
s_add_u32 m0, s33, 50720
v_mfma_f32_16x16x32_bf16 a[208:211], a[228:231], v[80:83], a[208:211]
buffer_load_dwordx4 v3, s[16:19], 0 offen offset:1024 nt lds
v_mfma_f32_16x16x32_bf16 a[208:211], a[228:231], v[84:87], a[208:211]
v_mfma_f32_16x16x32_bf16 v[72:75], a[80:83], a[32:35], v[44:47]
v_add_u32 v4, 2112, v4
v_mfma_f32_16x16x32_bf16 v[72:75], a[84:87], a[36:39], v[72:75]
s_add_u32 m0, s33, 50752
v_mfma_f32_16x16x32_bf16 v[72:75], a[88:91], a[40:43], v[72:75]
buffer_load_dwordx4 v3, s[16:19], 0 offen offset:2048 nt lds
v_mfma_f32_16x16x32_bf16 v[72:75], a[92:95], a[44:47], v[72:75]
v_exp_f32 v64, v64
v_exp_f32 v65, v65
v_exp_f32 v66, v66
v_exp_f32 v67, v67
v_cvt_pk_bf16_f32 v92, v64, v65
v_cvt_pk_bf16_f32 v93, v66, v67
v_mfma_f32_16x16x32_bf16 v[76:79], a[108:111], a[44:47], v[44:47]
v_mfma_f32_16x16x32_bf16 v[76:79], a[104:107], a[40:43], v[76:79]
v_exp_f32 v68, v68
v_mfma_f32_16x16x32_bf16 v[76:79], a[100:103], a[36:39], v[76:79]
v_mfma_f32_16x16x32_bf16 v[76:79], a[96:99], a[32:35], v[76:79]
s_add_u32 m0, s33, 50784
v_exp_f32 v69, v69
v_mfma_f32_16x16x32_bf16 v[56:59], a[112:115], a[32:35], v[44:47]
v_cvt_pk_bf16_f32 v94, v68, v69
v_mfma_f32_16x16x32_bf16 v[56:59], a[116:119], a[36:39], v[56:59]
v_exp_f32 v70, v70
v_mfma_f32_16x16x32_bf16 v[56:59], a[120:123], a[40:43], v[56:59]
buffer_load_dwordx4 v3, s[16:19], 0 offen offset:3072 nt lds
v_mfma_f32_16x16x32_bf16 v[56:59], a[124:127], a[44:47], v[56:59]
v_exp_f32 v71, v71
v_mfma_f32_16x16x32_bf16 v[60:63], a[140:143], a[44:47], v[44:47]
v_exp_f32 v72, v72
v_mfma_f32_16x16x32_bf16 v[60:63], a[136:139], a[40:43], v[60:63]
v_cvt_pk_bf16_f32 v95, v70, v71
v_mfma_f32_16x16x32_bf16 v[60:63], a[132:135], a[36:39], v[60:63]
v_exp_f32 v73, v73
v_mfma_f32_16x16x32_bf16 v[60:63], a[128:131], a[32:35], v[60:63]
v_cvt_pk_bf16_f32 v80, v72, v73
v_mfma_f32_16x16x32_bf16 v[128:131], a[144:147], v[88:91], v[128:131]
v_exp_f32 v74, v74
v_mfma_f32_16x16x32_bf16 v[128:131], a[176:179], v[92:95], v[128:131]
v_mfma_f32_16x16x32_bf16 v[132:135], a[180:183], v[92:95], v[132:135]
v_exp_f32 v75, v75
v_mfma_f32_16x16x32_bf16 v[132:135], a[148:151], v[88:91], v[132:135]
v_cvt_pk_bf16_f32 v81, v74, v75
v_mfma_f32_16x16x32_bf16 v[136:139], a[152:155], v[88:91], v[136:139]
v_exp_f32 v76, v76
v_mfma_f32_16x16x32_bf16 v[136:139], a[184:187], v[92:95], v[136:139]
v_mfma_f32_16x16x32_bf16 v[140:143], a[188:191], v[92:95], v[140:143]
v_exp_f32 v77, v77
v_mfma_f32_16x16x32_bf16 v[140:143], a[156:159], v[88:91], v[140:143]
v_cvt_pk_bf16_f32 v82, v76, v77
v_mfma_f32_16x16x32_bf16 v[144:147], a[160:163], v[88:91], v[144:147]
s_waitcnt lgkmcnt(0)
v_exp_f32 v78, v78
v_mfma_f32_16x16x32_bf16 v[144:147], a[192:195], v[92:95], v[144:147]
buffer_store_dwordx4 v[20:23], v3, s[28:31], s36 offen offset:1024 sc0 sc1
v_mfma_f32_16x16x32_bf16 v[148:151], a[196:199], v[92:95], v[148:151]
s_add_u32 s36, s36, 2048
v_exp_f32 v79, v79
v_mfma_f32_16x16x32_bf16 v[148:151], a[164:167], v[88:91], v[148:151]
v_cvt_pk_bf16_f32 v83, v78, v79
v_mfma_f32_16x16x32_bf16 v[152:155], a[168:171], v[88:91], v[152:155]
v_exp_f32 v56, v56
v_mfma_f32_16x16x32_bf16 v[152:155], a[200:203], v[92:95], v[152:155]
v_mfma_f32_16x16x32_bf16 v[156:159], a[204:207], v[92:95], v[156:159]
s_waitcnt vmcnt(14) lgkmcnt(1)
v_exp_f32 v57, v57
v_mfma_f32_16x16x32_bf16 v[156:159], a[172:175], v[88:91], v[156:159]
v_cvt_pk_bf16_f32 v84, v56, v57
v_mfma_f32_16x16x32_bf16 a[212:215], a[228:231], v[88:91], a[212:215]
s_barrier
v_exp_f32 v58, v58
v_mfma_f32_16x16x32_bf16 a[212:215], a[228:231], v[92:95], a[212:215]
v_mfma_f32_16x16x32_bf16 v[64:67], a[80:83], a[48:51], v[48:51]
v_exp_f32 v59, v59
v_mfma_f32_16x16x32_bf16 v[64:67], a[84:87], a[52:55], v[64:67]
ds_read_b128 a[80:83], v1
v_cvt_pk_bf16_f32 v85, v58, v59
v_mfma_f32_16x16x32_bf16 v[64:67], a[88:91], a[56:59], v[64:67]
v_exp_f32 v60, v60
v_mfma_f32_16x16x32_bf16 v[64:67], a[92:95], a[60:63], v[64:67]
ds_read_b128 a[84:87], v1 offset:64
ds_read_b128 a[88:91], v1 offset:128
v_mfma_f32_16x16x32_bf16 v[68:71], a[108:111], a[60:63], v[48:51]
v_exp_f32 v61, v61
v_mfma_f32_16x16x32_bf16 v[68:71], a[104:107], a[56:59], v[68:71]
ds_read_b128 a[92:95], v1 offset:192
v_cvt_pk_bf16_f32 v86, v60, v61
v_mfma_f32_16x16x32_bf16 v[68:71], a[100:103], a[52:55], v[68:71]
v_exp_f32 v62, v62
v_mfma_f32_16x16x32_bf16 v[68:71], a[96:99], a[48:51], v[68:71]
ds_read_b128 a[108:111], v1 offset:704
v_mfma_f32_16x16x32_bf16 v[72:75], a[112:115], a[48:51], v[48:51]
v_exp_f32 v63, v63
v_mfma_f32_16x16x32_bf16 v[72:75], a[116:119], a[52:55], v[72:75]
v_exp_f32 v64, v64
v_mfma_f32_16x16x32_bf16 v[72:75], a[120:123], a[56:59], v[72:75]
ds_read_b128 a[104:107], v1 offset:640
v_cvt_pk_bf16_f32 v87, v62, v63
v_mfma_f32_16x16x32_bf16 v[72:75], a[124:127], a[60:63], v[72:75]
v_exp_f32 v65, v65
v_mfma_f32_16x16x32_bf16 v[76:79], a[140:143], a[60:63], v[48:51]
ds_read_b128 a[100:103], v1 offset:576
v_cvt_pk_bf16_f32 v88, v64, v65
v_mfma_f32_16x16x32_bf16 v[76:79], a[136:139], a[56:59], v[76:79]
v_exp_f32 v66, v66
v_mfma_f32_16x16x32_bf16 v[76:79], a[132:135], a[52:55], v[76:79]
ds_read_b128 a[96:99], v1 offset:512
v_mfma_f32_16x16x32_bf16 v[76:79], a[128:131], a[48:51], v[76:79]
v_exp_f32 v67, v67
v_mfma_f32_16x16x32_bf16 v[160:163], a[144:147], v[80:83], v[160:163]
ds_read_b128 a[112:115], v1 offset:8448
v_cvt_pk_bf16_f32 v89, v66, v67
v_mfma_f32_16x16x32_bf16 v[160:163], a[176:179], v[84:87], v[160:163]
v_exp_f32 v68, v68
v_mfma_f32_16x16x32_bf16 v[164:167], a[180:183], v[84:87], v[164:167]
ds_read_b128 a[116:119], v1 offset:8512
v_mfma_f32_16x16x32_bf16 v[164:167], a[148:151], v[80:83], v[164:167]
v_exp_f32 v69, v69
v_mfma_f32_16x16x32_bf16 v[168:171], a[152:155], v[80:83], v[168:171]
ds_read_b128 a[120:123], v1 offset:8576
v_cvt_pk_bf16_f32 v90, v68, v69
v_mfma_f32_16x16x32_bf16 v[168:171], a[184:187], v[84:87], v[168:171]
v_exp_f32 v70, v70
v_mfma_f32_16x16x32_bf16 v[172:175], a[188:191], v[84:87], v[172:175]
ds_read_b128 a[124:127], v1 offset:8640
v_mfma_f32_16x16x32_bf16 v[172:175], a[156:159], v[80:83], v[172:175]
v_exp_f32 v71, v71
v_mfma_f32_16x16x32_bf16 v[176:179], a[160:163], v[80:83], v[176:179]
ds_read_b128 a[140:143], v1 offset:9152
v_cvt_pk_bf16_f32 v91, v70, v71
v_mfma_f32_16x16x32_bf16 v[176:179], a[192:195], v[84:87], v[176:179]
v_exp_f32 v72, v72
v_mfma_f32_16x16x32_bf16 v[180:183], a[196:199], v[84:87], v[180:183]
ds_read_b128 a[136:139], v1 offset:9088
v_mfma_f32_16x16x32_bf16 v[180:183], a[164:167], v[80:83], v[180:183]
v_exp_f32 v73, v73
v_mfma_f32_16x16x32_bf16 v[184:187], a[168:171], v[80:83], v[184:187]
ds_read_b128 a[132:135], v1 offset:9024
v_cvt_pk_bf16_f32 v92, v72, v73
v_mfma_f32_16x16x32_bf16 v[184:187], a[200:203], v[84:87], v[184:187]
s_sub_u32 s34, s34, 1
v_exp_f32 v74, v74
v_mfma_f32_16x16x32_bf16 v[188:191], a[204:207], v[84:87], v[188:191]
ds_read_b128 a[128:131], v1 offset:8960
v_mfma_f32_16x16x32_bf16 v[188:191], a[172:175], v[80:83], v[188:191]
s_cmp_lg_u32 s34, 0
v_exp_f32 v75, v75
v_mfma_f32_16x16x32_bf16 a[216:219], a[228:231], v[80:83], a[216:219]
s_waitcnt lgkmcnt(8)
v_cvt_pk_bf16_f32 v93, v74, v75
v_mfma_f32_16x16x32_bf16 a[216:219], a[228:231], v[84:87], a[216:219]
s_cbranch_scc1 L_m110
L_x10:
v_exp_f32 v76, v76
v_mfma_f32_16x16x32_bf16 v[56:59], a[80:83], a[64:67], v[52:55]
v_mfma_f32_16x16x32_bf16 v[56:59], a[84:87], a[68:71], v[56:59]
v_exp_f32 v77, v77
v_mfma_f32_16x16x32_bf16 v[56:59], a[88:91], a[72:75], v[56:59]
v_cvt_pk_bf16_f32 v94, v76, v77
v_mfma_f32_16x16x32_bf16 v[56:59], a[92:95], a[76:79], v[56:59]
v_exp_f32 v78, v78
v_mfma_f32_16x16x32_bf16 v[60:63], a[108:111], a[76:79], v[52:55]
v_mfma_f32_16x16x32_bf16 v[60:63], a[104:107], a[72:75], v[60:63]
s_waitcnt vmcnt(10) lgkmcnt(0)
v_exp_f32 v79, v79
v_mfma_f32_16x16x32_bf16 v[60:63], a[100:103], a[68:71], v[60:63]
v_cvt_pk_bf16_f32 v95, v78, v79
v_mfma_f32_16x16x32_bf16 v[60:63], a[96:99], a[64:67], v[60:63]
s_barrier
v_mfma_f32_16x16x32_bf16 v[192:195], a[144:147], v[88:91], v[192:195]
ds_read_b64_tr_b16 a[144:145], v2
v_mfma_f32_16x16x32_bf16 v[192:195], a[176:179], v[92:95], v[192:195]
v_exp_f32 v56, v56
v_mfma_f32_16x16x32_bf16 v[196:199], a[180:183], v[92:95], v[196:199]
ds_read_b64_tr_b16 a[146:147], v2 offset:512
v_mfma_f32_16x16x32_bf16 v[196:199], a[148:151], v[88:91], v[196:199]
ds_read_b64_tr_b16 a[148:149], v2 offset:32
v_mfma_f32_16x16x32_bf16 v[200:203], a[152:155], v[88:91], v[200:203]
v_exp_f32 v57, v57
v_mfma_f32_16x16x32_bf16 v[200:203], a[184:187], v[92:95], v[200:203]
ds_read_b64_tr_b16 a[150:151], v2 offset:544
v_cvt_pk_bf16_f32 v80, v56, v57
v_mfma_f32_16x16x32_bf16 v[204:207], a[188:191], v[92:95], v[204:207]
ds_read_b64_tr_b16 a[152:153], v2 offset:64
v_mfma_f32_16x16x32_bf16 v[204:207], a[156:159], v[88:91], v[204:207]
v_exp_f32 v58, v58
v_mfma_f32_16x16x32_bf16 v[208:211], a[160:163], v[88:91], v[208:211]
ds_read_b64_tr_b16 a[154:155], v2 offset:576
v_mfma_f32_16x16x32_bf16 v[208:211], a[192:195], v[92:95], v[208:211]
ds_read_b64_tr_b16 a[156:157], v2 offset:96
v_mfma_f32_16x16x32_bf16 v[212:215], a[196:199], v[92:95], v[212:215]
v_exp_f32 v59, v59
v_mfma_f32_16x16x32_bf16 v[212:215], a[164:167], v[88:91], v[212:215]
ds_read_b64_tr_b16 a[158:159], v2 offset:608
v_cvt_pk_bf16_f32 v81, v58, v59
v_mfma_f32_16x16x32_bf16 v[216:219], a[168:171], v[88:91], v[216:219]
ds_read_b64_tr_b16 a[160:161], v2 offset:128
v_mfma_f32_16x16x32_bf16 v[216:219], a[200:203], v[92:95], v[216:219]
v_exp_f32 v60, v60
v_mfma_f32_16x16x32_bf16 v[220:223], a[204:207], v[92:95], v[220:223]
ds_read_b64_tr_b16 a[162:163], v2 offset:640
v_mfma_f32_16x16x32_bf16 v[220:223], a[172:175], v[88:91], v[220:223]
ds_read_b64_tr_b16 a[164:165], v2 offset:160
v_mfma_f32_16x16x32_bf16 a[220:223], a[228:231], v[88:91], a[220:223]
v_exp_f32 v61, v61
v_mfma_f32_16x16x32_bf16 a[220:223], a[228:231], v[92:95], a[220:223]
ds_read_b64_tr_b16 a[166:167], v2 offset:672
v_cvt_pk_bf16_f32 v82, v60, v61
v_mfma_f32_16x16x32_bf16 v[64:67], a[80:83], a[0:3], v[36:39]
ds_read_b64_tr_b16 a[168:169], v2 offset:192
v_mfma_f32_16x16x32_bf16 v[64:67], a[84:87], a[4:7], v[64:67]
v_exp_f32 v62, v62
v_mfma_f32_16x16x32_bf16 v[64:67], a[88:91], a[8:11], v[64:67]
ds_read_b64_tr_b16 a[170:171], v2 offset:704
v_mfma_f32_16x16x32_bf16 v[64:67], a[92:95], a[12:15], v[64:67]
ds_read_b64_tr_b16 a[172:173], v2 offset:224
v_mfma_f32_16x16x32_bf16 v[68:71], a[108:111], a[12:15], v[36:39]
v_exp_f32 v63, v63
v_mfma_f32_16x16x32_bf16 v[68:71], a[104:107], a[8:11], v[68:71]
ds_read_b64_tr_b16 a[174:175], v2 offset:736
v_cvt_pk_bf16_f32 v83, v62, v63
v_mfma_f32_16x16x32_bf16 v[68:71], a[100:103], a[4:7], v[68:71]
ds_read_b64_tr_b16 a[176:177], v2 offset:8448
v_mfma_f32_16x16x32_bf16 v[68:71], a[96:99], a[0:3], v[68:71]
ds_read_b64_tr_b16 a[178:179], v2 offset:8960
v_mfma_f32_16x16x32_bf16 v[72:75], a[112:115], a[0:3], v[36:39]
v_exp_f32 v64, v64
v_mfma_f32_16x16x32_bf16 v[72:75], a[116:119], a[4:7], v[72:75]
ds_read_b64_tr_b16 a[180:181], v2 offset:8480
v_mfma_f32_16x16x32_bf16 v[72:75], a[120:123], a[8:11], v[72:75]
v_exp_f32 v65, v65
v_mfma_f32_16x16x32_bf16 v[72:75], a[124:127], a[12:15], v[72:75]
ds_read_b64_tr_b16 a[182:183], v2 offset:8992
v_cvt_pk_bf16_f32 v88, v64, v65
v_mfma_f32_16x16x32_bf16 v[76:79], a[140:143], a[12:15], v[36:39]
v_exp_f32 v66, v66
v_mfma_f32_16x16x32_bf16 v[76:79], a[136:139], a[8:11], v[76:79]
ds_read_b64_tr_b16 a[184:185], v2 offset:8512
v_mfma_f32_16x16x32_bf16 v[76:79], a[132:135], a[4:7], v[76:79]
s_waitcnt lgkmcnt(13)
v_exp_f32 v67, v67
v_mfma_f32_16x16x32_bf16 v[76:79], a[128:131], a[0:3], v[76:79]
ds_read_b64_tr_b16 a[186:187], v2 offset:9024
v_cvt_pk_bf16_f32 v89, v66, v67
v_mfma_f32_16x16x32_bf16 v[224:227], a[144:147], v[80:83], v[224:227]
v_exp_f32 v68, v68
v_mfma_f32_16x16x32_bf16 v[228:231], a[148:151], v[80:83], v[228:231]
ds_read_b64_tr_b16 a[188:189], v2 offset:8544
v_mfma_f32_16x16x32_bf16 v[232:235], a[152:155], v[80:83], v[232:235]
s_waitcnt lgkmcnt(7)
v_exp_f32 v69, v69
v_mfma_f32_16x16x32_bf16 v[236:239], a[156:159], v[80:83], v[236:239]
ds_read_b64_tr_b16 a[190:191], v2 offset:9056
v_cvt_pk_bf16_f32 v90, v68, v69
v_mfma_f32_16x16x32_bf16 v[240:243], a[160:163], v[80:83], v[240:243]
v_exp_f32 v70, v70
v_mfma_f32_16x16x32_bf16 v[244:247], a[164:167], v[80:83], v[244:247]
ds_read_b64_tr_b16 a[192:193], v2 offset:8576
v_mfma_f32_16x16x32_bf16 v[248:251], a[168:171], v[80:83], v[248:251]
v_exp_f32 v71, v71
v_mfma_f32_16x16x32_bf16 v[252:255], a[172:175], v[80:83], v[252:255]
ds_read_b64_tr_b16 a[194:195], v2 offset:9088
v_cvt_pk_bf16_f32 v91, v70, v71
v_mfma_f32_16x16x32_bf16 a[224:227], a[228:231], v[80:83], a[224:227]
v_exp_f32 v72, v72
v_mfma_f32_16x16x32_bf16 v[56:59], a[80:83], a[16:19], v[40:43]
ds_read_b64_tr_b16 a[196:197], v2 offset:8608
v_mfma_f32_16x16x32_bf16 v[56:59], a[84:87], a[20:23], v[56:59]
v_exp_f32 v73, v73
v_mfma_f32_16x16x32_bf16 v[56:59], a[88:91], a[24:27], v[56:59]
ds_read_b64_tr_b16 a[198:199], v2 offset:9120
ds_read_b128 v[16:19], v4
v_cvt_pk_bf16_f32 v92, v72, v73
v_mfma_f32_16x16x32_bf16 v[56:59], a[92:95], a[28:31], v[56:59]
v_exp_f32 v74, v74
v_mfma_f32_16x16x32_bf16 v[60:63], a[108:111], a[28:31], v[40:43]
ds_read_b64_tr_b16 a[200:201], v2 offset:8640
v_mfma_f32_16x16x32_bf16 v[60:63], a[104:107], a[24:27], v[60:63]
v_exp_f32 v75, v75
v_mfma_f32_16x16x32_bf16 v[60:63], a[100:103], a[20:23], v[60:63]
ds_read_b64_tr_b16 a[202:203], v2 offset:9152
v_cvt_pk_bf16_f32 v93, v74, v75
v_mfma_f32_16x16x32_bf16 v[60:63], a[96:99], a[16:19], v[60:63]
v_exp_f32 v76, v76
v_mfma_f32_16x16x32_bf16 v[64:67], a[112:115], a[16:19], v[40:43]
v_mfma_f32_16x16x32_bf16 v[64:67], a[116:119], a[20:23], v[64:67]
v_exp_f32 v77, v77
v_mfma_f32_16x16x32_bf16 v[64:67], a[120:123], a[24:27], v[64:67]
ds_read_b64_tr_b16 a[204:205], v2 offset:8672
v_cvt_pk_bf16_f32 v94, v76, v77
v_mfma_f32_16x16x32_bf16 v[64:67], a[124:127], a[28:31], v[64:67]
s_waitcnt lgkmcnt(3)
v_exp_f32 v78, v78
v_mfma_f32_16x16x32_bf16 v[68:71], a[140:143], a[28:31], v[40:43]
buffer_store_dwordx4 v[16:19], v3, s[28:31], s36 offen sc0 sc1
v_mfma_f32_16x16x32_bf16 v[68:71], a[136:139], a[24:27], v[68:71]
v_exp_f32 v79, v79
v_mfma_f32_16x16x32_bf16 v[68:71], a[132:135], a[20:23], v[68:71]
ds_read_b64_tr_b16 a[206:207], v2 offset:9184
v_cvt_pk_bf16_f32 v95, v78, v79
v_mfma_f32_16x16x32_bf16 v[68:71], a[128:131], a[16:19], v[68:71]
v_exp_f32 v56, v56
v_mfma_f32_16x16x32_bf16 v[96:99], a[144:147], v[88:91], v[96:99]
s_waitcnt lgkmcnt(9)
v_mfma_f32_16x16x32_bf16 v[96:99], a[176:179], v[92:95], v[96:99]
v_exp_f32 v57, v57
v_mfma_f32_16x16x32_bf16 v[100:103], a[180:183], v[92:95], v[100:103]
v_cvt_pk_bf16_f32 v80, v56, v57
v_mfma_f32_16x16x32_bf16 v[100:103], a[148:151], v[88:91], v[100:103]
v_exp_f32 v58, v58
v_mfma_f32_16x16x32_bf16 v[104:107], a[152:155], v[88:91], v[104:107]
v_mfma_f32_16x16x32_bf16 v[104:107], a[184:187], v[92:95], v[104:107]
v_exp_f32 v59, v59
v_mfma_f32_16x16x32_bf16 v[108:111], a[188:191], v[92:95], v[108:111]
v_cvt_pk_bf16_f32 v81, v58, v59
v_mfma_f32_16x16x32_bf16 v[108:111], a[156:159], v[88:91], v[108:111]
v_exp_f32 v60, v60
v_mfma_f32_16x16x32_bf16 v[112:115], a[160:163], v[88:91], v[112:115]
s_waitcnt lgkmcnt(0)
v_mfma_f32_16x16x32_bf16 v[112:115], a[192:195], v[92:95], v[112:115]
v_exp_f32 v61, v61
v_mfma_f32_16x16x32_bf16 v[116:119], a[196:199], v[92:95], v[116:119]
v_cvt_pk_bf16_f32 v82, v60, v61
v_mfma_f32_16x16x32_bf16 v[116:119], a[164:167], v[88:91], v[116:119]
v_exp_f32 v62, v62
v_mfma_f32_16x16x32_bf16 v[120:123], a[168:171], v[88:91], v[120:123]
v_mfma_f32_16x16x32_bf16 v[120:123], a[200:203], v[92:95], v[120:123]
v_exp_f32 v63, v63
v_mfma_f32_16x16x32_bf16 v[124:127], a[204:207], v[92:95], v[124:127]
v_cvt_pk_bf16_f32 v83, v62, v63
v_mfma_f32_16x16x32_bf16 v[124:127], a[172:175], v[88:91], v[124:127]
v_exp_f32 v64, v64
v_mfma_f32_16x16x32_bf16 a[208:211], a[228:231], v[88:91], a[208:211]
v_mfma_f32_16x16x32_bf16 a[208:211], a[228:231], v[92:95], a[208:211]
v_exp_f32 v65, v65
v_mfma_f32_16x16x32_bf16 v[72:75], a[80:83], a[32:35], v[44:47]
v_cvt_pk_bf16_f32 v84, v64, v65
v_mfma_f32_16x16x32_bf16 v[72:75], a[84:87], a[36:39], v[72:75]
v_exp_f32 v66, v66
v_mfma_f32_16x16x32_bf16 v[72:75], a[88:91], a[40:43], v[72:75]
v_mfma_f32_16x16x32_bf16 v[72:75], a[92:95], a[44:47], v[72:75]
v_exp_f32 v67, v67
v_mfma_f32_16x16x32_bf16 v[76:79], a[108:111], a[44:47], v[44:47]
v_cvt_pk_bf16_f32 v85, v66, v67
v_mfma_f32_16x16x32_bf16 v[76:79], a[104:107], a[40:43], v[76:79]
v_exp_f32 v68, v68
v_mfma_f32_16x16x32_bf16 v[76:79], a[100:103], a[36:39], v[76:79]
ds_read_b128 v[20:23], v4 offset:1056
v_mfma_f32_16x16x32_bf16 v[76:79], a[96:99], a[32:35], v[76:79]
v_exp_f32 v69, v69
v_mfma_f32_16x16x32_bf16 v[56:59], a[112:115], a[32:35], v[44:47]
v_cvt_pk_bf16_f32 v86, v68, v69
v_mfma_f32_16x16x32_bf16 v[56:59], a[116:119], a[36:39], v[56:59]
v_exp_f32 v70, v70
v_mfma_f32_16x16x32_bf16 v[56:59], a[120:123], a[40:43], v[56:59]
v_mfma_f32_16x16x32_bf16 v[56:59], a[124:127], a[44:47], v[56:59]
v_exp_f32 v71, v71
v_mfma_f32_16x16x32_bf16 v[60:63], a[140:143], a[44:47], v[44:47]
v_exp_f32 v72, v72
v_mfma_f32_16x16x32_bf16 v[60:63], a[136:139], a[40:43], v[60:63]
v_cvt_pk_bf16_f32 v87, v70, v71
v_mfma_f32_16x16x32_bf16 v[60:63], a[132:135], a[36:39], v[60:63]
v_exp_f32 v73, v73
v_mfma_f32_16x16x32_bf16 v[60:63], a[128:131], a[32:35], v[60:63]
v_cvt_pk_bf16_f32 v88, v72, v73
v_mfma_f32_16x16x32_bf16 v[128:131], a[144:147], v[80:83], v[128:131]
v_exp_f32 v74, v74
v_mfma_f32_16x16x32_bf16 v[128:131], a[176:179], v[84:87], v[128:131]
v_mfma_f32_16x16x32_bf16 v[132:135], a[180:183], v[84:87], v[132:135]
v_exp_f32 v75, v75
v_mfma_f32_16x16x32_bf16 v[132:135], a[148:151], v[80:83], v[132:135]
v_cvt_pk_bf16_f32 v89, v74, v75
v_mfma_f32_16x16x32_bf16 v[136:139], a[152:155], v[80:83], v[136:139]
v_exp_f32 v76, v76
v_mfma_f32_16x16x32_bf16 v[136:139], a[184:187], v[84:87], v[136:139]
v_mfma_f32_16x16x32_bf16 v[140:143], a[188:191], v[84:87], v[140:143]
v_exp_f32 v77, v77
v_mfma_f32_16x16x32_bf16 v[140:143], a[156:159], v[80:83], v[140:143]
v_cvt_pk_bf16_f32 v90, v76, v77
v_mfma_f32_16x16x32_bf16 v[144:147], a[160:163], v[80:83], v[144:147]
v_exp_f32 v78, v78
v_mfma_f32_16x16x32_bf16 v[144:147], a[192:195], v[84:87], v[144:147]
v_mfma_f32_16x16x32_bf16 v[148:151], a[196:199], v[84:87], v[148:151]
v_exp_f32 v79, v79
v_mfma_f32_16x16x32_bf16 v[148:151], a[164:167], v[80:83], v[148:151]
v_cvt_pk_bf16_f32 v91, v78, v79
v_mfma_f32_16x16x32_bf16 v[152:155], a[168:171], v[80:83], v[152:155]
v_exp_f32 v56, v56
v_mfma_f32_16x16x32_bf16 v[152:155], a[200:203], v[84:87], v[152:155]
v_mfma_f32_16x16x32_bf16 v[156:159], a[204:207], v[84:87], v[156:159]
s_waitcnt vmcnt(6) lgkmcnt(1)
v_exp_f32 v57, v57
v_mfma_f32_16x16x32_bf16 v[156:159], a[172:175], v[80:83], v[156:159]
v_cvt_pk_bf16_f32 v92, v56, v57
v_mfma_f32_16x16x32_bf16 a[212:215], a[228:231], v[80:83], a[212:215]
s_barrier
v_exp_f32 v58, v58
v_mfma_f32_16x16x32_bf16 a[212:215], a[228:231], v[84:87], a[212:215]
v_mfma_f32_16x16x32_bf16 v[64:67], a[80:83], a[48:51], v[48:51]
s_waitcnt lgkmcnt(0)
v_exp_f32 v59, v59
v_mfma_f32_16x16x32_bf16 v[64:67], a[84:87], a[52:55], v[64:67]
ds_read_b128 a[80:83], v1 offset:16896
v_cvt_pk_bf16_f32 v93, v58, v59
v_mfma_f32_16x16x32_bf16 v[64:67], a[88:91], a[56:59], v[64:67]
buffer_store_dwordx4 v[20:23], v3, s[28:31], s36 offen offset:1024 sc0 sc1
v_exp_f32 v60, v60
v_mfma_f32_16x16x32_bf16 v[64:67], a[92:95], a[60:63], v[64:67]
ds_read_b128 a[84:87], v1 offset:16960
ds_read_b128 a[88:91], v1 offset:17024
v_mfma_f32_16x16x32_bf16 v[68:71], a[108:111], a[60:63], v[48:51]
s_add_u32 s36, s36, 2048
v_exp_f32 v61, v61
v_mfma_f32_16x16x32_bf16 v[68:71], a[104:107], a[56:59], v[68:71]
ds_read_b128 a[92:95], v1 offset:17088
v_cvt_pk_bf16_f32 v94, v60, v61
v_mfma_f32_16x16x32_bf16 v[68:71], a[100:103], a[52:55], v[68:71]
v_exp_f32 v62, v62
v_mfma_f32_16x16x32_bf16 v[68:71], a[96:99], a[48:51], v[68:71]
ds_read_b128 a[108:111], v1 offset:17600
v_mfma_f32_16x16x32_bf16 v[72:75], a[112:115], a[48:51], v[48:51]
v_exp_f32 v63, v63
v_mfma_f32_16x16x32_bf16 v[72:75], a[116:119], a[52:55], v[72:75]
v_exp_f32 v64, v64
v_mfma_f32_16x16x32_bf16 v[72:75], a[120:123], a[56:59], v[72:75]
ds_read_b128 a[104:107], v1 offset:17536
v_cvt_pk_bf16_f32 v95, v62, v63
v_mfma_f32_16x16x32_bf16 v[72:75], a[124:127], a[60:63], v[72:75]
v_exp_f32 v65, v65
v_mfma_f32_16x16x32_bf16 v[76:79], a[140:143], a[60:63], v[48:51]
ds_read_b128 a[100:103], v1 offset:17472
v_cvt_pk_bf16_f32 v80, v64, v65
v_mfma_f32_16x16x32_bf16 v[76:79], a[136:139], a[56:59], v[76:79]
v_exp_f32 v66, v66
v_mfma_f32_16x16x32_bf16 v[76:79], a[132:135], a[52:55], v[76:79]
ds_read_b128 a[96:99], v1 offset:17408
v_mfma_f32_16x16x32_bf16 v[76:79], a[128:131], a[48:51], v[76:79]
v_exp_f32 v67, v67
v_mfma_f32_16x16x32_bf16 v[160:163], a[144:147], v[88:91], v[160:163]
ds_read_b128 a[112:115], v1 offset:25344
v_cvt_pk_bf16_f32 v81, v66, v67
v_mfma_f32_16x16x32_bf16 v[160:163], a[176:179], v[92:95], v[160:163]
v_exp_f32 v68, v68
v_mfma_f32_16x16x32_bf16 v[164:167], a[180:183], v[92:95], v[164:167]
ds_read_b128 a[116:119], v1 offset:25408
v_mfma_f32_16x16x32_bf16 v[164:167], a[148:151], v[88:91], v[164:167]
v_exp_f32 v69, v69
v_mfma_f32_16x16x32_bf16 v[168:171], a[152:155], v[88:91], v[168:171]
ds_read_b128 a[120:123], v1 offset:25472
v_cvt_pk_bf16_f32 v82, v68, v69
v_mfma_f32_16x16x32_bf16 v[168:171], a[184:187], v[92:95], v[168:171]
v_exp_f32 v70, v70
v_mfma_f32_16x16x32_bf16 v[172:175], a[188:191], v[92:95], v[172:175]
ds_read_b128 a[124:127], v1 offset:25536
v_mfma_f32_16x16x32_bf16 v[172:175], a[156:159], v[88:91], v[172:175]
v_exp_f32 v71, v71
v_mfma_f32_16x16x32_bf16 v[176:179], a[160:163], v[88:91], v[176:179]
ds_read_b128 a[140:143], v1 offset:26048
v_cvt_pk_bf16_f32 v83, v70, v71
v_mfma_f32_16x16x32_bf16 v[176:179], a[192:195], v[92:95], v[176:179]
v_exp_f32 v72, v72
v_mfma_f32_16x16x32_bf16 v[180:183], a[196:199], v[92:95], v[180:183]
ds_read_b128 a[136:139], v1 offset:25984
v_mfma_f32_16x16x32_bf16 v[180:183], a[164:167], v[88:91], v[180:183]
v_exp_f32 v73, v73
v_mfma_f32_16x16x32_bf16 v[184:187], a[168:171], v[88:91], v[184:187]
ds_read_b128 a[132:135], v1 offset:25920
v_cvt_pk_bf16_f32 v84, v72, v73
v_mfma_f32_16x16x32_bf16 v[184:187], a[200:203], v[92:95], v[184:187]
v_exp_f32 v74, v74
v_mfma_f32_16x16x32_bf16 v[188:191], a[204:207], v[92:95], v[188:191]
ds_read_b128 a[128:131], v1 offset:25856
v_mfma_f32_16x16x32_bf16 v[188:191], a[172:175], v[88:91], v[188:191]
v_exp_f32 v75, v75
v_mfma_f32_16x16x32_bf16 a[216:219], a[228:231], v[88:91], a[216:219]
s_waitcnt lgkmcnt(8)
v_cvt_pk_bf16_f32 v85, v74, v75
v_mfma_f32_16x16x32_bf16 a[216:219], a[228:231], v[92:95], a[216:219]
v_exp_f32 v76, v76
v_mfma_f32_16x16x32_bf16 v[56:59], a[80:83], a[64:67], v[52:55]
v_mfma_f32_16x16x32_bf16 v[56:59], a[84:87], a[68:71], v[56:59]
v_exp_f32 v77, v77
v_mfma_f32_16x16x32_bf16 v[56:59], a[88:91], a[72:75], v[56:59]
v_cvt_pk_bf16_f32 v86, v76, v77
v_mfma_f32_16x16x32_bf16 v[56:59], a[92:95], a[76:79], v[56:59]
v_exp_f32 v78, v78
v_mfma_f32_16x16x32_bf16 v[60:63], a[108:111], a[76:79], v[52:55]
v_mfma_f32_16x16x32_bf16 v[60:63], a[104:107], a[72:75], v[60:63]
s_waitcnt vmcnt(3) lgkmcnt(0)
v_exp_f32 v79, v79
v_mfma_f32_16x16x32_bf16 v[60:63], a[100:103], a[68:71], v[60:63]
v_cvt_pk_bf16_f32 v87, v78, v79
v_mfma_f32_16x16x32_bf16 v[60:63], a[96:99], a[64:67], v[60:63]
s_barrier
v_mfma_f32_16x16x32_bf16 v[192:195], a[144:147], v[80:83], v[192:195]
ds_read_b64_tr_b16 a[144:145], v2 offset:16896
v_mfma_f32_16x16x32_bf16 v[192:195], a[176:179], v[84:87], v[192:195]
v_exp_f32 v56, v56
v_mfma_f32_16x16x32_bf16 v[196:199], a[180:183], v[84:87], v[196:199]
ds_read_b64_tr_b16 a[146:147], v2 offset:17408
v_mfma_f32_16x16x32_bf16 v[196:199], a[148:151], v[80:83], v[196:199]
ds_read_b64_tr_b16 a[148:149], v2 offset:16928
v_mfma_f32_16x16x32_bf16 v[200:203], a[152:155], v[80:83], v[200:203]
v_exp_f32 v57, v57
v_mfma_f32_16x16x32_bf16 v[200:203], a[184:187], v[84:87], v[200:203]
ds_read_b64_tr_b16 a[150:151], v2 offset:17440
v_cvt_pk_bf16_f32 v88, v56, v57
v_mfma_f32_16x16x32_bf16 v[204:207], a[188:191], v[84:87], v[204:207]
ds_read_b64_tr_b16 a[152:153], v2 offset:16960
v_mfma_f32_16x16x32_bf16 v[204:207], a[156:159], v[80:83], v[204:207]
v_exp_f32 v58, v58
v_mfma_f32_16x16x32_bf16 v[208:211], a[160:163], v[80:83], v[208:211]
ds_read_b64_tr_b16 a[154:155], v2 offset:17472
v_mfma_f32_16x16x32_bf16 v[208:211], a[192:195], v[84:87], v[208:211]
ds_read_b64_tr_b16 a[156:157], v2 offset:16992
v_mfma_f32_16x16x32_bf16 v[212:215], a[196:199], v[84:87], v[212:215]
v_exp_f32 v59, v59
v_mfma_f32_16x16x32_bf16 v[212:215], a[164:167], v[80:83], v[212:215]
ds_read_b64_tr_b16 a[158:159], v2 offset:17504
v_cvt_pk_bf16_f32 v89, v58, v59
v_mfma_f32_16x16x32_bf16 v[216:219], a[168:171], v[80:83], v[216:219]
ds_read_b64_tr_b16 a[160:161], v2 offset:17024
v_mfma_f32_16x16x32_bf16 v[216:219], a[200:203], v[84:87], v[216:219]
v_exp_f32 v60, v60
v_mfma_f32_16x16x32_bf16 v[220:223], a[204:207], v[84:87], v[220:223]
ds_read_b64_tr_b16 a[162:163], v2 offset:17536
v_mfma_f32_16x16x32_bf16 v[220:223], a[172:175], v[80:83], v[220:223]
ds_read_b64_tr_b16 a[164:165], v2 offset:17056
v_mfma_f32_16x16x32_bf16 a[220:223], a[228:231], v[80:83], a[220:223]
v_exp_f32 v61, v61
v_mfma_f32_16x16x32_bf16 a[220:223], a[228:231], v[84:87], a[220:223]
ds_read_b64_tr_b16 a[166:167], v2 offset:17568
v_cvt_pk_bf16_f32 v90, v60, v61
v_mfma_f32_16x16x32_bf16 v[64:67], a[80:83], a[0:3], v[36:39]
ds_read_b64_tr_b16 a[168:169], v2 offset:17088
v_mfma_f32_16x16x32_bf16 v[64:67], a[84:87], a[4:7], v[64:67]
v_exp_f32 v62, v62
v_mfma_f32_16x16x32_bf16 v[64:67], a[88:91], a[8:11], v[64:67]
ds_read_b64_tr_b16 a[170:171], v2 offset:17600
v_mfma_f32_16x16x32_bf16 v[64:67], a[92:95], a[12:15], v[64:67]
ds_read_b64_tr_b16 a[172:173], v2 offset:17120
v_mfma_f32_16x16x32_bf16 v[68:71], a[108:111], a[12:15], v[36:39]
v_exp_f32 v63, v63
v_mfma_f32_16x16x32_bf16 v[68:71], a[104:107], a[8:11], v[68:71]
ds_read_b64_tr_b16 a[174:175], v2 offset:17632
v_cvt_pk_bf16_f32 v91, v62, v63
v_mfma_f32_16x16x32_bf16 v[68:71], a[100:103], a[4:7], v[68:71]
ds_read_b64_tr_b16 a[176:177], v2 offset:25344
v_mfma_f32_16x16x32_bf16 v[68:71], a[96:99], a[0:3], v[68:71]
ds_read_b64_tr_b16 a[178:179], v2 offset:25856
v_mfma_f32_16x16x32_bf16 v[72:75], a[112:115], a[0:3], v[36:39]
v_exp_f32 v64, v64
v_mfma_f32_16x16x32_bf16 v[72:75], a[116:119], a[4:7], v[72:75]
ds_read_b64_tr_b16 a[180:181], v2 offset:25376
v_mfma_f32_16x16x32_bf16 v[72:75], a[120:123], a[8:11], v[72:75]
v_exp_f32 v65, v65
v_mfma_f32_16x16x32_bf16 v[72:75], a[124:127], a[12:15], v[72:75]
ds_read_b64_tr_b16 a[182:183], v2 offset:25888
v_cvt_pk_bf16_f32 v80, v64, v65
v_mfma_f32_16x16x32_bf16 v[76:79], a[140:143], a[12:15], v[36:39]
v_exp_f32 v66, v66
v_mfma_f32_16x16x32_bf16 v[76:79], a[136:139], a[8:11], v[76:79]
ds_read_b64_tr_b16 a[184:185], v2 offset:25408
v_mfma_f32_16x16x32_bf16 v[76:79], a[132:135], a[4:7], v[76:79]
s_waitcnt lgkmcnt(13)
v_exp_f32 v67, v67
v_mfma_f32_16x16x32_bf16 v[76:79], a[128:131], a[0:3], v[76:79]
ds_read_b64_tr_b16 a[186:187], v2 offset:25920
v_cvt_pk_bf16_f32 v81, v66, v67
v_mfma_f32_16x16x32_bf16 v[224:227], a[144:147], v[88:91], v[224:227]
v_exp_f32 v68, v68
v_mfma_f32_16x16x32_bf16 v[228:231], a[148:151], v[88:91], v[228:231]
ds_read_b64_tr_b16 a[188:189], v2 offset:25440
v_mfma_f32_16x16x32_bf16 v[232:235], a[152:155], v[88:91], v[232:235]
s_waitcnt lgkmcnt(7)
v_exp_f32 v69, v69
v_mfma_f32_16x16x32_bf16 v[236:239], a[156:159], v[88:91], v[236:239]
ds_read_b64_tr_b16 a[190:191], v2 offset:25952
v_cvt_pk_bf16_f32 v82, v68, v69
v_mfma_f32_16x16x32_bf16 v[240:243], a[160:163], v[88:91], v[240:243]
v_exp_f32 v70, v70
v_mfma_f32_16x16x32_bf16 v[244:247], a[164:167], v[88:91], v[244:247]
ds_read_b64_tr_b16 a[192:193], v2 offset:25472
v_mfma_f32_16x16x32_bf16 v[248:251], a[168:171], v[88:91], v[248:251]
v_exp_f32 v71, v71
v_mfma_f32_16x16x32_bf16 v[252:255], a[172:175], v[88:91], v[252:255]
ds_read_b64_tr_b16 a[194:195], v2 offset:25984
v_cvt_pk_bf16_f32 v83, v70, v71
v_mfma_f32_16x16x32_bf16 a[224:227], a[228:231], v[88:91], a[224:227]
v_exp_f32 v72, v72
v_mfma_f32_16x16x32_bf16 v[56:59], a[80:83], a[16:19], v[40:43]
ds_read_b64_tr_b16 a[196:197], v2 offset:25504
v_mfma_f32_16x16x32_bf16 v[56:59], a[84:87], a[20:23], v[56:59]
v_exp_f32 v73, v73
v_mfma_f32_16x16x32_bf16 v[56:59], a[88:91], a[24:27], v[56:59]
ds_read_b64_tr_b16 a[198:199], v2 offset:26016
v_cvt_pk_bf16_f32 v84, v72, v73
v_mfma_f32_16x16x32_bf16 v[56:59], a[92:95], a[28:31], v[56:59]
v_exp_f32 v74, v74
v_mfma_f32_16x16x32_bf16 v[60:63], a[108:111], a[28:31], v[40:43]
ds_read_b64_tr_b16 a[200:201], v2 offset:25536
v_accvgpr_read_b32 v32, a245
v_mfma_f32_16x16x32_bf16 v[60:63], a[104:107], a[24:27], v[60:63]
v_exp_f32 v75, v75
v_mfma_f32_16x16x32_bf16 v[60:63], a[100:103], a[20:23], v[60:63]
ds_read_b64_tr_b16 a[202:203], v2 offset:26048
v_cvt_pk_bf16_f32 v85, v74, v75
v_mfma_f32_16x16x32_bf16 v[60:63], a[96:99], a[16:19], v[60:63]
v_exp_f32 v76, v76
v_mfma_f32_16x16x32_bf16 v[64:67], a[112:115], a[16:19], v[40:43]
v_accvgpr_read_b32 v33, a247
v_accvgpr_read_b32 v11, a224
v_mfma_f32_16x16x32_bf16 v[64:67], a[116:119], a[20:23], v[64:67]
v_exp_f32 v77, v77
v_mfma_f32_16x16x32_bf16 v[64:67], a[120:123], a[24:27], v[64:67]
ds_read_b64_tr_b16 a[204:205], v2 offset:25568
v_cvt_pk_bf16_f32 v86, v76, v77
v_mfma_f32_16x16x32_bf16 v[64:67], a[124:127], a[28:31], v[64:67]
ds_write_b128 v32, v[240:243]
v_exp_f32 v78, v78
v_mfma_f32_16x16x32_bf16 v[68:71], a[140:143], a[28:31], v[40:43]
ds_write_b128 v32, v[244:247] offset:1024
v_mfma_f32_16x16x32_bf16 v[68:71], a[136:139], a[24:27], v[68:71]
v_exp_f32 v79, v79
v_mfma_f32_16x16x32_bf16 v[68:71], a[132:135], a[20:23], v[68:71]
ds_read_b64_tr_b16 a[206:207], v2 offset:26080
v_cvt_pk_bf16_f32 v87, v78, v79
v_mfma_f32_16x16x32_bf16 v[68:71], a[128:131], a[16:19], v[68:71]
ds_write_b128 v32, v[248:251] offset:2048
v_exp_f32 v56, v56
v_mfma_f32_16x16x32_bf16 a[208:211], a[228:231], v[80:83], a[208:211]
s_waitcnt lgkmcnt(11)
ds_write_b128 v32, v[252:255] offset:3072
v_mfma_f32_16x16x32_bf16 a[208:211], a[228:231], v[84:87], a[208:211]
ds_write_b32 v33, v11
v_exp_f32 v57, v57
v_accvgpr_read_b32 v32, a246
v_mfma_f32_16x16x32_bf16 v[96:99], a[144:147], v[80:83], v[96:99]
v_cvt_pk_bf16_f32 v88, v56, v57
v_accvgpr_read_b32 v33, a248
v_mfma_f32_16x16x32_bf16 v[96:99], a[176:179], v[84:87], v[96:99]
v_exp_f32 v58, v58
v_mfma_f32_16x16x32_bf16 v[100:103], a[180:183], v[84:87], v[100:103]
v_mfma_f32_16x16x32_bf16 v[100:103], a[148:151], v[80:83], v[100:103]
v_exp_f32 v59, v59
v_mfma_f32_16x16x32_bf16 v[104:107], a[152:155], v[80:83], v[104:107]
v_cvt_pk_bf16_f32 v89, v58, v59
v_accvgpr_read_b32 v10, a208
v_mfma_f32_16x16x32_bf16 v[104:107], a[184:187], v[84:87], v[104:107]
s_waitcnt lgkmcnt(0)
v_exp_f32 v60, v60
v_mfma_f32_16x16x32_bf16 v[108:111], a[188:191], v[84:87], v[108:111]
s_waitcnt lgkmcnt(3)
v_rcp_f32 v14, v10
v_mfma_f32_16x16x32_bf16 v[108:111], a[156:159], v[80:83], v[108:111]
s_barrier
v_exp_f32 v61, v61
v_mfma_f32_16x16x32_bf16 v[112:115], a[160:163], v[80:83], v[112:115]
ds_read_b32 v12, v33
v_cvt_pk_bf16_f32 v90, v60, v61
v_mfma_f32_16x16x32_bf16 v[112:115], a[192:195], v[84:87], v[112:115]
ds_read_b128 v[240:243], v32
ds_read_b128 v[244:247], v32 offset:1024
v_exp_f32 v62, v62
v_mfma_f32_16x16x32_bf16 v[116:119], a[196:199], v[84:87], v[116:119]
ds_read_b128 v[248:251], v32 offset:2048
ds_read_b128 v[252:255], v32 offset:3072
v_mfma_f32_16x16x32_bf16 v[116:119], a[164:167], v[80:83], v[116:119]
v_exp_f32 v63, v63
v_mfma_f32_16x16x32_bf16 v[120:123], a[168:171], v[80:83], v[120:123]
v_cvt_pk_bf16_f32 v91, v62, v63
v_accvgpr_read_b32 v32, a249
v_mfma_f32_16x16x32_bf16 v[120:123], a[200:203], v[84:87], v[120:123]
v_exp_f32 v64, v64
v_mfma_f32_16x16x32_bf16 v[124:127], a[204:207], v[84:87], v[124:127]
v_mfma_f32_16x16x32_bf16 v[124:127], a[172:175], v[80:83], v[124:127]
v_exp_f32 v65, v65
v_mfma_f32_16x16x32_bf16 v[72:75], a[80:83], a[32:35], v[44:47]
v_cvt_pk_bf16_f32 v92, v64, v65
v_add_f32 v5, v5, v10
v_mfma_f32_16x16x32_bf16 v[72:75], a[84:87], a[36:39], v[72:75]
v_exp_f32 v66, v66
v_mfma_f32_16x16x32_bf16 v[72:75], a[88:91], a[40:43], v[72:75]
v_mfma_f32_16x16x32_bf16 v[72:75], a[92:95], a[44:47], v[72:75]
v_exp_f32 v67, v67
v_add_f32 v5, v5, v14
v_pk_mul_f32 v[96:97], v[96:97], v[14:15] op_sel_hi:[1,0]
v_pk_mul_f32 v[98:99], v[98:99], v[14:15] op_sel_hi:[1,0]
v_pk_mul_f32 v[100:101], v[100:101], v[14:15] op_sel_hi:[1,0]
v_pk_mul_f32 v[102:103], v[102:103], v[14:15] op_sel_hi:[1,0]
v_pk_mul_f32 v[104:105], v[104:105], v[14:15] op_sel_hi:[1,0]
v_pk_mul_f32 v[106:107], v[106:107], v[14:15] op_sel_hi:[1,0]
v_pk_mul_f32 v[108:109], v[108:109], v[14:15] op_sel_hi:[1,0]
v_pk_mul_f32 v[110:111], v[110:111], v[14:15] op_sel_hi:[1,0]
v_pk_mul_f32 v[112:113], v[112:113], v[14:15] op_sel_hi:[1,0]
v_pk_mul_f32 v[114:115], v[114:115], v[14:15] op_sel_hi:[1,0]
v_pk_mul_f32 v[116:117], v[116:117], v[14:15] op_sel_hi:[1,0]
v_pk_mul_f32 v[118:119], v[118:119], v[14:15] op_sel_hi:[1,0]
v_pk_mul_f32 v[120:121], v[120:121], v[14:15] op_sel_hi:[1,0]
v_pk_mul_f32 v[122:123], v[122:123], v[14:15] op_sel_hi:[1,0]
v_pk_mul_f32 v[124:125], v[124:125], v[14:15] op_sel_hi:[1,0]
v_pk_mul_f32 v[126:127], v[126:127], v[14:15] op_sel_hi:[1,0]
v_cvt_pk_bf16_f32 v96, v96, v97
v_cvt_pk_bf16_f32 v97, v98, v99
v_cvt_pk_bf16_f32 v100, v100, v101
v_cvt_pk_bf16_f32 v101, v102, v103
v_cvt_pk_bf16_f32 v104, v104, v105
v_cvt_pk_bf16_f32 v105, v106, v107
v_cvt_pk_bf16_f32 v108, v108, v109
v_mfma_f32_16x16x32_bf16 v[76:79], a[108:111], a[44:47], v[44:47]
ds_write_b64 v7, v[96:97]
v_cvt_pk_bf16_f32 v93, v66, v67
v_cvt_pk_bf16_f32 v109, v110, v111
v_mfma_f32_16x16x32_bf16 v[76:79], a[104:107], a[40:43], v[76:79]
ds_write_b64 v7, v[100:101] offset:32
v_exp_f32 v68, v68
v_mfma_f32_16x16x32_bf16 v[76:79], a[100:103], a[36:39], v[76:79]
ds_write_b64 v7, v[104:105] offset:64
v_cvt_pk_bf16_f32 v112, v112, v113
v_cvt_pk_bf16_f32 v113, v114, v115
v_mfma_f32_16x16x32_bf16 v[76:79], a[96:99], a[32:35], v[76:79]
ds_write_b64 v7, v[108:109] offset:96
v_exp_f32 v69, v69
v_cvt_pk_bf16_f32 v116, v116, v117
v_cvt_pk_bf16_f32 v117, v118, v119
v_cvt_pk_bf16_f32 v120, v120, v121
v_mfma_f32_16x16x32_bf16 v[56:59], a[112:115], a[32:35], v[44:47]
ds_write_b64 v7, v[112:113] offset:128
v_cvt_pk_bf16_f32 v94, v68, v69
v_cvt_pk_bf16_f32 v121, v122, v123
v_mfma_f32_16x16x32_bf16 v[56:59], a[116:119], a[36:39], v[56:59]
ds_write_b64 v7, v[116:117] offset:160
v_exp_f32 v70, v70
v_mfma_f32_16x16x32_bf16 v[56:59], a[120:123], a[40:43], v[56:59]
ds_write_b64 v7, v[120:121] offset:192
v_cvt_pk_bf16_f32 v124, v124, v125
v_cvt_pk_bf16_f32 v125, v126, v127
v_mfma_f32_16x16x32_bf16 v[56:59], a[124:127], a[44:47], v[56:59]
s_waitcnt lgkmcnt(7)
v_exp_f32 v71, v71
v_mfma_f32_16x16x32_bf16 v[60:63], a[140:143], a[44:47], v[44:47]
v_exp_f32 v72, v72
v_mfma_f32_16x16x32_bf16 v[60:63], a[136:139], a[40:43], v[60:63]
v_cvt_pk_bf16_f32 v95, v70, v71
v_add_f32 v11, v11, v12
v_mfma_f32_16x16x32_bf16 v[60:63], a[132:135], a[36:39], v[60:63]
v_exp_f32 v73, v73
v_mfma_f32_16x16x32_bf16 v[60:63], a[128:131], a[32:35], v[60:63]
ds_write_b64 v7, v[124:125] offset:224
v_cvt_pk_bf16_f32 v80, v72, v73
v_rcp_f32 v14, v11
v_add_f32 v5, v5, v11
v_add_f32 v5, v5, v14
v_pk_add_f32 v[224:225], v[224:225], v[240:241]
v_pk_add_f32 v[226:227], v[226:227], v[242:243]
v_pk_add_f32 v[228:229], v[228:229], v[244:245]
v_pk_add_f32 v[230:231], v[230:231], v[246:247]
v_pk_add_f32 v[232:233], v[232:233], v[248:249]
v_pk_add_f32 v[234:235], v[234:235], v[250:251]
v_pk_add_f32 v[236:237], v[236:237], v[252:253]
v_pk_add_f32 v[238:239], v[238:239], v[254:255]
v_pk_mul_f32 v[224:225], v[224:225], v[14:15] op_sel_hi:[1,0]
v_pk_mul_f32 v[226:227], v[226:227], v[14:15] op_sel_hi:[1,0]
v_pk_mul_f32 v[228:229], v[228:229], v[14:15] op_sel_hi:[1,0]
v_pk_mul_f32 v[230:231], v[230:231], v[14:15] op_sel_hi:[1,0]
v_pk_mul_f32 v[232:233], v[232:233], v[14:15] op_sel_hi:[1,0]
v_pk_mul_f32 v[234:235], v[234:235], v[14:15] op_sel_hi:[1,0]
v_pk_mul_f32 v[236:237], v[236:237], v[14:15] op_sel_hi:[1,0]
v_pk_mul_f32 v[238:239], v[238:239], v[14:15] op_sel_hi:[1,0]
v_mfma_f32_16x16x32_bf16 a[212:215], a[228:231], v[88:91], a[212:215]
v_exp_f32 v74, v74
v_mfma_f32_16x16x32_bf16 a[212:215], a[228:231], v[92:95], a[212:215]
ds_read_b128 v[96:99], v8
ds_read_b128 v[100:103], v8 offset:1056
ds_read_b128 v[104:107], v8 offset:2112
ds_read_b128 v[108:111], v8 offset:3168
v_cvt_pk_bf16_f32 v224, v224, v225
v_cvt_pk_bf16_f32 v225, v226, v227
v_mfma_f32_16x16x32_bf16 v[128:131], a[144:147], v[88:91], v[128:131]
v_exp_f32 v75, v75
v_mfma_f32_16x16x32_bf16 v[128:131], a[176:179], v[92:95], v[128:131]
ds_write_b64 v32, v[224:225]
v_cvt_pk_bf16_f32 v81, v74, v75
v_cvt_pk_bf16_f32 v228, v228, v229
v_mfma_f32_16x16x32_bf16 v[132:135], a[180:183], v[92:95], v[132:135]
v_exp_f32 v76, v76
v_mfma_f32_16x16x32_bf16 v[132:135], a[148:151], v[88:91], v[132:135]
v_cvt_pk_bf16_f32 v229, v230, v231
v_cvt_pk_bf16_f32 v232, v232, v233
v_mfma_f32_16x16x32_bf16 v[136:139], a[152:155], v[88:91], v[136:139]
v_exp_f32 v77, v77
v_mfma_f32_16x16x32_bf16 v[136:139], a[184:187], v[92:95], v[136:139]
ds_write_b64 v32, v[228:229] offset:32
v_cvt_pk_bf16_f32 v82, v76, v77
v_cvt_pk_bf16_f32 v233, v234, v235
v_mfma_f32_16x16x32_bf16 v[140:143], a[188:191], v[92:95], v[140:143]
s_waitcnt lgkmcnt(5)
v_exp_f32 v78, v78
v_mfma_f32_16x16x32_bf16 v[140:143], a[156:159], v[88:91], v[140:143]
buffer_store_dwordx4 v[96:99], v9, s[28:31], s42 offen sc0 sc1
ds_write_b64 v32, v[232:233] offset:64
v_cvt_pk_bf16_f32 v236, v236, v237
v_cvt_pk_bf16_f32 v237, v238, v239
v_mfma_f32_16x16x32_bf16 v[144:147], a[160:163], v[88:91], v[144:147]
s_waitcnt lgkmcnt(5)
v_exp_f32 v79, v79
v_mfma_f32_16x16x32_bf16 v[144:147], a[192:195], v[92:95], v[144:147]
buffer_store_dwordx4 v[100:103], v9, s[28:31], s42 offen offset:1024 sc0 sc1
v_cvt_pk_bf16_f32 v83, v78, v79
v_accvgpr_read_b32 v10, a212
v_mfma_f32_16x16x32_bf16 v[148:151], a[196:199], v[92:95], v[148:151]
s_waitcnt lgkmcnt(4)
v_exp_f32 v56, v56
v_mfma_f32_16x16x32_bf16 v[148:151], a[164:167], v[88:91], v[148:151]
buffer_store_dwordx4 v[104:107], v9, s[28:31], s42 offen offset:2048 sc0 sc1
ds_write_b64 v32, v[236:237] offset:96
v_mfma_f32_16x16x32_bf16 v[152:155], a[168:171], v[88:91], v[152:155]
s_waitcnt lgkmcnt(4)
v_exp_f32 v57, v57
v_mfma_f32_16x16x32_bf16 v[152:155], a[200:203], v[92:95], v[152:155]
buffer_store_dwordx4 v[108:111], v9, s[28:31], s42 offen offset:3072 sc0 sc1
v_cvt_pk_bf16_f32 v84, v56, v57
v_accvgpr_read_b32 v32, a250
v_accvgpr_read_b32 v33, a251
v_mfma_f32_16x16x32_bf16 v[156:159], a[204:207], v[92:95], v[156:159]
v_exp_f32 v58, v58
v_mfma_f32_16x16x32_bf16 v[156:159], a[172:175], v[88:91], v[156:159]
ds_read_b128 v[240:243], v32
ds_read_b128 v[244:247], v32 offset:4224
v_mfma_f32_16x16x32_bf16 v[64:67], a[80:83], a[48:51], v[48:51]
v_exp_f32 v59, v59
v_mfma_f32_16x16x32_bf16 v[64:67], a[84:87], a[52:55], v[64:67]
v_cvt_pk_bf16_f32 v85, v58, v59
v_mfma_f32_16x16x32_bf16 v[64:67], a[88:91], a[56:59], v[64:67]
v_exp_f32 v60, v60
v_mfma_f32_16x16x32_bf16 v[64:67], a[92:95], a[60:63], v[64:67]
v_rcp_f32 v14, v10
v_add_f32 v5, v5, v10
v_add_f32 v5, v5, v14
v_pk_mul_f32 v[128:129], v[128:129], v[14:15] op_sel_hi:[1,0]
v_pk_mul_f32 v[130:131], v[130:131], v[14:15] op_sel_hi:[1,0]
v_pk_mul_f32 v[132:133], v[132:133], v[14:15] op_sel_hi:[1,0]
v_pk_mul_f32 v[134:135], v[134:135], v[14:15] op_sel_hi:[1,0]
v_pk_mul_f32 v[136:137], v[136:137], v[14:15] op_sel_hi:[1,0]
v_pk_mul_f32 v[138:139], v[138:139], v[14:15] op_sel_hi:[1,0]
v_pk_mul_f32 v[140:141], v[140:141], v[14:15] op_sel_hi:[1,0]
v_pk_mul_f32 v[142:143], v[142:143], v[14:15] op_sel_hi:[1,0]
v_pk_mul_f32 v[144:145], v[144:145], v[14:15] op_sel_hi:[1,0]
v_pk_mul_f32 v[146:147], v[146:147], v[14:15] op_sel_hi:[1,0]
v_pk_mul_f32 v[148:149], v[148:149], v[14:15] op_sel_hi:[1,0]
v_pk_mul_f32 v[150:151], v[150:151], v[14:15] op_sel_hi:[1,0]
v_pk_mul_f32 v[152:153], v[152:153], v[14:15] op_sel_hi:[1,0]
v_pk_mul_f32 v[154:155], v[154:155], v[14:15] op_sel_hi:[1,0]
v_pk_mul_f32 v[156:157], v[156:157], v[14:15] op_sel_hi:[1,0]
v_pk_mul_f32 v[158:159], v[158:159], v[14:15] op_sel_hi:[1,0]
v_cvt_pk_bf16_f32 v128, v128, v129
v_cvt_pk_bf16_f32 v129, v130, v131
v_cvt_pk_bf16_f32 v132, v132, v133
v_cvt_pk_bf16_f32 v133, v134, v135
v_cvt_pk_bf16_f32 v136, v136, v137
v_mfma_f32_16x16x32_bf16 v[68:71], a[108:111], a[60:63], v[48:51]
ds_write_b64 v7, v[128:129] offset:512
v_exp_f32 v61, v61
v_mfma_f32_16x16x32_bf16 v[68:71], a[104:107], a[56:59], v[68:71]
ds_write_b64 v7, v[132:133] offset:544
v_cvt_pk_bf16_f32 v86, v60, v61
v_cvt_pk_bf16_f32 v137, v138, v139
v_mfma_f32_16x16x32_bf16 v[68:71], a[100:103], a[52:55], v[68:71]
s_waitcnt lgkmcnt(3)
v_exp_f32 v62, v62
v_mfma_f32_16x16x32_bf16 v[68:71], a[96:99], a[48:51], v[68:71]
buffer_store_dwordx4 v[240:243], v33, s[28:31], s43 offen sc0 sc1
ds_write_b64 v7, v[136:137] offset:576
v_cvt_pk_bf16_f32 v140, v140, v141
v_cvt_pk_bf16_f32 v141, v142, v143
v_cvt_pk_bf16_f32 v144, v144, v145
v_cvt_pk_bf16_f32 v145, v146, v147
v_cvt_pk_bf16_f32 v148, v148, v149
v_cvt_pk_bf16_f32 v149, v150, v151
v_cvt_pk_bf16_f32 v152, v152, v153
v_mfma_f32_16x16x32_bf16 v[72:75], a[112:115], a[48:51], v[48:51]
ds_write_b64 v7, v[140:141] offset:608
v_exp_f32 v63, v63
v_mfma_f32_16x16x32_bf16 v[72:75], a[116:119], a[52:55], v[72:75]
s_add_u32 s43, s43, 4096
v_exp_f32 v64, v64
v_mfma_f32_16x16x32_bf16 v[72:75], a[120:123], a[56:59], v[72:75]
s_waitcnt lgkmcnt(4)
v_cvt_pk_bf16_f32 v87, v62, v63
v_cvt_pk_bf16_f32 v153, v154, v155
v_mfma_f32_16x16x32_bf16 v[72:75], a[124:127], a[60:63], v[72:75]
buffer_store_dwordx4 v[244:247], v33, s[28:31], s43 offen sc0 sc1
ds_write_b64 v7, v[144:145] offset:640
v_exp_f32 v65, v65
v_mfma_f32_16x16x32_bf16 v[76:79], a[140:143], a[60:63], v[48:51]
v_exp_f32 v66, v66
v_mfma_f32_16x16x32_bf16 v[76:79], a[136:139], a[56:59], v[76:79]
v_exp_f32 v67, v67
v_mfma_f32_16x16x32_bf16 v[76:79], a[132:135], a[52:55], v[76:79]
v_cvt_pk_bf16_f32 v88, v64, v65
v_cvt_pk_bf16_f32 v89, v66, v67
v_mfma_f32_16x16x32_bf16 v[76:79], a[128:131], a[48:51], v[76:79]
ds_write_b64 v7, v[148:149] offset:672
v_exp_f32 v68, v68
v_mfma_f32_16x16x32_bf16 a[216:219], a[228:231], v[80:83], a[216:219]
v_exp_f32 v69, v69
v_mfma_f32_16x16x32_bf16 a[216:219], a[228:231], v[84:87], a[216:219]
ds_write_b64 v7, v[152:153] offset:704
v_cvt_pk_bf16_f32 v156, v156, v157
v_cvt_pk_bf16_f32 v157, v158, v159
v_mfma_f32_16x16x32_bf16 v[160:163], a[144:147], v[80:83], v[160:163]
v_exp_f32 v70, v70
v_mfma_f32_16x16x32_bf16 v[160:163], a[176:179], v[84:87], v[160:163]
ds_write_b64 v7, v[156:157] offset:736
v_exp_f32 v71, v71
v_mfma_f32_16x16x32_bf16 v[164:167], a[180:183], v[84:87], v[164:167]
v_cvt_pk_bf16_f32 v90, v68, v69
v_cvt_pk_bf16_f32 v91, v70, v71
v_mfma_f32_16x16x32_bf16 v[164:167], a[148:151], v[80:83], v[164:167]
ds_read_b128 v[128:131], v8 offset:512
ds_read_b128 v[132:135], v8 offset:1568
v_exp_f32 v72, v72
v_mfma_f32_16x16x32_bf16 v[168:171], a[152:155], v[80:83], v[168:171]
v_exp_f32 v73, v73
v_mfma_f32_16x16x32_bf16 v[168:171], a[184:187], v[84:87], v[168:171]
ds_read_b128 v[136:139], v8 offset:2624
ds_read_b128 v[140:143], v8 offset:3680
v_mfma_f32_16x16x32_bf16 v[172:175], a[188:191], v[84:87], v[172:175]
v_exp_f32 v74, v74
v_mfma_f32_16x16x32_bf16 v[172:175], a[156:159], v[80:83], v[172:175]
v_exp_f32 v75, v75
v_mfma_f32_16x16x32_bf16 v[176:179], a[160:163], v[80:83], v[176:179]
v_cvt_pk_bf16_f32 v92, v72, v73
v_cvt_pk_bf16_f32 v93, v74, v75
v_mfma_f32_16x16x32_bf16 v[176:179], a[192:195], v[84:87], v[176:179]
v_exp_f32 v76, v76
v_mfma_f32_16x16x32_bf16 v[180:183], a[196:199], v[84:87], v[180:183]
v_exp_f32 v77, v77
v_mfma_f32_16x16x32_bf16 v[180:183], a[164:167], v[80:83], v[180:183]
v_exp_f32 v78, v78
v_mfma_f32_16x16x32_bf16 v[184:187], a[168:171], v[80:83], v[184:187]
s_waitcnt lgkmcnt(3)
v_exp_f32 v79, v79
v_mfma_f32_16x16x32_bf16 v[184:187], a[200:203], v[84:87], v[184:187]
buffer_store_dwordx4 v[128:131], v9, s[28:31], s42 offen offset:512 sc0 sc1
v_cvt_pk_bf16_f32 v94, v76, v77
v_cvt_pk_bf16_f32 v95, v78, v79
v_mfma_f32_16x16x32_bf16 v[188:191], a[204:207], v[84:87], v[188:191]
s_waitcnt lgkmcnt(2)
v_mfma_f32_16x16x32_bf16 v[188:191], a[172:175], v[80:83], v[188:191]
buffer_store_dwordx4 v[132:135], v9, s[28:31], s42 offen offset:1536 sc0 sc1
v_mfma_f32_16x16x32_bf16 a[220:223], a[228:231], v[88:91], a[220:223]
s_waitcnt lgkmcnt(1)
v_mfma_f32_16x16x32_bf16 a[220:223], a[228:231], v[92:95], a[220:223]
v_mfma_f32_16x16x32_bf16 v[192:195], a[144:147], v[88:91], v[192:195]
v_mfma_f32_16x16x32_bf16 v[192:195], a[176:179], v[92:95], v[192:195]
buffer_store_dwordx4 v[136:139], v9, s[28:31], s42 offen offset:2560 sc0 sc1
v_accvgpr_read_b32 v10, a216
v_rcp_f32 v14, v10
v_add_f32 v5, v5, v10
v_add_f32 v5, v5, v14
v_pk_mul_f32 v[160:161], v[160:161], v[14:15] op_sel_hi:[1,0]
v_pk_mul_f32 v[162:163], v[162:163], v[14:15] op_sel_hi:[1,0]
v_pk_mul_f32 v[164:165], v[164:165], v[14:15] op_sel_hi:[1,0]
v_pk_mul_f32 v[166:167], v[166:167], v[14:15] op_sel_hi:[1,0]
v_pk_mul_f32 v[168:169], v[168:169], v[14:15] op_sel_hi:[1,0]
v_pk_mul_f32 v[170:171], v[170:171], v[14:15] op_sel_hi:[1,0]
v_pk_mul_f32 v[172:173], v[172:173], v[14:15] op_sel_hi:[1,0]
v_pk_mul_f32 v[174:175], v[174:175], v[14:15] op_sel_hi:[1,0]
v_pk_mul_f32 v[176:177], v[176:177], v[14:15] op_sel_hi:[1,0]
v_pk_mul_f32 v[178:179], v[178:179], v[14:15] op_sel_hi:[1,0]
v_pk_mul_f32 v[180:181], v[180:181], v[14:15] op_sel_hi:[1,0]
v_pk_mul_f32 v[182:183], v[182:183], v[14:15] op_sel_hi:[1,0]
v_pk_mul_f32 v[184:185], v[184:185], v[14:15] op_sel_hi:[1,0]
v_pk_mul_f32 v[186:187], v[186:187], v[14:15] op_sel_hi:[1,0]
v_pk_mul_f32 v[188:189], v[188:189], v[14:15] op_sel_hi:[1,0]
v_pk_mul_f32 v[190:191], v[190:191], v[14:15] op_sel_hi:[1,0]
v_cvt_pk_bf16_f32 v160, v160, v161
v_cvt_pk_bf16_f32 v161, v162, v163
v_cvt_pk_bf16_f32 v164, v164, v165
v_cvt_pk_bf16_f32 v165, v166, v167
v_mfma_f32_16x16x32_bf16 v[196:199], a[180:183], v[92:95], v[196:199]
ds_write_b64 v7, v[160:161] offset:8448
ds_write_b64 v7, v[164:165] offset:8480
v_cvt_pk_bf16_f32 v168, v168, v169
v_cvt_pk_bf16_f32 v169, v170, v171
v_mfma_f32_16x16x32_bf16 v[196:199], a[148:151], v[88:91], v[196:199]
ds_write_b64 v7, v[168:169] offset:8512
v_cvt_pk_bf16_f32 v172, v172, v173
v_cvt_pk_bf16_f32 v173, v174, v175
v_cvt_pk_bf16_f32 v176, v176, v177
v_cvt_pk_bf16_f32 v177, v178, v179
v_cvt_pk_bf16_f32 v180, v180, v181
v_cvt_pk_bf16_f32 v181, v182, v183
v_cvt_pk_bf16_f32 v184, v184, v185
v_cvt_pk_bf16_f32 v185, v186, v187
v_cvt_pk_bf16_f32 v188, v188, v189
v_cvt_pk_bf16_f32 v189, v190, v191
v_accvgpr_read_b32 v10, a220
v_mfma_f32_16x16x32_bf16 v[200:203], a[152:155], v[88:91], v[200:203]
ds_write_b64 v7, v[172:173] offset:8544
ds_write_b64 v7, v[176:177] offset:8576
v_rcp_f32 v14, v10
v_mfma_f32_16x16x32_bf16 v[200:203], a[184:187], v[92:95], v[200:203]
ds_write_b64 v7, v[180:181] offset:8608
v_add_f32 v5, v5, v10
v_add_f32 v5, v5, v14
v_mfma_f32_16x16x32_bf16 v[204:207], a[188:191], v[92:95], v[204:207]
ds_write_b64 v7, v[184:185] offset:8640
v_mul_f32 v192, v14, v192
v_mul_f32 v193, v14, v193
v_mfma_f32_16x16x32_bf16 v[204:207], a[156:159], v[88:91], v[204:207]
ds_write_b64 v7, v[188:189] offset:8672
v_mul_f32 v194, v14, v194
v_mul_f32 v195, v14, v195
v_mfma_f32_16x16x32_bf16 v[208:211], a[160:163], v[88:91], v[208:211]
s_waitcnt lgkmcnt(8)
v_cvt_pk_bf16_f32 v192, v192, v193
v_cvt_pk_bf16_f32 v193, v194, v195
v_mfma_f32_16x16x32_bf16 v[208:211], a[192:195], v[92:95], v[208:211]
buffer_store_dwordx4 v[140:143], v9, s[28:31], s42 offen offset:3584 sc0 sc1
ds_read_b128 v[160:163], v8 offset:8448
ds_read_b128 v[164:167], v8 offset:9504
ds_read_b128 v[168:171], v8 offset:10560
ds_read_b128 v[172:175], v8 offset:11616
ds_write_b64 v7, v[192:193] offset:8960
v_mul_f32 v196, v14, v196
v_mul_f32 v197, v14, v197
v_mfma_f32_16x16x32_bf16 v[212:215], a[196:199], v[92:95], v[212:215]
s_add_u32 s42, s42, 8192
v_mul_f32 v198, v14, v198
v_mul_f32 v199, v14, v199
v_mfma_f32_16x16x32_bf16 v[212:215], a[164:167], v[88:91], v[212:215]
v_cvt_pk_bf16_f32 v196, v196, v197
v_cvt_pk_bf16_f32 v197, v198, v199
v_mfma_f32_16x16x32_bf16 v[216:219], a[168:171], v[88:91], v[216:219]
v_mul_f32 v200, v14, v200
v_mul_f32 v201, v14, v201
v_mfma_f32_16x16x32_bf16 v[216:219], a[200:203], v[92:95], v[216:219]
ds_write_b64 v7, v[196:197] offset:8992
v_mul_f32 v202, v14, v202
v_mul_f32 v203, v14, v203
v_mfma_f32_16x16x32_bf16 v[220:223], a[204:207], v[92:95], v[220:223]
v_cvt_pk_bf16_f32 v200, v200, v201
v_cvt_pk_bf16_f32 v201, v202, v203
v_mfma_f32_16x16x32_bf16 v[220:223], a[172:175], v[88:91], v[220:223]
s_waitcnt lgkmcnt(5)
buffer_store_dwordx4 v[160:163], v9, s[28:31], s42 offen sc0 sc1
ds_write_b64 v7, v[200:201] offset:9024
s_branch L_tail
.p2align 6
L_n010:
v_exp_f32 v76, v76
v_mfma_f32_16x16x32_bf16 v[56:59], a[80:83], a[64:67], v[52:55]
buffer_load_dwordx4 v[20:23], v3, s[24:27], s35 offen offset:1024 nt
v_mfma_f32_16x16x32_bf16 v[56:59], a[84:87], a[68:71], v[56:59]
v_exp_f32 v77, v77
v_mfma_f32_16x16x32_bf16 v[56:59], a[88:91], a[72:75], v[56:59]
v_cvt_pk_bf16_f32 v94, v76, v77
v_mfma_f32_16x16x32_bf16 v[56:59], a[92:95], a[76:79], v[56:59]
v_exp_f32 v78, v78
v_mfma_f32_16x16x32_bf16 v[60:63], a[108:111], a[76:79], v[52:55]
v_mfma_f32_16x16x32_bf16 v[60:63], a[104:107], a[72:75], v[60:63]
s_waitcnt vmcnt(5) lgkmcnt(0)
v_exp_f32 v79, v79
v_mfma_f32_16x16x32_bf16 v[60:63], a[100:103], a[68:71], v[60:63]
v_cvt_pk_bf16_f32 v95, v78, v79
v_mfma_f32_16x16x32_bf16 v[60:63], a[96:99], a[64:67], v[60:63]
s_barrier
s_add_u32 s16, s16, 16384
s_addc_u32 s17, s17, 0
v_mfma_f32_16x16x32_bf16 v[192:195], a[144:147], v[88:91], v[192:195]
ds_read_b64_tr_b16 a[144:145], v2
v_mfma_f32_16x16x32_bf16 v[192:195], a[176:179], v[92:95], v[192:195]
v_exp_f32 v56, v56
v_mfma_f32_16x16x32_bf16 v[196:199], a[180:183], v[92:95], v[196:199]
ds_read_b64_tr_b16 a[146:147], v2 offset:512
v_mfma_f32_16x16x32_bf16 v[196:199], a[148:151], v[88:91], v[196:199]
ds_read_b64_tr_b16 a[148:149], v2 offset:32
v_mfma_f32_16x16x32_bf16 v[200:203], a[152:155], v[88:91], v[200:203]
v_exp_f32 v57, v57
v_mfma_f32_16x16x32_bf16 v[200:203], a[184:187], v[92:95], v[200:203]
ds_read_b64_tr_b16 a[150:151], v2 offset:544
v_cvt_pk_bf16_f32 v80, v56, v57
v_mfma_f32_16x16x32_bf16 v[204:207], a[188:191], v[92:95], v[204:207]
ds_read_b64_tr_b16 a[152:153], v2 offset:64
v_mfma_f32_16x16x32_bf16 v[204:207], a[156:159], v[88:91], v[204:207]
v_exp_f32 v58, v58
v_mfma_f32_16x16x32_bf16 v[208:211], a[160:163], v[88:91], v[208:211]
ds_read_b64_tr_b16 a[154:155], v2 offset:576
v_mfma_f32_16x16x32_bf16 v[208:211], a[192:195], v[92:95], v[208:211]
ds_read_b64_tr_b16 a[156:157], v2 offset:96
v_mfma_f32_16x16x32_bf16 v[212:215], a[196:199], v[92:95], v[212:215]
v_exp_f32 v59, v59
v_mfma_f32_16x16x32_bf16 v[212:215], a[164:167], v[88:91], v[212:215]
ds_read_b64_tr_b16 a[158:159], v2 offset:608
v_cvt_pk_bf16_f32 v81, v58, v59
v_mfma_f32_16x16x32_bf16 v[216:219], a[168:171], v[88:91], v[216:219]
ds_read_b64_tr_b16 a[160:161], v2 offset:128
v_mfma_f32_16x16x32_bf16 v[216:219], a[200:203], v[92:95], v[216:219]
v_mfma_f32_16x16x32_bf16 v[220:223], a[204:207], v[92:95], v[220:223]
ds_read_b64_tr_b16 a[162:163], v2 offset:640
v_mfma_f32_16x16x32_bf16 v[220:223], a[172:175], v[88:91], v[220:223]
ds_read_b64_tr_b16 a[164:165], v2 offset:160
v_mfma_f32_16x16x32_bf16 a[220:223], a[228:231], v[88:91], a[220:223]
v_mfma_f32_16x16x32_bf16 a[220:223], a[228:231], v[92:95], a[220:223]
ds_read_b64_tr_b16 a[166:167], v2 offset:672
v_mfma_f32_16x16x32_bf16 v[64:67], a[80:83], a[0:3], v[36:39]
s_waitcnt vmcnt(6)
ds_read_b64_tr_b16 a[168:169], v2 offset:192
v_mfma_f32_16x16x32_bf16 v[64:67], a[84:87], a[4:7], v[64:67]
v_mfma_f32_16x16x32_bf16 v[64:67], a[88:91], a[8:11], v[64:67]
ds_read_b64_tr_b16 a[170:171], v2 offset:704
v_lshlrev_b32 v32, 16, v16
v_mfma_f32_16x16x32_bf16 v[64:67], a[92:95], a[12:15], v[64:67]
ds_read_b64_tr_b16 a[172:173], v2 offset:224
v_and_b32 v33, s45, v16
v_exp_f32 v60, v60
v_exp_f32 v61, v61
v_exp_f32 v62, v62
v_exp_f32 v63, v63
v_cvt_pk_bf16_f32 v82, v60, v61
v_cvt_pk_bf16_f32 v83, v62, v63
v_mfma_f32_16x16x32_bf16 v[68:71], a[108:111], a[12:15], v[36:39]
v_mfma_f32_16x16x32_bf16 v[68:71], a[104:107], a[8:11], v[68:71]
ds_read_b64_tr_b16 a[174:175], v2 offset:736
v_mfma_f32_16x16x32_bf16 v[68:71], a[100:103], a[4:7], v[68:71]
ds_read_b64_tr_b16 a[176:177], v2 offset:8448
v_mul_f32 v32, s38, v32
v_mfma_f32_16x16x32_bf16 v[68:71], a[96:99], a[0:3], v[68:71]
ds_read_b64_tr_b16 a[178:179], v2 offset:8960
v_mul_f32 v33, s38, v33
v_mfma_f32_16x16x32_bf16 v[72:75], a[112:115], a[0:3], v[36:39]
v_mfma_f32_16x16x32_bf16 v[72:75], a[116:119], a[4:7], v[72:75]
ds_read_b64_tr_b16 a[180:181], v2 offset:8480
v_cvt_pk_bf16_f32 v16, v32, v33
v_mfma_f32_16x16x32_bf16 v[72:75], a[120:123], a[8:11], v[72:75]
v_mfma_f32_16x16x32_bf16 v[72:75], a[124:127], a[12:15], v[72:75]
ds_read_b64_tr_b16 a[182:183], v2 offset:8992
v_exp_f32 v64, v64
v_exp_f32 v65, v65
v_exp_f32 v66, v66
v_exp_f32 v67, v67
v_cvt_pk_bf16_f32 v88, v64, v65
v_cvt_pk_bf16_f32 v89, v66, v67
v_mfma_f32_16x16x32_bf16 v[76:79], a[140:143], a[12:15], v[36:39]
v_mfma_f32_16x16x32_bf16 v[76:79], a[136:139], a[8:11], v[76:79]
ds_read_b64_tr_b16 a[184:185], v2 offset:8512
v_lshlrev_b32 v34, 16, v17
v_mfma_f32_16x16x32_bf16 v[76:79], a[132:135], a[4:7], v[76:79]
s_waitcnt lgkmcnt(13)
v_mfma_f32_16x16x32_bf16 v[76:79], a[128:131], a[0:3], v[76:79]
ds_read_b64_tr_b16 a[186:187], v2 offset:9024
v_mfma_f32_16x16x32_bf16 v[224:227], a[144:147], v[80:83], v[224:227]
v_mfma_f32_16x16x32_bf16 v[228:231], a[148:151], v[80:83], v[228:231]
ds_read_b64_tr_b16 a[188:189], v2 offset:8544
v_and_b32 v35, s45, v17
v_mfma_f32_16x16x32_bf16 v[232:235], a[152:155], v[80:83], v[232:235]
s_waitcnt lgkmcnt(7)
v_mfma_f32_16x16x32_bf16 v[236:239], a[156:159], v[80:83], v[236:239]
ds_read_b64_tr_b16 a[190:191], v2 offset:9056
v_mfma_f32_16x16x32_bf16 v[240:243], a[160:163], v[80:83], v[240:243]
v_mfma_f32_16x16x32_bf16 v[244:247], a[164:167], v[80:83], v[244:247]
ds_read_b64_tr_b16 a[192:193], v2 offset:8576
v_mul_f32 v34, s38, v34
v_mfma_f32_16x16x32_bf16 v[248:251], a[168:171], v[80:83], v[248:251]
v_exp_f32 v68, v68
v_exp_f32 v69, v69
v_exp_f32 v70, v70
v_exp_f32 v71, v71
v_cvt_pk_bf16_f32 v90, v68, v69
v_cvt_pk_bf16_f32 v91, v70, v71
v_mfma_f32_16x16x32_bf16 v[252:255], a[172:175], v[80:83], v[252:255]
ds_read_b64_tr_b16 a[194:195], v2 offset:9088
v_mfma_f32_16x16x32_bf16 a[224:227], a[228:231], v[80:83], a[224:227]
s_add_u32 m0, s33, 50688
v_exp_f32 v72, v72
v_mfma_f32_16x16x32_bf16 v[56:59], a[80:83], a[16:19], v[40:43]
buffer_load_dwordx4 v3, s[16:19], 0 offen nt lds
v_mfma_f32_16x16x32_bf16 v[56:59], a[84:87], a[20:23], v[56:59]
v_exp_f32 v73, v73
v_mfma_f32_16x16x32_bf16 v[56:59], a[88:91], a[24:27], v[56:59]
ds_read_b64_tr_b16 a[196:197], v2 offset:8608
v_cvt_pk_bf16_f32 v92, v72, v73
v_mfma_f32_16x16x32_bf16 v[56:59], a[92:95], a[28:31], v[56:59]
v_exp_f32 v74, v74
v_mfma_f32_16x16x32_bf16 v[60:63], a[108:111], a[28:31], v[40:43]
ds_read_b64_tr_b16 a[198:199], v2 offset:9120
v_mul_f32 v35, s38, v35
v_mfma_f32_16x16x32_bf16 v[60:63], a[104:107], a[24:27], v[60:63]
v_exp_f32 v75, v75
v_mfma_f32_16x16x32_bf16 v[60:63], a[100:103], a[20:23], v[60:63]
ds_read_b64_tr_b16 a[200:201], v2 offset:8640
v_cvt_pk_bf16_f32 v93, v74, v75
v_mfma_f32_16x16x32_bf16 v[60:63], a[96:99], a[16:19], v[60:63]
s_add_u32 m0, s33, 50720
v_mfma_f32_16x16x32_bf16 v[64:67], a[112:115], a[16:19], v[40:43]
buffer_load_dwordx4 v3, s[16:19], 0 offen offset:1024 nt lds
v_mfma_f32_16x16x32_bf16 v[64:67], a[116:119], a[20:23], v[64:67]
v_mfma_f32_16x16x32_bf16 v[64:67], a[120:123], a[24:27], v[64:67]
ds_read_b64_tr_b16 a[202:203], v2 offset:9152
v_mfma_f32_16x16x32_bf16 v[64:67], a[124:127], a[28:31], v[64:67]
v_exp_f32 v76, v76
v_exp_f32 v77, v77
v_exp_f32 v78, v78
v_exp_f32 v79, v79
v_cvt_pk_bf16_f32 v94, v76, v77
v_cvt_pk_bf16_f32 v95, v78, v79
v_mfma_f32_16x16x32_bf16 v[68:71], a[140:143], a[28:31], v[40:43]
ds_read_b64_tr_b16 a[204:205], v2 offset:8672
v_cvt_pk_bf16_f32 v17, v34, v35
v_mfma_f32_16x16x32_bf16 v[68:71], a[136:139], a[24:27], v[68:71]
s_waitcnt lgkmcnt(7)
v_mfma_f32_16x16x32_bf16 v[68:71], a[132:135], a[20:23], v[68:71]
ds_read_b64_tr_b16 a[206:207], v2 offset:9184
v_mfma_f32_16x16x32_bf16 v[68:71], a[128:131], a[16:19], v[68:71]
s_add_u32 m0, s33, 50752
v_mfma_f32_16x16x32_bf16 v[96:99], a[144:147], v[88:91], v[96:99]
buffer_load_dwordx4 v3, s[16:19], 0 offen offset:2048 nt lds
v_mfma_f32_16x16x32_bf16 v[96:99], a[176:179], v[92:95], v[96:99]
v_mfma_f32_16x16x32_bf16 v[100:103], a[180:183], v[92:95], v[100:103]
v_lshlrev_b32 v32, 16, v18
v_mfma_f32_16x16x32_bf16 v[100:103], a[148:151], v[88:91], v[100:103]
v_mfma_f32_16x16x32_bf16 v[104:107], a[152:155], v[88:91], v[104:107]
buffer_load_dwordx4 v[24:27], v3, s[24:27], s35 offen offset:2048 nt
v_mfma_f32_16x16x32_bf16 v[104:107], a[184:187], v[92:95], v[104:107]
v_exp_f32 v56, v56
v_exp_f32 v57, v57
v_exp_f32 v58, v58
v_exp_f32 v59, v59
v_cvt_pk_bf16_f32 v80, v56, v57
v_cvt_pk_bf16_f32 v81, v58, v59
v_mfma_f32_16x16x32_bf16 v[108:111], a[188:191], v[92:95], v[108:111]
s_waitcnt lgkmcnt(0)
v_and_b32 v33, s45, v18
v_mfma_f32_16x16x32_bf16 v[108:111], a[156:159], v[88:91], v[108:111]
s_add_u32 m0, s33, 50784
v_mfma_f32_16x16x32_bf16 v[112:115], a[160:163], v[88:91], v[112:115]
buffer_load_dwordx4 v3, s[16:19], 0 offen offset:3072 nt lds
v_mfma_f32_16x16x32_bf16 v[112:115], a[192:195], v[92:95], v[112:115]
v_mfma_f32_16x16x32_bf16 v[116:119], a[196:199], v[92:95], v[116:119]
s_add_u32 s12, s12, 16384
s_addc_u32 s13, s13, 0
v_mfma_f32_16x16x32_bf16 v[116:119], a[164:167], v[88:91], v[116:119]
v_mfma_f32_16x16x32_bf16 v[120:123], a[168:171], v[88:91], v[120:123]
v_mul_f32 v32, s38, v32
v_mul_f32 v33, s38, v33
v_mfma_f32_16x16x32_bf16 v[120:123], a[200:203], v[92:95], v[120:123]
s_add_u32 m0, s33, 0
v_exp_f32 v60, v60
v_exp_f32 v61, v61
v_exp_f32 v62, v62
v_exp_f32 v63, v63
v_cvt_pk_bf16_f32 v82, v60, v61
v_cvt_pk_bf16_f32 v83, v62, v63
v_mfma_f32_16x16x32_bf16 v[124:127], a[204:207], v[92:95], v[124:127]
v_cvt_pk_bf16_f32 v18, v32, v33
v_mfma_f32_16x16x32_bf16 v[124:127], a[172:175], v[88:91], v[124:127]
v_mfma_f32_16x16x32_bf16 a[208:211], a[228:231], v[88:91], a[208:211]
buffer_load_dwordx4 v3, s[12:15], 0 offen nt lds
v_mfma_f32_16x16x32_bf16 a[208:211], a[228:231], v[92:95], a[208:211]
v_mfma_f32_16x16x32_bf16 v[72:75], a[80:83], a[32:35], v[44:47]
v_lshlrev_b32 v34, 16, v19
v_mfma_f32_16x16x32_bf16 v[72:75], a[84:87], a[36:39], v[72:75]
v_mfma_f32_16x16x32_bf16 v[72:75], a[88:91], a[40:43], v[72:75]
v_and_b32 v35, s45, v19
v_mul_f32 v34, s38, v34
v_mfma_f32_16x16x32_bf16 v[72:75], a[92:95], a[44:47], v[72:75]
s_add_u32 m0, s33, 32
v_exp_f32 v64, v64
v_exp_f32 v65, v65
v_exp_f32 v66, v66
v_exp_f32 v67, v67
v_cvt_pk_bf16_f32 v84, v64, v65
v_cvt_pk_bf16_f32 v85, v66, v67
v_mfma_f32_16x16x32_bf16 v[76:79], a[108:111], a[44:47], v[44:47]
v_mul_f32 v35, s38, v35
v_mfma_f32_16x16x32_bf16 v[76:79], a[104:107], a[40:43], v[76:79]
v_exp_f32 v68, v68
v_mfma_f32_16x16x32_bf16 v[76:79], a[100:103], a[36:39], v[76:79]
buffer_load_dwordx4 v3, s[12:15], 0 offen offset:1024 nt lds
v_mfma_f32_16x16x32_bf16 v[76:79], a[96:99], a[32:35], v[76:79]
v_exp_f32 v69, v69
v_mfma_f32_16x16x32_bf16 v[56:59], a[112:115], a[32:35], v[44:47]
v_cvt_pk_bf16_f32 v86, v68, v69
v_cvt_pk_bf16_f32 v19, v34, v35
v_mfma_f32_16x16x32_bf16 v[56:59], a[116:119], a[36:39], v[56:59]
v_exp_f32 v70, v70
v_mfma_f32_16x16x32_bf16 v[56:59], a[120:123], a[40:43], v[56:59]
v_mfma_f32_16x16x32_bf16 v[56:59], a[124:127], a[44:47], v[56:59]
s_add_u32 m0, s33, 64
v_exp_f32 v71, v71
v_mfma_f32_16x16x32_bf16 v[60:63], a[140:143], a[44:47], v[44:47]
v_mfma_f32_16x16x32_bf16 v[60:63], a[136:139], a[40:43], v[60:63]
v_cvt_pk_bf16_f32 v87, v70, v71
v_mfma_f32_16x16x32_bf16 v[60:63], a[132:135], a[36:39], v[60:63]
v_mfma_f32_16x16x32_bf16 v[60:63], a[128:131], a[32:35], v[60:63]
v_mfma_f32_16x16x32_bf16 v[128:131], a[144:147], v[80:83], v[128:131]
v_mfma_f32_16x16x32_bf16 v[128:131], a[176:179], v[84:87], v[128:131]
buffer_load_dwordx4 v3, s[12:15], 0 offen offset:2048 nt lds
v_exp_f32 v72, v72
v_exp_f32 v73, v73
v_exp_f32 v74, v74
v_exp_f32 v75, v75
v_cvt_pk_bf16_f32 v88, v72, v73
v_cvt_pk_bf16_f32 v89, v74, v75
v_mfma_f32_16x16x32_bf16 v[132:135], a[180:183], v[84:87], v[132:135]
v_mfma_f32_16x16x32_bf16 v[132:135], a[148:151], v[80:83], v[132:135]
v_mfma_f32_16x16x32_bf16 v[136:139], a[152:155], v[80:83], v[136:139]
s_add_u32 m0, s33, 96
v_mfma_f32_16x16x32_bf16 v[136:139], a[184:187], v[84:87], v[136:139]
buffer_load_dwordx4 v3, s[12:15], 0 offen offset:3072 nt lds
v_mfma_f32_16x16x32_bf16 v[140:143], a[188:191], v[84:87], v[140:143]
v_mfma_f32_16x16x32_bf16 v[140:143], a[156:159], v[80:83], v[140:143]
v_mfma_f32_16x16x32_bf16 v[144:147], a[160:163], v[80:83], v[144:147]
v_mfma_f32_16x16x32_bf16 v[144:147], a[192:195], v[84:87], v[144:147]
ds_write_b128 v4, v[16:19]
v_exp_f32 v76, v76
v_exp_f32 v77, v77
v_exp_f32 v78, v78
v_exp_f32 v79, v79
v_cvt_pk_bf16_f32 v90, v76, v77
v_cvt_pk_bf16_f32 v91, v78, v79
v_mfma_f32_16x16x32_bf16 v[148:151], a[196:199], v[84:87], v[148:151]
v_mfma_f32_16x16x32_bf16 v[148:151], a[164:167], v[80:83], v[148:151]
v_mfma_f32_16x16x32_bf16 v[152:155], a[168:171], v[80:83], v[152:155]
v_mfma_f32_16x16x32_bf16 v[152:155], a[200:203], v[84:87], v[152:155]
v_mfma_f32_16x16x32_bf16 v[156:159], a[204:207], v[84:87], v[156:159]
s_waitcnt vmcnt(10) lgkmcnt(1)
v_mfma_f32_16x16x32_bf16 v[156:159], a[172:175], v[80:83], v[156:159]
v_mfma_f32_16x16x32_bf16 a[212:215], a[228:231], v[80:83], a[212:215]
s_barrier
v_mfma_f32_16x16x32_bf16 a[212:215], a[228:231], v[84:87], a[212:215]
v_exp_f32 v56, v56
v_exp_f32 v57, v57
v_exp_f32 v58, v58
v_exp_f32 v59, v59
v_cvt_pk_bf16_f32 v92, v56, v57
v_cvt_pk_bf16_f32 v93, v58, v59
v_mfma_f32_16x16x32_bf16 v[64:67], a[80:83], a[48:51], v[48:51]
v_mfma_f32_16x16x32_bf16 v[64:67], a[84:87], a[52:55], v[64:67]
ds_read_b128 a[80:83], v1 offset:16896
v_mfma_f32_16x16x32_bf16 v[64:67], a[88:91], a[56:59], v[64:67]
v_exp_f32 v60, v60
v_mfma_f32_16x16x32_bf16 v[64:67], a[92:95], a[60:63], v[64:67]
ds_read_b128 a[84:87], v1 offset:16960
ds_read_b128 a[88:91], v1 offset:17024
v_mfma_f32_16x16x32_bf16 v[68:71], a[108:111], a[60:63], v[48:51]
v_exp_f32 v61, v61
v_mfma_f32_16x16x32_bf16 v[68:71], a[104:107], a[56:59], v[68:71]
ds_read_b128 a[92:95], v1 offset:17088
v_cvt_pk_bf16_f32 v94, v60, v61
v_mfma_f32_16x16x32_bf16 v[68:71], a[100:103], a[52:55], v[68:71]
v_exp_f32 v62, v62
v_mfma_f32_16x16x32_bf16 v[68:71], a[96:99], a[48:51], v[68:71]
ds_read_b128 a[108:111], v1 offset:17600
v_mfma_f32_16x16x32_bf16 v[72:75], a[112:115], a[48:51], v[48:51]
v_exp_f32 v63, v63
v_mfma_f32_16x16x32_bf16 v[72:75], a[116:119], a[52:55], v[72:75]
v_mfma_f32_16x16x32_bf16 v[72:75], a[120:123], a[56:59], v[72:75]
ds_read_b128 a[104:107], v1 offset:17536
v_cvt_pk_bf16_f32 v95, v62, v63
v_mfma_f32_16x16x32_bf16 v[72:75], a[124:127], a[60:63], v[72:75]
v_mfma_f32_16x16x32_bf16 v[76:79], a[140:143], a[60:63], v[48:51]
ds_read_b128 a[100:103], v1 offset:17472
v_mfma_f32_16x16x32_bf16 v[76:79], a[136:139], a[56:59], v[76:79]
v_mfma_f32_16x16x32_bf16 v[76:79], a[132:135], a[52:55], v[76:79]
ds_read_b128 a[96:99], v1 offset:17408
v_mfma_f32_16x16x32_bf16 v[76:79], a[128:131], a[48:51], v[76:79]
v_exp_f32 v64, v64
v_exp_f32 v65, v65
v_exp_f32 v66, v66
v_exp_f32 v67, v67
v_cvt_pk_bf16_f32 v80, v64, v65
v_cvt_pk_bf16_f32 v81, v66, v67
v_mfma_f32_16x16x32_bf16 v[160:163], a[144:147], v[88:91], v[160:163]
ds_read_b128 a[112:115], v1 offset:25344
v_mfma_f32_16x16x32_bf16 v[160:163], a[176:179], v[92:95], v[160:163]
v_mfma_f32_16x16x32_bf16 v[164:167], a[180:183], v[92:95], v[164:167]
ds_read_b128 a[116:119], v1 offset:25408
v_mfma_f32_16x16x32_bf16 v[164:167], a[148:151], v[88:91], v[164:167]
v_mfma_f32_16x16x32_bf16 v[168:171], a[152:155], v[88:91], v[168:171]
ds_read_b128 a[120:123], v1 offset:25472
v_mfma_f32_16x16x32_bf16 v[168:171], a[184:187], v[92:95], v[168:171]
v_mfma_f32_16x16x32_bf16 v[172:175], a[188:191], v[92:95], v[172:175]
ds_read_b128 a[124:127], v1 offset:25536
v_mfma_f32_16x16x32_bf16 v[172:175], a[156:159], v[88:91], v[172:175]
v_exp_f32 v68, v68
v_exp_f32 v69, v69
v_exp_f32 v70, v70
v_exp_f32 v71, v71
v_cvt_pk_bf16_f32 v82, v68, v69
v_cvt_pk_bf16_f32 v83, v70, v71
v_mfma_f32_16x16x32_bf16 v[176:179], a[160:163], v[88:91], v[176:179]
ds_read_b128 a[140:143], v1 offset:26048
v_mfma_f32_16x16x32_bf16 v[176:179], a[192:195], v[92:95], v[176:179]
v_mfma_f32_16x16x32_bf16 v[180:183], a[196:199], v[92:95], v[180:183]
ds_read_b128 a[136:139], v1 offset:25984
v_mfma_f32_16x16x32_bf16 v[180:183], a[164:167], v[88:91], v[180:183]
v_mfma_f32_16x16x32_bf16 v[184:187], a[168:171], v[88:91], v[184:187]
ds_read_b128 a[132:135], v1 offset:25920
v_mfma_f32_16x16x32_bf16 v[184:187], a[200:203], v[92:95], v[184:187]
v_mfma_f32_16x16x32_bf16 v[188:191], a[204:207], v[92:95], v[188:191]
ds_read_b128 a[128:131], v1 offset:25856
v_mfma_f32_16x16x32_bf16 v[188:191], a[172:175], v[88:91], v[188:191]
v_exp_f32 v72, v72
v_exp_f32 v73, v73
v_exp_f32 v74, v74
v_exp_f32 v75, v75
v_cvt_pk_bf16_f32 v84, v72, v73
v_cvt_pk_bf16_f32 v85, v74, v75
v_mfma_f32_16x16x32_bf16 a[216:219], a[228:231], v[88:91], a[216:219]
s_waitcnt lgkmcnt(8)
v_mfma_f32_16x16x32_bf16 a[216:219], a[228:231], v[92:95], a[216:219]
v_mfma_f32_16x16x32_bf16 v[56:59], a[80:83], a[64:67], v[52:55]
buffer_load_dwordx4 v[16:19], v3, s[24:27], s35 offen offset:3072 nt
v_mfma_f32_16x16x32_bf16 v[56:59], a[84:87], a[68:71], v[56:59]
s_add_u32 s35, s35, 3072
v_mfma_f32_16x16x32_bf16 v[56:59], a[88:91], a[72:75], v[56:59]
v_mfma_f32_16x16x32_bf16 v[56:59], a[92:95], a[76:79], v[56:59]
v_exp_f32 v76, v76
v_exp_f32 v77, v77
v_exp_f32 v78, v78
v_exp_f32 v79, v79
v_cvt_pk_bf16_f32 v86, v76, v77
v_cvt_pk_bf16_f32 v87, v78, v79
v_mfma_f32_16x16x32_bf16 v[60:63], a[108:111], a[76:79], v[52:55]
v_mfma_f32_16x16x32_bf16 v[60:63], a[104:107], a[72:75], v[60:63]
s_waitcnt vmcnt(5) lgkmcnt(0)
v_mfma_f32_16x16x32_bf16 v[60:63], a[100:103], a[68:71], v[60:63]
s_waitcnt vmcnt(10)
v_lshlrev_b32 v32, 16, v20
v_mfma_f32_16x16x32_bf16 v[60:63], a[96:99], a[64:67], v[60:63]
s_barrier
s_add_u32 s16, s16, 16384
s_addc_u32 s17, s17, 0
v_mfma_f32_16x16x32_bf16 v[192:195], a[144:147], v[80:83], v[192:195]
ds_read_b64_tr_b16 a[144:145], v2 offset:16896
v_and_b32 v33, s45, v20
v_mfma_f32_16x16x32_bf16 v[192:195], a[176:179], v[84:87], v[192:195]
v_exp_f32 v56, v56
v_mfma_f32_16x16x32_bf16 v[196:199], a[180:183], v[84:87], v[196:199]
ds_read_b64_tr_b16 a[146:147], v2 offset:17408
v_mul_f32 v32, s38, v32
v_mfma_f32_16x16x32_bf16 v[196:199], a[148:151], v[80:83], v[196:199]
ds_read_b64_tr_b16 a[148:149], v2 offset:16928
v_mul_f32 v33, s38, v33
v_mfma_f32_16x16x32_bf16 v[200:203], a[152:155], v[80:83], v[200:203]
v_exp_f32 v57, v57
v_mfma_f32_16x16x32_bf16 v[200:203], a[184:187], v[84:87], v[200:203]
ds_read_b64_tr_b16 a[150:151], v2 offset:17440
v_cvt_pk_bf16_f32 v88, v56, v57
v_mfma_f32_16x16x32_bf16 v[204:207], a[188:191], v[84:87], v[204:207]
ds_read_b64_tr_b16 a[152:153], v2 offset:16960
v_cvt_pk_bf16_f32 v20, v32, v33
v_mfma_f32_16x16x32_bf16 v[204:207], a[156:159], v[80:83], v[204:207]
v_exp_f32 v58, v58
v_mfma_f32_16x16x32_bf16 v[208:211], a[160:163], v[80:83], v[208:211]
ds_read_b64_tr_b16 a[154:155], v2 offset:17472
v_lshlrev_b32 v34, 16, v21
v_mfma_f32_16x16x32_bf16 v[208:211], a[192:195], v[84:87], v[208:211]
ds_read_b64_tr_b16 a[156:157], v2 offset:16992
v_and_b32 v35, s45, v21
v_mfma_f32_16x16x32_bf16 v[212:215], a[196:199], v[84:87], v[212:215]
v_exp_f32 v59, v59
v_mfma_f32_16x16x32_bf16 v[212:215], a[164:167], v[80:83], v[212:215]
ds_read_b64_tr_b16 a[158:159], v2 offset:17504
v_cvt_pk_bf16_f32 v89, v58, v59
v_mfma_f32_16x16x32_bf16 v[216:219], a[168:171], v[80:83], v[216:219]
ds_read_b64_tr_b16 a[160:161], v2 offset:17024
v_mul_f32 v34, s38, v34
v_mfma_f32_16x16x32_bf16 v[216:219], a[200:203], v[84:87], v[216:219]
v_mfma_f32_16x16x32_bf16 v[220:223], a[204:207], v[84:87], v[220:223]
ds_read_b64_tr_b16 a[162:163], v2 offset:17536
v_mul_f32 v35, s38, v35
v_mfma_f32_16x16x32_bf16 v[220:223], a[172:175], v[80:83], v[220:223]
ds_read_b64_tr_b16 a[164:165], v2 offset:17056
v_cvt_pk_bf16_f32 v21, v34, v35
v_mfma_f32_16x16x32_bf16 a[220:223], a[228:231], v[80:83], a[220:223]
v_mfma_f32_16x16x32_bf16 a[220:223], a[228:231], v[84:87], a[220:223]
ds_read_b64_tr_b16 a[166:167], v2 offset:17568
v_mfma_f32_16x16x32_bf16 v[64:67], a[80:83], a[0:3], v[36:39]
ds_read_b64_tr_b16 a[168:169], v2 offset:17088
v_lshlrev_b32 v32, 16, v22
v_mfma_f32_16x16x32_bf16 v[64:67], a[84:87], a[4:7], v[64:67]
v_mfma_f32_16x16x32_bf16 v[64:67], a[88:91], a[8:11], v[64:67]
ds_read_b64_tr_b16 a[170:171], v2 offset:17600
v_and_b32 v33, s45, v22
v_mfma_f32_16x16x32_bf16 v[64:67], a[92:95], a[12:15], v[64:67]
ds_read_b64_tr_b16 a[172:173], v2 offset:17120
v_mul_f32 v32, s38, v32
v_exp_f32 v60, v60
v_exp_f32 v61, v61
v_exp_f32 v62, v62
v_exp_f32 v63, v63
v_cvt_pk_bf16_f32 v90, v60, v61
v_cvt_pk_bf16_f32 v91, v62, v63
v_mfma_f32_16x16x32_bf16 v[68:71], a[108:111], a[12:15], v[36:39]
v_mfma_f32_16x16x32_bf16 v[68:71], a[104:107], a[8:11], v[68:71]
ds_read_b64_tr_b16 a[174:175], v2 offset:17632
v_mfma_f32_16x16x32_bf16 v[68:71], a[100:103], a[4:7], v[68:71]
ds_read_b64_tr_b16 a[176:177], v2 offset:25344
v_mul_f32 v33, s38, v33
v_mfma_f32_16x16x32_bf16 v[68:71], a[96:99], a[0:3], v[68:71]
ds_read_b64_tr_b16 a[178:179], v2 offset:25856
v_cvt_pk_bf16_f32 v22, v32, v33
v_mfma_f32_16x16x32_bf16 v[72:75], a[112:115], a[0:3], v[36:39]
v_mfma_f32_16x16x32_bf16 v[72:75], a[116:119], a[4:7], v[72:75]
ds_read_b64_tr_b16 a[180:181], v2 offset:25376
v_lshlrev_b32 v34, 16, v23
v_mfma_f32_16x16x32_bf16 v[72:75], a[120:123], a[8:11], v[72:75]
v_mfma_f32_16x16x32_bf16 v[72:75], a[124:127], a[12:15], v[72:75]
ds_read_b64_tr_b16 a[182:183], v2 offset:25888
v_exp_f32 v64, v64
v_exp_f32 v65, v65
v_exp_f32 v66, v66
v_exp_f32 v67, v67
v_cvt_pk_bf16_f32 v80, v64, v65
v_cvt_pk_bf16_f32 v81, v66, v67
v_mfma_f32_16x16x32_bf16 v[76:79], a[140:143], a[12:15], v[36:39]
v_mfma_f32_16x16x32_bf16 v[76:79], a[136:139], a[8:11], v[76:79]
ds_read_b64_tr_b16 a[184:185], v2 offset:25408
v_and_b32 v35, s45, v23
v_mfma_f32_16x16x32_bf16 v[76:79], a[132:135], a[4:7], v[76:79]
s_waitcnt lgkmcnt(13)
v_mfma_f32_16x16x32_bf16 v[76:79], a[128:131], a[0:3], v[76:79]
ds_read_b64_tr_b16 a[186:187], v2 offset:25920
v_mfma_f32_16x16x32_bf16 v[224:227], a[144:147], v[88:91], v[224:227]
v_mfma_f32_16x16x32_bf16 v[228:231], a[148:151], v[88:91], v[228:231]
ds_read_b64_tr_b16 a[188:189], v2 offset:25440
v_mul_f32 v34, s38, v34
v_mfma_f32_16x16x32_bf16 v[232:235], a[152:155], v[88:91], v[232:235]
s_waitcnt lgkmcnt(7)
v_mfma_f32_16x16x32_bf16 v[236:239], a[156:159], v[88:91], v[236:239]
ds_read_b64_tr_b16 a[190:191], v2 offset:25952
v_mfma_f32_16x16x32_bf16 v[240:243], a[160:163], v[88:91], v[240:243]
v_mfma_f32_16x16x32_bf16 v[244:247], a[164:167], v[88:91], v[244:247]
ds_read_b64_tr_b16 a[192:193], v2 offset:25472
v_mul_f32 v35, s38, v35
v_mfma_f32_16x16x32_bf16 v[248:251], a[168:171], v[88:91], v[248:251]
v_exp_f32 v68, v68
v_exp_f32 v69, v69
v_exp_f32 v70, v70
v_exp_f32 v71, v71
v_cvt_pk_bf16_f32 v82, v68, v69
v_cvt_pk_bf16_f32 v83, v70, v71
v_mfma_f32_16x16x32_bf16 v[252:255], a[172:175], v[88:91], v[252:255]
ds_read_b64_tr_b16 a[194:195], v2 offset:25984
v_mfma_f32_16x16x32_bf16 a[224:227], a[228:231], v[88:91], a[224:227]
s_add_u32 m0, s33, 33792
v_exp_f32 v72, v72
v_mfma_f32_16x16x32_bf16 v[56:59], a[80:83], a[16:19], v[40:43]
buffer_load_dwordx4 v3, s[16:19], 0 offen nt lds
v_mfma_f32_16x16x32_bf16 v[56:59], a[84:87], a[20:23], v[56:59]
v_exp_f32 v73, v73
v_mfma_f32_16x16x32_bf16 v[56:59], a[88:91], a[24:27], v[56:59]
ds_read_b64_tr_b16 a[196:197], v2 offset:25504
v_cvt_pk_bf16_f32 v84, v72, v73
v_mfma_f32_16x16x32_bf16 v[56:59], a[92:95], a[28:31], v[56:59]
v_exp_f32 v74, v74
v_mfma_f32_16x16x32_bf16 v[60:63], a[108:111], a[28:31], v[40:43]
ds_read_b64_tr_b16 a[198:199], v2 offset:26016
v_cvt_pk_bf16_f32 v23, v34, v35
v_mfma_f32_16x16x32_bf16 v[60:63], a[104:107], a[24:27], v[60:63]
v_exp_f32 v75, v75
v_mfma_f32_16x16x32_bf16 v[60:63], a[100:103], a[20:23], v[60:63]
ds_read_b64_tr_b16 a[200:201], v2 offset:25536
v_cvt_pk_bf16_f32 v85, v74, v75
v_mfma_f32_16x16x32_bf16 v[60:63], a[96:99], a[16:19], v[60:63]
s_add_u32 m0, s33, 33824
v_mfma_f32_16x16x32_bf16 v[64:67], a[112:115], a[16:19], v[40:43]
buffer_load_dwordx4 v3, s[16:19], 0 offen offset:1024 nt lds
v_mfma_f32_16x16x32_bf16 v[64:67], a[116:119], a[20:23], v[64:67]
v_mfma_f32_16x16x32_bf16 v[64:67], a[120:123], a[24:27], v[64:67]
ds_read_b64_tr_b16 a[202:203], v2 offset:26048
v_mfma_f32_16x16x32_bf16 v[64:67], a[124:127], a[28:31], v[64:67]
s_waitcnt vmcnt(8)
v_exp_f32 v76, v76
v_exp_f32 v77, v77
v_exp_f32 v78, v78
v_exp_f32 v79, v79
v_cvt_pk_bf16_f32 v86, v76, v77
v_cvt_pk_bf16_f32 v87, v78, v79
v_mfma_f32_16x16x32_bf16 v[68:71], a[140:143], a[28:31], v[40:43]
ds_read_b64_tr_b16 a[204:205], v2 offset:25568
v_lshlrev_b32 v32, 16, v24
v_mfma_f32_16x16x32_bf16 v[68:71], a[136:139], a[24:27], v[68:71]
s_waitcnt lgkmcnt(7)
v_mfma_f32_16x16x32_bf16 v[68:71], a[132:135], a[20:23], v[68:71]
ds_read_b64_tr_b16 a[206:207], v2 offset:26080
v_mfma_f32_16x16x32_bf16 v[68:71], a[128:131], a[16:19], v[68:71]
s_add_u32 m0, s33, 33856
v_mfma_f32_16x16x32_bf16 v[96:99], a[144:147], v[80:83], v[96:99]
buffer_load_dwordx4 v3, s[16:19], 0 offen offset:2048 nt lds
v_mfma_f32_16x16x32_bf16 v[96:99], a[176:179], v[84:87], v[96:99]
v_mfma_f32_16x16x32_bf16 v[100:103], a[180:183], v[84:87], v[100:103]
v_and_b32 v33, s45, v24
v_mfma_f32_16x16x32_bf16 v[100:103], a[148:151], v[80:83], v[100:103]
v_mfma_f32_16x16x32_bf16 v[104:107], a[152:155], v[80:83], v[104:107]
ds_write_b128 v4, v[20:23] offset:1056
v_mfma_f32_16x16x32_bf16 v[104:107], a[184:187], v[84:87], v[104:107]
v_exp_f32 v56, v56
v_exp_f32 v57, v57
v_exp_f32 v58, v58
v_exp_f32 v59, v59
v_cvt_pk_bf16_f32 v88, v56, v57
v_cvt_pk_bf16_f32 v89, v58, v59
v_mfma_f32_16x16x32_bf16 v[108:111], a[188:191], v[84:87], v[108:111]
s_waitcnt lgkmcnt(1)
v_mul_f32 v32, s38, v32
v_mfma_f32_16x16x32_bf16 v[108:111], a[156:159], v[80:83], v[108:111]
s_add_u32 m0, s33, 33888
v_mfma_f32_16x16x32_bf16 v[112:115], a[160:163], v[80:83], v[112:115]
buffer_load_dwordx4 v3, s[16:19], 0 offen offset:3072 nt lds
v_mfma_f32_16x16x32_bf16 v[112:115], a[192:195], v[84:87], v[112:115]
v_mfma_f32_16x16x32_bf16 v[116:119], a[196:199], v[84:87], v[116:119]
s_add_u32 s12, s12, 16384
s_addc_u32 s13, s13, 0
v_mfma_f32_16x16x32_bf16 v[116:119], a[164:167], v[80:83], v[116:119]
v_mfma_f32_16x16x32_bf16 v[120:123], a[168:171], v[80:83], v[120:123]
v_mul_f32 v33, s38, v33
v_cvt_pk_bf16_f32 v24, v32, v33
v_mfma_f32_16x16x32_bf16 v[120:123], a[200:203], v[84:87], v[120:123]
s_add_u32 m0, s33, 16896
v_exp_f32 v60, v60
v_exp_f32 v61, v61
v_exp_f32 v62, v62
v_exp_f32 v63, v63
v_cvt_pk_bf16_f32 v90, v60, v61
v_cvt_pk_bf16_f32 v91, v62, v63
v_mfma_f32_16x16x32_bf16 v[124:127], a[204:207], v[84:87], v[124:127]
v_lshlrev_b32 v34, 16, v25
v_mfma_f32_16x16x32_bf16 v[124:127], a[172:175], v[80:83], v[124:127]
v_mfma_f32_16x16x32_bf16 a[208:211], a[228:231], v[80:83], a[208:211]
buffer_load_dwordx4 v3, s[12:15], 0 offen nt lds
v_mfma_f32_16x16x32_bf16 a[208:211], a[228:231], v[84:87], a[208:211]
v_mfma_f32_16x16x32_bf16 v[72:75], a[80:83], a[32:35], v[44:47]
v_and_b32 v35, s45, v25
v_mfma_f32_16x16x32_bf16 v[72:75], a[84:87], a[36:39], v[72:75]
v_mfma_f32_16x16x32_bf16 v[72:75], a[88:91], a[40:43], v[72:75]
v_mul_f32 v34, s38, v34
v_mul_f32 v35, s38, v35
v_mfma_f32_16x16x32_bf16 v[72:75], a[92:95], a[44:47], v[72:75]
s_add_u32 m0, s33, 16928
v_exp_f32 v64, v64
v_exp_f32 v65, v65
v_exp_f32 v66, v66
v_exp_f32 v67, v67
v_cvt_pk_bf16_f32 v92, v64, v65
v_cvt_pk_bf16_f32 v93, v66, v67
v_mfma_f32_16x16x32_bf16 v[76:79], a[108:111], a[44:47], v[44:47]
v_cvt_pk_bf16_f32 v25, v34, v35
v_mfma_f32_16x16x32_bf16 v[76:79], a[104:107], a[40:43], v[76:79]
v_exp_f32 v68, v68
v_mfma_f32_16x16x32_bf16 v[76:79], a[100:103], a[36:39], v[76:79]
buffer_load_dwordx4 v3, s[12:15], 0 offen offset:1024 nt lds
v_mfma_f32_16x16x32_bf16 v[76:79], a[96:99], a[32:35], v[76:79]
v_exp_f32 v69, v69
v_mfma_f32_16x16x32_bf16 v[56:59], a[112:115], a[32:35], v[44:47]
v_cvt_pk_bf16_f32 v94, v68, v69
v_lshlrev_b32 v32, 16, v26
v_mfma_f32_16x16x32_bf16 v[56:59], a[116:119], a[36:39], v[56:59]
v_exp_f32 v70, v70
v_mfma_f32_16x16x32_bf16 v[56:59], a[120:123], a[40:43], v[56:59]
v_and_b32 v33, s45, v26
v_mul_f32 v32, s38, v32
v_mfma_f32_16x16x32_bf16 v[56:59], a[124:127], a[44:47], v[56:59]
s_add_u32 m0, s33, 16960
v_exp_f32 v71, v71
v_mfma_f32_16x16x32_bf16 v[60:63], a[140:143], a[44:47], v[44:47]
v_mfma_f32_16x16x32_bf16 v[60:63], a[136:139], a[40:43], v[60:63]
v_cvt_pk_bf16_f32 v95, v70, v71
v_mul_f32 v33, s38, v33
v_mfma_f32_16x16x32_bf16 v[60:63], a[132:135], a[36:39], v[60:63]
v_mfma_f32_16x16x32_bf16 v[60:63], a[128:131], a[32:35], v[60:63]
v_cvt_pk_bf16_f32 v26, v32, v33
v_mfma_f32_16x16x32_bf16 v[128:131], a[144:147], v[88:91], v[128:131]
v_mfma_f32_16x16x32_bf16 v[128:131], a[176:179], v[92:95], v[128:131]
buffer_load_dwordx4 v3, s[12:15], 0 offen offset:2048 nt lds
v_exp_f32 v72, v72
v_exp_f32 v73, v73
v_exp_f32 v74, v74
v_exp_f32 v75, v75
v_cvt_pk_bf16_f32 v80, v72, v73
v_cvt_pk_bf16_f32 v81, v74, v75
v_mfma_f32_16x16x32_bf16 v[132:135], a[180:183], v[92:95], v[132:135]
v_mfma_f32_16x16x32_bf16 v[132:135], a[148:151], v[88:91], v[132:135]
v_lshlrev_b32 v34, 16, v27
v_mfma_f32_16x16x32_bf16 v[136:139], a[152:155], v[88:91], v[136:139]
s_add_u32 m0, s33, 16992
v_mfma_f32_16x16x32_bf16 v[136:139], a[184:187], v[92:95], v[136:139]
buffer_load_dwordx4 v3, s[12:15], 0 offen offset:3072 nt lds
v_mfma_f32_16x16x32_bf16 v[140:143], a[188:191], v[92:95], v[140:143]
v_mfma_f32_16x16x32_bf16 v[140:143], a[156:159], v[88:91], v[140:143]
v_and_b32 v35, s45, v27
v_mfma_f32_16x16x32_bf16 v[144:147], a[160:163], v[88:91], v[144:147]
v_mul_f32 v34, s38, v34
v_mul_f32 v35, s38, v35
v_cvt_pk_bf16_f32 v27, v34, v35
v_mfma_f32_16x16x32_bf16 v[144:147], a[192:195], v[92:95], v[144:147]
ds_write_b128 v4, v[24:27] offset:2112
v_exp_f32 v76, v76
v_exp_f32 v77, v77
v_exp_f32 v78, v78
v_exp_f32 v79, v79
v_cvt_pk_bf16_f32 v82, v76, v77
v_cvt_pk_bf16_f32 v83, v78, v79
v_mfma_f32_16x16x32_bf16 v[148:151], a[196:199], v[92:95], v[148:151]
v_mfma_f32_16x16x32_bf16 v[148:151], a[164:167], v[88:91], v[148:151]
v_add_u32 v4, 3168, v4
v_mfma_f32_16x16x32_bf16 v[152:155], a[168:171], v[88:91], v[152:155]
v_mfma_f32_16x16x32_bf16 v[152:155], a[200:203], v[92:95], v[152:155]
v_mfma_f32_16x16x32_bf16 v[156:159], a[204:207], v[92:95], v[156:159]
s_waitcnt vmcnt(9) lgkmcnt(2)
v_mfma_f32_16x16x32_bf16 v[156:159], a[172:175], v[88:91], v[156:159]
v_mfma_f32_16x16x32_bf16 a[212:215], a[228:231], v[88:91], a[212:215]
s_barrier
v_mfma_f32_16x16x32_bf16 a[212:215], a[228:231], v[92:95], a[212:215]
v_exp_f32 v56, v56
v_exp_f32 v57, v57
v_exp_f32 v58, v58
v_exp_f32 v59, v59
v_cvt_pk_bf16_f32 v84, v56, v57
v_cvt_pk_bf16_f32 v85, v58, v59
v_mfma_f32_16x16x32_bf16 v[64:67], a[80:83], a[48:51], v[48:51]
v_mfma_f32_16x16x32_bf16 v[64:67], a[84:87], a[52:55], v[64:67]
ds_read_b128 a[80:83], v1
v_mfma_f32_16x16x32_bf16 v[64:67], a[88:91], a[56:59], v[64:67]
v_exp_f32 v60, v60
v_mfma_f32_16x16x32_bf16 v[64:67], a[92:95], a[60:63], v[64:67]
ds_read_b128 a[84:87], v1 offset:64
ds_read_b128 a[88:91], v1 offset:128
v_mfma_f32_16x16x32_bf16 v[68:71], a[108:111], a[60:63], v[48:51]
v_exp_f32 v61, v61
v_mfma_f32_16x16x32_bf16 v[68:71], a[104:107], a[56:59], v[68:71]
ds_read_b128 a[92:95], v1 offset:192
v_cvt_pk_bf16_f32 v86, v60, v61
v_mfma_f32_16x16x32_bf16 v[68:71], a[100:103], a[52:55], v[68:71]
v_exp_f32 v62, v62
v_mfma_f32_16x16x32_bf16 v[68:71], a[96:99], a[48:51], v[68:71]
ds_read_b128 a[108:111], v1 offset:704
v_mfma_f32_16x16x32_bf16 v[72:75], a[112:115], a[48:51], v[48:51]
v_exp_f32 v63, v63
v_mfma_f32_16x16x32_bf16 v[72:75], a[116:119], a[52:55], v[72:75]
v_mfma_f32_16x16x32_bf16 v[72:75], a[120:123], a[56:59], v[72:75]
ds_read_b128 a[104:107], v1 offset:640
v_cvt_pk_bf16_f32 v87, v62, v63
v_mfma_f32_16x16x32_bf16 v[72:75], a[124:127], a[60:63], v[72:75]
v_mfma_f32_16x16x32_bf16 v[76:79], a[140:143], a[60:63], v[48:51]
ds_read_b128 a[100:103], v1 offset:576
v_mfma_f32_16x16x32_bf16 v[76:79], a[136:139], a[56:59], v[76:79]
v_mfma_f32_16x16x32_bf16 v[76:79], a[132:135], a[52:55], v[76:79]
ds_read_b128 a[96:99], v1 offset:512
v_mfma_f32_16x16x32_bf16 v[76:79], a[128:131], a[48:51], v[76:79]
v_exp_f32 v64, v64
v_exp_f32 v65, v65
v_exp_f32 v66, v66
v_exp_f32 v67, v67
v_cvt_pk_bf16_f32 v88, v64, v65
v_cvt_pk_bf16_f32 v89, v66, v67
v_mfma_f32_16x16x32_bf16 v[160:163], a[144:147], v[80:83], v[160:163]
ds_read_b128 a[112:115], v1 offset:8448
v_mfma_f32_16x16x32_bf16 v[160:163], a[176:179], v[84:87], v[160:163]
v_mfma_f32_16x16x32_bf16 v[164:167], a[180:183], v[84:87], v[164:167]
ds_read_b128 a[116:119], v1 offset:8512
v_mfma_f32_16x16x32_bf16 v[164:167], a[148:151], v[80:83], v[164:167]
v_mfma_f32_16x16x32_bf16 v[168:171], a[152:155], v[80:83], v[168:171]
ds_read_b128 a[120:123], v1 offset:8576
v_mfma_f32_16x16x32_bf16 v[168:171], a[184:187], v[84:87], v[168:171]
v_mfma_f32_16x16x32_bf16 v[172:175], a[188:191], v[84:87], v[172:175]
ds_read_b128 a[124:127], v1 offset:8640
v_mfma_f32_16x16x32_bf16 v[172:175], a[156:159], v[80:83], v[172:175]
v_exp_f32 v68, v68
v_exp_f32 v69, v69
v_exp_f32 v70, v70
v_exp_f32 v71, v71
v_cvt_pk_bf16_f32 v90, v68, v69
v_cvt_pk_bf16_f32 v91, v70, v71
v_mfma_f32_16x16x32_bf16 v[176:179], a[160:163], v[80:83], v[176:179]
ds_read_b128 a[140:143], v1 offset:9152
v_mfma_f32_16x16x32_bf16 v[176:179], a[192:195], v[84:87], v[176:179]
v_mfma_f32_16x16x32_bf16 v[180:183], a[196:199], v[84:87], v[180:183]
ds_read_b128 a[136:139], v1 offset:9088
v_mfma_f32_16x16x32_bf16 v[180:183], a[164:167], v[80:83], v[180:183]
v_mfma_f32_16x16x32_bf16 v[184:187], a[168:171], v[80:83], v[184:187]
ds_read_b128 a[132:135], v1 offset:9024
v_mfma_f32_16x16x32_bf16 v[184:187], a[200:203], v[84:87], v[184:187]
s_sub_u32 s34, s34, 1
v_mfma_f32_16x16x32_bf16 v[188:191], a[204:207], v[84:87], v[188:191]
ds_read_b128 a[128:131], v1 offset:8960
v_mfma_f32_16x16x32_bf16 v[188:191], a[172:175], v[80:83], v[188:191]
s_cmp_lg_u32 s34, 0
v_exp_f32 v72, v72
v_exp_f32 v73, v73
v_exp_f32 v74, v74
v_exp_f32 v75, v75
v_cvt_pk_bf16_f32 v92, v72, v73
v_cvt_pk_bf16_f32 v93, v74, v75
v_mfma_f32_16x16x32_bf16 a[216:219], a[228:231], v[80:83], a[216:219]
s_waitcnt lgkmcnt(8)
v_mfma_f32_16x16x32_bf16 a[216:219], a[228:231], v[84:87], a[216:219]
s_cbranch_scc1 L_n010
s_branch L_x00
.p2align 6
L_n110:
v_exp_f32 v76, v76
v_mfma_f32_16x16x32_bf16 v[56:59], a[80:83], a[64:67], v[52:55]
v_mfma_f32_16x16x32_bf16 v[56:59], a[84:87], a[68:71], v[56:59]
v_exp_f32 v77, v77
v_mfma_f32_16x16x32_bf16 v[56:59], a[88:91], a[72:75], v[56:59]
v_cvt_pk_bf16_f32 v94, v76, v77
v_mfma_f32_16x16x32_bf16 v[56:59], a[92:95], a[76:79], v[56:59]
v_exp_f32 v78, v78
v_mfma_f32_16x16x32_bf16 v[60:63], a[108:111], a[76:79], v[52:55]
v_mfma_f32_16x16x32_bf16 v[60:63], a[104:107], a[72:75], v[60:63]
s_waitcnt vmcnt(10) lgkmcnt(0)
v_exp_f32 v79, v79
v_mfma_f32_16x16x32_bf16 v[60:63], a[100:103], a[68:71], v[60:63]
v_cvt_pk_bf16_f32 v95, v78, v79
v_mfma_f32_16x16x32_bf16 v[60:63], a[96:99], a[64:67], v[60:63]
s_barrier
s_add_u32 s12, s12, 16384
s_addc_u32 s13, s13, 0
v_mfma_f32_16x16x32_bf16 v[192:195], a[144:147], v[88:91], v[192:195]
ds_read_b64_tr_b16 a[144:145], v2
ds_read_b64_tr_b16 a[146:147], v2 offset:512
v_mfma_f32_16x16x32_bf16 v[192:195], a[176:179], v[92:95], v[192:195]
v_exp_f32 v56, v56
v_mfma_f32_16x16x32_bf16 v[196:199], a[180:183], v[92:95], v[196:199]
v_mfma_f32_16x16x32_bf16 v[196:199], a[148:151], v[88:91], v[196:199]
ds_read_b64_tr_b16 a[148:149], v2 offset:32
ds_read_b64_tr_b16 a[150:151], v2 offset:544
v_mfma_f32_16x16x32_bf16 v[200:203], a[152:155], v[88:91], v[200:203]
s_add_u32 m0, s33, 0
v_exp_f32 v57, v57
v_mfma_f32_16x16x32_bf16 v[200:203], a[184:187], v[92:95], v[200:203]
ds_read_b64_tr_b16 a[152:153], v2 offset:64
v_cvt_pk_bf16_f32 v80, v56, v57
v_mfma_f32_16x16x32_bf16 v[204:207], a[188:191], v[92:95], v[204:207]
buffer_load_dwordx4 v3, s[12:15], 0 offen nt lds
v_mfma_f32_16x16x32_bf16 v[204:207], a[156:159], v[88:91], v[204:207]
v_exp_f32 v58, v58
v_mfma_f32_16x16x32_bf16 v[208:211], a[160:163], v[88:91], v[208:211]
ds_read_b64_tr_b16 a[154:155], v2 offset:576
ds_read_b64_tr_b16 a[156:157], v2 offset:96
v_mfma_f32_16x16x32_bf16 v[208:211], a[192:195], v[92:95], v[208:211]
ds_read_b64_tr_b16 a[158:159], v2 offset:608
v_mfma_f32_16x16x32_bf16 v[212:215], a[196:199], v[92:95], v[212:215]
v_exp_f32 v59, v59
v_mfma_f32_16x16x32_bf16 v[212:215], a[164:167], v[88:91], v[212:215]
ds_read_b64_tr_b16 a[160:161], v2 offset:128
v_cvt_pk_bf16_f32 v81, v58, v59
v_mfma_f32_16x16x32_bf16 v[216:219], a[168:171], v[88:91], v[216:219]
ds_read_b64_tr_b16 a[162:163], v2 offset:640
v_mfma_f32_16x16x32_bf16 v[216:219], a[200:203], v[92:95], v[216:219]
s_add_u32 m0, s33, 32
v_exp_f32 v60, v60
v_mfma_f32_16x16x32_bf16 v[220:223], a[204:207], v[92:95], v[220:223]
buffer_load_dwordx4 v3, s[12:15], 0 offen offset:1024 nt lds
v_mfma_f32_16x16x32_bf16 v[220:223], a[172:175], v[88:91], v[220:223]
ds_read_b64_tr_b16 a[164:165], v2 offset:160
v_mfma_f32_16x16x32_bf16 a[220:223], a[228:231], v[88:91], a[220:223]
v_exp_f32 v61, v61
v_mfma_f32_16x16x32_bf16 a[220:223], a[228:231], v[92:95], a[220:223]
ds_read_b64_tr_b16 a[166:167], v2 offset:672
v_cvt_pk_bf16_f32 v82, v60, v61
v_mfma_f32_16x16x32_bf16 v[64:67], a[80:83], a[0:3], v[36:39]
ds_read_b64_tr_b16 a[168:169], v2 offset:192
v_mfma_f32_16x16x32_bf16 v[64:67], a[84:87], a[4:7], v[64:67]
v_exp_f32 v62, v62
v_mfma_f32_16x16x32_bf16 v[64:67], a[88:91], a[8:11], v[64:67]
ds_read_b64_tr_b16 a[170:171], v2 offset:704
v_mfma_f32_16x16x32_bf16 v[64:67], a[92:95], a[12:15], v[64:67]
ds_read_b64_tr_b16 a[172:173], v2 offset:224
v_mfma_f32_16x16x32_bf16 v[68:71], a[108:111], a[12:15], v[36:39]
s_add_u32 m0, s33, 64
v_exp_f32 v63, v63
v_mfma_f32_16x16x32_bf16 v[68:71], a[104:107], a[8:11], v[68:71]
ds_read_b64_tr_b16 a[174:175], v2 offset:736
v_cvt_pk_bf16_f32 v83, v62, v63
v_mfma_f32_16x16x32_bf16 v[68:71], a[100:103], a[4:7], v[68:71]
buffer_load_dwordx4 v3, s[12:15], 0 offen offset:2048 nt lds
v_mfma_f32_16x16x32_bf16 v[68:71], a[96:99], a[0:3], v[68:71]
ds_read_b64_tr_b16 a[176:177], v2 offset:8448
v_mfma_f32_16x16x32_bf16 v[72:75], a[112:115], a[0:3], v[36:39]
v_mfma_f32_16x16x32_bf16 v[72:75], a[116:119], a[4:7], v[72:75]
ds_read_b64_tr_b16 a[178:179], v2 offset:8960
v_mfma_f32_16x16x32_bf16 v[72:75], a[120:123], a[8:11], v[72:75]
v_mfma_f32_16x16x32_bf16 v[72:75], a[124:127], a[12:15], v[72:75]
ds_read_b64_tr_b16 a[180:181], v2 offset:8480
v_exp_f32 v64, v64
v_exp_f32 v65, v65
v_exp_f32 v66, v66
v_exp_f32 v67, v67
v_cvt_pk_bf16_f32 v88, v64, v65
v_cvt_pk_bf16_f32 v89, v66, v67
v_mfma_f32_16x16x32_bf16 v[76:79], a[140:143], a[12:15], v[36:39]
v_mfma_f32_16x16x32_bf16 v[76:79], a[136:139], a[8:11], v[76:79]
s_waitcnt lgkmcnt(11)
ds_read_b64_tr_b16 a[182:183], v2 offset:8992
v_mfma_f32_16x16x32_bf16 v[76:79], a[132:135], a[4:7], v[76:79]
s_add_u32 m0, s33, 96
v_mfma_f32_16x16x32_bf16 v[76:79], a[128:131], a[0:3], v[76:79]
ds_read_b64_tr_b16 a[184:185], v2 offset:8512
v_mfma_f32_16x16x32_bf16 v[224:227], a[144:147], v[80:83], v[224:227]
v_exp_f32 v68, v68
v_mfma_f32_16x16x32_bf16 v[228:231], a[148:151], v[80:83], v[228:231]
buffer_load_dwordx4 v3, s[12:15], 0 offen offset:3072 nt lds
v_mfma_f32_16x16x32_bf16 v[232:235], a[152:155], v[80:83], v[232:235]
s_waitcnt lgkmcnt(5)
v_exp_f32 v69, v69
v_mfma_f32_16x16x32_bf16 v[236:239], a[156:159], v[80:83], v[236:239]
ds_read_b64_tr_b16 a[186:187], v2 offset:9024
v_cvt_pk_bf16_f32 v90, v68, v69
v_mfma_f32_16x16x32_bf16 v[240:243], a[160:163], v[80:83], v[240:243]
v_exp_f32 v70, v70
v_mfma_f32_16x16x32_bf16 v[244:247], a[164:167], v[80:83], v[244:247]
ds_read_b64_tr_b16 a[188:189], v2 offset:8544
v_mfma_f32_16x16x32_bf16 v[248:251], a[168:171], v[80:83], v[248:251]
v_exp_f32 v71, v71
v_mfma_f32_16x16x32_bf16 v[252:255], a[172:175], v[80:83], v[252:255]
ds_read_b64_tr_b16 a[190:191], v2 offset:9056
v_cvt_pk_bf16_f32 v91, v70, v71
v_mfma_f32_16x16x32_bf16 a[224:227], a[228:231], v[80:83], a[224:227]
v_exp_f32 v72, v72
v_mfma_f32_16x16x32_bf16 v[56:59], a[80:83], a[16:19], v[40:43]
ds_read_b64_tr_b16 a[192:193], v2 offset:8576
v_mfma_f32_16x16x32_bf16 v[56:59], a[84:87], a[20:23], v[56:59]
v_exp_f32 v73, v73
v_mfma_f32_16x16x32_bf16 v[56:59], a[88:91], a[24:27], v[56:59]
ds_read_b64_tr_b16 a[194:195], v2 offset:9088
v_cvt_pk_bf16_f32 v92, v72, v73
v_mfma_f32_16x16x32_bf16 v[56:59], a[92:95], a[28:31], v[56:59]
v_exp_f32 v74, v74
v_mfma_f32_16x16x32_bf16 v[60:63], a[108:111], a[28:31], v[40:43]
ds_read_b64_tr_b16 a[196:197], v2 offset:8608
v_mfma_f32_16x16x32_bf16 v[60:63], a[104:107], a[24:27], v[60:63]
v_exp_f32 v75, v75
v_mfma_f32_16x16x32_bf16 v[60:63], a[100:103], a[20:23], v[60:63]
ds_read_b64_tr_b16 a[198:199], v2 offset:9120
v_cvt_pk_bf16_f32 v93, v74, v75
v_mfma_f32_16x16x32_bf16 v[60:63], a[96:99], a[16:19], v[60:63]
v_mfma_f32_16x16x32_bf16 v[64:67], a[112:115], a[16:19], v[40:43]
ds_read_b64_tr_b16 a[200:201], v2 offset:8640
v_mfma_f32_16x16x32_bf16 v[64:67], a[116:119], a[20:23], v[64:67]
v_mfma_f32_16x16x32_bf16 v[64:67], a[120:123], a[24:27], v[64:67]
ds_read_b64_tr_b16 a[202:203], v2 offset:9152
v_mfma_f32_16x16x32_bf16 v[64:67], a[124:127], a[28:31], v[64:67]
v_exp_f32 v76, v76
v_exp_f32 v77, v77
v_exp_f32 v78, v78
v_exp_f32 v79, v79
v_cvt_pk_bf16_f32 v94, v76, v77
v_cvt_pk_bf16_f32 v95, v78, v79
v_mfma_f32_16x16x32_bf16 v[68:71], a[140:143], a[28:31], v[40:43]
ds_read_b64_tr_b16 a[204:205], v2 offset:8672
v_mfma_f32_16x16x32_bf16 v[68:71], a[136:139], a[24:27], v[68:71]
v_mfma_f32_16x16x32_bf16 v[68:71], a[132:135], a[20:23], v[68:71]
ds_read_b64_tr_b16 a[206:207], v2 offset:9184
v_mfma_f32_16x16x32_bf16 v[68:71], a[128:131], a[16:19], v[68:71]
v_exp_f32 v56, v56
v_mfma_f32_16x16x32_bf16 v[96:99], a[144:147], v[88:91], v[96:99]
s_waitcnt lgkmcnt(8)
v_mfma_f32_16x16x32_bf16 v[96:99], a[176:179], v[92:95], v[96:99]
v_exp_f32 v57, v57
v_mfma_f32_16x16x32_bf16 v[100:103], a[180:183], v[92:95], v[100:103]
v_cvt_pk_bf16_f32 v80, v56, v57
v_mfma_f32_16x16x32_bf16 v[100:103], a[148:151], v[88:91], v[100:103]
v_exp_f32 v58, v58
v_mfma_f32_16x16x32_bf16 v[104:107], a[152:155], v[88:91], v[104:107]
v_mfma_f32_16x16x32_bf16 v[104:107], a[184:187], v[92:95], v[104:107]
v_exp_f32 v59, v59
v_mfma_f32_16x16x32_bf16 v[108:111], a[188:191], v[92:95], v[108:111]
v_cvt_pk_bf16_f32 v81, v58, v59
v_mfma_f32_16x16x32_bf16 v[108:111], a[156:159], v[88:91], v[108:111]
s_waitcnt lgkmcnt(0)
v_exp_f32 v60, v60
v_mfma_f32_16x16x32_bf16 v[112:115], a[160:163], v[88:91], v[112:115]
s_waitcnt lgkmcnt(0)
v_mfma_f32_16x16x32_bf16 v[112:115], a[192:195], v[92:95], v[112:115]
s_barrier
v_exp_f32 v61, v61
v_mfma_f32_16x16x32_bf16 v[116:119], a[196:199], v[92:95], v[116:119]
s_add_u32 s16, s16, 16384
s_addc_u32 s17, s17, 0
v_cvt_pk_bf16_f32 v82, v60, v61
v_mfma_f32_16x16x32_bf16 v[116:119], a[164:167], v[88:91], v[116:119]
s_add_u32 m0, s33, 33792
v_exp_f32 v62, v62
v_mfma_f32_16x16x32_bf16 v[120:123], a[168:171], v[88:91], v[120:123]
buffer_load_dwordx4 v3, s[16:19], 0 offen nt lds
v_mfma_f32_16x16x32_bf16 v[120:123], a[200:203], v[92:95], v[120:123]
v_exp_f32 v63, v63
v_mfma_f32_16x16x32_bf16 v[124:127], a[204:207], v[92:95], v[124:127]
ds_read_b128 v[16:19], v4
v_cvt_pk_bf16_f32 v83, v62, v63
v_mfma_f32_16x16x32_bf16 v[124:127], a[172:175], v[88:91], v[124:127]
s_add_u32 m0, s33, 33824
v_mfma_f32_16x16x32_bf16 a[208:211], a[228:231], v[88:91], a[208:211]
buffer_load_dwordx4 v3, s[16:19], 0 offen offset:1024 nt lds
v_mfma_f32_16x16x32_bf16 a[208:211], a[228:231], v[92:95], a[208:211]
v_mfma_f32_16x16x32_bf16 v[72:75], a[80:83], a[32:35], v[44:47]
v_mfma_f32_16x16x32_bf16 v[72:75], a[84:87], a[36:39], v[72:75]
s_add_u32 m0, s33, 33856
v_mfma_f32_16x16x32_bf16 v[72:75], a[88:91], a[40:43], v[72:75]
buffer_load_dwordx4 v3, s[16:19], 0 offen offset:2048 nt lds
v_mfma_f32_16x16x32_bf16 v[72:75], a[92:95], a[44:47], v[72:75]
v_exp_f32 v64, v64
v_exp_f32 v65, v65
v_exp_f32 v66, v66
v_exp_f32 v67, v67
v_cvt_pk_bf16_f32 v84, v64, v65
v_cvt_pk_bf16_f32 v85, v66, v67
v_mfma_f32_16x16x32_bf16 v[76:79], a[108:111], a[44:47], v[44:47]
v_mfma_f32_16x16x32_bf16 v[76:79], a[104:107], a[40:43], v[76:79]
v_exp_f32 v68, v68
v_mfma_f32_16x16x32_bf16 v[76:79], a[100:103], a[36:39], v[76:79]
v_mfma_f32_16x16x32_bf16 v[76:79], a[96:99], a[32:35], v[76:79]
s_add_u32 m0, s33, 33888
v_exp_f32 v69, v69
v_mfma_f32_16x16x32_bf16 v[56:59], a[112:115], a[32:35], v[44:47]
v_cvt_pk_bf16_f32 v86, v68, v69
v_mfma_f32_16x16x32_bf16 v[56:59], a[116:119], a[36:39], v[56:59]
v_exp_f32 v70, v70
v_mfma_f32_16x16x32_bf16 v[56:59], a[120:123], a[40:43], v[56:59]
buffer_load_dwordx4 v3, s[16:19], 0 offen offset:3072 nt lds
v_mfma_f32_16x16x32_bf16 v[56:59], a[124:127], a[44:47], v[56:59]
v_exp_f32 v71, v71
v_mfma_f32_16x16x32_bf16 v[60:63], a[140:143], a[44:47], v[44:47]
v_exp_f32 v72, v72
v_mfma_f32_16x16x32_bf16 v[60:63], a[136:139], a[40:43], v[60:63]
v_cvt_pk_bf16_f32 v87, v70, v71
v_mfma_f32_16x16x32_bf16 v[60:63], a[132:135], a[36:39], v[60:63]
v_exp_f32 v73, v73
v_mfma_f32_16x16x32_bf16 v[60:63], a[128:131], a[32:35], v[60:63]
v_cvt_pk_bf16_f32 v88, v72, v73
v_mfma_f32_16x16x32_bf16 v[128:131], a[144:147], v[80:83], v[128:131]
v_exp_f32 v74, v74
v_mfma_f32_16x16x32_bf16 v[128:131], a[176:179], v[84:87], v[128:131]
v_mfma_f32_16x16x32_bf16 v[132:135], a[180:183], v[84:87], v[132:135]
v_exp_f32 v75, v75
v_mfma_f32_16x16x32_bf16 v[132:135], a[148:151], v[80:83], v[132:135]
v_cvt_pk_bf16_f32 v89, v74, v75
v_mfma_f32_16x16x32_bf16 v[136:139], a[152:155], v[80:83], v[136:139]
v_mfma_f32_16x16x32_bf16 v[136:139], a[184:187], v[84:87], v[136:139]
v_mfma_f32_16x16x32_bf16 v[140:143], a[188:191], v[84:87], v[140:143]
v_mfma_f32_16x16x32_bf16 v[140:143], a[156:159], v[80:83], v[140:143]
v_mfma_f32_16x16x32_bf16 v[144:147], a[160:163], v[80:83], v[144:147]
s_waitcnt lgkmcnt(0)
v_mfma_f32_16x16x32_bf16 v[144:147], a[192:195], v[84:87], v[144:147]
buffer_store_dwordx4 v[16:19], v3, s[28:31], s36 offen sc0 sc1
v_exp_f32 v76, v76
v_exp_f32 v77, v77
v_exp_f32 v78, v78
v_exp_f32 v79, v79
v_cvt_pk_bf16_f32 v90, v76, v77
v_cvt_pk_bf16_f32 v91, v78, v79
v_mfma_f32_16x16x32_bf16 v[148:151], a[196:199], v[84:87], v[148:151]
v_mfma_f32_16x16x32_bf16 v[148:151], a[164:167], v[80:83], v[148:151]
v_mfma_f32_16x16x32_bf16 v[152:155], a[168:171], v[80:83], v[152:155]
v_exp_f32 v56, v56
v_mfma_f32_16x16x32_bf16 v[152:155], a[200:203], v[84:87], v[152:155]
v_mfma_f32_16x16x32_bf16 v[156:159], a[204:207], v[84:87], v[156:159]
s_waitcnt vmcnt(14) lgkmcnt(1)
v_exp_f32 v57, v57
v_mfma_f32_16x16x32_bf16 v[156:159], a[172:175], v[80:83], v[156:159]
v_cvt_pk_bf16_f32 v92, v56, v57
v_mfma_f32_16x16x32_bf16 a[212:215], a[228:231], v[80:83], a[212:215]
s_barrier
v_exp_f32 v58, v58
v_mfma_f32_16x16x32_bf16 a[212:215], a[228:231], v[84:87], a[212:215]
v_mfma_f32_16x16x32_bf16 v[64:67], a[80:83], a[48:51], v[48:51]
v_exp_f32 v59, v59
v_mfma_f32_16x16x32_bf16 v[64:67], a[84:87], a[52:55], v[64:67]
ds_read_b128 a[80:83], v1 offset:16896
v_cvt_pk_bf16_f32 v93, v58, v59
v_mfma_f32_16x16x32_bf16 v[64:67], a[88:91], a[56:59], v[64:67]
v_exp_f32 v60, v60
v_mfma_f32_16x16x32_bf16 v[64:67], a[92:95], a[60:63], v[64:67]
ds_read_b128 a[84:87], v1 offset:16960
ds_read_b128 a[88:91], v1 offset:17024
v_mfma_f32_16x16x32_bf16 v[68:71], a[108:111], a[60:63], v[48:51]
v_exp_f32 v61, v61
v_mfma_f32_16x16x32_bf16 v[68:71], a[104:107], a[56:59], v[68:71]
ds_read_b128 a[92:95], v1 offset:17088
v_cvt_pk_bf16_f32 v94, v60, v61
v_mfma_f32_16x16x32_bf16 v[68:71], a[100:103], a[52:55], v[68:71]
v_exp_f32 v62, v62
v_mfma_f32_16x16x32_bf16 v[68:71], a[96:99], a[48:51], v[68:71]
ds_read_b128 a[108:111], v1 offset:17600
v_mfma_f32_16x16x32_bf16 v[72:75], a[112:115], a[48:51], v[48:51]
v_exp_f32 v63, v63
v_mfma_f32_16x16x32_bf16 v[72:75], a[116:119], a[52:55], v[72:75]
v_mfma_f32_16x16x32_bf16 v[72:75], a[120:123], a[56:59], v[72:75]
ds_read_b128 a[104:107], v1 offset:17536
v_cvt_pk_bf16_f32 v95, v62, v63
v_mfma_f32_16x16x32_bf16 v[72:75], a[124:127], a[60:63], v[72:75]
v_mfma_f32_16x16x32_bf16 v[76:79], a[140:143], a[60:63], v[48:51]
ds_read_b128 a[100:103], v1 offset:17472
v_mfma_f32_16x16x32_bf16 v[76:79], a[136:139], a[56:59], v[76:79]
v_mfma_f32_16x16x32_bf16 v[76:79], a[132:135], a[52:55], v[76:79]
ds_read_b128 a[96:99], v1 offset:17408
v_mfma_f32_16x16x32_bf16 v[76:79], a[128:131], a[48:51], v[76:79]
v_exp_f32 v64, v64
v_exp_f32 v65, v65
v_exp_f32 v66, v66
v_exp_f32 v67, v67
v_cvt_pk_bf16_f32 v80, v64, v65
v_cvt_pk_bf16_f32 v81, v66, v67
v_mfma_f32_16x16x32_bf16 v[160:163], a[144:147], v[88:91], v[160:163]
ds_read_b128 a[112:115], v1 offset:25344
v_mfma_f32_16x16x32_bf16 v[160:163], a[176:179], v[92:95], v[160:163]
v_exp_f32 v68, v68
v_mfma_f32_16x16x32_bf16 v[164:167], a[180:183], v[92:95], v[164:167]
ds_read_b128 a[116:119], v1 offset:25408
v_mfma_f32_16x16x32_bf16 v[164:167], a[148:151], v[88:91], v[164:167]
v_exp_f32 v69, v69
v_mfma_f32_16x16x32_bf16 v[168:171], a[152:155], v[88:91], v[168:171]
ds_read_b128 a[120:123], v1 offset:25472
v_cvt_pk_bf16_f32 v82, v68, v69
v_mfma_f32_16x16x32_bf16 v[168:171], a[184:187], v[92:95], v[168:171]
v_exp_f32 v70, v70
v_mfma_f32_16x16x32_bf16 v[172:175], a[188:191], v[92:95], v[172:175]
ds_read_b128 a[124:127], v1 offset:25536
v_mfma_f32_16x16x32_bf16 v[172:175], a[156:159], v[88:91], v[172:175]
v_exp_f32 v71, v71
v_mfma_f32_16x16x32_bf16 v[176:179], a[160:163], v[88:91], v[176:179]
ds_read_b128 a[140:143], v1 offset:26048
v_cvt_pk_bf16_f32 v83, v70, v71
v_mfma_f32_16x16x32_bf16 v[176:179], a[192:195], v[92:95], v[176:179]
v_exp_f32 v72, v72
v_mfma_f32_16x16x32_bf16 v[180:183], a[196:199], v[92:95], v[180:183]
ds_read_b128 a[136:139], v1 offset:25984
v_mfma_f32_16x16x32_bf16 v[180:183], a[164:167], v[88:91], v[180:183]
v_exp_f32 v73, v73
v_mfma_f32_16x16x32_bf16 v[184:187], a[168:171], v[88:91], v[184:187]
ds_read_b128 a[132:135], v1 offset:25920
v_cvt_pk_bf16_f32 v84, v72, v73
v_mfma_f32_16x16x32_bf16 v[184:187], a[200:203], v[92:95], v[184:187]
v_exp_f32 v74, v74
v_mfma_f32_16x16x32_bf16 v[188:191], a[204:207], v[92:95], v[188:191]
ds_read_b128 a[128:131], v1 offset:25856
v_mfma_f32_16x16x32_bf16 v[188:191], a[172:175], v[88:91], v[188:191]
v_exp_f32 v75, v75
v_mfma_f32_16x16x32_bf16 a[216:219], a[228:231], v[88:91], a[216:219]
s_waitcnt lgkmcnt(8)
v_cvt_pk_bf16_f32 v85, v74, v75
v_mfma_f32_16x16x32_bf16 a[216:219], a[228:231], v[92:95], a[216:219]
v_mfma_f32_16x16x32_bf16 v[56:59], a[80:83], a[64:67], v[52:55]
v_mfma_f32_16x16x32_bf16 v[56:59], a[84:87], a[68:71], v[56:59]
v_mfma_f32_16x16x32_bf16 v[56:59], a[88:91], a[72:75], v[56:59]
v_mfma_f32_16x16x32_bf16 v[56:59], a[92:95], a[76:79], v[56:59]
v_exp_f32 v76, v76
v_exp_f32 v77, v77
v_exp_f32 v78, v78
v_exp_f32 v79, v79
v_cvt_pk_bf16_f32 v86, v76, v77
v_cvt_pk_bf16_f32 v87, v78, v79
v_mfma_f32_16x16x32_bf16 v[60:63], a[108:111], a[76:79], v[52:55]
v_mfma_f32_16x16x32_bf16 v[60:63], a[104:107], a[72:75], v[60:63]
s_waitcnt vmcnt(10) lgkmcnt(0)
v_mfma_f32_16x16x32_bf16 v[60:63], a[100:103], a[68:71], v[60:63]
v_mfma_f32_16x16x32_bf16 v[60:63], a[96:99], a[64:67], v[60:63]
s_barrier
s_add_u32 s12, s12, 16384
s_addc_u32 s13, s13, 0
v_mfma_f32_16x16x32_bf16 v[192:195], a[144:147], v[80:83], v[192:195]
ds_read_b64_tr_b16 a[144:145], v2 offset:16896
ds_read_b64_tr_b16 a[146:147], v2 offset:17408
v_mfma_f32_16x16x32_bf16 v[192:195], a[176:179], v[84:87], v[192:195]
v_exp_f32 v56, v56
v_mfma_f32_16x16x32_bf16 v[196:199], a[180:183], v[84:87], v[196:199]
v_mfma_f32_16x16x32_bf16 v[196:199], a[148:151], v[80:83], v[196:199]
ds_read_b64_tr_b16 a[148:149], v2 offset:16928
ds_read_b64_tr_b16 a[150:151], v2 offset:17440
v_mfma_f32_16x16x32_bf16 v[200:203], a[152:155], v[80:83], v[200:203]
s_add_u32 m0, s33, 16896
v_exp_f32 v57, v57
v_mfma_f32_16x16x32_bf16 v[200:203], a[184:187], v[84:87], v[200:203]
ds_read_b64_tr_b16 a[152:153], v2 offset:16960
v_cvt_pk_bf16_f32 v88, v56, v57
v_mfma_f32_16x16x32_bf16 v[204:207], a[188:191], v[84:87], v[204:207]
buffer_load_dwordx4 v3, s[12:15], 0 offen nt lds
v_mfma_f32_16x16x32_bf16 v[204:207], a[156:159], v[80:83], v[204:207]
v_exp_f32 v58, v58
v_mfma_f32_16x16x32_bf16 v[208:211], a[160:163], v[80:83], v[208:211]
ds_read_b64_tr_b16 a[154:155], v2 offset:17472
ds_read_b64_tr_b16 a[156:157], v2 offset:16992
v_mfma_f32_16x16x32_bf16 v[208:211], a[192:195], v[84:87], v[208:211]
ds_read_b64_tr_b16 a[158:159], v2 offset:17504
v_mfma_f32_16x16x32_bf16 v[212:215], a[196:199], v[84:87], v[212:215]
v_exp_f32 v59, v59
v_mfma_f32_16x16x32_bf16 v[212:215], a[164:167], v[80:83], v[212:215]
ds_read_b64_tr_b16 a[160:161], v2 offset:17024
v_cvt_pk_bf16_f32 v89, v58, v59
v_mfma_f32_16x16x32_bf16 v[216:219], a[168:171], v[80:83], v[216:219]
ds_read_b64_tr_b16 a[162:163], v2 offset:17536
v_mfma_f32_16x16x32_bf16 v[216:219], a[200:203], v[84:87], v[216:219]
s_add_u32 m0, s33, 16928
v_exp_f32 v60, v60
v_mfma_f32_16x16x32_bf16 v[220:223], a[204:207], v[84:87], v[220:223]
buffer_load_dwordx4 v3, s[12:15], 0 offen offset:1024 nt lds
v_mfma_f32_16x16x32_bf16 v[220:223], a[172:175], v[80:83], v[220:223]
ds_read_b64_tr_b16 a[164:165], v2 offset:17056
v_mfma_f32_16x16x32_bf16 a[220:223], a[228:231], v[80:83], a[220:223]
v_exp_f32 v61, v61
v_mfma_f32_16x16x32_bf16 a[220:223], a[228:231], v[84:87], a[220:223]
ds_read_b64_tr_b16 a[166:167], v2 offset:17568
v_cvt_pk_bf16_f32 v90, v60, v61
v_mfma_f32_16x16x32_bf16 v[64:67], a[80:83], a[0:3], v[36:39]
ds_read_b64_tr_b16 a[168:169], v2 offset:17088
v_mfma_f32_16x16x32_bf16 v[64:67], a[84:87], a[4:7], v[64:67]
v_exp_f32 v62, v62
v_mfma_f32_16x16x32_bf16 v[64:67], a[88:91], a[8:11], v[64:67]
ds_read_b64_tr_b16 a[170:171], v2 offset:17600
v_mfma_f32_16x16x32_bf16 v[64:67], a[92:95], a[12:15], v[64:67]
ds_read_b64_tr_b16 a[172:173], v2 offset:17120
v_mfma_f32_16x16x32_bf16 v[68:71], a[108:111], a[12:15], v[36:39]
s_add_u32 m0, s33, 16960
v_exp_f32 v63, v63
v_mfma_f32_16x16x32_bf16 v[68:71], a[104:107], a[8:11], v[68:71]
ds_read_b64_tr_b16 a[174:175], v2 offset:17632
v_cvt_pk_bf16_f32 v91, v62, v63
v_mfma_f32_16x16x32_bf16 v[68:71], a[100:103], a[4:7], v[68:71]
buffer_load_dwordx4 v3, s[12:15], 0 offen offset:2048 nt lds
v_mfma_f32_16x16x32_bf16 v[68:71], a[96:99], a[0:3], v[68:71]
ds_read_b64_tr_b16 a[176:177], v2 offset:25344
v_mfma_f32_16x16x32_bf16 v[72:75], a[112:115], a[0:3], v[36:39]
v_mfma_f32_16x16x32_bf16 v[72:75], a[116:119], a[4:7], v[72:75]
ds_read_b64_tr_b16 a[178:179], v2 offset:25856
v_mfma_f32_16x16x32_bf16 v[72:75], a[120:123], a[8:11], v[72:75]
v_mfma_f32_16x16x32_bf16 v[72:75], a[124:127], a[12:15], v[72:75]
ds_read_b64_tr_b16 a[180:181], v2 offset:25376
v_exp_f32 v64, v64
v_exp_f32 v65, v65
v_exp_f32 v66, v66
v_exp_f32 v67, v67
v_cvt_pk_bf16_f32 v80, v64, v65
v_cvt_pk_bf16_f32 v81, v66, v67
v_mfma_f32_16x16x32_bf16 v[76:79], a[140:143], a[12:15], v[36:39]
v_mfma_f32_16x16x32_bf16 v[76:79], a[136:139], a[8:11], v[76:79]
s_waitcnt lgkmcnt(11)
ds_read_b64_tr_b16 a[182:183], v2 offset:25888
v_mfma_f32_16x16x32_bf16 v[76:79], a[132:135], a[4:7], v[76:79]
s_add_u32 m0, s33, 16992
v_mfma_f32_16x16x32_bf16 v[76:79], a[128:131], a[0:3], v[76:79]
ds_read_b64_tr_b16 a[184:185], v2 offset:25408
v_mfma_f32_16x16x32_bf16 v[224:227], a[144:147], v[88:91], v[224:227]
v_exp_f32 v68, v68
v_mfma_f32_16x16x32_bf16 v[228:231], a[148:151], v[88:91], v[228:231]
buffer_load_dwordx4 v3, s[12:15], 0 offen offset:3072 nt lds
v_mfma_f32_16x16x32_bf16 v[232:235], a[152:155], v[88:91], v[232:235]
s_waitcnt lgkmcnt(5)
v_exp_f32 v69, v69
v_mfma_f32_16x16x32_bf16 v[236:239], a[156:159], v[88:91], v[236:239]
ds_read_b64_tr_b16 a[186:187], v2 offset:25920
v_cvt_pk_bf16_f32 v82, v68, v69
v_mfma_f32_16x16x32_bf16 v[240:243], a[160:163], v[88:91], v[240:243]
v_exp_f32 v70, v70
v_mfma_f32_16x16x32_bf16 v[244:247], a[164:167], v[88:91], v[244:247]
ds_read_b64_tr_b16 a[188:189], v2 offset:25440
v_mfma_f32_16x16x32_bf16 v[248:251], a[168:171], v[88:91], v[248:251]
v_exp_f32 v71, v71
v_mfma_f32_16x16x32_bf16 v[252:255], a[172:175], v[88:91], v[252:255]
ds_read_b64_tr_b16 a[190:191], v2 offset:25952
v_cvt_pk_bf16_f32 v83, v70, v71
v_mfma_f32_16x16x32_bf16 a[224:227], a[228:231], v[88:91], a[224:227]
v_exp_f32 v72, v72
v_mfma_f32_16x16x32_bf16 v[56:59], a[80:83], a[16:19], v[40:43]
ds_read_b64_tr_b16 a[192:193], v2 offset:25472
v_mfma_f32_16x16x32_bf16 v[56:59], a[84:87], a[20:23], v[56:59]
v_exp_f32 v73, v73
v_mfma_f32_16x16x32_bf16 v[56:59], a[88:91], a[24:27], v[56:59]
ds_read_b64_tr_b16 a[194:195], v2 offset:25984
v_cvt_pk_bf16_f32 v84, v72, v73
v_mfma_f32_16x16x32_bf16 v[56:59], a[92:95], a[28:31], v[56:59]
v_exp_f32 v74, v74
v_mfma_f32_16x16x32_bf16 v[60:63], a[108:111], a[28:31], v[40:43]
ds_read_b64_tr_b16 a[196:197], v2 offset:25504
v_mfma_f32_16x16x32_bf16 v[60:63], a[104:107], a[24:27], v[60:63]
v_exp_f32 v75, v75
v_mfma_f32_16x16x32_bf16 v[60:63], a[100:103], a[20:23], v[60:63]
ds_read_b64_tr_b16 a[198:199], v2 offset:26016
v_cvt_pk_bf16_f32 v85, v74, v75
v_mfma_f32_16x16x32_bf16 v[60:63], a[96:99], a[16:19], v[60:63]
v_mfma_f32_16x16x32_bf16 v[64:67], a[112:115], a[16:19], v[40:43]
ds_read_b64_tr_b16 a[200:201], v2 offset:25536
v_mfma_f32_16x16x32_bf16 v[64:67], a[116:119], a[20:23], v[64:67]
v_mfma_f32_16x16x32_bf16 v[64:67], a[120:123], a[24:27], v[64:67]
ds_read_b64_tr_b16 a[202:203], v2 offset:26048
v_mfma_f32_16x16x32_bf16 v[64:67], a[124:127], a[28:31], v[64:67]
v_exp_f32 v76, v76
v_exp_f32 v77, v77
v_exp_f32 v78, v78
v_exp_f32 v79, v79
v_cvt_pk_bf16_f32 v86, v76, v77
v_cvt_pk_bf16_f32 v87, v78, v79
v_mfma_f32_16x16x32_bf16 v[68:71], a[140:143], a[28:31], v[40:43]
ds_read_b64_tr_b16 a[204:205], v2 offset:25568
v_mfma_f32_16x16x32_bf16 v[68:71], a[136:139], a[24:27], v[68:71]
v_mfma_f32_16x16x32_bf16 v[68:71], a[132:135], a[20:23], v[68:71]
ds_read_b64_tr_b16 a[206:207], v2 offset:26080
v_mfma_f32_16x16x32_bf16 v[68:71], a[128:131], a[16:19], v[68:71]
v_exp_f32 v56, v56
v_mfma_f32_16x16x32_bf16 v[96:99], a[144:147], v[80:83], v[96:99]
s_waitcnt lgkmcnt(8)
v_mfma_f32_16x16x32_bf16 v[96:99], a[176:179], v[84:87], v[96:99]
v_exp_f32 v57, v57
v_mfma_f32_16x16x32_bf16 v[100:103], a[180:183], v[84:87], v[100:103]
v_cvt_pk_bf16_f32 v88, v56, v57
v_mfma_f32_16x16x32_bf16 v[100:103], a[148:151], v[80:83], v[100:103]
v_exp_f32 v58, v58
v_mfma_f32_16x16x32_bf16 v[104:107], a[152:155], v[80:83], v[104:107]
v_mfma_f32_16x16x32_bf16 v[104:107], a[184:187], v[84:87], v[104:107]
v_exp_f32 v59, v59
v_mfma_f32_16x16x32_bf16 v[108:111], a[188:191], v[84:87], v[108:111]
v_cvt_pk_bf16_f32 v89, v58, v59
v_mfma_f32_16x16x32_bf16 v[108:111], a[156:159], v[80:83], v[108:111]
s_waitcnt lgkmcnt(0)
v_exp_f32 v60, v60
v_mfma_f32_16x16x32_bf16 v[112:115], a[160:163], v[80:83], v[112:115]
s_waitcnt lgkmcnt(0)
v_mfma_f32_16x16x32_bf16 v[112:115], a[192:195], v[84:87], v[112:115]
s_barrier
v_exp_f32 v61, v61
v_mfma_f32_16x16x32_bf16 v[116:119], a[196:199], v[84:87], v[116:119]
s_add_u32 s16, s16, 16384
s_addc_u32 s17, s17, 0
v_cvt_pk_bf16_f32 v90, v60, v61
v_mfma_f32_16x16x32_bf16 v[116:119], a[164:167], v[80:83], v[116:119]
s_add_u32 m0, s33, 50688
v_exp_f32 v62, v62
v_mfma_f32_16x16x32_bf16 v[120:123], a[168:171], v[80:83], v[120:123]
buffer_load_dwordx4 v3, s[16:19], 0 offen nt lds
v_mfma_f32_16x16x32_bf16 v[120:123], a[200:203], v[84:87], v[120:123]
v_exp_f32 v63, v63
v_mfma_f32_16x16x32_bf16 v[124:127], a[204:207], v[84:87], v[124:127]
ds_read_b128 v[20:23], v4 offset:1056
v_cvt_pk_bf16_f32 v91, v62, v63
v_mfma_f32_16x16x32_bf16 v[124:127], a[172:175], v[80:83], v[124:127]
s_add_u32 m0, s33, 50720
v_mfma_f32_16x16x32_bf16 a[208:211], a[228:231], v[80:83], a[208:211]
buffer_load_dwordx4 v3, s[16:19], 0 offen offset:1024 nt lds
v_mfma_f32_16x16x32_bf16 a[208:211], a[228:231], v[84:87], a[208:211]
v_mfma_f32_16x16x32_bf16 v[72:75], a[80:83], a[32:35], v[44:47]
v_add_u32 v4, 2112, v4
v_mfma_f32_16x16x32_bf16 v[72:75], a[84:87], a[36:39], v[72:75]
s_add_u32 m0, s33, 50752
v_mfma_f32_16x16x32_bf16 v[72:75], a[88:91], a[40:43], v[72:75]
buffer_load_dwordx4 v3, s[16:19], 0 offen offset:2048 nt lds
v_mfma_f32_16x16x32_bf16 v[72:75], a[92:95], a[44:47], v[72:75]
v_exp_f32 v64, v64
v_exp_f32 v65, v65
v_exp_f32 v66, v66
v_exp_f32 v67, v67
v_cvt_pk_bf16_f32 v92, v64, v65
v_cvt_pk_bf16_f32 v93, v66, v67
v_mfma_f32_16x16x32_bf16 v[76:79], a[108:111], a[44:47], v[44:47]
v_mfma_f32_16x16x32_bf16 v[76:79], a[104:107], a[40:43], v[76:79]
v_exp_f32 v68, v68
v_mfma_f32_16x16x32_bf16 v[76:79], a[100:103], a[36:39], v[76:79]
v_mfma_f32_16x16x32_bf16 v[76:79], a[96:99], a[32:35], v[76:79]
s_add_u32 m0, s33, 50784
v_exp_f32 v69, v69
v_mfma_f32_16x16x32_bf16 v[56:59], a[112:115], a[32:35], v[44:47]
v_cvt_pk_bf16_f32 v94, v68, v69
v_mfma_f32_16x16x32_bf16 v[56:59], a[116:119], a[36:39], v[56:59]
v_exp_f32 v70, v70
v_mfma_f32_16x16x32_bf16 v[56:59], a[120:123], a[40:43], v[56:59]
buffer_load_dwordx4 v3, s[16:19], 0 offen offset:3072 nt lds
v_mfma_f32_16x16x32_bf16 v[56:59], a[124:127], a[44:47], v[56:59]
v_exp_f32 v71, v71
v_mfma_f32_16x16x32_bf16 v[60:63], a[140:143], a[44:47], v[44:47]
v_exp_f32 v72, v72
v_mfma_f32_16x16x32_bf16 v[60:63], a[136:139], a[40:43], v[60:63]
v_cvt_pk_bf16_f32 v95, v70, v71
v_mfma_f32_16x16x32_bf16 v[60:63], a[132:135], a[36:39], v[60:63]
v_exp_f32 v73, v73
v_mfma_f32_16x16x32_bf16 v[60:63], a[128:131], a[32:35], v[60:63]
v_cvt_pk_bf16_f32 v80, v72, v73
v_mfma_f32_16x16x32_bf16 v[128:131], a[144:147], v[88:91], v[128:131]
v_exp_f32 v74, v74
v_mfma_f32_16x16x32_bf16 v[128:131], a[176:179], v[92:95], v[128:131]
v_mfma_f32_16x16x32_bf16 v[132:135], a[180:183], v[92:95], v[132:135]
v_exp_f32 v75, v75
v_mfma_f32_16x16x32_bf16 v[132:135], a[148:151], v[88:91], v[132:135]
v_cvt_pk_bf16_f32 v81, v74, v75
v_mfma_f32_16x16x32_bf16 v[136:139], a[152:155], v[88:91], v[136:139]
v_mfma_f32_16x16x32_bf16 v[136:139], a[184:187], v[92:95], v[136:139]
v_mfma_f32_16x16x32_bf16 v[140:143], a[188:191], v[92:95], v[140:143]
v_mfma_f32_16x16x32_bf16 v[140:143], a[156:159], v[88:91], v[140:143]
v_mfma_f32_16x16x32_bf16 v[144:147], a[160:163], v[88:91], v[144:147]
s_waitcnt lgkmcnt(0)
v_mfma_f32_16x16x32_bf16 v[144:147], a[192:195], v[92:95], v[144:147]
buffer_store_dwordx4 v[20:23], v3, s[28:31], s36 offen offset:1024 sc0 sc1
v_exp_f32 v76, v76
v_exp_f32 v77, v77
v_exp_f32 v78, v78
v_exp_f32 v79, v79
v_cvt_pk_bf16_f32 v82, v76, v77
v_cvt_pk_bf16_f32 v83, v78, v79
v_mfma_f32_16x16x32_bf16 v[148:151], a[196:199], v[92:95], v[148:151]
s_add_u32 s36, s36, 2048
v_mfma_f32_16x16x32_bf16 v[148:151], a[164:167], v[88:91], v[148:151]
v_mfma_f32_16x16x32_bf16 v[152:155], a[168:171], v[88:91], v[152:155]
v_exp_f32 v56, v56
v_mfma_f32_16x16x32_bf16 v[152:155], a[200:203], v[92:95], v[152:155]
v_mfma_f32_16x16x32_bf16 v[156:159], a[204:207], v[92:95], v[156:159]
s_waitcnt vmcnt(14) lgkmcnt(1)
v_exp_f32 v57, v57
v_mfma_f32_16x16x32_bf16 v[156:159], a[172:175], v[88:91], v[156:159]
v_cvt_pk_bf16_f32 v84, v56, v57
v_mfma_f32_16x16x32_bf16 a[212:215], a[228:231], v[88:91], a[212:215]
s_barrier
v_exp_f32 v58, v58
v_mfma_f32_16x16x32_bf16 a[212:215], a[228:231], v[92:95], a[212:215]
v_mfma_f32_16x16x32_bf16 v[64:67], a[80:83], a[48:51], v[48:51]
v_exp_f32 v59, v59
v_mfma_f32_16x16x32_bf16 v[64:67], a[84:87], a[52:55], v[64:67]
ds_read_b128 a[80:83], v1
v_cvt_pk_bf16_f32 v85, v58, v59
v_mfma_f32_16x16x32_bf16 v[64:67], a[88:91], a[56:59], v[64:67]
v_exp_f32 v60, v60
v_mfma_f32_16x16x32_bf16 v[64:67], a[92:95], a[60:63], v[64:67]
ds_read_b128 a[84:87], v1 offset:64
ds_read_b128 a[88:91], v1 offset:128
v_mfma_f32_16x16x32_bf16 v[68:71], a[108:111], a[60:63], v[48:51]
v_exp_f32 v61, v61
v_mfma_f32_16x16x32_bf16 v[68:71], a[104:107], a[56:59], v[68:71]
ds_read_b128 a[92:95], v1 offset:192
v_cvt_pk_bf16_f32 v86, v60, v61
v_mfma_f32_16x16x32_bf16 v[68:71], a[100:103], a[52:55], v[68:71]
v_exp_f32 v62, v62
v_mfma_f32_16x16x32_bf16 v[68:71], a[96:99], a[48:51], v[68:71]
ds_read_b128 a[108:111], v1 offset:704
v_mfma_f32_16x16x32_bf16 v[72:75], a[112:115], a[48:51], v[48:51]
v_exp_f32 v63, v63
v_mfma_f32_16x16x32_bf16 v[72:75], a[116:119], a[52:55], v[72:75]
v_mfma_f32_16x16x32_bf16 v[72:75], a[120:123], a[56:59], v[72:75]
ds_read_b128 a[104:107], v1 offset:640
v_cvt_pk_bf16_f32 v87, v62, v63
v_mfma_f32_16x16x32_bf16 v[72:75], a[124:127], a[60:63], v[72:75]
v_mfma_f32_16x16x32_bf16 v[76:79], a[140:143], a[60:63], v[48:51]
ds_read_b128 a[100:103], v1 offset:576
v_mfma_f32_16x16x32_bf16 v[76:79], a[136:139], a[56:59], v[76:79]
v_mfma_f32_16x16x32_bf16 v[76:79], a[132:135], a[52:55], v[76:79]
ds_read_b128 a[96:99], v1 offset:512
v_mfma_f32_16x16x32_bf16 v[76:79], a[128:131], a[48:51], v[76:79]
v_exp_f32 v64, v64
v_exp_f32 v65, v65
v_exp_f32 v66, v66
v_exp_f32 v67, v67
v_cvt_pk_bf16_f32 v88, v64, v65
v_cvt_pk_bf16_f32 v89, v66, v67
v_mfma_f32_16x16x32_bf16 v[160:163], a[144:147], v[80:83], v[160:163]
ds_read_b128 a[112:115], v1 offset:8448
v_mfma_f32_16x16x32_bf16 v[160:163], a[176:179], v[84:87], v[160:163]
v_exp_f32 v68, v68
v_mfma_f32_16x16x32_bf16 v[164:167], a[180:183], v[84:87], v[164:167]
ds_read_b128 a[116:119], v1 offset:8512
v_mfma_f32_16x16x32_bf16 v[164:167], a[148:151], v[80:83], v[164:167]
v_exp_f32 v69, v69
v_mfma_f32_16x16x32_bf16 v[168:171], a[152:155], v[80:83], v[168:171]
ds_read_b128 a[120:123], v1 offset:8576
v_cvt_pk_bf16_f32 v90, v68, v69
v_mfma_f32_16x16x32_bf16 v[168:171], a[184:187], v[84:87], v[168:171]
v_exp_f32 v70, v70
v_mfma_f32_16x16x32_bf16 v[172:175], a[188:191], v[84:87], v[172:175]
ds_read_b128 a[124:127], v1 offset:8640
v_mfma_f32_16x16x32_bf16 v[172:175], a[156:159], v[80:83], v[172:175]
v_exp_f32 v71, v71
v_mfma_f32_16x16x32_bf16 v[176:179], a[160:163], v[80:83], v[176:179]
ds_read_b128 a[140:143], v1 offset:9152
v_cvt_pk_bf16_f32 v91, v70, v71
v_mfma_f32_16x16x32_bf16 v[176:179], a[192:195], v[84:87], v[176:179]
v_exp_f32 v72, v72
v_mfma_f32_16x16x32_bf16 v[180:183], a[196:199], v[84:87], v[180:183]
ds_read_b128 a[136:139], v1 offset:9088
v_mfma_f32_16x16x32_bf16 v[180:183], a[164:167], v[80:83], v[180:183]
v_exp_f32 v73, v73
v_mfma_f32_16x16x32_bf16 v[184:187], a[168:171], v[80:83], v[184:187]
ds_read_b128 a[132:135], v1 offset:9024
v_cvt_pk_bf16_f32 v92, v72, v73
v_mfma_f32_16x16x32_bf16 v[184:187], a[200:203], v[84:87], v[184:187]
s_sub_u32 s34, s34, 1
v_exp_f32 v74, v74
v_mfma_f32_16x16x32_bf16 v[188:191], a[204:207], v[84:87], v[188:191]
ds_read_b128 a[128:131], v1 offset:8960
v_mfma_f32_16x16x32_bf16 v[188:191], a[172:175], v[80:83], v[188:191]
s_cmp_lg_u32 s34, 0
v_exp_f32 v75, v75
v_mfma_f32_16x16x32_bf16 a[216:219], a[228:231], v[80:83], a[216:219]
s_waitcnt lgkmcnt(8)
v_cvt_pk_bf16_f32 v93, v74, v75
v_mfma_f32_16x16x32_bf16 a[216:219], a[228:231], v[84:87], a[216:219]
s_cbranch_scc1 L_n110
s_branch L_x10
.p2align 6
L_n011:
v_exp_f32 v76, v76
v_mfma_f32_16x16x32_bf16 v[56:59], a[80:83], a[64:67], v[52:55]
v_mfma_f32_16x16x32_bf16 v[56:59], a[84:87], a[68:71], v[56:59]
v_exp_f32 v77, v77
v_mfma_f32_16x16x32_bf16 v[56:59], a[88:91], a[72:75], v[56:59]
v_cvt_pk_bf16_f32 v94, v76, v77
v_mfma_f32_16x16x32_bf16 v[56:59], a[92:95], a[76:79], v[56:59]
v_exp_f32 v78, v78
v_mfma_f32_16x16x32_bf16 v[60:63], a[108:111], a[76:79], v[52:55]
buffer_load_dwordx4 v[20:23], v3, s[24:27], s35 offen offset:1024 nt
v_mfma_f32_16x16x32_bf16 v[60:63], a[104:107], a[72:75], v[60:63]
s_waitcnt vmcnt(5) lgkmcnt(0)
v_exp_f32 v79, v79
v_mfma_f32_16x16x32_bf16 v[60:63], a[100:103], a[68:71], v[60:63]
v_cvt_pk_bf16_f32 v95, v78, v79
v_mfma_f32_16x16x32_bf16 v[60:63], a[96:99], a[64:67], v[60:63]
s_barrier
s_add_u32 s16, s16, 16384
s_addc_u32 s17, s17, 0
v_mfma_f32_16x16x32_bf16 v[192:195], a[144:147], v[88:91], v[192:195]
ds_read_b64_tr_b16 a[144:145], v2 offset:8448
v_mfma_f32_16x16x32_bf16 v[192:195], a[176:179], v[92:95], v[192:195]
v_exp_f32 v56, v56
v_mfma_f32_16x16x32_bf16 v[196:199], a[180:183], v[92:95], v[196:199]
ds_read_b64_tr_b16 a[146:147], v2 offset:8960
v_mfma_f32_16x16x32_bf16 v[196:199], a[148:151], v[88:91], v[196:199]
ds_read_b64_tr_b16 a[148:149], v2 offset:8480
v_mfma_f32_16x16x32_bf16 v[200:203], a[152:155], v[88:91], v[200:203]
v_exp_f32 v57, v57
v_mfma_f32_16x16x32_bf16 v[200:203], a[184:187], v[92:95], v[200:203]
ds_read_b64_tr_b16 a[150:151], v2 offset:8992
v_cvt_pk_bf16_f32 v80, v56, v57
v_mfma_f32_16x16x32_bf16 v[204:207], a[188:191], v[92:95], v[204:207]
ds_read_b64_tr_b16 a[152:153], v2 offset:8512
v_mfma_f32_16x16x32_bf16 v[204:207], a[156:159], v[88:91], v[204:207]
v_exp_f32 v58, v58
v_mfma_f32_16x16x32_bf16 v[208:211], a[160:163], v[88:91], v[208:211]
ds_read_b64_tr_b16 a[154:155], v2 offset:9024
v_mfma_f32_16x16x32_bf16 v[208:211], a[192:195], v[92:95], v[208:211]
ds_read_b64_tr_b16 a[156:157], v2 offset:8544
v_mfma_f32_16x16x32_bf16 v[212:215], a[196:199], v[92:95], v[212:215]
v_exp_f32 v59, v59
v_mfma_f32_16x16x32_bf16 v[212:215], a[164:167], v[88:91], v[212:215]
ds_read_b64_tr_b16 a[158:159], v2 offset:9056
v_cvt_pk_bf16_f32 v81, v58, v59
v_mfma_f32_16x16x32_bf16 v[216:219], a[168:171], v[88:91], v[216:219]
ds_read_b64_tr_b16 a[160:161], v2 offset:8576
v_mfma_f32_16x16x32_bf16 v[216:219], a[200:203], v[92:95], v[216:219]
v_mfma_f32_16x16x32_bf16 v[220:223], a[204:207], v[92:95], v[220:223]
ds_read_b64_tr_b16 a[162:163], v2 offset:9088
v_mfma_f32_16x16x32_bf16 v[220:223], a[172:175], v[88:91], v[220:223]
ds_read_b64_tr_b16 a[164:165], v2 offset:8608
v_mfma_f32_16x16x32_bf16 a[220:223], a[228:231], v[88:91], a[220:223]
v_mfma_f32_16x16x32_bf16 a[220:223], a[228:231], v[92:95], a[220:223]
ds_read_b64_tr_b16 a[166:167], v2 offset:9120
v_mfma_f32_16x16x32_bf16 v[64:67], a[80:83], a[0:3], v[36:39]
s_waitcnt vmcnt(6)
ds_read_b64_tr_b16 a[168:169], v2 offset:8640
v_mfma_f32_16x16x32_bf16 v[64:67], a[84:87], a[4:7], v[64:67]
v_mfma_f32_16x16x32_bf16 v[64:67], a[88:91], a[8:11], v[64:67]
ds_read_b64_tr_b16 a[170:171], v2 offset:9152
v_lshlrev_b32 v32, 16, v16
v_mfma_f32_16x16x32_bf16 v[64:67], a[92:95], a[12:15], v[64:67]
ds_read_b64_tr_b16 a[172:173], v2 offset:8672
v_and_b32 v33, s45, v16
v_exp_f32 v60, v60
v_exp_f32 v61, v61
v_exp_f32 v62, v62
v_exp_f32 v63, v63
v_cvt_pk_bf16_f32 v82, v60, v61
v_cvt_pk_bf16_f32 v83, v62, v63
v_mfma_f32_16x16x32_bf16 v[68:71], a[108:111], a[12:15], v[36:39]
v_mfma_f32_16x16x32_bf16 v[68:71], a[104:107], a[8:11], v[68:71]
ds_read_b64_tr_b16 a[174:175], v2 offset:9184
v_mfma_f32_16x16x32_bf16 v[68:71], a[100:103], a[4:7], v[68:71]
ds_read_b64_tr_b16 a[176:177], v2
v_mul_f32 v32, s38, v32
v_mfma_f32_16x16x32_bf16 v[68:71], a[96:99], a[0:3], v[68:71]
ds_read_b64_tr_b16 a[178:179], v2 offset:512
v_mul_f32 v33, s38, v33
v_mfma_f32_16x16x32_bf16 v[72:75], a[112:115], a[0:3], v[36:39]
v_mfma_f32_16x16x32_bf16 v[72:75], a[116:119], a[4:7], v[72:75]
ds_read_b64_tr_b16 a[180:181], v2 offset:32
v_cvt_pk_bf16_f32 v16, v32, v33
v_mfma_f32_16x16x32_bf16 v[72:75], a[120:123], a[8:11], v[72:75]
v_mfma_f32_16x16x32_bf16 v[72:75], a[124:127], a[12:15], v[72:75]
ds_read_b64_tr_b16 a[182:183], v2 offset:544
v_exp_f32 v64, v64
v_exp_f32 v65, v65
v_exp_f32 v66, v66
v_exp_f32 v67, v67
v_cvt_pk_bf16_f32 v88, v64, v65
v_cvt_pk_bf16_f32 v89, v66, v67
v_mfma_f32_16x16x32_bf16 v[76:79], a[140:143], a[12:15], v[36:39]
v_mfma_f32_16x16x32_bf16 v[76:79], a[136:139], a[8:11], v[76:79]
ds_read_b64_tr_b16 a[184:185], v2 offset:64
v_lshlrev_b32 v34, 16, v17
v_mfma_f32_16x16x32_bf16 v[76:79], a[132:135], a[4:7], v[76:79]
s_waitcnt lgkmcnt(13)
v_mfma_f32_16x16x32_bf16 v[76:79], a[128:131], a[0:3], v[76:79]
ds_read_b64_tr_b16 a[186:187], v2 offset:576
v_mfma_f32_16x16x32_bf16 v[224:227], a[144:147], v[80:83], v[224:227]
v_mfma_f32_16x16x32_bf16 v[228:231], a[148:151], v[80:83], v[228:231]
ds_read_b64_tr_b16 a[188:189], v2 offset:96
v_and_b32 v35, s45, v17
v_mfma_f32_16x16x32_bf16 v[232:235], a[152:155], v[80:83], v[232:235]
s_waitcnt lgkmcnt(7)
v_mfma_f32_16x16x32_bf16 v[236:239], a[156:159], v[80:83], v[236:239]
ds_read_b64_tr_b16 a[190:191], v2 offset:608
v_mfma_f32_16x16x32_bf16 v[240:243], a[160:163], v[80:83], v[240:243]
v_mfma_f32_16x16x32_bf16 v[244:247], a[164:167], v[80:83], v[244:247]
ds_read_b64_tr_b16 a[192:193], v2 offset:128
v_mul_f32 v34, s38, v34
v_mfma_f32_16x16x32_bf16 v[248:251], a[168:171], v[80:83], v[248:251]
v_exp_f32 v68, v68
v_exp_f32 v69, v69
v_exp_f32 v70, v70
v_exp_f32 v71, v71
v_cvt_pk_bf16_f32 v90, v68, v69
v_cvt_pk_bf16_f32 v91, v70, v71
v_mfma_f32_16x16x32_bf16 v[252:255], a[172:175], v[80:83], v[252:255]
ds_read_b64_tr_b16 a[194:195], v2 offset:640
v_mfma_f32_16x16x32_bf16 a[224:227], a[228:231], v[80:83], a[224:227]
v_exp_f32 v72, v72
v_mfma_f32_16x16x32_bf16 v[56:59], a[80:83], a[16:19], v[40:43]
ds_read_b64_tr_b16 a[196:197], v2 offset:160
v_mul_f32 v35, s38, v35
v_mfma_f32_16x16x32_bf16 v[56:59], a[84:87], a[20:23], v[56:59]
v_exp_f32 v73, v73
v_mfma_f32_16x16x32_bf16 v[56:59], a[88:91], a[24:27], v[56:59]
ds_read_b64_tr_b16 a[198:199], v2 offset:672
v_cvt_pk_bf16_f32 v92, v72, v73
v_mfma_f32_16x16x32_bf16 v[56:59], a[92:95], a[28:31], v[56:59]
s_add_u32 m0, s33, 50688
v_exp_f32 v74, v74
v_mfma_f32_16x16x32_bf16 v[60:63], a[108:111], a[28:31], v[40:43]
buffer_load_dwordx4 v3, s[16:19], 0 offen nt lds
v_mfma_f32_16x16x32_bf16 v[60:63], a[104:107], a[24:27], v[60:63]
v_exp_f32 v75, v75
v_mfma_f32_16x16x32_bf16 v[60:63], a[100:103], a[20:23], v[60:63]
ds_read_b64_tr_b16 a[200:201], v2 offset:192
v_cvt_pk_bf16_f32 v93, v74, v75
v_mfma_f32_16x16x32_bf16 v[60:63], a[96:99], a[16:19], v[60:63]
v_mfma_f32_16x16x32_bf16 v[64:67], a[112:115], a[16:19], v[40:43]
ds_read_b64_tr_b16 a[202:203], v2 offset:704
v_cvt_pk_bf16_f32 v17, v34, v35
v_mfma_f32_16x16x32_bf16 v[64:67], a[116:119], a[20:23], v[64:67]
v_mfma_f32_16x16x32_bf16 v[64:67], a[120:123], a[24:27], v[64:67]
ds_read_b64_tr_b16 a[204:205], v2 offset:224
v_mfma_f32_16x16x32_bf16 v[64:67], a[124:127], a[28:31], v[64:67]
s_add_u32 m0, s33, 50720
v_exp_f32 v76, v76
v_exp_f32 v77, v77
v_exp_f32 v78, v78
v_exp_f32 v79, v79
v_cvt_pk_bf16_f32 v94, v76, v77
v_cvt_pk_bf16_f32 v95, v78, v79
v_mfma_f32_16x16x32_bf16 v[68:71], a[140:143], a[28:31], v[40:43]
buffer_load_dwordx4 v3, s[16:19], 0 offen offset:1024 nt lds
v_mfma_f32_16x16x32_bf16 v[68:71], a[136:139], a[24:27], v[68:71]
v_mfma_f32_16x16x32_bf16 v[68:71], a[132:135], a[20:23], v[68:71]
ds_read_b64_tr_b16 a[206:207], v2 offset:736
v_mfma_f32_16x16x32_bf16 v[68:71], a[128:131], a[16:19], v[68:71]
v_mfma_f32_16x16x32_bf16 v[96:99], a[144:147], v[88:91], v[96:99]
s_waitcnt lgkmcnt(8)
v_lshlrev_b32 v32, 16, v18
v_and_b32 v33, s45, v18
v_mfma_f32_16x16x32_bf16 v[96:99], a[176:179], v[92:95], v[96:99]
v_mfma_f32_16x16x32_bf16 v[100:103], a[180:183], v[92:95], v[100:103]
v_mul_f32 v32, s38, v32
v_mfma_f32_16x16x32_bf16 v[100:103], a[148:151], v[88:91], v[100:103]
s_add_u32 m0, s33, 50752
v_mfma_f32_16x16x32_bf16 v[104:107], a[152:155], v[88:91], v[104:107]
buffer_load_dwordx4 v3, s[16:19], 0 offen offset:2048 nt lds
v_mfma_f32_16x16x32_bf16 v[104:107], a[184:187], v[92:95], v[104:107]
v_exp_f32 v56, v56
v_exp_f32 v57, v57
v_exp_f32 v58, v58
v_exp_f32 v59, v59
v_cvt_pk_bf16_f32 v80, v56, v57
v_cvt_pk_bf16_f32 v81, v58, v59
v_mfma_f32_16x16x32_bf16 v[108:111], a[188:191], v[92:95], v[108:111]
v_mul_f32 v33, s38, v33
v_mfma_f32_16x16x32_bf16 v[108:111], a[156:159], v[88:91], v[108:111]
s_waitcnt lgkmcnt(0)
v_mfma_f32_16x16x32_bf16 v[112:115], a[160:163], v[88:91], v[112:115]
buffer_load_dwordx4 v[24:27], v3, s[24:27], s35 offen offset:2048 nt
v_mfma_f32_16x16x32_bf16 v[112:115], a[192:195], v[92:95], v[112:115]
v_mfma_f32_16x16x32_bf16 v[116:119], a[196:199], v[92:95], v[116:119]
v_cvt_pk_bf16_f32 v18, v32, v33
v_mfma_f32_16x16x32_bf16 v[116:119], a[164:167], v[88:91], v[116:119]
s_add_u32 m0, s33, 50784
v_mfma_f32_16x16x32_bf16 v[120:123], a[168:171], v[88:91], v[120:123]
buffer_load_dwordx4 v3, s[16:19], 0 offen offset:3072 nt lds
v_mfma_f32_16x16x32_bf16 v[120:123], a[200:203], v[92:95], v[120:123]
v_exp_f32 v60, v60
v_exp_f32 v61, v61
v_exp_f32 v62, v62
v_exp_f32 v63, v63
v_cvt_pk_bf16_f32 v82, v60, v61
v_cvt_pk_bf16_f32 v83, v62, v63
v_mfma_f32_16x16x32_bf16 v[124:127], a[204:207], v[92:95], v[124:127]
s_add_u32 s12, s12, 16384
s_addc_u32 s13, s13, 0
v_mfma_f32_16x16x32_bf16 v[124:127], a[172:175], v[88:91], v[124:127]
v_mfma_f32_16x16x32_bf16 a[208:211], a[228:231], v[88:91], a[208:211]
v_lshlrev_b32 v34, 16, v19
v_and_b32 v35, s45, v19
v_mfma_f32_16x16x32_bf16 a[208:211], a[228:231], v[92:95], a[208:211]
s_add_u32 m0, s33, 0
v_mfma_f32_16x16x32_bf16 v[72:75], a[80:83], a[32:35], v[44:47]
v_mul_f32 v34, s38, v34
v_mfma_f32_16x16x32_bf16 v[72:75], a[84:87], a[36:39], v[72:75]
v_mfma_f32_16x16x32_bf16 v[72:75], a[88:91], a[40:43], v[72:75]
buffer_load_dwordx4 v3, s[12:15], 0 offen nt lds
v_mfma_f32_16x16x32_bf16 v[72:75], a[92:95], a[44:47], v[72:75]
v_exp_f32 v64, v64
v_exp_f32 v65, v65
v_exp_f32 v66, v66
v_exp_f32 v67, v67
v_cvt_pk_bf16_f32 v84, v64, v65
v_cvt_pk_bf16_f32 v85, v66, v67
v_mfma_f32_16x16x32_bf16 v[76:79], a[108:111], a[44:47], v[44:47]
v_mul_f32 v35, s38, v35
v_mfma_f32_16x16x32_bf16 v[76:79], a[104:107], a[40:43], v[76:79]
v_exp_f32 v68, v68
v_mfma_f32_16x16x32_bf16 v[76:79], a[100:103], a[36:39], v[76:79]
v_cvt_pk_bf16_f32 v19, v34, v35
v_mfma_f32_16x16x32_bf16 v[76:79], a[96:99], a[32:35], v[76:79]
s_add_u32 m0, s33, 32
v_exp_f32 v69, v69
v_mfma_f32_16x16x32_bf16 v[56:59], a[112:115], a[32:35], v[44:47]
v_cvt_pk_bf16_f32 v86, v68, v69
v_mfma_f32_16x16x32_bf16 v[56:59], a[116:119], a[36:39], v[56:59]
v_exp_f32 v70, v70
v_mfma_f32_16x16x32_bf16 v[56:59], a[120:123], a[40:43], v[56:59]
buffer_load_dwordx4 v3, s[12:15], 0 offen offset:1024 nt lds
v_mfma_f32_16x16x32_bf16 v[56:59], a[124:127], a[44:47], v[56:59]
v_exp_f32 v71, v71
v_mfma_f32_16x16x32_bf16 v[60:63], a[140:143], a[44:47], v[44:47]
v_mfma_f32_16x16x32_bf16 v[60:63], a[136:139], a[40:43], v[60:63]
v_cvt_pk_bf16_f32 v87, v70, v71
v_mfma_f32_16x16x32_bf16 v[60:63], a[132:135], a[36:39], v[60:63]
v_mfma_f32_16x16x32_bf16 v[60:63], a[128:131], a[32:35], v[60:63]
v_mfma_f32_16x16x32_bf16 v[128:131], a[144:147], v[80:83], v[128:131]
s_add_u32 m0, s33, 64
v_mfma_f32_16x16x32_bf16 v[128:131], a[176:179], v[84:87], v[128:131]
buffer_load_dwordx4 v3, s[12:15], 0 offen offset:2048 nt lds
v_exp_f32 v72, v72
v_exp_f32 v73, v73
v_exp_f32 v74, v74
v_exp_f32 v75, v75
v_cvt_pk_bf16_f32 v88, v72, v73
v_cvt_pk_bf16_f32 v89, v74, v75
v_mfma_f32_16x16x32_bf16 v[132:135], a[180:183], v[84:87], v[132:135]
v_mfma_f32_16x16x32_bf16 v[132:135], a[148:151], v[80:83], v[132:135]
v_mfma_f32_16x16x32_bf16 v[136:139], a[152:155], v[80:83], v[136:139]
v_mfma_f32_16x16x32_bf16 v[136:139], a[184:187], v[84:87], v[136:139]
v_mfma_f32_16x16x32_bf16 v[140:143], a[188:191], v[84:87], v[140:143]
v_mfma_f32_16x16x32_bf16 v[140:143], a[156:159], v[80:83], v[140:143]
v_mfma_f32_16x16x32_bf16 v[144:147], a[160:163], v[80:83], v[144:147]
s_add_u32 m0, s33, 96
v_mfma_f32_16x16x32_bf16 v[144:147], a[192:195], v[84:87], v[144:147]
buffer_load_dwordx4 v3, s[12:15], 0 offen offset:3072 nt lds
v_exp_f32 v76, v76
v_exp_f32 v77, v77
v_exp_f32 v78, v78
v_exp_f32 v79, v79
v_cvt_pk_bf16_f32 v90, v76, v77
v_cvt_pk_bf16_f32 v91, v78, v79
v_mfma_f32_16x16x32_bf16 v[148:151], a[196:199], v[84:87], v[148:151]
v_mfma_f32_16x16x32_bf16 v[148:151], a[164:167], v[80:83], v[148:151]
v_mfma_f32_16x16x32_bf16 v[152:155], a[168:171], v[80:83], v[152:155]
v_mfma_f32_16x16x32_bf16 v[152:155], a[200:203], v[84:87], v[152:155]
ds_write_b128 v4, v[16:19]
v_mfma_f32_16x16x32_bf16 v[156:159], a[204:207], v[84:87], v[156:159]
s_waitcnt vmcnt(10) lgkmcnt(1)
v_mfma_f32_16x16x32_bf16 v[156:159], a[172:175], v[80:83], v[156:159]
v_mfma_f32_16x16x32_bf16 a[212:215], a[228:231], v[80:83], a[212:215]
s_barrier
v_mfma_f32_16x16x32_bf16 a[212:215], a[228:231], v[84:87], a[212:215]
v_exp_f32 v56, v56
v_exp_f32 v57, v57
v_exp_f32 v58, v58
v_exp_f32 v59, v59
v_cvt_pk_bf16_f32 v92, v56, v57
v_cvt_pk_bf16_f32 v93, v58, v59
v_mfma_f32_16x16x32_bf16 v[64:67], a[80:83], a[48:51], v[48:51]
v_mfma_f32_16x16x32_bf16 v[64:67], a[84:87], a[52:55], v[64:67]
ds_read_b128 a[80:83], v1 offset:25344
v_mfma_f32_16x16x32_bf16 v[64:67], a[88:91], a[56:59], v[64:67]
v_exp_f32 v60, v60
v_mfma_f32_16x16x32_bf16 v[64:67], a[92:95], a[60:63], v[64:67]
ds_read_b128 a[84:87], v1 offset:25408
ds_read_b128 a[88:91], v1 offset:25472
v_mfma_f32_16x16x32_bf16 v[68:71], a[108:111], a[60:63], v[48:51]
v_exp_f32 v61, v61
v_mfma_f32_16x16x32_bf16 v[68:71], a[104:107], a[56:59], v[68:71]
ds_read_b128 a[92:95], v1 offset:25536
v_cvt_pk_bf16_f32 v94, v60, v61
v_mfma_f32_16x16x32_bf16 v[68:71], a[100:103], a[52:55], v[68:71]
v_exp_f32 v62, v62
v_mfma_f32_16x16x32_bf16 v[68:71], a[96:99], a[48:51], v[68:71]
ds_read_b128 a[108:111], v1 offset:26048
v_mfma_f32_16x16x32_bf16 v[72:75], a[112:115], a[48:51], v[48:51]
v_exp_f32 v63, v63
v_mfma_f32_16x16x32_bf16 v[72:75], a[116:119], a[52:55], v[72:75]
v_mfma_f32_16x16x32_bf16 v[72:75], a[120:123], a[56:59], v[72:75]
ds_read_b128 a[104:107], v1 offset:25984
v_cvt_pk_bf16_f32 v95, v62, v63
v_mfma_f32_16x16x32_bf16 v[72:75], a[124:127], a[60:63], v[72:75]
v_mfma_f32_16x16x32_bf16 v[76:79], a[140:143], a[60:63], v[48:51]
ds_read_b128 a[100:103], v1 offset:25920
v_mfma_f32_16x16x32_bf16 v[76:79], a[136:139], a[56:59], v[76:79]
v_mfma_f32_16x16x32_bf16 v[76:79], a[132:135], a[52:55], v[76:79]
ds_read_b128 a[96:99], v1 offset:25856
v_mfma_f32_16x16x32_bf16 v[76:79], a[128:131], a[48:51], v[76:79]
v_exp_f32 v64, v64
v_exp_f32 v65, v65
v_exp_f32 v66, v66
v_exp_f32 v67, v67
v_cvt_pk_bf16_f32 v80, v64, v65
v_cvt_pk_bf16_f32 v81, v66, v67
v_mfma_f32_16x16x32_bf16 v[160:163], a[144:147], v[88:91], v[160:163]
ds_read_b128 a[112:115], v1 offset:16896
v_mfma_f32_16x16x32_bf16 v[160:163], a[176:179], v[92:95], v[160:163]
v_mfma_f32_16x16x32_bf16 v[164:167], a[180:183], v[92:95], v[164:167]
ds_read_b128 a[116:119], v1 offset:16960
v_mfma_f32_16x16x32_bf16 v[164:167], a[148:151], v[88:91], v[164:167]
v_mfma_f32_16x16x32_bf16 v[168:171], a[152:155], v[88:91], v[168:171]
ds_read_b128 a[120:123], v1 offset:17024
v_mfma_f32_16x16x32_bf16 v[168:171], a[184:187], v[92:95], v[168:171]
v_mfma_f32_16x16x32_bf16 v[172:175], a[188:191], v[92:95], v[172:175]
ds_read_b128 a[124:127], v1 offset:17088
v_mfma_f32_16x16x32_bf16 v[172:175], a[156:159], v[88:91], v[172:175]
v_exp_f32 v68, v68
v_exp_f32 v69, v69
v_exp_f32 v70, v70
v_exp_f32 v71, v71
v_cvt_pk_bf16_f32 v82, v68, v69
v_cvt_pk_bf16_f32 v83, v70, v71
v_mfma_f32_16x16x32_bf16 v[176:179], a[160:163], v[88:91], v[176:179]
ds_read_b128 a[140:143], v1 offset:17600
v_mfma_f32_16x16x32_bf16 v[176:179], a[192:195], v[92:95], v[176:179]
v_mfma_f32_16x16x32_bf16 v[180:183], a[196:199], v[92:95], v[180:183]
ds_read_b128 a[136:139], v1 offset:17536
v_mfma_f32_16x16x32_bf16 v[180:183], a[164:167], v[88:91], v[180:183]
v_mfma_f32_16x16x32_bf16 v[184:187], a[168:171], v[88:91], v[184:187]
ds_read_b128 a[132:135], v1 offset:17472
v_mfma_f32_16x16x32_bf16 v[184:187], a[200:203], v[92:95], v[184:187]
v_mfma_f32_16x16x32_bf16 v[188:191], a[204:207], v[92:95], v[188:191]
ds_read_b128 a[128:131], v1 offset:17408
v_mfma_f32_16x16x32_bf16 v[188:191], a[172:175], v[88:91], v[188:191]
v_exp_f32 v72, v72
v_exp_f32 v73, v73
v_exp_f32 v74, v74
v_exp_f32 v75, v75
v_cvt_pk_bf16_f32 v84, v72, v73
v_cvt_pk_bf16_f32 v85, v74, v75
v_mfma_f32_16x16x32_bf16 a[216:219], a[228:231], v[88:91], a[216:219]
s_waitcnt lgkmcnt(8)
v_mfma_f32_16x16x32_bf16 a[216:219], a[228:231], v[92:95], a[216:219]
v_mfma_f32_16x16x32_bf16 v[56:59], a[80:83], a[64:67], v[52:55]
v_mfma_f32_16x16x32_bf16 v[56:59], a[84:87], a[68:71], v[56:59]
v_mfma_f32_16x16x32_bf16 v[56:59], a[88:91], a[72:75], v[56:59]
v_mfma_f32_16x16x32_bf16 v[56:59], a[92:95], a[76:79], v[56:59]
v_exp_f32 v76, v76
v_exp_f32 v77, v77
v_exp_f32 v78, v78
v_exp_f32 v79, v79
v_cvt_pk_bf16_f32 v86, v76, v77
v_cvt_pk_bf16_f32 v87, v78, v79
v_mfma_f32_16x16x32_bf16 v[60:63], a[108:111], a[76:79], v[52:55]
buffer_load_dwordx4 v[16:19], v3, s[24:27], s35 offen offset:3072 nt
v_mfma_f32_16x16x32_bf16 v[60:63], a[104:107], a[72:75], v[60:63]
s_waitcnt vmcnt(5) lgkmcnt(0)
v_mfma_f32_16x16x32_bf16 v[60:63], a[100:103], a[68:71], v[60:63]
s_waitcnt vmcnt(10)
v_lshlrev_b32 v32, 16, v20
v_mfma_f32_16x16x32_bf16 v[60:63], a[96:99], a[64:67], v[60:63]
s_barrier
s_add_u32 s16, s16, 16384
s_addc_u32 s17, s17, 0
v_mfma_f32_16x16x32_bf16 v[192:195], a[144:147], v[80:83], v[192:195]
ds_read_b64_tr_b16 a[144:145], v2 offset:25344
v_and_b32 v33, s45, v20
v_mfma_f32_16x16x32_bf16 v[192:195], a[176:179], v[84:87], v[192:195]
s_add_u32 s35, s35, 3072
v_exp_f32 v56, v56
v_mfma_f32_16x16x32_bf16 v[196:199], a[180:183], v[84:87], v[196:199]
ds_read_b64_tr_b16 a[146:147], v2 offset:25856
v_mul_f32 v32, s38, v32
v_mfma_f32_16x16x32_bf16 v[196:199], a[148:151], v[80:83], v[196:199]
ds_read_b64_tr_b16 a[148:149], v2 offset:25376
v_mul_f32 v33, s38, v33
v_mfma_f32_16x16x32_bf16 v[200:203], a[152:155], v[80:83], v[200:203]
v_exp_f32 v57, v57
v_mfma_f32_16x16x32_bf16 v[200:203], a[184:187], v[84:87], v[200:203]
ds_read_b64_tr_b16 a[150:151], v2 offset:25888
v_cvt_pk_bf16_f32 v88, v56, v57
v_mfma_f32_16x16x32_bf16 v[204:207], a[188:191], v[84:87], v[204:207]
ds_read_b64_tr_b16 a[152:153], v2 offset:25408
v_cvt_pk_bf16_f32 v20, v32, v33
v_mfma_f32_16x16x32_bf16 v[204:207], a[156:159], v[80:83], v[204:207]
v_exp_f32 v58, v58
v_mfma_f32_16x16x32_bf16 v[208:211], a[160:163], v[80:83], v[208:211]
ds_read_b64_tr_b16 a[154:155], v2 offset:25920
v_lshlrev_b32 v34, 16, v21
v_mfma_f32_16x16x32_bf16 v[208:211], a[192:195], v[84:87], v[208:211]
ds_read_b64_tr_b16 a[156:157], v2 offset:25440
v_and_b32 v35, s45, v21
v_mfma_f32_16x16x32_bf16 v[212:215], a[196:199], v[84:87], v[212:215]
v_exp_f32 v59, v59
v_mfma_f32_16x16x32_bf16 v[212:215], a[164:167], v[80:83], v[212:215]
ds_read_b64_tr_b16 a[158:159], v2 offset:25952
v_cvt_pk_bf16_f32 v89, v58, v59
v_mfma_f32_16x16x32_bf16 v[216:219], a[168:171], v[80:83], v[216:219]
ds_read_b64_tr_b16 a[160:161], v2 offset:25472
v_mul_f32 v34, s38, v34
v_mfma_f32_16x16x32_bf16 v[216:219], a[200:203], v[84:87], v[216:219]
v_mfma_f32_16x16x32_bf16 v[220:223], a[204:207], v[84:87], v[220:223]
ds_read_b64_tr_b16 a[162:163], v2 offset:25984
v_mul_f32 v35, s38, v35
v_mfma_f32_16x16x32_bf16 v[220:223], a[172:175], v[80:83], v[220:223]
ds_read_b64_tr_b16 a[164:165], v2 offset:25504
v_cvt_pk_bf16_f32 v21, v34, v35
v_mfma_f32_16x16x32_bf16 a[220:223], a[228:231], v[80:83], a[220:223]
v_mfma_f32_16x16x32_bf16 a[220:223], a[228:231], v[84:87], a[220:223]
ds_read_b64_tr_b16 a[166:167], v2 offset:26016
v_mfma_f32_16x16x32_bf16 v[64:67], a[80:83], a[0:3], v[36:39]
ds_read_b64_tr_b16 a[168:169], v2 offset:25536
v_lshlrev_b32 v32, 16, v22
v_mfma_f32_16x16x32_bf16 v[64:67], a[84:87], a[4:7], v[64:67]
v_mfma_f32_16x16x32_bf16 v[64:67], a[88:91], a[8:11], v[64:67]
ds_read_b64_tr_b16 a[170:171], v2 offset:26048
v_and_b32 v33, s45, v22
v_mfma_f32_16x16x32_bf16 v[64:67], a[92:95], a[12:15], v[64:67]
ds_read_b64_tr_b16 a[172:173], v2 offset:25568
v_mul_f32 v32, s38, v32
v_exp_f32 v60, v60
v_exp_f32 v61, v61
v_exp_f32 v62, v62
v_exp_f32 v63, v63
v_cvt_pk_bf16_f32 v90, v60, v61
v_cvt_pk_bf16_f32 v91, v62, v63
v_mfma_f32_16x16x32_bf16 v[68:71], a[108:111], a[12:15], v[36:39]
v_mfma_f32_16x16x32_bf16 v[68:71], a[104:107], a[8:11], v[68:71]
ds_read_b64_tr_b16 a[174:175], v2 offset:26080
v_mfma_f32_16x16x32_bf16 v[68:71], a[100:103], a[4:7], v[68:71]
ds_read_b64_tr_b16 a[176:177], v2 offset:16896
v_mul_f32 v33, s38, v33
v_mfma_f32_16x16x32_bf16 v[68:71], a[96:99], a[0:3], v[68:71]
ds_read_b64_tr_b16 a[178:179], v2 offset:17408
v_cvt_pk_bf16_f32 v22, v32, v33
v_mfma_f32_16x16x32_bf16 v[72:75], a[112:115], a[0:3], v[36:39]
v_mfma_f32_16x16x32_bf16 v[72:75], a[116:119], a[4:7], v[72:75]
ds_read_b64_tr_b16 a[180:181], v2 offset:16928
v_lshlrev_b32 v34, 16, v23
v_mfma_f32_16x16x32_bf16 v[72:75], a[120:123], a[8:11], v[72:75]
v_mfma_f32_16x16x32_bf16 v[72:75], a[124:127], a[12:15], v[72:75]
ds_read_b64_tr_b16 a[182:183], v2 offset:17440
v_exp_f32 v64, v64
v_exp_f32 v65, v65
v_exp_f32 v66, v66
v_exp_f32 v67, v67
v_cvt_pk_bf16_f32 v80, v64, v65
v_cvt_pk_bf16_f32 v81, v66, v67
v_mfma_f32_16x16x32_bf16 v[76:79], a[140:143], a[12:15], v[36:39]
v_mfma_f32_16x16x32_bf16 v[76:79], a[136:139], a[8:11], v[76:79]
ds_read_b64_tr_b16 a[184:185], v2 offset:16960
v_and_b32 v35, s45, v23
v_mfma_f32_16x16x32_bf16 v[76:79], a[132:135], a[4:7], v[76:79]
s_waitcnt lgkmcnt(13)
v_mfma_f32_16x16x32_bf16 v[76:79], a[128:131], a[0:3], v[76:79]
ds_read_b64_tr_b16 a[186:187], v2 offset:17472
v_mfma_f32_16x16x32_bf16 v[224:227], a[144:147], v[88:91], v[224:227]
v_mfma_f32_16x16x32_bf16 v[228:231], a[148:151], v[88:91], v[228:231]
ds_read_b64_tr_b16 a[188:189], v2 offset:16992
v_mul_f32 v34, s38, v34
v_mfma_f32_16x16x32_bf16 v[232:235], a[152:155], v[88:91], v[232:235]
s_waitcnt lgkmcnt(7)
v_mfma_f32_16x16x32_bf16 v[236:239], a[156:159], v[88:91], v[236:239]
ds_read_b64_tr_b16 a[190:191], v2 offset:17504
v_mfma_f32_16x16x32_bf16 v[240:243], a[160:163], v[88:91], v[240:243]
v_mfma_f32_16x16x32_bf16 v[244:247], a[164:167], v[88:91], v[244:247]
ds_read_b64_tr_b16 a[192:193], v2 offset:17024
v_mul_f32 v35, s38, v35
v_mfma_f32_16x16x32_bf16 v[248:251], a[168:171], v[88:91], v[248:251]
v_exp_f32 v68, v68
v_exp_f32 v69, v69
v_exp_f32 v70, v70
v_exp_f32 v71, v71
v_cvt_pk_bf16_f32 v82, v68, v69
v_cvt_pk_bf16_f32 v83, v70, v71
v_mfma_f32_16x16x32_bf16 v[252:255], a[172:175], v[88:91], v[252:255]
ds_read_b64_tr_b16 a[194:195], v2 offset:17536
v_mfma_f32_16x16x32_bf16 a[224:227], a[228:231], v[88:91], a[224:227]
v_exp_f32 v72, v72
v_mfma_f32_16x16x32_bf16 v[56:59], a[80:83], a[16:19], v[40:43]
ds_read_b64_tr_b16 a[196:197], v2 offset:17056
v_cvt_pk_bf16_f32 v23, v34, v35
v_mfma_f32_16x16x32_bf16 v[56:59], a[84:87], a[20:23], v[56:59]
v_exp_f32 v73, v73
v_mfma_f32_16x16x32_bf16 v[56:59], a[88:91], a[24:27], v[56:59]
ds_read_b64_tr_b16 a[198:199], v2 offset:17568
v_cvt_pk_bf16_f32 v84, v72, v73
v_mfma_f32_16x16x32_bf16 v[56:59], a[92:95], a[28:31], v[56:59]
s_add_u32 m0, s33, 33792
v_exp_f32 v74, v74
v_mfma_f32_16x16x32_bf16 v[60:63], a[108:111], a[28:31], v[40:43]
buffer_load_dwordx4 v3, s[16:19], 0 offen nt lds
v_mfma_f32_16x16x32_bf16 v[60:63], a[104:107], a[24:27], v[60:63]
v_exp_f32 v75, v75
v_mfma_f32_16x16x32_bf16 v[60:63], a[100:103], a[20:23], v[60:63]
ds_read_b64_tr_b16 a[200:201], v2 offset:17088
v_cvt_pk_bf16_f32 v85, v74, v75
v_mfma_f32_16x16x32_bf16 v[60:63], a[96:99], a[16:19], v[60:63]
v_mfma_f32_16x16x32_bf16 v[64:67], a[112:115], a[16:19], v[40:43]
ds_read_b64_tr_b16 a[202:203], v2 offset:17600
v_mfma_f32_16x16x32_bf16 v[64:67], a[116:119], a[20:23], v[64:67]
v_mfma_f32_16x16x32_bf16 v[64:67], a[120:123], a[24:27], v[64:67]
ds_read_b64_tr_b16 a[204:205], v2 offset:17120
v_mfma_f32_16x16x32_bf16 v[64:67], a[124:127], a[28:31], v[64:67]
s_add_u32 m0, s33, 33824
v_exp_f32 v76, v76
v_exp_f32 v77, v77
v_exp_f32 v78, v78
v_exp_f32 v79, v79
v_cvt_pk_bf16_f32 v86, v76, v77
v_cvt_pk_bf16_f32 v87, v78, v79
v_mfma_f32_16x16x32_bf16 v[68:71], a[140:143], a[28:31], v[40:43]
buffer_load_dwordx4 v3, s[16:19], 0 offen offset:1024 nt lds
v_mfma_f32_16x16x32_bf16 v[68:71], a[136:139], a[24:27], v[68:71]
s_waitcnt vmcnt(8)
v_mfma_f32_16x16x32_bf16 v[68:71], a[132:135], a[20:23], v[68:71]
ds_read_b64_tr_b16 a[206:207], v2 offset:17632
v_mfma_f32_16x16x32_bf16 v[68:71], a[128:131], a[16:19], v[68:71]
v_mfma_f32_16x16x32_bf16 v[96:99], a[144:147], v[80:83], v[96:99]
s_waitcnt lgkmcnt(8)
v_lshlrev_b32 v32, 16, v24
v_and_b32 v33, s45, v24
v_mfma_f32_16x16x32_bf16 v[96:99], a[176:179], v[84:87], v[96:99]
v_mfma_f32_16x16x32_bf16 v[100:103], a[180:183], v[84:87], v[100:103]
v_mul_f32 v32, s38, v32
v_mfma_f32_16x16x32_bf16 v[100:103], a[148:151], v[80:83], v[100:103]
s_add_u32 m0, s33, 33856
v_mfma_f32_16x16x32_bf16 v[104:107], a[152:155], v[80:83], v[104:107]
buffer_load_dwordx4 v3, s[16:19], 0 offen offset:2048 nt lds
v_mfma_f32_16x16x32_bf16 v[104:107], a[184:187], v[84:87], v[104:107]
v_exp_f32 v56, v56
v_exp_f32 v57, v57
v_exp_f32 v58, v58
v_exp_f32 v59, v59
v_cvt_pk_bf16_f32 v88, v56, v57
v_cvt_pk_bf16_f32 v89, v58, v59
v_mfma_f32_16x16x32_bf16 v[108:111], a[188:191], v[84:87], v[108:111]
v_mul_f32 v33, s38, v33
v_mfma_f32_16x16x32_bf16 v[108:111], a[156:159], v[80:83], v[108:111]
s_waitcnt lgkmcnt(0)
v_mfma_f32_16x16x32_bf16 v[112:115], a[160:163], v[80:83], v[112:115]
ds_write_b128 v4, v[20:23] offset:1056
v_mfma_f32_16x16x32_bf16 v[112:115], a[192:195], v[84:87], v[112:115]
v_mfma_f32_16x16x32_bf16 v[116:119], a[196:199], v[84:87], v[116:119]
v_cvt_pk_bf16_f32 v24, v32, v33
v_mfma_f32_16x16x32_bf16 v[116:119], a[164:167], v[80:83], v[116:119]
s_add_u32 m0, s33, 33888
v_mfma_f32_16x16x32_bf16 v[120:123], a[168:171], v[80:83], v[120:123]
buffer_load_dwordx4 v3, s[16:19], 0 offen offset:3072 nt lds
v_mfma_f32_16x16x32_bf16 v[120:123], a[200:203], v[84:87], v[120:123]
v_exp_f32 v60, v60
v_exp_f32 v61, v61
v_exp_f32 v62, v62
v_exp_f32 v63, v63
v_cvt_pk_bf16_f32 v90, v60, v61
v_cvt_pk_bf16_f32 v91, v62, v63
v_mfma_f32_16x16x32_bf16 v[124:127], a[204:207], v[84:87], v[124:127]
s_add_u32 s12, s12, 16384
s_addc_u32 s13, s13, 0
v_mfma_f32_16x16x32_bf16 v[124:127], a[172:175], v[80:83], v[124:127]
v_mfma_f32_16x16x32_bf16 a[208:211], a[228:231], v[80:83], a[208:211]
v_lshlrev_b32 v34, 16, v25
v_and_b32 v35, s45, v25
v_mfma_f32_16x16x32_bf16 a[208:211], a[228:231], v[84:87], a[208:211]
s_add_u32 m0, s33, 16896
v_mfma_f32_16x16x32_bf16 v[72:75], a[80:83], a[32:35], v[44:47]
v_mul_f32 v34, s38, v34
v_mfma_f32_16x16x32_bf16 v[72:75], a[84:87], a[36:39], v[72:75]
v_mfma_f32_16x16x32_bf16 v[72:75], a[88:91], a[40:43], v[72:75]
buffer_load_dwordx4 v3, s[12:15], 0 offen nt lds
v_mfma_f32_16x16x32_bf16 v[72:75], a[92:95], a[44:47], v[72:75]
v_exp_f32 v64, v64
v_exp_f32 v65, v65
v_exp_f32 v66, v66
v_exp_f32 v67, v67
v_cvt_pk_bf16_f32 v92, v64, v65
v_cvt_pk_bf16_f32 v93, v66, v67
v_mfma_f32_16x16x32_bf16 v[76:79], a[108:111], a[44:47], v[44:47]
v_mul_f32 v35, s38, v35
v_mfma_f32_16x16x32_bf16 v[76:79], a[104:107], a[40:43], v[76:79]
v_exp_f32 v68, v68
v_mfma_f32_16x16x32_bf16 v[76:79], a[100:103], a[36:39], v[76:79]
v_cvt_pk_bf16_f32 v25, v34, v35
v_lshlrev_b32 v32, 16, v26
v_mfma_f32_16x16x32_bf16 v[76:79], a[96:99], a[32:35], v[76:79]
s_add_u32 m0, s33, 16928
v_exp_f32 v69, v69
v_mfma_f32_16x16x32_bf16 v[56:59], a[112:115], a[32:35], v[44:47]
v_cvt_pk_bf16_f32 v94, v68, v69
v_and_b32 v33, s45, v26
v_mfma_f32_16x16x32_bf16 v[56:59], a[116:119], a[36:39], v[56:59]
v_exp_f32 v70, v70
v_mfma_f32_16x16x32_bf16 v[56:59], a[120:123], a[40:43], v[56:59]
buffer_load_dwordx4 v3, s[12:15], 0 offen offset:1024 nt lds
v_mfma_f32_16x16x32_bf16 v[56:59], a[124:127], a[44:47], v[56:59]
v_exp_f32 v71, v71
v_mfma_f32_16x16x32_bf16 v[60:63], a[140:143], a[44:47], v[44:47]
v_mfma_f32_16x16x32_bf16 v[60:63], a[136:139], a[40:43], v[60:63]
v_cvt_pk_bf16_f32 v95, v70, v71
v_mul_f32 v32, s38, v32
v_mfma_f32_16x16x32_bf16 v[60:63], a[132:135], a[36:39], v[60:63]
v_mfma_f32_16x16x32_bf16 v[60:63], a[128:131], a[32:35], v[60:63]
v_mul_f32 v33, s38, v33
v_mfma_f32_16x16x32_bf16 v[128:131], a[144:147], v[88:91], v[128:131]
s_add_u32 m0, s33, 16960
v_mfma_f32_16x16x32_bf16 v[128:131], a[176:179], v[92:95], v[128:131]
buffer_load_dwordx4 v3, s[12:15], 0 offen offset:2048 nt lds
v_exp_f32 v72, v72
v_exp_f32 v73, v73
v_exp_f32 v74, v74
v_exp_f32 v75, v75
v_cvt_pk_bf16_f32 v80, v72, v73
v_cvt_pk_bf16_f32 v81, v74, v75
v_mfma_f32_16x16x32_bf16 v[132:135], a[180:183], v[92:95], v[132:135]
v_mfma_f32_16x16x32_bf16 v[132:135], a[148:151], v[88:91], v[132:135]
v_cvt_pk_bf16_f32 v26, v32, v33
v_mfma_f32_16x16x32_bf16 v[136:139], a[152:155], v[88:91], v[136:139]
v_mfma_f32_16x16x32_bf16 v[136:139], a[184:187], v[92:95], v[136:139]
v_lshlrev_b32 v34, 16, v27
v_and_b32 v35, s45, v27
v_mfma_f32_16x16x32_bf16 v[140:143], a[188:191], v[92:95], v[140:143]
v_mfma_f32_16x16x32_bf16 v[140:143], a[156:159], v[88:91], v[140:143]
v_mul_f32 v34, s38, v34
v_mfma_f32_16x16x32_bf16 v[144:147], a[160:163], v[88:91], v[144:147]
s_add_u32 m0, s33, 16992
v_mfma_f32_16x16x32_bf16 v[144:147], a[192:195], v[92:95], v[144:147]
buffer_load_dwordx4 v3, s[12:15], 0 offen offset:3072 nt lds
v_exp_f32 v76, v76
v_exp_f32 v77, v77
v_exp_f32 v78, v78
v_exp_f32 v79, v79
v_cvt_pk_bf16_f32 v82, v76, v77
v_cvt_pk_bf16_f32 v83, v78, v79
v_mfma_f32_16x16x32_bf16 v[148:151], a[196:199], v[92:95], v[148:151]
v_mfma_f32_16x16x32_bf16 v[148:151], a[164:167], v[88:91], v[148:151]
v_mul_f32 v35, s38, v35
v_mfma_f32_16x16x32_bf16 v[152:155], a[168:171], v[88:91], v[152:155]
v_cvt_pk_bf16_f32 v27, v34, v35
v_mfma_f32_16x16x32_bf16 v[152:155], a[200:203], v[92:95], v[152:155]
ds_write_b128 v4, v[24:27] offset:2112
v_mfma_f32_16x16x32_bf16 v[156:159], a[204:207], v[92:95], v[156:159]
s_waitcnt vmcnt(9) lgkmcnt(2)
v_mfma_f32_16x16x32_bf16 v[156:159], a[172:175], v[88:91], v[156:159]
v_add_u32 v4, 3168, v4
v_mfma_f32_16x16x32_bf16 a[212:215], a[228:231], v[88:91], a[212:215]
s_barrier
v_mfma_f32_16x16x32_bf16 a[212:215], a[228:231], v[92:95], a[212:215]
v_exp_f32 v56, v56
v_exp_f32 v57, v57
v_exp_f32 v58, v58
v_exp_f32 v59, v59
v_cvt_pk_bf16_f32 v84, v56, v57
v_cvt_pk_bf16_f32 v85, v58, v59
v_mfma_f32_16x16x32_bf16 v[64:67], a[80:83], a[48:51], v[48:51]
v_mfma_f32_16x16x32_bf16 v[64:67], a[84:87], a[52:55], v[64:67]
ds_read_b128 a[80:83], v1 offset:8448
v_mfma_f32_16x16x32_bf16 v[64:67], a[88:91], a[56:59], v[64:67]
v_exp_f32 v60, v60
v_mfma_f32_16x16x32_bf16 v[64:67], a[92:95], a[60:63], v[64:67]
ds_read_b128 a[84:87], v1 offset:8512
ds_read_b128 a[88:91], v1 offset:8576
v_mfma_f32_16x16x32_bf16 v[68:71], a[108:111], a[60:63], v[48:51]
v_exp_f32 v61, v61
v_mfma_f32_16x16x32_bf16 v[68:71], a[104:107], a[56:59], v[68:71]
ds_read_b128 a[92:95], v1 offset:8640
v_cvt_pk_bf16_f32 v86, v60, v61
v_mfma_f32_16x16x32_bf16 v[68:71], a[100:103], a[52:55], v[68:71]
v_exp_f32 v62, v62
v_mfma_f32_16x16x32_bf16 v[68:71], a[96:99], a[48:51], v[68:71]
ds_read_b128 a[108:111], v1 offset:9152
v_mfma_f32_16x16x32_bf16 v[72:75], a[112:115], a[48:51], v[48:51]
v_exp_f32 v63, v63
v_mfma_f32_16x16x32_bf16 v[72:75], a[116:119], a[52:55], v[72:75]
v_mfma_f32_16x16x32_bf16 v[72:75], a[120:123], a[56:59], v[72:75]
ds_read_b128 a[104:107], v1 offset:9088
v_cvt_pk_bf16_f32 v87, v62, v63
v_mfma_f32_16x16x32_bf16 v[72:75], a[124:127], a[60:63], v[72:75]
v_mfma_f32_16x16x32_bf16 v[76:79], a[140:143], a[60:63], v[48:51]
ds_read_b128 a[100:103], v1 offset:9024
v_mfma_f32_16x16x32_bf16 v[76:79], a[136:139], a[56:59], v[76:79]
v_mfma_f32_16x16x32_bf16 v[76:79], a[132:135], a[52:55], v[76:79]
ds_read_b128 a[96:99], v1 offset:8960
v_mfma_f32_16x16x32_bf16 v[76:79], a[128:131], a[48:51], v[76:79]
v_exp_f32 v64, v64
v_exp_f32 v65, v65
v_exp_f32 v66, v66
v_exp_f32 v67, v67
v_cvt_pk_bf16_f32 v88, v64, v65
v_cvt_pk_bf16_f32 v89, v66, v67
v_mfma_f32_16x16x32_bf16 v[160:163], a[144:147], v[80:83], v[160:163]
ds_read_b128 a[112:115], v1
v_mfma_f32_16x16x32_bf16 v[160:163], a[176:179], v[84:87], v[160:163]
v_mfma_f32_16x16x32_bf16 v[164:167], a[180:183], v[84:87], v[164:167]
ds_read_b128 a[116:119], v1 offset:64
v_mfma_f32_16x16x32_bf16 v[164:167], a[148:151], v[80:83], v[164:167]
v_mfma_f32_16x16x32_bf16 v[168:171], a[152:155], v[80:83], v[168:171]
ds_read_b128 a[120:123], v1 offset:128
v_mfma_f32_16x16x32_bf16 v[168:171], a[184:187], v[84:87], v[168:171]
v_mfma_f32_16x16x32_bf16 v[172:175], a[188:191], v[84:87], v[172:175]
ds_read_b128 a[124:127], v1 offset:192
v_mfma_f32_16x16x32_bf16 v[172:175], a[156:159], v[80:83], v[172:175]
v_exp_f32 v68, v68
v_exp_f32 v69, v69
v_exp_f32 v70, v70
v_exp_f32 v71, v71
v_cvt_pk_bf16_f32 v90, v68, v69
v_cvt_pk_bf16_f32 v91, v70, v71
v_mfma_f32_16x16x32_bf16 v[176:179], a[160:163], v[80:83], v[176:179]
ds_read_b128 a[140:143], v1 offset:704
v_mfma_f32_16x16x32_bf16 v[176:179], a[192:195], v[84:87], v[176:179]
v_mfma_f32_16x16x32_bf16 v[180:183], a[196:199], v[84:87], v[180:183]
ds_read_b128 a[136:139], v1 offset:640
v_mfma_f32_16x16x32_bf16 v[180:183], a[164:167], v[80:83], v[180:183]
v_mfma_f32_16x16x32_bf16 v[184:187], a[168:171], v[80:83], v[184:187]
ds_read_b128 a[132:135], v1 offset:576
v_mfma_f32_16x16x32_bf16 v[184:187], a[200:203], v[84:87], v[184:187]
s_sub_u32 s34, s34, 1
v_mfma_f32_16x16x32_bf16 v[188:191], a[204:207], v[84:87], v[188:191]
ds_read_b128 a[128:131], v1 offset:512
v_mfma_f32_16x16x32_bf16 v[188:191], a[172:175], v[80:83], v[188:191]
s_cmp_lg_u32 s34, 0
v_exp_f32 v72, v72
v_exp_f32 v73, v73
v_exp_f32 v74, v74
v_exp_f32 v75, v75
v_cvt_pk_bf16_f32 v92, v72, v73
v_cvt_pk_bf16_f32 v93, v74, v75
v_mfma_f32_16x16x32_bf16 a[216:219], a[228:231], v[80:83], a[216:219]
s_waitcnt lgkmcnt(8)
v_mfma_f32_16x16x32_bf16 a[216:219], a[228:231], v[84:87], a[216:219]
s_cbranch_scc1 L_n011
s_branch L_x01
.p2align 6
L_n111:
v_exp_f32 v76, v76
v_mfma_f32_16x16x32_bf16 v[56:59], a[80:83], a[64:67], v[52:55]
v_mfma_f32_16x16x32_bf16 v[56:59], a[84:87], a[68:71], v[56:59]
v_exp_f32 v77, v77
v_mfma_f32_16x16x32_bf16 v[56:59], a[88:91], a[72:75], v[56:59]
v_cvt_pk_bf16_f32 v94, v76, v77
v_mfma_f32_16x16x32_bf16 v[56:59], a[92:95], a[76:79], v[56:59]
v_exp_f32 v78, v78
v_mfma_f32_16x16x32_bf16 v[60:63], a[108:111], a[76:79], v[52:55]
v_mfma_f32_16x16x32_bf16 v[60:63], a[104:107], a[72:75], v[60:63]
s_waitcnt vmcnt(10) lgkmcnt(0)
v_exp_f32 v79, v79
v_mfma_f32_16x16x32_bf16 v[60:63], a[100:103], a[68:71], v[60:63]
v_cvt_pk_bf16_f32 v95, v78, v79
v_mfma_f32_16x16x32_bf16 v[60:63], a[96:99], a[64:67], v[60:63]
s_barrier
s_add_u32 s12, s12, 16384
s_addc_u32 s13, s13, 0
v_mfma_f32_16x16x32_bf16 v[192:195], a[144:147], v[88:91], v[192:195]
ds_read_b64_tr_b16 a[144:145], v2 offset:8448
ds_read_b64_tr_b16 a[146:147], v2 offset:8960
v_mfma_f32_16x16x32_bf16 v[192:195], a[176:179], v[92:95], v[192:195]
v_exp_f32 v56, v56
v_mfma_f32_16x16x32_bf16 v[196:199], a[180:183], v[92:95], v[196:199]
v_mfma_f32_16x16x32_bf16 v[196:199], a[148:151], v[88:91], v[196:199]
ds_read_b64_tr_b16 a[148:149], v2 offset:8480
ds_read_b64_tr_b16 a[150:151], v2 offset:8992
v_mfma_f32_16x16x32_bf16 v[200:203], a[152:155], v[88:91], v[200:203]
v_exp_f32 v57, v57
v_mfma_f32_16x16x32_bf16 v[200:203], a[184:187], v[92:95], v[200:203]
ds_read_b64_tr_b16 a[152:153], v2 offset:8512
v_cvt_pk_bf16_f32 v80, v56, v57
v_mfma_f32_16x16x32_bf16 v[204:207], a[188:191], v[92:95], v[204:207]
ds_read_b64_tr_b16 a[154:155], v2 offset:9024
v_mfma_f32_16x16x32_bf16 v[204:207], a[156:159], v[88:91], v[204:207]
s_add_u32 m0, s33, 0
v_exp_f32 v58, v58
v_mfma_f32_16x16x32_bf16 v[208:211], a[160:163], v[88:91], v[208:211]
buffer_load_dwordx4 v3, s[12:15], 0 offen nt lds
v_mfma_f32_16x16x32_bf16 v[208:211], a[192:195], v[92:95], v[208:211]
ds_read_b64_tr_b16 a[156:157], v2 offset:8544
ds_read_b64_tr_b16 a[158:159], v2 offset:9056
v_mfma_f32_16x16x32_bf16 v[212:215], a[196:199], v[92:95], v[212:215]
v_exp_f32 v59, v59
v_mfma_f32_16x16x32_bf16 v[212:215], a[164:167], v[88:91], v[212:215]
ds_read_b64_tr_b16 a[160:161], v2 offset:8576
v_cvt_pk_bf16_f32 v81, v58, v59
v_mfma_f32_16x16x32_bf16 v[216:219], a[168:171], v[88:91], v[216:219]
ds_read_b64_tr_b16 a[162:163], v2 offset:9088
v_mfma_f32_16x16x32_bf16 v[216:219], a[200:203], v[92:95], v[216:219]
v_exp_f32 v60, v60
v_mfma_f32_16x16x32_bf16 v[220:223], a[204:207], v[92:95], v[220:223]
ds_read_b64_tr_b16 a[164:165], v2 offset:8608
v_mfma_f32_16x16x32_bf16 v[220:223], a[172:175], v[88:91], v[220:223]
ds_read_b64_tr_b16 a[166:167], v2 offset:9120
v_mfma_f32_16x16x32_bf16 a[220:223], a[228:231], v[88:91], a[220:223]
s_add_u32 m0, s33, 32
v_exp_f32 v61, v61
v_mfma_f32_16x16x32_bf16 a[220:223], a[228:231], v[92:95], a[220:223]
ds_read_b64_tr_b16 a[168:169], v2 offset:8640
v_cvt_pk_bf16_f32 v82, v60, v61
v_mfma_f32_16x16x32_bf16 v[64:67], a[80:83], a[0:3], v[36:39]
buffer_load_dwordx4 v3, s[12:15], 0 offen offset:1024 nt lds
v_mfma_f32_16x16x32_bf16 v[64:67], a[84:87], a[4:7], v[64:67]
v_exp_f32 v62, v62
v_mfma_f32_16x16x32_bf16 v[64:67], a[88:91], a[8:11], v[64:67]
ds_read_b64_tr_b16 a[170:171], v2 offset:9152
v_mfma_f32_16x16x32_bf16 v[64:67], a[92:95], a[12:15], v[64:67]
ds_read_b64_tr_b16 a[172:173], v2 offset:8672
v_mfma_f32_16x16x32_bf16 v[68:71], a[108:111], a[12:15], v[36:39]
v_exp_f32 v63, v63
v_mfma_f32_16x16x32_bf16 v[68:71], a[104:107], a[8:11], v[68:71]
ds_read_b64_tr_b16 a[174:175], v2 offset:9184
v_cvt_pk_bf16_f32 v83, v62, v63
v_mfma_f32_16x16x32_bf16 v[68:71], a[100:103], a[4:7], v[68:71]
ds_read_b64_tr_b16 a[176:177], v2
v_mfma_f32_16x16x32_bf16 v[68:71], a[96:99], a[0:3], v[68:71]
ds_read_b64_tr_b16 a[178:179], v2 offset:512
v_mfma_f32_16x16x32_bf16 v[72:75], a[112:115], a[0:3], v[36:39]
s_add_u32 m0, s33, 64
v_mfma_f32_16x16x32_bf16 v[72:75], a[116:119], a[4:7], v[72:75]
buffer_load_dwordx4 v3, s[12:15], 0 offen offset:2048 nt lds
v_mfma_f32_16x16x32_bf16 v[72:75], a[120:123], a[8:11], v[72:75]
v_mfma_f32_16x16x32_bf16 v[72:75], a[124:127], a[12:15], v[72:75]
ds_read_b64_tr_b16 a[180:181], v2 offset:32
v_exp_f32 v64, v64
v_exp_f32 v65, v65
v_exp_f32 v66, v66
v_exp_f32 v67, v67
v_cvt_pk_bf16_f32 v88, v64, v65
v_cvt_pk_bf16_f32 v89, v66, v67
v_mfma_f32_16x16x32_bf16 v[76:79], a[140:143], a[12:15], v[36:39]
v_mfma_f32_16x16x32_bf16 v[76:79], a[136:139], a[8:11], v[76:79]
ds_read_b64_tr_b16 a[182:183], v2 offset:544
v_mfma_f32_16x16x32_bf16 v[76:79], a[132:135], a[4:7], v[76:79]
s_waitcnt lgkmcnt(12)
v_mfma_f32_16x16x32_bf16 v[76:79], a[128:131], a[0:3], v[76:79]
ds_read_b64_tr_b16 a[184:185], v2 offset:64
v_mfma_f32_16x16x32_bf16 v[224:227], a[144:147], v[80:83], v[224:227]
v_exp_f32 v68, v68
v_mfma_f32_16x16x32_bf16 v[228:231], a[148:151], v[80:83], v[228:231]
s_waitcnt lgkmcnt(5)
ds_read_b64_tr_b16 a[186:187], v2 offset:576
v_mfma_f32_16x16x32_bf16 v[232:235], a[152:155], v[80:83], v[232:235]
s_add_u32 m0, s33, 96
v_exp_f32 v69, v69
v_mfma_f32_16x16x32_bf16 v[236:239], a[156:159], v[80:83], v[236:239]
ds_read_b64_tr_b16 a[188:189], v2 offset:96
v_cvt_pk_bf16_f32 v90, v68, v69
v_mfma_f32_16x16x32_bf16 v[240:243], a[160:163], v[80:83], v[240:243]
v_exp_f32 v70, v70
v_mfma_f32_16x16x32_bf16 v[244:247], a[164:167], v[80:83], v[244:247]
buffer_load_dwordx4 v3, s[12:15], 0 offen offset:3072 nt lds
v_mfma_f32_16x16x32_bf16 v[248:251], a[168:171], v[80:83], v[248:251]
v_exp_f32 v71, v71
v_mfma_f32_16x16x32_bf16 v[252:255], a[172:175], v[80:83], v[252:255]
ds_read_b64_tr_b16 a[190:191], v2 offset:608
v_cvt_pk_bf16_f32 v91, v70, v71
v_mfma_f32_16x16x32_bf16 a[224:227], a[228:231], v[80:83], a[224:227]
v_exp_f32 v72, v72
v_mfma_f32_16x16x32_bf16 v[56:59], a[80:83], a[16:19], v[40:43]
ds_read_b64_tr_b16 a[192:193], v2 offset:128
v_mfma_f32_16x16x32_bf16 v[56:59], a[84:87], a[20:23], v[56:59]
v_exp_f32 v73, v73
v_mfma_f32_16x16x32_bf16 v[56:59], a[88:91], a[24:27], v[56:59]
ds_read_b64_tr_b16 a[194:195], v2 offset:640
v_cvt_pk_bf16_f32 v92, v72, v73
v_mfma_f32_16x16x32_bf16 v[56:59], a[92:95], a[28:31], v[56:59]
v_exp_f32 v74, v74
v_mfma_f32_16x16x32_bf16 v[60:63], a[108:111], a[28:31], v[40:43]
ds_read_b64_tr_b16 a[196:197], v2 offset:160
v_mfma_f32_16x16x32_bf16 v[60:63], a[104:107], a[24:27], v[60:63]
v_exp_f32 v75, v75
v_mfma_f32_16x16x32_bf16 v[60:63], a[100:103], a[20:23], v[60:63]
ds_read_b64_tr_b16 a[198:199], v2 offset:672
v_cvt_pk_bf16_f32 v93, v74, v75
v_mfma_f32_16x16x32_bf16 v[60:63], a[96:99], a[16:19], v[60:63]
v_mfma_f32_16x16x32_bf16 v[64:67], a[112:115], a[16:19], v[40:43]
ds_read_b64_tr_b16 a[200:201], v2 offset:192
v_mfma_f32_16x16x32_bf16 v[64:67], a[116:119], a[20:23], v[64:67]
v_mfma_f32_16x16x32_bf16 v[64:67], a[120:123], a[24:27], v[64:67]
ds_read_b64_tr_b16 a[202:203], v2 offset:704
v_mfma_f32_16x16x32_bf16 v[64:67], a[124:127], a[28:31], v[64:67]
v_exp_f32 v76, v76
v_exp_f32 v77, v77
v_exp_f32 v78, v78
v_exp_f32 v79, v79
v_cvt_pk_bf16_f32 v94, v76, v77
v_cvt_pk_bf16_f32 v95, v78, v79
v_mfma_f32_16x16x32_bf16 v[68:71], a[140:143], a[28:31], v[40:43]
ds_read_b64_tr_b16 a[204:205], v2 offset:224
v_mfma_f32_16x16x32_bf16 v[68:71], a[136:139], a[24:27], v[68:71]
v_mfma_f32_16x16x32_bf16 v[68:71], a[132:135], a[20:23], v[68:71]
ds_read_b64_tr_b16 a[206:207], v2 offset:736
v_mfma_f32_16x16x32_bf16 v[68:71], a[128:131], a[16:19], v[68:71]
v_exp_f32 v56, v56
v_mfma_f32_16x16x32_bf16 v[96:99], a[144:147], v[88:91], v[96:99]
s_waitcnt lgkmcnt(8)
v_mfma_f32_16x16x32_bf16 v[96:99], a[176:179], v[92:95], v[96:99]
v_exp_f32 v57, v57
v_mfma_f32_16x16x32_bf16 v[100:103], a[180:183], v[92:95], v[100:103]
v_cvt_pk_bf16_f32 v80, v56, v57
v_mfma_f32_16x16x32_bf16 v[100:103], a[148:151], v[88:91], v[100:103]
v_exp_f32 v58, v58
v_mfma_f32_16x16x32_bf16 v[104:107], a[152:155], v[88:91], v[104:107]
v_mfma_f32_16x16x32_bf16 v[104:107], a[184:187], v[92:95], v[104:107]
v_exp_f32 v59, v59
v_mfma_f32_16x16x32_bf16 v[108:111], a[188:191], v[92:95], v[108:111]
v_cvt_pk_bf16_f32 v81, v58, v59
v_mfma_f32_16x16x32_bf16 v[108:111], a[156:159], v[88:91], v[108:111]
s_waitcnt lgkmcnt(0)
v_exp_f32 v60, v60
v_mfma_f32_16x16x32_bf16 v[112:115], a[160:163], v[88:91], v[112:115]
s_waitcnt lgkmcnt(0)
v_mfma_f32_16x16x32_bf16 v[112:115], a[192:195], v[92:95], v[112:115]
s_barrier
v_exp_f32 v61, v61
v_mfma_f32_16x16x32_bf16 v[116:119], a[196:199], v[92:95], v[116:119]
s_add_u32 s16, s16, 16384
s_addc_u32 s17, s17, 0
v_cvt_pk_bf16_f32 v82, v60, v61
v_mfma_f32_16x16x32_bf16 v[116:119], a[164:167], v[88:91], v[116:119]
v_exp_f32 v62, v62
v_mfma_f32_16x16x32_bf16 v[120:123], a[168:171], v[88:91], v[120:123]
v_mfma_f32_16x16x32_bf16 v[120:123], a[200:203], v[92:95], v[120:123]
s_add_u32 m0, s33, 33792
v_exp_f32 v63, v63
v_mfma_f32_16x16x32_bf16 v[124:127], a[204:207], v[92:95], v[124:127]
v_cvt_pk_bf16_f32 v83, v62, v63
v_mfma_f32_16x16x32_bf16 v[124:127], a[172:175], v[88:91], v[124:127]
v_mfma_f32_16x16x32_bf16 a[208:211], a[228:231], v[88:91], a[208:211]
buffer_load_dwordx4 v3, s[16:19], 0 offen nt lds
v_mfma_f32_16x16x32_bf16 a[208:211], a[228:231], v[92:95], a[208:211]
v_mfma_f32_16x16x32_bf16 v[72:75], a[80:83], a[32:35], v[44:47]
ds_read_b128 v[16:19], v4
v_mfma_f32_16x16x32_bf16 v[72:75], a[84:87], a[36:39], v[72:75]
s_add_u32 m0, s33, 33824
v_mfma_f32_16x16x32_bf16 v[72:75], a[88:91], a[40:43], v[72:75]
buffer_load_dwordx4 v3, s[16:19], 0 offen offset:1024 nt lds
v_mfma_f32_16x16x32_bf16 v[72:75], a[92:95], a[44:47], v[72:75]
v_exp_f32 v64, v64
v_exp_f32 v65, v65
v_exp_f32 v66, v66
v_exp_f32 v67, v67
v_cvt_pk_bf16_f32 v84, v64, v65
v_cvt_pk_bf16_f32 v85, v66, v67
v_mfma_f32_16x16x32_bf16 v[76:79], a[108:111], a[44:47], v[44:47]
v_mfma_f32_16x16x32_bf16 v[76:79], a[104:107], a[40:43], v[76:79]
s_add_u32 m0, s33, 33856
v_exp_f32 v68, v68
v_mfma_f32_16x16x32_bf16 v[76:79], a[100:103], a[36:39], v[76:79]
buffer_load_dwordx4 v3, s[16:19], 0 offen offset:2048 nt lds
v_mfma_f32_16x16x32_bf16 v[76:79], a[96:99], a[32:35], v[76:79]
v_exp_f32 v69, v69
v_mfma_f32_16x16x32_bf16 v[56:59], a[112:115], a[32:35], v[44:47]
v_cvt_pk_bf16_f32 v86, v68, v69
v_mfma_f32_16x16x32_bf16 v[56:59], a[116:119], a[36:39], v[56:59]
v_exp_f32 v70, v70
v_mfma_f32_16x16x32_bf16 v[56:59], a[120:123], a[40:43], v[56:59]
v_mfma_f32_16x16x32_bf16 v[56:59], a[124:127], a[44:47], v[56:59]
s_add_u32 m0, s33, 33888
v_exp_f32 v71, v71
v_mfma_f32_16x16x32_bf16 v[60:63], a[140:143], a[44:47], v[44:47]
v_exp_f32 v72, v72
v_mfma_f32_16x16x32_bf16 v[60:63], a[136:139], a[40:43], v[60:63]
v_cvt_pk_bf16_f32 v87, v70, v71
v_mfma_f32_16x16x32_bf16 v[60:63], a[132:135], a[36:39], v[60:63]
v_exp_f32 v73, v73
v_mfma_f32_16x16x32_bf16 v[60:63], a[128:131], a[32:35], v[60:63]
v_cvt_pk_bf16_f32 v88, v72, v73
v_mfma_f32_16x16x32_bf16 v[128:131], a[144:147], v[80:83], v[128:131]
v_exp_f32 v74, v74
v_mfma_f32_16x16x32_bf16 v[128:131], a[176:179], v[84:87], v[128:131]
buffer_load_dwordx4 v3, s[16:19], 0 offen offset:3072 nt lds
v_mfma_f32_16x16x32_bf16 v[132:135], a[180:183], v[84:87], v[132:135]
v_exp_f32 v75, v75
v_mfma_f32_16x16x32_bf16 v[132:135], a[148:151], v[80:83], v[132:135]
v_cvt_pk_bf16_f32 v89, v74, v75
v_mfma_f32_16x16x32_bf16 v[136:139], a[152:155], v[80:83], v[136:139]
v_mfma_f32_16x16x32_bf16 v[136:139], a[184:187], v[84:87], v[136:139]
v_mfma_f32_16x16x32_bf16 v[140:143], a[188:191], v[84:87], v[140:143]
v_mfma_f32_16x16x32_bf16 v[140:143], a[156:159], v[80:83], v[140:143]
v_mfma_f32_16x16x32_bf16 v[144:147], a[160:163], v[80:83], v[144:147]
v_mfma_f32_16x16x32_bf16 v[144:147], a[192:195], v[84:87], v[144:147]
v_exp_f32 v76, v76
v_exp_f32 v77, v77
v_exp_f32 v78, v78
v_exp_f32 v79, v79
v_cvt_pk_bf16_f32 v90, v76, v77
v_cvt_pk_bf16_f32 v91, v78, v79
v_mfma_f32_16x16x32_bf16 v[148:151], a[196:199], v[84:87], v[148:151]
v_mfma_f32_16x16x32_bf16 v[148:151], a[164:167], v[80:83], v[148:151]
v_mfma_f32_16x16x32_bf16 v[152:155], a[168:171], v[80:83], v[152:155]
s_waitcnt lgkmcnt(0)
v_exp_f32 v56, v56
v_mfma_f32_16x16x32_bf16 v[152:155], a[200:203], v[84:87], v[152:155]
buffer_store_dwordx4 v[16:19], v3, s[28:31], s36 offen sc0 sc1
v_mfma_f32_16x16x32_bf16 v[156:159], a[204:207], v[84:87], v[156:159]
s_waitcnt vmcnt(14) lgkmcnt(1)
v_exp_f32 v57, v57
v_mfma_f32_16x16x32_bf16 v[156:159], a[172:175], v[80:83], v[156:159]
v_cvt_pk_bf16_f32 v92, v56, v57
v_mfma_f32_16x16x32_bf16 a[212:215], a[228:231], v[80:83], a[212:215]
s_barrier
v_exp_f32 v58, v58
v_mfma_f32_16x16x32_bf16 a[212:215], a[228:231], v[84:87], a[212:215]
v_mfma_f32_16x16x32_bf16 v[64:67], a[80:83], a[48:51], v[48:51]
v_exp_f32 v59, v59
v_mfma_f32_16x16x32_bf16 v[64:67], a[84:87], a[52:55], v[64:67]
ds_read_b128 a[80:83], v1 offset:25344
v_cvt_pk_bf16_f32 v93, v58, v59
v_mfma_f32_16x16x32_bf16 v[64:67], a[88:91], a[56:59], v[64:67]
v_exp_f32 v60, v60
v_mfma_f32_16x16x32_bf16 v[64:67], a[92:95], a[60:63], v[64:67]
ds_read_b128 a[84:87], v1 offset:25408
ds_read_b128 a[88:91], v1 offset:25472
v_mfma_f32_16x16x32_bf16 v[68:71], a[108:111], a[60:63], v[48:51]
v_exp_f32 v61, v61
v_mfma_f32_16x16x32_bf16 v[68:71], a[104:107], a[56:59], v[68:71]
ds_read_b128 a[92:95], v1 offset:25536
v_cvt_pk_bf16_f32 v94, v60, v61
v_mfma_f32_16x16x32_bf16 v[68:71], a[100:103], a[52:55], v[68:71]
v_exp_f32 v62, v62
v_mfma_f32_16x16x32_bf16 v[68:71], a[96:99], a[48:51], v[68:71]
ds_read_b128 a[108:111], v1 offset:26048
v_mfma_f32_16x16x32_bf16 v[72:75], a[112:115], a[48:51], v[48:51]
v_exp_f32 v63, v63
v_mfma_f32_16x16x32_bf16 v[72:75], a[116:119], a[52:55], v[72:75]
v_mfma_f32_16x16x32_bf16 v[72:75], a[120:123], a[56:59], v[72:75]
ds_read_b128 a[104:107], v1 offset:25984
v_cvt_pk_bf16_f32 v95, v62, v63
v_mfma_f32_16x16x32_bf16 v[72:75], a[124:127], a[60:63], v[72:75]
v_mfma_f32_16x16x32_bf16 v[76:79], a[140:143], a[60:63], v[48:51]
ds_read_b128 a[100:103], v1 offset:25920
v_mfma_f32_16x16x32_bf16 v[76:79], a[136:139], a[56:59], v[76:79]
v_mfma_f32_16x16x32_bf16 v[76:79], a[132:135], a[52:55], v[76:79]
ds_read_b128 a[96:99], v1 offset:25856
v_mfma_f32_16x16x32_bf16 v[76:79], a[128:131], a[48:51], v[76:79]
v_exp_f32 v64, v64
v_exp_f32 v65, v65
v_exp_f32 v66, v66
v_exp_f32 v67, v67
v_cvt_pk_bf16_f32 v80, v64, v65
v_cvt_pk_bf16_f32 v81, v66, v67
v_mfma_f32_16x16x32_bf16 v[160:163], a[144:147], v[88:91], v[160:163]
ds_read_b128 a[112:115], v1 offset:16896
v_mfma_f32_16x16x32_bf16 v[160:163], a[176:179], v[92:95], v[160:163]
v_exp_f32 v68, v68
v_mfma_f32_16x16x32_bf16 v[164:167], a[180:183], v[92:95], v[164:167]
ds_read_b128 a[116:119], v1 offset:16960
v_mfma_f32_16x16x32_bf16 v[164:167], a[148:151], v[88:91], v[164:167]
v_exp_f32 v69, v69
v_mfma_f32_16x16x32_bf16 v[168:171], a[152:155], v[88:91], v[168:171]
ds_read_b128 a[120:123], v1 offset:17024
v_cvt_pk_bf16_f32 v82, v68, v69
v_mfma_f32_16x16x32_bf16 v[168:171], a[184:187], v[92:95], v[168:171]
v_exp_f32 v70, v70
v_mfma_f32_16x16x32_bf16 v[172:175], a[188:191], v[92:95], v[172:175]
ds_read_b128 a[124:127], v1 offset:17088
v_mfma_f32_16x16x32_bf16 v[172:175], a[156:159], v[88:91], v[172:175]
v_exp_f32 v71, v71
v_mfma_f32_16x16x32_bf16 v[176:179], a[160:163], v[88:91], v[176:179]
ds_read_b128 a[140:143], v1 offset:17600
v_cvt_pk_bf16_f32 v83, v70, v71
v_mfma_f32_16x16x32_bf16 v[176:179], a[192:195], v[92:95], v[176:179]
v_exp_f32 v72, v72
v_mfma_f32_16x16x32_bf16 v[180:183], a[196:199], v[92:95], v[180:183]
ds_read_b128 a[136:139], v1 offset:17536
v_mfma_f32_16x16x32_bf16 v[180:183], a[164:167], v[88:91], v[180:183]
v_exp_f32 v73, v73
v_mfma_f32_16x16x32_bf16 v[184:187], a[168:171], v[88:91], v[184:187]
ds_read_b128 a[132:135], v1 offset:17472
v_cvt_pk_bf16_f32 v84, v72, v73
v_mfma_f32_16x16x32_bf16 v[184:187], a[200:203], v[92:95], v[184:187]
v_exp_f32 v74, v74
v_mfma_f32_16x16x32_bf16 v[188:191], a[204:207], v[92:95], v[188:191]
ds_read_b128 a[128:131], v1 offset:17408
v_mfma_f32_16x16x32_bf16 v[188:191], a[172:175], v[88:91], v[188:191]
v_exp_f32 v75, v75
v_mfma_f32_16x16x32_bf16 a[216:219], a[228:231], v[88:91], a[216:219]
s_waitcnt lgkmcnt(8)
v_cvt_pk_bf16_f32 v85, v74, v75
v_mfma_f32_16x16x32_bf16 a[216:219], a[228:231], v[92:95], a[216:219]
v_mfma_f32_16x16x32_bf16 v[56:59], a[80:83], a[64:67], v[52:55]
v_mfma_f32_16x16x32_bf16 v[56:59], a[84:87], a[68:71], v[56:59]
v_mfma_f32_16x16x32_bf16 v[56:59], a[88:91], a[72:75], v[56:59]
v_mfma_f32_16x16x32_bf16 v[56:59], a[92:95], a[76:79], v[56:59]
v_exp_f32 v76, v76
v_exp_f32 v77, v77
v_exp_f32 v78, v78
v_exp_f32 v79, v79
v_cvt_pk_bf16_f32 v86, v76, v77
v_cvt_pk_bf16_f32 v87, v78, v79
v_mfma_f32_16x16x32_bf16 v[60:63], a[108:111], a[76:79], v[52:55]
v_mfma_f32_16x16x32_bf16 v[60:63], a[104:107], a[72:75], v[60:63]
s_waitcnt vmcnt(10) lgkmcnt(0)
v_mfma_f32_16x16x32_bf16 v[60:63], a[100:103], a[68:71], v[60:63]
v_mfma_f32_16x16x32_bf16 v[60:63], a[96:99], a[64:67], v[60:63]
s_barrier
s_add_u32 s12, s12, 16384
s_addc_u32 s13, s13, 0
v_mfma_f32_16x16x32_bf16 v[192:195], a[144:147], v[80:83], v[192:195]
ds_read_b64_tr_b16 a[144:145], v2 offset:25344
ds_read_b64_tr_b16 a[146:147], v2 offset:25856
v_mfma_f32_16x16x32_bf16 v[192:195], a[176:179], v[84:87], v[192:195]
v_exp_f32 v56, v56
v_mfma_f32_16x16x32_bf16 v[196:199], a[180:183], v[84:87], v[196:199]
v_mfma_f32_16x16x32_bf16 v[196:199], a[148:151], v[80:83], v[196:199]
ds_read_b64_tr_b16 a[148:149], v2 offset:25376
ds_read_b64_tr_b16 a[150:151], v2 offset:25888
v_mfma_f32_16x16x32_bf16 v[200:203], a[152:155], v[80:83], v[200:203]
v_exp_f32 v57, v57
v_mfma_f32_16x16x32_bf16 v[200:203], a[184:187], v[84:87], v[200:203]
ds_read_b64_tr_b16 a[152:153], v2 offset:25408
v_cvt_pk_bf16_f32 v88, v56, v57
v_mfma_f32_16x16x32_bf16 v[204:207], a[188:191], v[84:87], v[204:207]
ds_read_b64_tr_b16 a[154:155], v2 offset:25920
v_mfma_f32_16x16x32_bf16 v[204:207], a[156:159], v[80:83], v[204:207]
s_add_u32 m0, s33, 16896
v_exp_f32 v58, v58
v_mfma_f32_16x16x32_bf16 v[208:211], a[160:163], v[80:83], v[208:211]
buffer_load_dwordx4 v3, s[12:15], 0 offen nt lds
v_mfma_f32_16x16x32_bf16 v[208:211], a[192:195], v[84:87], v[208:211]
ds_read_b64_tr_b16 a[156:157], v2 offset:25440
ds_read_b64_tr_b16 a[158:159], v2 offset:25952
v_mfma_f32_16x16x32_bf16 v[212:215], a[196:199], v[84:87], v[212:215]
v_exp_f32 v59, v59
v_mfma_f32_16x16x32_bf16 v[212:215], a[164:167], v[80:83], v[212:215]
ds_read_b64_tr_b16 a[160:161], v2 offset:25472
v_cvt_pk_bf16_f32 v89, v58, v59
v_mfma_f32_16x16x32_bf16 v[216:219], a[168:171], v[80:83], v[216:219]
ds_read_b64_tr_b16 a[162:163], v2 offset:25984
v_mfma_f32_16x16x32_bf16 v[216:219], a[200:203], v[84:87], v[216:219]
v_exp_f32 v60, v60
v_mfma_f32_16x16x32_bf16 v[220:223], a[204:207], v[84:87], v[220:223]
ds_read_b64_tr_b16 a[164:165], v2 offset:25504
v_mfma_f32_16x16x32_bf16 v[220:223], a[172:175], v[80:83], v[220:223]
ds_read_b64_tr_b16 a[166:167], v2 offset:26016
v_mfma_f32_16x16x32_bf16 a[220:223], a[228:231], v[80:83], a[220:223]
s_add_u32 m0, s33, 16928
v_exp_f32 v61, v61
v_mfma_f32_16x16x32_bf16 a[220:223], a[228:231], v[84:87], a[220:223]
ds_read_b64_tr_b16 a[168:169], v2 offset:25536
v_cvt_pk_bf16_f32 v90, v60, v61
v_mfma_f32_16x16x32_bf16 v[64:67], a[80:83], a[0:3], v[36:39]
buffer_load_dwordx4 v3, s[12:15], 0 offen offset:1024 nt lds
v_mfma_f32_16x16x32_bf16 v[64:67], a[84:87], a[4:7], v[64:67]
v_exp_f32 v62, v62
v_mfma_f32_16x16x32_bf16 v[64:67], a[88:91], a[8:11], v[64:67]
ds_read_b64_tr_b16 a[170:171], v2 offset:26048
v_mfma_f32_16x16x32_bf16 v[64:67], a[92:95], a[12:15], v[64:67]
ds_read_b64_tr_b16 a[172:173], v2 offset:25568
v_mfma_f32_16x16x32_bf16 v[68:71], a[108:111], a[12:15], v[36:39]
v_exp_f32 v63, v63
v_mfma_f32_16x16x32_bf16 v[68:71], a[104:107], a[8:11], v[68:71]
ds_read_b64_tr_b16 a[174:175], v2 offset:26080
v_cvt_pk_bf16_f32 v91, v62, v63
v_mfma_f32_16x16x32_bf16 v[68:71], a[100:103], a[4:7], v[68:71]
ds_read_b64_tr_b16 a[176:177], v2 offset:16896
v_mfma_f32_16x16x32_bf16 v[68:71], a[96:99], a[0:3], v[68:71]
ds_read_b64_tr_b16 a[178:179], v2 offset:17408
v_mfma_f32_16x16x32_bf16 v[72:75], a[112:115], a[0:3], v[36:39]
s_add_u32 m0, s33, 16960
v_mfma_f32_16x16x32_bf16 v[72:75], a[116:119], a[4:7], v[72:75]
buffer_load_dwordx4 v3, s[12:15], 0 offen offset:2048 nt lds
v_mfma_f32_16x16x32_bf16 v[72:75], a[120:123], a[8:11], v[72:75]
v_mfma_f32_16x16x32_bf16 v[72:75], a[124:127], a[12:15], v[72:75]
ds_read_b64_tr_b16 a[180:181], v2 offset:16928
v_exp_f32 v64, v64
v_exp_f32 v65, v65
v_exp_f32 v66, v66
v_exp_f32 v67, v67
v_cvt_pk_bf16_f32 v80, v64, v65
v_cvt_pk_bf16_f32 v81, v66, v67
v_mfma_f32_16x16x32_bf16 v[76:79], a[140:143], a[12:15], v[36:39]
v_mfma_f32_16x16x32_bf16 v[76:79], a[136:139], a[8:11], v[76:79]
ds_read_b64_tr_b16 a[182:183], v2 offset:17440
v_mfma_f32_16x16x32_bf16 v[76:79], a[132:135], a[4:7], v[76:79]
s_waitcnt lgkmcnt(12)
v_mfma_f32_16x16x32_bf16 v[76:79], a[128:131], a[0:3], v[76:79]
ds_read_b64_tr_b16 a[184:185], v2 offset:16960
v_mfma_f32_16x16x32_bf16 v[224:227], a[144:147], v[88:91], v[224:227]
v_exp_f32 v68, v68
v_mfma_f32_16x16x32_bf16 v[228:231], a[148:151], v[88:91], v[228:231]
s_waitcnt lgkmcnt(5)
ds_read_b64_tr_b16 a[186:187], v2 offset:17472
v_mfma_f32_16x16x32_bf16 v[232:235], a[152:155], v[88:91], v[232:235]
s_add_u32 m0, s33, 16992
v_exp_f32 v69, v69
v_mfma_f32_16x16x32_bf16 v[236:239], a[156:159], v[88:91], v[236:239]
ds_read_b64_tr_b16 a[188:189], v2 offset:16992
v_cvt_pk_bf16_f32 v82, v68, v69
v_mfma_f32_16x16x32_bf16 v[240:243], a[160:163], v[88:91], v[240:243]
v_exp_f32 v70, v70
v_mfma_f32_16x16x32_bf16 v[244:247], a[164:167], v[88:91], v[244:247]
buffer_load_dwordx4 v3, s[12:15], 0 offen offset:3072 nt lds
v_mfma_f32_16x16x32_bf16 v[248:251], a[168:171], v[88:91], v[248:251]
v_exp_f32 v71, v71
v_mfma_f32_16x16x32_bf16 v[252:255], a[172:175], v[88:91], v[252:255]
ds_read_b64_tr_b16 a[190:191], v2 offset:17504
v_cvt_pk_bf16_f32 v83, v70, v71
v_mfma_f32_16x16x32_bf16 a[224:227], a[228:231], v[88:91], a[224:227]
v_exp_f32 v72, v72
v_mfma_f32_16x16x32_bf16 v[56:59], a[80:83], a[16:19], v[40:43]
ds_read_b64_tr_b16 a[192:193], v2 offset:17024
v_mfma_f32_16x16x32_bf16 v[56:59], a[84:87], a[20:23], v[56:59]
v_exp_f32 v73, v73
v_mfma_f32_16x16x32_bf16 v[56:59], a[88:91], a[24:27], v[56:59]
ds_read_b64_tr_b16 a[194:195], v2 offset:17536
v_cvt_pk_bf16_f32 v84, v72, v73
v_mfma_f32_16x16x32_bf16 v[56:59], a[92:95], a[28:31], v[56:59]
v_exp_f32 v74, v74
v_mfma_f32_16x16x32_bf16 v[60:63], a[108:111], a[28:31], v[40:43]
ds_read_b64_tr_b16 a[196:197], v2 offset:17056
v_mfma_f32_16x16x32_bf16 v[60:63], a[104:107], a[24:27], v[60:63]
v_exp_f32 v75, v75
v_mfma_f32_16x16x32_bf16 v[60:63], a[100:103], a[20:23], v[60:63]
ds_read_b64_tr_b16 a[198:199], v2 offset:17568
v_cvt_pk_bf16_f32 v85, v74, v75
v_mfma_f32_16x16x32_bf16 v[60:63], a[96:99], a[16:19], v[60:63]
v_mfma_f32_16x16x32_bf16 v[64:67], a[112:115], a[16:19], v[40:43]
ds_read_b64_tr_b16 a[200:201], v2 offset:17088
v_mfma_f32_16x16x32_bf16 v[64:67], a[116:119], a[20:23], v[64:67]
v_mfma_f32_16x16x32_bf16 v[64:67], a[120:123], a[24:27], v[64:67]
ds_read_b64_tr_b16 a[202:203], v2 offset:17600
v_mfma_f32_16x16x32_bf16 v[64:67], a[124:127], a[28:31], v[64:67]
v_exp_f32 v76, v76
v_exp_f32 v77, v77
v_exp_f32 v78, v78
v_exp_f32 v79, v79
v_cvt_pk_bf16_f32 v86, v76, v77
v_cvt_pk_bf16_f32 v87, v78, v79
v_mfma_f32_16x16x32_bf16 v[68:71], a[140:143], a[28:31], v[40:43]
ds_read_b64_tr_b16 a[204:205], v2 offset:17120
v_mfma_f32_16x16x32_bf16 v[68:71], a[136:139], a[24:27], v[68:71]
v_mfma_f32_16x16x32_bf16 v[68:71], a[132:135], a[20:23], v[68:71]
ds_read_b64_tr_b16 a[206:207], v2 offset:17632
v_mfma_f32_16x16x32_bf16 v[68:71], a[128:131], a[16:19], v[68:71]
v_exp_f32 v56, v56
v_mfma_f32_16x16x32_bf16 v[96:99], a[144:147], v[80:83], v[96:99]
s_waitcnt lgkmcnt(8)
v_mfma_f32_16x16x32_bf16 v[96:99], a[176:179], v[84:87], v[96:99]
v_exp_f32 v57, v57
v_mfma_f32_16x16x32_bf16 v[100:103], a[180:183], v[84:87], v[100:103]
v_cvt_pk_bf16_f32 v88, v56, v57
v_mfma_f32_16x16x32_bf16 v[100:103], a[148:151], v[80:83], v[100:103]
v_exp_f32 v58, v58
v_mfma_f32_16x16x32_bf16 v[104:107], a[152:155], v[80:83], v[104:107]
v_mfma_f32_16x16x32_bf16 v[104:107], a[184:187], v[84:87], v[104:107]
v_exp_f32 v59, v59
v_mfma_f32_16x16x32_bf16 v[108:111], a[188:191], v[84:87], v[108:111]
v_cvt_pk_bf16_f32 v89, v58, v59
v_mfma_f32_16x16x32_bf16 v[108:111], a[156:159], v[80:83], v[108:111]
s_waitcnt lgkmcnt(0)
v_exp_f32 v60, v60
v_mfma_f32_16x16x32_bf16 v[112:115], a[160:163], v[80:83], v[112:115]
s_waitcnt lgkmcnt(0)
v_mfma_f32_16x16x32_bf16 v[112:115], a[192:195], v[84:87], v[112:115]
s_barrier
v_exp_f32 v61, v61
v_mfma_f32_16x16x32_bf16 v[116:119], a[196:199], v[84:87], v[116:119]
s_add_u32 s16, s16, 16384
s_addc_u32 s17, s17, 0
v_cvt_pk_bf16_f32 v90, v60, v61
v_mfma_f32_16x16x32_bf16 v[116:119], a[164:167], v[80:83], v[116:119]
v_exp_f32 v62, v62
v_mfma_f32_16x16x32_bf16 v[120:123], a[168:171], v[80:83], v[120:123]
v_mfma_f32_16x16x32_bf16 v[120:123], a[200:203], v[84:87], v[120:123]
s_add_u32 m0, s33, 50688
v_exp_f32 v63, v63
v_mfma_f32_16x16x32_bf16 v[124:127], a[204:207], v[84:87], v[124:127]
v_cvt_pk_bf16_f32 v91, v62, v63
v_mfma_f32_16x16x32_bf16 v[124:127], a[172:175], v[80:83], v[124:127]
v_mfma_f32_16x16x32_bf16 a[208:211], a[228:231], v[80:83], a[208:211]
buffer_load_dwordx4 v3, s[16:19], 0 offen nt lds
v_mfma_f32_16x16x32_bf16 a[208:211], a[228:231], v[84:87], a[208:211]
v_mfma_f32_16x16x32_bf16 v[72:75], a[80:83], a[32:35], v[44:47]
ds_read_b128 v[20:23], v4 offset:1056
v_mfma_f32_16x16x32_bf16 v[72:75], a[84:87], a[36:39], v[72:75]
s_add_u32 m0, s33, 50720
v_mfma_f32_16x16x32_bf16 v[72:75], a[88:91], a[40:43], v[72:75]
buffer_load_dwordx4 v3, s[16:19], 0 offen offset:1024 nt lds
v_mfma_f32_16x16x32_bf16 v[72:75], a[92:95], a[44:47], v[72:75]
v_exp_f32 v64, v64
v_exp_f32 v65, v65
v_exp_f32 v66, v66
v_exp_f32 v67, v67
v_cvt_pk_bf16_f32 v92, v64, v65
v_cvt_pk_bf16_f32 v93, v66, v67
v_mfma_f32_16x16x32_bf16 v[76:79], a[108:111], a[44:47], v[44:47]
v_add_u32 v4, 2112, v4
v_mfma_f32_16x16x32_bf16 v[76:79], a[104:107], a[40:43], v[76:79]
s_add_u32 m0, s33, 50752
v_exp_f32 v68, v68
v_mfma_f32_16x16x32_bf16 v[76:79], a[100:103], a[36:39], v[76:79]
buffer_load_dwordx4 v3, s[16:19], 0 offen offset:2048 nt lds
v_mfma_f32_16x16x32_bf16 v[76:79], a[96:99], a[32:35], v[76:79]
v_exp_f32 v69, v69
v_mfma_f32_16x16x32_bf16 v[56:59], a[112:115], a[32:35], v[44:47]
v_cvt_pk_bf16_f32 v94, v68, v69
v_mfma_f32_16x16x32_bf16 v[56:59], a[116:119], a[36:39], v[56:59]
v_exp_f32 v70, v70
v_mfma_f32_16x16x32_bf16 v[56:59], a[120:123], a[40:43], v[56:59]
v_mfma_f32_16x16x32_bf16 v[56:59], a[124:127], a[44:47], v[56:59]
s_add_u32 m0, s33, 50784
v_exp_f32 v71, v71
v_mfma_f32_16x16x32_bf16 v[60:63], a[140:143], a[44:47], v[44:47]
v_exp_f32 v72, v72
v_mfma_f32_16x16x32_bf16 v[60:63], a[136:139], a[40:43], v[60:63]
v_cvt_pk_bf16_f32 v95, v70, v71
v_mfma_f32_16x16x32_bf16 v[60:63], a[132:135], a[36:39], v[60:63]
v_exp_f32 v73, v73
v_mfma_f32_16x16x32_bf16 v[60:63], a[128:131], a[32:35], v[60:63]
v_cvt_pk_bf16_f32 v80, v72, v73
v_mfma_f32_16x16x32_bf16 v[128:131], a[144:147], v[88:91], v[128:131]
v_exp_f32 v74, v74
v_mfma_f32_16x16x32_bf16 v[128:131], a[176:179], v[92:95], v[128:131]
buffer_load_dwordx4 v3, s[16:19], 0 offen offset:3072 nt lds
v_mfma_f32_16x16x32_bf16 v[132:135], a[180:183], v[92:95], v[132:135]
v_exp_f32 v75, v75
v_mfma_f32_16x16x32_bf16 v[132:135], a[148:151], v[88:91], v[132:135]
v_cvt_pk_bf16_f32 v81, v74, v75
v_mfma_f32_16x16x32_bf16 v[136:139], a[152:155], v[88:91], v[136:139]
v_mfma_f32_16x16x32_bf16 v[136:139], a[184:187], v[92:95], v[136:139]
v_mfma_f32_16x16x32_bf16 v[140:143], a[188:191], v[92:95], v[140:143]
v_mfma_f32_16x16x32_bf16 v[140:143], a[156:159], v[88:91], v[140:143]
v_mfma_f32_16x16x32_bf16 v[144:147], a[160:163], v[88:91], v[144:147]
v_mfma_f32_16x16x32_bf16 v[144:147], a[192:195], v[92:95], v[144:147]
v_exp_f32 v76, v76
v_exp_f32 v77, v77
v_exp_f32 v78, v78
v_exp_f32 v79, v79
v_cvt_pk_bf16_f32 v82, v76, v77
v_cvt_pk_bf16_f32 v83, v78, v79
v_mfma_f32_16x16x32_bf16 v[148:151], a[196:199], v[92:95], v[148:151]
v_mfma_f32_16x16x32_bf16 v[148:151], a[164:167], v[88:91], v[148:151]
v_mfma_f32_16x16x32_bf16 v[152:155], a[168:171], v[88:91], v[152:155]
s_waitcnt lgkmcnt(0)
v_exp_f32 v56, v56
v_mfma_f32_16x16x32_bf16 v[152:155], a[200:203], v[92:95], v[152:155]
buffer_store_dwordx4 v[20:23], v3, s[28:31], s36 offen offset:1024 sc0 sc1
v_mfma_f32_16x16x32_bf16 v[156:159], a[204:207], v[92:95], v[156:159]
s_waitcnt vmcnt(14) lgkmcnt(1)
v_exp_f32 v57, v57
v_mfma_f32_16x16x32_bf16 v[156:159], a[172:175], v[88:91], v[156:159]
v_cvt_pk_bf16_f32 v84, v56, v57
v_mfma_f32_16x16x32_bf16 a[212:215], a[228:231], v[88:91], a[212:215]
s_barrier
v_exp_f32 v58, v58
v_mfma_f32_16x16x32_bf16 a[212:215], a[228:231], v[92:95], a[212:215]
v_mfma_f32_16x16x32_bf16 v[64:67], a[80:83], a[48:51], v[48:51]
s_add_u32 s36, s36, 2048
v_exp_f32 v59, v59
v_mfma_f32_16x16x32_bf16 v[64:67], a[84:87], a[52:55], v[64:67]
ds_read_b128 a[80:83], v1 offset:8448
v_cvt_pk_bf16_f32 v85, v58, v59
v_mfma_f32_16x16x32_bf16 v[64:67], a[88:91], a[56:59], v[64:67]
v_exp_f32 v60, v60
v_mfma_f32_16x16x32_bf16 v[64:67], a[92:95], a[60:63], v[64:67]
ds_read_b128 a[84:87], v1 offset:8512
ds_read_b128 a[88:91], v1 offset:8576
v_mfma_f32_16x16x32_bf16 v[68:71], a[108:111], a[60:63], v[48:51]
v_exp_f32 v61, v61
v_mfma_f32_16x16x32_bf16 v[68:71], a[104:107], a[56:59], v[68:71]
ds_read_b128 a[92:95], v1 offset:8640
v_cvt_pk_bf16_f32 v86, v60, v61
v_mfma_f32_16x16x32_bf16 v[68:71], a[100:103], a[52:55], v[68:71]
v_exp_f32 v62, v62
v_mfma_f32_16x16x32_bf16 v[68:71], a[96:99], a[48:51], v[68:71]
ds_read_b128 a[108:111], v1 offset:9152
v_mfma_f32_16x16x32_bf16 v[72:75], a[112:115], a[48:51], v[48:51]
v_exp_f32 v63, v63
v_mfma_f32_16x16x32_bf16 v[72:75], a[116:119], a[52:55], v[72:75]
v_mfma_f32_16x16x32_bf16 v[72:75], a[120:123], a[56:59], v[72:75]
ds_read_b128 a[104:107], v1 offset:9088
v_cvt_pk_bf16_f32 v87, v62, v63
v_mfma_f32_16x16x32_bf16 v[72:75], a[124:127], a[60:63], v[72:75]
v_mfma_f32_16x16x32_bf16 v[76:79], a[140:143], a[60:63], v[48:51]
ds_read_b128 a[100:103], v1 offset:9024
v_mfma_f32_16x16x32_bf16 v[76:79], a[136:139], a[56:59], v[76:79]
v_mfma_f32_16x16x32_bf16 v[76:79], a[132:135], a[52:55], v[76:79]
ds_read_b128 a[96:99], v1 offset:8960
v_mfma_f32_16x16x32_bf16 v[76:79], a[128:131], a[48:51], v[76:79]
v_exp_f32 v64, v64
v_exp_f32 v65, v65
v_exp_f32 v66, v66
v_exp_f32 v67, v67
v_cvt_pk_bf16_f32 v88, v64, v65
v_cvt_pk_bf16_f32 v89, v66, v67
v_mfma_f32_16x16x32_bf16 v[160:163], a[144:147], v[80:83], v[160:163]
ds_read_b128 a[112:115], v1
v_mfma_f32_16x16x32_bf16 v[160:163], a[176:179], v[84:87], v[160:163]
v_exp_f32 v68, v68
v_mfma_f32_16x16x32_bf16 v[164:167], a[180:183], v[84:87], v[164:167]
ds_read_b128 a[116:119], v1 offset:64
v_mfma_f32_16x16x32_bf16 v[164:167], a[148:151], v[80:83], v[164:167]
v_exp_f32 v69, v69
v_mfma_f32_16x16x32_bf16 v[168:171], a[152:155], v[80:83], v[168:171]
ds_read_b128 a[120:123], v1 offset:128
v_cvt_pk_bf16_f32 v90, v68, v69
v_mfma_f32_16x16x32_bf16 v[168:171], a[184:187], v[84:87], v[168:171]
v_exp_f32 v70, v70
v_mfma_f32_16x16x32_bf16 v[172:175], a[188:191], v[84:87], v[172:175]
ds_read_b128 a[124:127], v1 offset:192
v_mfma_f32_16x16x32_bf16 v[172:175], a[156:159], v[80:83], v[172:175]
v_exp_f32 v71, v71
v_mfma_f32_16x16x32_bf16 v[176:179], a[160:163], v[80:83], v[176:179]
ds_read_b128 a[140:143], v1 offset:704
v_cvt_pk_bf16_f32 v91, v70, v71
v_mfma_f32_16x16x32_bf16 v[176:179], a[192:195], v[84:87], v[176:179]
v_exp_f32 v72, v72
v_mfma_f32_16x16x32_bf16 v[180:183], a[196:199], v[84:87], v[180:183]
ds_read_b128 a[136:139], v1 offset:640
v_mfma_f32_16x16x32_bf16 v[180:183], a[164:167], v[80:83], v[180:183]
v_exp_f32 v73, v73
v_mfma_f32_16x16x32_bf16 v[184:187], a[168:171], v[80:83], v[184:187]
ds_read_b128 a[132:135], v1 offset:576
v_cvt_pk_bf16_f32 v92, v72, v73
v_mfma_f32_16x16x32_bf16 v[184:187], a[200:203], v[84:87], v[184:187]
s_sub_u32 s34, s34, 1
v_exp_f32 v74, v74
v_mfma_f32_16x16x32_bf16 v[188:191], a[204:207], v[84:87], v[188:191]
ds_read_b128 a[128:131], v1 offset:512
v_mfma_f32_16x16x32_bf16 v[188:191], a[172:175], v[80:83], v[188:191]
s_cmp_lg_u32 s34, 0
v_exp_f32 v75, v75
v_mfma_f32_16x16x32_bf16 a[216:219], a[228:231], v[80:83], a[216:219]
s_waitcnt lgkmcnt(8)
v_cvt_pk_bf16_f32 v93, v74, v75
v_mfma_f32_16x16x32_bf16 a[216:219], a[228:231], v[84:87], a[216:219]
s_cbranch_scc1 L_n111
s_branch L_x11
.p2align 6
L_odd:
ds_read_b128 a[80:83], v1 offset:8448
ds_read_b128 a[84:87], v1 offset:8512
ds_read_b128 a[88:91], v1 offset:8576
ds_read_b128 a[92:95], v1 offset:8640
ds_read_b128 a[96:99], v1 offset:8960
ds_read_b128 a[100:103], v1 offset:9024
ds_read_b128 a[104:107], v1 offset:9088
ds_read_b128 a[108:111], v1 offset:9152
s_waitcnt vmcnt(5)
buffer_load_dwordx4 v[188:191], v3, s[20:23], s46 offen offset:3072 nt
v_lshlrev_b32 v56, 16, v164
v_and_b32 v57, s45, v164
v_lshlrev_b32 v58, 16, v165
v_and_b32 v59, s45, v165
v_lshlrev_b32 v60, 16, v166
v_and_b32 v61, s45, v166
v_lshlrev_b32 v62, 16, v167
v_and_b32 v63, s45, v167
v_pk_mul_f32 v[56:57], v[56:57], s[38:39]
v_pk_mul_f32 v[58:59], v[58:59], s[38:39]
v_pk_mul_f32 v[60:61], v[60:61], s[38:39]
v_pk_mul_f32 v[62:63], v[62:63], s[38:39]
v_cvt_pk_bf16_f32 v164, v56, v57
v_cvt_pk_bf16_f32 v165, v58, v59
v_cvt_pk_bf16_f32 v166, v60, v61
v_cvt_pk_bf16_f32 v167, v62, v63
ds_write_b128 v10, v[164:167] offset:1056
s_waitcnt lgkmcnt(13)
v_bitop3_b32 v16, v16, v35, s41 bitop3:0x28
v_bitop3_b32 v17, v17, v35, s41 bitop3:0x28
v_bitop3_b32 v18, v18, v35, s41 bitop3:0x28
v_bitop3_b32 v19, v19, v35, s41 bitop3:0x28
v_bitop3_b32 v20, v20, v35, s41 bitop3:0x28
v_bitop3_b32 v21, v21, v35, s41 bitop3:0x28
v_bitop3_b32 v22, v22, v35, s41 bitop3:0x28
v_bitop3_b32 v23, v23, v35, s41 bitop3:0x28
v_bitop3_b32 v24, v24, v35, s41 bitop3:0x28
v_bitop3_b32 v25, v25, v35, s41 bitop3:0x28
v_bitop3_b32 v26, v26, v35, s41 bitop3:0x28
v_bitop3_b32 v27, v27, v35, s41 bitop3:0x28
v_bitop3_b32 v28, v28, v35, s41 bitop3:0x28
v_bitop3_b32 v29, v29, v35, s41 bitop3:0x28
v_bitop3_b32 v30, v30, v35, s41 bitop3:0x28
v_bitop3_b32 v31, v31, v35, s41 bitop3:0x28
ds_read_b128 a[112:115], v1
ds_read_b128 a[116:119], v1 offset:64
ds_read_b128 a[120:123], v1 offset:128
ds_read_b128 a[124:127], v1 offset:192
ds_read_b128 a[128:131], v1 offset:512
ds_read_b128 a[132:135], v1 offset:576
ds_read_b128 a[136:139], v1 offset:640
ds_read_b128 a[140:143], v1 offset:704
s_waitcnt vmcnt(5)
s_add_u32 m0, s33, 33792
s_nop 0
buffer_load_dwordx4 v3, s[16:19], 0 offen nt lds
v_lshlrev_b32 v56, 16, v168
v_and_b32 v57, s45, v168
v_lshlrev_b32 v58, 16, v169
v_and_b32 v59, s45, v169
v_lshlrev_b32 v60, 16, v170
v_and_b32 v61, s45, v170
v_lshlrev_b32 v62, 16, v171
v_and_b32 v63, s45, v171
v_pk_mul_f32 v[56:57], v[56:57], s[38:39]
v_pk_mul_f32 v[58:59], v[58:59], s[38:39]
v_pk_mul_f32 v[60:61], v[60:61], s[38:39]
v_pk_mul_f32 v[62:63], v[62:63], s[38:39]
v_cvt_pk_bf16_f32 v168, v56, v57
v_cvt_pk_bf16_f32 v169, v58, v59
v_cvt_pk_bf16_f32 v170, v60, v61
v_cvt_pk_bf16_f32 v171, v62, v63
ds_write_b128 v10, v[168:171] offset:2112
s_waitcnt vmcnt(5)
s_add_u32 m0, s33, 33824
s_nop 0
buffer_load_dwordx4 v3, s[16:19], 0 offen offset:1024 nt lds
v_lshlrev_b32 v56, 16, v172
v_and_b32 v57, s45, v172
v_lshlrev_b32 v58, 16, v173
v_and_b32 v59, s45, v173
v_lshlrev_b32 v60, 16, v174
v_and_b32 v61, s45, v174
v_lshlrev_b32 v62, 16, v175
v_and_b32 v63, s45, v175
v_pk_mul_f32 v[56:57], v[56:57], s[38:39]
v_pk_mul_f32 v[58:59], v[58:59], s[38:39]
v_pk_mul_f32 v[60:61], v[60:61], s[38:39]
v_pk_mul_f32 v[62:63], v[62:63], s[38:39]
v_cvt_pk_bf16_f32 v172, v56, v57
v_cvt_pk_bf16_f32 v173, v58, v59
v_cvt_pk_bf16_f32 v174, v60, v61
v_cvt_pk_bf16_f32 v175, v62, v63
ds_write_b128 v10, v[172:175] offset:3168
s_waitcnt vmcnt(5)
s_add_u32 m0, s33, 33856
s_nop 0
buffer_load_dwordx4 v3, s[16:19], 0 offen offset:2048 nt lds
v_lshlrev_b32 v56, 16, v176
v_and_b32 v57, s45, v176
v_lshlrev_b32 v58, 16, v177
v_and_b32 v59, s45, v177
v_lshlrev_b32 v60, 16, v178
v_and_b32 v61, s45, v178
v_lshlrev_b32 v62, 16, v179
v_and_b32 v63, s45, v179
v_pk_mul_f32 v[56:57], v[56:57], s[38:39]
v_pk_mul_f32 v[58:59], v[58:59], s[38:39]
v_pk_mul_f32 v[60:61], v[60:61], s[38:39]
v_pk_mul_f32 v[62:63], v[62:63], s[38:39]
v_cvt_pk_bf16_f32 v176, v56, v57
v_cvt_pk_bf16_f32 v177, v58, v59
v_cvt_pk_bf16_f32 v178, v60, v61
v_cvt_pk_bf16_f32 v179, v62, v63
ds_write_b128 v10, v[176:179] offset:4224
s_waitcnt vmcnt(5)
s_add_u32 m0, s33, 33888
s_nop 0
buffer_load_dwordx4 v3, s[16:19], 0 offen offset:3072 nt lds
v_lshlrev_b32 v56, 16, v180
v_and_b32 v57, s45, v180
v_lshlrev_b32 v58, 16, v181
v_and_b32 v59, s45, v181
v_lshlrev_b32 v60, 16, v182
v_and_b32 v61, s45, v182
v_lshlrev_b32 v62, 16, v183
v_and_b32 v63, s45, v183
v_pk_mul_f32 v[56:57], v[56:57], s[38:39]
v_pk_mul_f32 v[58:59], v[58:59], s[38:39]
v_pk_mul_f32 v[60:61], v[60:61], s[38:39]
v_pk_mul_f32 v[62:63], v[62:63], s[38:39]
v_cvt_pk_bf16_f32 v180, v56, v57
v_cvt_pk_bf16_f32 v181, v58, v59
v_cvt_pk_bf16_f32 v182, v60, v61
v_cvt_pk_bf16_f32 v183, v62, v63
ds_write_b128 v10, v[180:183] offset:5280
s_waitcnt vmcnt(5)
s_add_u32 s46, s46, 4096
buffer_load_dwordx4 v[192:195], v3, s[20:23], s46 offen nt
v_lshlrev_b32 v56, 16, v184
v_and_b32 v57, s45, v184
v_lshlrev_b32 v58, 16, v185
v_and_b32 v59, s45, v185
v_lshlrev_b32 v60, 16, v186
v_and_b32 v61, s45, v186
v_lshlrev_b32 v62, 16, v187
v_and_b32 v63, s45, v187
v_pk_mul_f32 v[56:57], v[56:57], s[38:39]
v_pk_mul_f32 v[58:59], v[58:59], s[38:39]
v_pk_mul_f32 v[60:61], v[60:61], s[38:39]
v_pk_mul_f32 v[62:63], v[62:63], s[38:39]
v_cvt_pk_bf16_f32 v184, v56, v57
v_cvt_pk_bf16_f32 v185, v58, v59
v_cvt_pk_bf16_f32 v186, v60, v61
v_cvt_pk_bf16_f32 v187, v62, v63
ds_write_b128 v10, v[184:187] offset:6336
s_waitcnt vmcnt(5)
buffer_load_dwordx4 v[196:199], v3, s[20:23], s46 offen offset:1024 nt
v_lshlrev_b32 v56, 16, v188
v_and_b32 v57, s45, v188
v_lshlrev_b32 v58, 16, v189
v_and_b32 v59, s45, v189
v_lshlrev_b32 v60, 16, v190
v_and_b32 v61, s45, v190
v_lshlrev_b32 v62, 16, v191
v_and_b32 v63, s45, v191
v_pk_mul_f32 v[56:57], v[56:57], s[38:39]
v_pk_mul_f32 v[58:59], v[58:59], s[38:39]
v_pk_mul_f32 v[60:61], v[60:61], s[38:39]
v_pk_mul_f32 v[62:63], v[62:63], s[38:39]
v_cvt_pk_bf16_f32 v188, v56, v57
v_cvt_pk_bf16_f32 v189, v58, v59
v_cvt_pk_bf16_f32 v190, v60, v61
v_cvt_pk_bf16_f32 v191, v62, v63
ds_write_b128 v10, v[188:191] offset:7392
ds_read_b128 a[0:3], v6
ds_read_b128 a[4:7], v6 offset:64
ds_read_b128 a[8:11], v6 offset:128
ds_read_b128 a[12:15], v6 offset:192
ds_read_b128 a[16:19], v6 offset:512
ds_read_b128 a[20:23], v6 offset:576
ds_read_b128 a[24:27], v6 offset:640
ds_read_b128 a[28:31], v6 offset:704
s_waitcnt lgkmcnt(14)
v_mfma_f32_16x16x32_bf16 v[52:55], v[16:19], a[64:67], v[52:55]
v_mfma_f32_16x16x32_bf16 v[52:55], v[20:23], a[68:71], v[52:55]
v_mfma_f32_16x16x32_bf16 v[52:55], v[24:27], a[72:75], v[52:55]
v_mfma_f32_16x16x32_bf16 v[52:55], v[28:31], a[76:79], v[52:55]
v_mfma_f32_16x16x32_bf16 v[56:59], a[80:83], a[64:67], v[52:55]
v_mfma_f32_16x16x32_bf16 v[56:59], a[84:87], a[68:71], v[56:59]
v_mfma_f32_16x16x32_bf16 v[56:59], a[88:91], a[72:75], v[56:59]
v_mfma_f32_16x16x32_bf16 v[56:59], a[92:95], a[76:79], v[56:59]
v_mfma_f32_16x16x32_bf16 v[60:63], a[108:111], a[76:79], v[52:55]
v_mfma_f32_16x16x32_bf16 v[60:63], a[104:107], a[72:75], v[60:63]
v_mfma_f32_16x16x32_bf16 v[60:63], a[100:103], a[68:71], v[60:63]
v_mfma_f32_16x16x32_bf16 v[60:63], a[96:99], a[64:67], v[60:63]
s_waitcnt lgkmcnt(4)
v_mfma_f32_16x16x32_bf16 v[36:39], v[16:19], a[0:3], v[36:39]
v_mfma_f32_16x16x32_bf16 v[36:39], v[20:23], a[4:7], v[36:39]
v_mfma_f32_16x16x32_bf16 v[36:39], v[24:27], a[8:11], v[36:39]
v_mfma_f32_16x16x32_bf16 v[36:39], v[28:31], a[12:15], v[36:39]
v_mfma_f32_16x16x32_bf16 v[64:67], a[80:83], a[0:3], v[36:39]
v_exp_f32 v56, v56
v_mfma_f32_16x16x32_bf16 v[64:67], a[84:87], a[4:7], v[64:67]
v_exp_f32 v57, v57
v_mfma_f32_16x16x32_bf16 v[64:67], a[88:91], a[8:11], v[64:67]
v_exp_f32 v58, v58
v_mfma_f32_16x16x32_bf16 v[64:67], a[92:95], a[12:15], v[64:67]
v_exp_f32 v59, v59
v_mfma_f32_16x16x32_bf16 v[68:71], a[108:111], a[12:15], v[36:39]
v_exp_f32 v60, v60
v_mfma_f32_16x16x32_bf16 v[68:71], a[104:107], a[8:11], v[68:71]
v_exp_f32 v61, v61
v_mfma_f32_16x16x32_bf16 v[68:71], a[100:103], a[4:7], v[68:71]
v_exp_f32 v62, v62
v_mfma_f32_16x16x32_bf16 v[68:71], a[96:99], a[0:3], v[68:71]
s_waitcnt lgkmcnt(14)
v_exp_f32 v63, v63
v_mfma_f32_16x16x32_bf16 v[72:75], a[112:115], a[0:3], v[36:39]
v_exp_f32 v64, v64
v_mfma_f32_16x16x32_bf16 v[72:75], a[116:119], a[4:7], v[72:75]
v_cvt_pk_bf16_f32 v80, v56, v57
v_cvt_pk_bf16_f32 v81, v58, v59
v_mfma_f32_16x16x32_bf16 v[72:75], a[120:123], a[8:11], v[72:75]
v_exp_f32 v65, v65
v_mfma_f32_16x16x32_bf16 v[72:75], a[124:127], a[12:15], v[72:75]
v_cvt_pk_bf16_f32 v88, v64, v65
v_mfma_f32_16x16x32_bf16 v[76:79], a[140:143], a[12:15], v[36:39]
v_exp_f32 v66, v66
v_mfma_f32_16x16x32_bf16 v[76:79], a[136:139], a[8:11], v[76:79]
v_cvt_pk_bf16_f32 v82, v60, v61
v_cvt_pk_bf16_f32 v83, v62, v63
v_mfma_f32_16x16x32_bf16 v[76:79], a[132:135], a[4:7], v[76:79]
v_exp_f32 v67, v67
v_mfma_f32_16x16x32_bf16 v[76:79], a[128:131], a[0:3], v[76:79]
v_cvt_pk_bf16_f32 v89, v66, v67
s_waitcnt vmcnt(5)
buffer_load_dwordx4 v[200:203], v3, s[20:23], s46 offen offset:2048 nt
s_waitcnt vmcnt(5)
buffer_load_dwordx4 v[204:207], v3, s[20:23], s46 offen offset:3072 nt
s_waitcnt vmcnt(5)
s_add_u32 s46, s46, 4096
buffer_load_dwordx4 v[208:211], v3, s[20:23], s46 offen nt
s_waitcnt vmcnt(5)
buffer_load_dwordx4 v[212:215], v3, s[20:23], s46 offen offset:1024 nt
s_waitcnt lgkmcnt(14)
s_barrier
ds_read_b64_tr_b16 a[144:145], v2 offset:8448
ds_read_b64_tr_b16 a[146:147], v2 offset:8960
ds_read_b64_tr_b16 a[148:149], v2 offset:8480
ds_read_b64_tr_b16 a[150:151], v2 offset:8992
ds_read_b64_tr_b16 a[152:153], v2 offset:8512
ds_read_b64_tr_b16 a[154:155], v2 offset:9024
ds_read_b64_tr_b16 a[156:157], v2 offset:8544
ds_read_b64_tr_b16 a[158:159], v2 offset:9056
ds_read_b64_tr_b16 a[160:161], v2 offset:8576
ds_read_b64_tr_b16 a[162:163], v2 offset:9088
ds_read_b64_tr_b16 a[164:165], v2 offset:8608
ds_read_b64_tr_b16 a[166:167], v2 offset:9120
ds_read_b64_tr_b16 a[168:169], v2 offset:8640
ds_read_b64_tr_b16 a[170:171], v2 offset:9152
ds_read_b64_tr_b16 a[172:173], v2 offset:8672
ds_read_b64_tr_b16 a[174:175], v2 offset:9184
s_waitcnt lgkmcnt(8)
v_mfma_f32_16x16x32_bf16 v[224:227], a[144:147], v[80:83], 0
v_exp_f32 v68, v68
v_mfma_f32_16x16x32_bf16 v[228:231], a[148:151], v[80:83], 0
ds_read_b64_tr_b16 a[176:177], v2
ds_read_b64_tr_b16 a[178:179], v2 offset:512
v_mfma_f32_16x16x32_bf16 v[232:235], a[152:155], v[80:83], 0
v_exp_f32 v69, v69
v_mfma_f32_16x16x32_bf16 v[236:239], a[156:159], v[80:83], 0
s_waitcnt lgkmcnt(2)
v_cvt_pk_bf16_f32 v90, v68, v69
v_mfma_f32_16x16x32_bf16 v[240:243], a[160:163], v[80:83], 0
v_exp_f32 v70, v70
v_mfma_f32_16x16x32_bf16 v[244:247], a[164:167], v[80:83], 0
ds_read_b64_tr_b16 a[180:181], v2 offset:32
ds_read_b64_tr_b16 a[182:183], v2 offset:544
v_mfma_f32_16x16x32_bf16 v[248:251], a[168:171], v[80:83], 0
v_exp_f32 v71, v71
v_mfma_f32_16x16x32_bf16 v[252:255], a[172:175], v[80:83], 0
ds_read_b64_tr_b16 a[184:185], v2 offset:64
v_cvt_pk_bf16_f32 v91, v70, v71
v_mfma_f32_16x16x32_bf16 a[224:227], a[228:231], v[80:83], 0
v_exp_f32 v72, v72
v_mfma_f32_16x16x32_bf16 v[40:43], v[16:19], a[16:19], v[40:43]
s_waitcnt vmcnt(5)
buffer_load_dwordx4 v[216:219], v3, s[20:23], s46 offen offset:2048 nt
v_lshlrev_b32 v160, 16, v192
v_and_b32 v161, s45, v192
v_lshlrev_b32 v162, 16, v193
v_and_b32 v163, s45, v193
v_lshlrev_b32 v164, 16, v194
v_and_b32 v165, s45, v194
v_lshlrev_b32 v166, 16, v195
v_and_b32 v167, s45, v195
v_pk_mul_f32 v[160:161], v[160:161], s[38:39]
v_pk_mul_f32 v[162:163], v[162:163], s[38:39]
v_pk_mul_f32 v[164:165], v[164:165], s[38:39]
v_pk_mul_f32 v[166:167], v[166:167], s[38:39]
v_cvt_pk_bf16_f32 v192, v160, v161
v_cvt_pk_bf16_f32 v193, v162, v163
v_cvt_pk_bf16_f32 v194, v164, v165
v_cvt_pk_bf16_f32 v195, v166, v167
ds_write_b128 v10, v[192:195] offset:8448
v_mfma_f32_16x16x32_bf16 v[40:43], v[20:23], a[20:23], v[40:43]
ds_read_b64_tr_b16 a[186:187], v2 offset:576
ds_read_b64_tr_b16 a[188:189], v2 offset:96
v_mfma_f32_16x16x32_bf16 v[40:43], v[24:27], a[24:27], v[40:43]
ds_read_b64_tr_b16 a[190:191], v2 offset:608
ds_read_b64_tr_b16 a[192:193], v2 offset:128
v_mfma_f32_16x16x32_bf16 v[40:43], v[28:31], a[28:31], v[40:43]
s_waitcnt vmcnt(5)
buffer_load_dwordx4 v[220:223], v3, s[20:23], s46 offen offset:3072 nt
v_lshlrev_b32 v160, 16, v196
v_and_b32 v161, s45, v196
v_lshlrev_b32 v162, 16, v197
v_and_b32 v163, s45, v197
v_lshlrev_b32 v164, 16, v198
v_and_b32 v165, s45, v198
v_lshlrev_b32 v166, 16, v199
v_and_b32 v167, s45, v199
v_pk_mul_f32 v[160:161], v[160:161], s[38:39]
v_pk_mul_f32 v[162:163], v[162:163], s[38:39]
v_pk_mul_f32 v[164:165], v[164:165], s[38:39]
v_pk_mul_f32 v[166:167], v[166:167], s[38:39]
v_cvt_pk_bf16_f32 v196, v160, v161
v_cvt_pk_bf16_f32 v197, v162, v163
v_cvt_pk_bf16_f32 v198, v164, v165
v_cvt_pk_bf16_f32 v199, v166, v167
ds_write_b128 v10, v[196:199] offset:9504
v_mfma_f32_16x16x32_bf16 v[56:59], a[80:83], a[16:19], v[40:43]
ds_read_b64_tr_b16 a[194:195], v2 offset:640
ds_read_b64_tr_b16 a[196:197], v2 offset:160
v_mfma_f32_16x16x32_bf16 v[56:59], a[84:87], a[20:23], v[56:59]
v_exp_f32 v73, v73
v_mfma_f32_16x16x32_bf16 v[56:59], a[88:91], a[24:27], v[56:59]
ds_read_b64_tr_b16 a[198:199], v2 offset:672
v_cvt_pk_bf16_f32 v92, v72, v73
v_mfma_f32_16x16x32_bf16 v[56:59], a[92:95], a[28:31], v[56:59]
v_exp_f32 v74, v74
v_mfma_f32_16x16x32_bf16 v[60:63], a[108:111], a[28:31], v[40:43]
s_waitcnt vmcnt(5)
s_add_u32 s12, s12, 16384
s_addc_u32 s13, s13, 0
s_add_u32 m0, s33, 16896
s_nop 0
buffer_load_dwordx4 v3, s[12:15], 0 offen nt lds
v_lshlrev_b32 v160, 16, v200
v_and_b32 v161, s45, v200
v_lshlrev_b32 v162, 16, v201
v_and_b32 v163, s45, v201
v_lshlrev_b32 v164, 16, v202
v_and_b32 v165, s45, v202
v_lshlrev_b32 v166, 16, v203
v_and_b32 v167, s45, v203
v_pk_mul_f32 v[160:161], v[160:161], s[38:39]
v_pk_mul_f32 v[162:163], v[162:163], s[38:39]
v_pk_mul_f32 v[164:165], v[164:165], s[38:39]
v_pk_mul_f32 v[166:167], v[166:167], s[38:39]
v_cvt_pk_bf16_f32 v200, v160, v161
v_cvt_pk_bf16_f32 v201, v162, v163
v_cvt_pk_bf16_f32 v202, v164, v165
v_cvt_pk_bf16_f32 v203, v166, v167
ds_write_b128 v10, v[200:203] offset:10560
v_mfma_f32_16x16x32_bf16 v[60:63], a[104:107], a[24:27], v[60:63]
v_exp_f32 v75, v75
v_mfma_f32_16x16x32_bf16 v[60:63], a[100:103], a[20:23], v[60:63]
ds_read_b64_tr_b16 a[200:201], v2 offset:192
v_cvt_pk_bf16_f32 v93, v74, v75
v_mfma_f32_16x16x32_bf16 v[60:63], a[96:99], a[16:19], v[60:63]
v_exp_f32 v76, v76
v_mfma_f32_16x16x32_bf16 v[64:67], a[112:115], a[16:19], v[40:43]
ds_read_b64_tr_b16 a[202:203], v2 offset:704
v_mfma_f32_16x16x32_bf16 v[64:67], a[116:119], a[20:23], v[64:67]
v_exp_f32 v77, v77
v_mfma_f32_16x16x32_bf16 v[64:67], a[120:123], a[24:27], v[64:67]
ds_read_b64_tr_b16 a[204:205], v2 offset:224
v_cvt_pk_bf16_f32 v94, v76, v77
v_mfma_f32_16x16x32_bf16 v[64:67], a[124:127], a[28:31], v[64:67]
v_exp_f32 v78, v78
v_mfma_f32_16x16x32_bf16 v[68:71], a[140:143], a[28:31], v[40:43]
s_waitcnt vmcnt(5)
s_add_u32 m0, s33, 16928
s_nop 0
buffer_load_dwordx4 v3, s[12:15], 0 offen offset:1024 nt lds
v_lshlrev_b32 v160, 16, v204
v_and_b32 v161, s45, v204
v_lshlrev_b32 v162, 16, v205
v_and_b32 v163, s45, v205
v_lshlrev_b32 v164, 16, v206
v_and_b32 v165, s45, v206
v_lshlrev_b32 v166, 16, v207
v_and_b32 v167, s45, v207
v_pk_mul_f32 v[160:161], v[160:161], s[38:39]
v_pk_mul_f32 v[162:163], v[162:163], s[38:39]
v_pk_mul_f32 v[164:165], v[164:165], s[38:39]
v_pk_mul_f32 v[166:167], v[166:167], s[38:39]
v_cvt_pk_bf16_f32 v204, v160, v161
v_cvt_pk_bf16_f32 v205, v162, v163
v_cvt_pk_bf16_f32 v206, v164, v165
v_cvt_pk_bf16_f32 v207, v166, v167
ds_write_b128 v10, v[204:207] offset:11616
v_mfma_f32_16x16x32_bf16 v[68:71], a[136:139], a[24:27], v[68:71]
v_exp_f32 v79, v79
v_mfma_f32_16x16x32_bf16 v[68:71], a[132:135], a[20:23], v[68:71]
ds_read_b64_tr_b16 a[206:207], v2 offset:736
v_cvt_pk_bf16_f32 v95, v78, v79
v_mfma_f32_16x16x32_bf16 v[68:71], a[128:131], a[16:19], v[68:71]
s_waitcnt lgkmcnt(11)
v_exp_f32 v56, v56
v_mfma_f32_16x16x32_bf16 v[96:99], a[144:147], v[88:91], 0
s_waitcnt vmcnt(5)
s_add_u32 m0, s33, 16960
s_nop 0
buffer_load_dwordx4 v3, s[12:15], 0 offen offset:2048 nt lds
v_lshlrev_b32 v160, 16, v208
v_and_b32 v161, s45, v208
v_lshlrev_b32 v162, 16, v209
v_and_b32 v163, s45, v209
v_lshlrev_b32 v164, 16, v210
v_and_b32 v165, s45, v210
v_lshlrev_b32 v166, 16, v211
v_and_b32 v167, s45, v211
v_pk_mul_f32 v[160:161], v[160:161], s[38:39]
v_pk_mul_f32 v[162:163], v[162:163], s[38:39]
v_pk_mul_f32 v[164:165], v[164:165], s[38:39]
v_pk_mul_f32 v[166:167], v[166:167], s[38:39]
v_cvt_pk_bf16_f32 v208, v160, v161
v_cvt_pk_bf16_f32 v209, v162, v163
v_cvt_pk_bf16_f32 v210, v164, v165
v_cvt_pk_bf16_f32 v211, v166, v167
ds_write_b128 v10, v[208:211] offset:12672
v_mfma_f32_16x16x32_bf16 v[96:99], a[176:179], v[92:95], v[96:99]
v_exp_f32 v57, v57
v_mfma_f32_16x16x32_bf16 v[100:103], a[180:183], v[92:95], 0
v_cvt_pk_bf16_f32 v80, v56, v57
v_mfma_f32_16x16x32_bf16 v[100:103], a[148:151], v[88:91], v[100:103]
v_exp_f32 v58, v58
v_mfma_f32_16x16x32_bf16 v[104:107], a[152:155], v[88:91], 0
v_mfma_f32_16x16x32_bf16 v[104:107], a[184:187], v[92:95], v[104:107]
v_exp_f32 v59, v59
v_mfma_f32_16x16x32_bf16 v[108:111], a[188:191], v[92:95], 0
v_cvt_pk_bf16_f32 v81, v58, v59
v_mfma_f32_16x16x32_bf16 v[108:111], a[156:159], v[88:91], v[108:111]
s_waitcnt lgkmcnt(1)
v_exp_f32 v60, v60
v_mfma_f32_16x16x32_bf16 v[112:115], a[160:163], v[88:91], 0
s_waitcnt vmcnt(5)
s_add_u32 m0, s33, 16992
s_nop 0
buffer_load_dwordx4 v3, s[12:15], 0 offen offset:3072 nt lds
v_lshlrev_b32 v160, 16, v212
v_and_b32 v161, s45, v212
v_lshlrev_b32 v162, 16, v213
v_and_b32 v163, s45, v213
v_lshlrev_b32 v164, 16, v214
v_and_b32 v165, s45, v214
v_lshlrev_b32 v166, 16, v215
v_and_b32 v167, s45, v215
v_pk_mul_f32 v[160:161], v[160:161], s[38:39]
v_pk_mul_f32 v[162:163], v[162:163], s[38:39]
v_pk_mul_f32 v[164:165], v[164:165], s[38:39]
v_pk_mul_f32 v[166:167], v[166:167], s[38:39]
v_cvt_pk_bf16_f32 v212, v160, v161
v_cvt_pk_bf16_f32 v213, v162, v163
v_cvt_pk_bf16_f32 v214, v164, v165
v_cvt_pk_bf16_f32 v215, v166, v167
ds_write_b128 v10, v[212:215] offset:13728
v_mfma_f32_16x16x32_bf16 v[112:115], a[192:195], v[92:95], v[112:115]
v_exp_f32 v61, v61
v_mfma_f32_16x16x32_bf16 v[116:119], a[196:199], v[92:95], 0
v_cvt_pk_bf16_f32 v82, v60, v61
v_mfma_f32_16x16x32_bf16 v[116:119], a[164:167], v[88:91], v[116:119]
v_exp_f32 v62, v62
v_mfma_f32_16x16x32_bf16 v[120:123], a[168:171], v[88:91], 0
s_waitcnt vmcnt(5)
s_add_u32 s16, s16, 16384
s_addc_u32 s17, s17, 0
s_add_u32 m0, s33, 50688
s_nop 0
buffer_load_dwordx4 v3, s[16:19], 0 offen nt lds
v_lshlrev_b32 v160, 16, v216
v_and_b32 v161, s45, v216
v_lshlrev_b32 v162, 16, v217
v_and_b32 v163, s45, v217
v_lshlrev_b32 v164, 16, v218
v_and_b32 v165, s45, v218
v_lshlrev_b32 v166, 16, v219
v_and_b32 v167, s45, v219
v_pk_mul_f32 v[160:161], v[160:161], s[38:39]
v_pk_mul_f32 v[162:163], v[162:163], s[38:39]
v_pk_mul_f32 v[164:165], v[164:165], s[38:39]
v_pk_mul_f32 v[166:167], v[166:167], s[38:39]
v_cvt_pk_bf16_f32 v216, v160, v161
v_cvt_pk_bf16_f32 v217, v162, v163
v_cvt_pk_bf16_f32 v218, v164, v165
v_cvt_pk_bf16_f32 v219, v166, v167
ds_write_b128 v10, v[216:219] offset:14784
v_mfma_f32_16x16x32_bf16 v[120:123], a[200:203], v[92:95], v[120:123]
v_exp_f32 v63, v63
v_mfma_f32_16x16x32_bf16 v[124:127], a[204:207], v[92:95], 0
v_cvt_pk_bf16_f32 v83, v62, v63
v_mfma_f32_16x16x32_bf16 v[124:127], a[172:175], v[88:91], v[124:127]
v_exp_f32 v64, v64
v_mfma_f32_16x16x32_bf16 a[208:211], a[228:231], v[88:91], 0
v_mfma_f32_16x16x32_bf16 a[208:211], a[228:231], v[92:95], a[208:211]
v_exp_f32 v65, v65
s_waitcnt vmcnt(5)
s_add_u32 m0, s33, 50720
s_nop 0
buffer_load_dwordx4 v3, s[16:19], 0 offen offset:1024 nt lds
v_lshlrev_b32 v160, 16, v220
v_and_b32 v161, s45, v220
v_lshlrev_b32 v162, 16, v221
v_and_b32 v163, s45, v221
v_lshlrev_b32 v164, 16, v222
v_and_b32 v165, s45, v222
v_lshlrev_b32 v166, 16, v223
v_and_b32 v167, s45, v223
v_pk_mul_f32 v[160:161], v[160:161], s[38:39]
v_pk_mul_f32 v[162:163], v[162:163], s[38:39]
v_pk_mul_f32 v[164:165], v[164:165], s[38:39]
v_pk_mul_f32 v[166:167], v[166:167], s[38:39]
v_cvt_pk_bf16_f32 v220, v160, v161
v_cvt_pk_bf16_f32 v221, v162, v163
v_cvt_pk_bf16_f32 v222, v164, v165
v_cvt_pk_bf16_f32 v223, v166, v167
ds_write_b128 v10, v[220:223] offset:15840
ds_read_b128 a[32:35], v6 offset:8448
ds_read_b128 a[36:39], v6 offset:8512
ds_read_b128 a[40:43], v6 offset:8576
ds_read_b128 a[44:47], v6 offset:8640
ds_read_b128 a[48:51], v6 offset:8960
ds_read_b128 a[52:55], v6 offset:9024
ds_read_b128 a[56:59], v6 offset:9088
ds_read_b128 a[60:63], v6 offset:9152
s_add_u32 m0, s33, 50752
s_nop 0
buffer_load_dwordx4 v3, s[16:19], 0 offen offset:2048 nt lds
s_add_u32 m0, s33, 50784
s_nop 0
buffer_load_dwordx4 v3, s[16:19], 0 offen offset:3072 nt lds
s_waitcnt lgkmcnt(4)
v_mfma_f32_16x16x32_bf16 v[44:47], v[16:19], a[32:35], v[44:47]
v_mfma_f32_16x16x32_bf16 v[44:47], v[20:23], a[36:39], v[44:47]
v_mfma_f32_16x16x32_bf16 v[44:47], v[24:27], a[40:43], v[44:47]
v_mfma_f32_16x16x32_bf16 v[44:47], v[28:31], a[44:47], v[44:47]
v_mfma_f32_16x16x32_bf16 v[72:75], a[80:83], a[32:35], v[44:47]
v_cvt_pk_bf16_f32 v84, v64, v65
v_mfma_f32_16x16x32_bf16 v[72:75], a[84:87], a[36:39], v[72:75]
v_exp_f32 v66, v66
v_mfma_f32_16x16x32_bf16 v[72:75], a[88:91], a[40:43], v[72:75]
v_mfma_f32_16x16x32_bf16 v[72:75], a[92:95], a[44:47], v[72:75]
v_exp_f32 v67, v67
v_mfma_f32_16x16x32_bf16 v[76:79], a[108:111], a[44:47], v[44:47]
v_cvt_pk_bf16_f32 v85, v66, v67
v_mfma_f32_16x16x32_bf16 v[76:79], a[104:107], a[40:43], v[76:79]
v_mfma_f32_16x16x32_bf16 v[76:79], a[100:103], a[36:39], v[76:79]
v_mfma_f32_16x16x32_bf16 v[76:79], a[96:99], a[32:35], v[76:79]
v_mfma_f32_16x16x32_bf16 v[56:59], a[112:115], a[32:35], v[44:47]
v_mfma_f32_16x16x32_bf16 v[56:59], a[116:119], a[36:39], v[56:59]
v_mfma_f32_16x16x32_bf16 v[56:59], a[120:123], a[40:43], v[56:59]
v_mfma_f32_16x16x32_bf16 v[56:59], a[124:127], a[44:47], v[56:59]
v_exp_f32 v68, v68
v_exp_f32 v69, v69
v_exp_f32 v70, v70
v_exp_f32 v71, v71
v_cvt_pk_bf16_f32 v86, v68, v69
v_cvt_pk_bf16_f32 v87, v70, v71
v_mfma_f32_16x16x32_bf16 v[60:63], a[140:143], a[44:47], v[44:47]
v_mfma_f32_16x16x32_bf16 v[60:63], a[136:139], a[40:43], v[60:63]
v_mfma_f32_16x16x32_bf16 v[60:63], a[132:135], a[36:39], v[60:63]
v_mfma_f32_16x16x32_bf16 v[60:63], a[128:131], a[32:35], v[60:63]
s_add_u32 s12, s12, 16384
s_addc_u32 s13, s13, 0
v_mfma_f32_16x16x32_bf16 v[128:131], a[144:147], v[80:83], 0
s_add_u32 m0, s33, 0
v_mfma_f32_16x16x32_bf16 v[128:131], a[176:179], v[84:87], v[128:131]
buffer_load_dwordx4 v3, s[12:15], 0 offen nt lds
v_exp_f32 v72, v72
v_exp_f32 v73, v73
v_exp_f32 v74, v74
v_exp_f32 v75, v75
v_cvt_pk_bf16_f32 v88, v72, v73
v_cvt_pk_bf16_f32 v89, v74, v75
v_mfma_f32_16x16x32_bf16 v[132:135], a[180:183], v[84:87], 0
v_mfma_f32_16x16x32_bf16 v[132:135], a[148:151], v[80:83], v[132:135]
v_mfma_f32_16x16x32_bf16 v[136:139], a[152:155], v[80:83], 0
s_add_u32 m0, s33, 32
v_mfma_f32_16x16x32_bf16 v[136:139], a[184:187], v[84:87], v[136:139]
buffer_load_dwordx4 v3, s[12:15], 0 offen offset:1024 nt lds
v_mfma_f32_16x16x32_bf16 v[140:143], a[188:191], v[84:87], 0
v_mfma_f32_16x16x32_bf16 v[140:143], a[156:159], v[80:83], v[140:143]
v_mfma_f32_16x16x32_bf16 v[144:147], a[160:163], v[80:83], 0
s_add_u32 m0, s33, 64
v_mfma_f32_16x16x32_bf16 v[144:147], a[192:195], v[84:87], v[144:147]
buffer_load_dwordx4 v3, s[12:15], 0 offen offset:2048 nt lds
v_exp_f32 v76, v76
v_exp_f32 v77, v77
v_exp_f32 v78, v78
v_exp_f32 v79, v79
v_cvt_pk_bf16_f32 v90, v76, v77
v_cvt_pk_bf16_f32 v91, v78, v79
v_mfma_f32_16x16x32_bf16 v[148:151], a[196:199], v[84:87], 0
v_mfma_f32_16x16x32_bf16 v[148:151], a[164:167], v[80:83], v[148:151]
v_mfma_f32_16x16x32_bf16 v[152:155], a[168:171], v[80:83], 0
s_add_u32 m0, s33, 96
v_mfma_f32_16x16x32_bf16 v[152:155], a[200:203], v[84:87], v[152:155]
buffer_load_dwordx4 v3, s[12:15], 0 offen offset:3072 nt lds
v_mfma_f32_16x16x32_bf16 v[156:159], a[204:207], v[84:87], 0
s_waitcnt vmcnt(8) lgkmcnt(12)
v_mfma_f32_16x16x32_bf16 v[156:159], a[172:175], v[80:83], v[156:159]
v_mfma_f32_16x16x32_bf16 a[212:215], a[228:231], v[80:83], 0
s_barrier
v_mfma_f32_16x16x32_bf16 a[212:215], a[228:231], v[84:87], a[212:215]
s_waitcnt lgkmcnt(0)
v_exp_f32 v56, v56
v_exp_f32 v57, v57
v_exp_f32 v58, v58
v_exp_f32 v59, v59
v_cvt_pk_bf16_f32 v92, v56, v57
v_cvt_pk_bf16_f32 v93, v58, v59
v_mfma_f32_16x16x32_bf16 v[48:51], v[16:19], a[48:51], v[48:51]
v_mfma_f32_16x16x32_bf16 v[48:51], v[20:23], a[52:55], v[48:51]
v_mfma_f32_16x16x32_bf16 v[48:51], v[24:27], a[56:59], v[48:51]
v_mfma_f32_16x16x32_bf16 v[48:51], v[28:31], a[60:63], v[48:51]
v_mfma_f32_16x16x32_bf16 v[64:67], a[80:83], a[48:51], v[48:51]
v_mfma_f32_16x16x32_bf16 v[64:67], a[84:87], a[52:55], v[64:67]
ds_read_b128 a[80:83], v1 offset:25344
v_mfma_f32_16x16x32_bf16 v[64:67], a[88:91], a[56:59], v[64:67]
v_mfma_f32_16x16x32_bf16 v[64:67], a[92:95], a[60:63], v[64:67]
ds_read_b128 a[84:87], v1 offset:25408
ds_read_b128 a[88:91], v1 offset:25472
v_mfma_f32_16x16x32_bf16 v[68:71], a[108:111], a[60:63], v[48:51]
v_mfma_f32_16x16x32_bf16 v[68:71], a[104:107], a[56:59], v[68:71]
ds_read_b128 a[92:95], v1 offset:25536
v_mfma_f32_16x16x32_bf16 v[68:71], a[100:103], a[52:55], v[68:71]
v_mfma_f32_16x16x32_bf16 v[68:71], a[96:99], a[48:51], v[68:71]
ds_read_b128 a[108:111], v1 offset:26048
v_exp_f32 v60, v60
v_exp_f32 v61, v61
v_exp_f32 v62, v62
v_exp_f32 v63, v63
v_cvt_pk_bf16_f32 v94, v60, v61
v_cvt_pk_bf16_f32 v95, v62, v63
v_mfma_f32_16x16x32_bf16 v[72:75], a[112:115], a[48:51], v[48:51]
v_mfma_f32_16x16x32_bf16 v[72:75], a[116:119], a[52:55], v[72:75]
v_mfma_f32_16x16x32_bf16 v[72:75], a[120:123], a[56:59], v[72:75]
ds_read_b128 a[104:107], v1 offset:25984
v_mfma_f32_16x16x32_bf16 v[72:75], a[124:127], a[60:63], v[72:75]
v_mfma_f32_16x16x32_bf16 v[76:79], a[140:143], a[60:63], v[48:51]
ds_read_b128 a[100:103], v1 offset:25920
v_mfma_f32_16x16x32_bf16 v[76:79], a[136:139], a[56:59], v[76:79]
v_mfma_f32_16x16x32_bf16 v[76:79], a[132:135], a[52:55], v[76:79]
ds_read_b128 a[96:99], v1 offset:25856
v_mfma_f32_16x16x32_bf16 v[76:79], a[128:131], a[48:51], v[76:79]
v_exp_f32 v64, v64
v_exp_f32 v65, v65
v_exp_f32 v66, v66
v_exp_f32 v67, v67
v_cvt_pk_bf16_f32 v80, v64, v65
v_cvt_pk_bf16_f32 v81, v66, v67
v_mfma_f32_16x16x32_bf16 v[160:163], a[144:147], v[88:91], 0
ds_read_b128 a[112:115], v1 offset:16896
v_mfma_f32_16x16x32_bf16 v[160:163], a[176:179], v[92:95], v[160:163]
v_mfma_f32_16x16x32_bf16 v[164:167], a[180:183], v[92:95], 0
ds_read_b128 a[116:119], v1 offset:16960
v_mfma_f32_16x16x32_bf16 v[164:167], a[148:151], v[88:91], v[164:167]
v_mfma_f32_16x16x32_bf16 v[168:171], a[152:155], v[88:91], 0
ds_read_b128 a[120:123], v1 offset:17024
v_mfma_f32_16x16x32_bf16 v[168:171], a[184:187], v[92:95], v[168:171]
v_mfma_f32_16x16x32_bf16 v[172:175], a[188:191], v[92:95], 0
ds_read_b128 a[124:127], v1 offset:17088
v_mfma_f32_16x16x32_bf16 v[172:175], a[156:159], v[88:91], v[172:175]
v_exp_f32 v68, v68
v_exp_f32 v69, v69
v_exp_f32 v70, v70
v_exp_f32 v71, v71
v_cvt_pk_bf16_f32 v82, v68, v69
v_cvt_pk_bf16_f32 v83, v70, v71
v_mfma_f32_16x16x32_bf16 v[176:179], a[160:163], v[88:91], 0
ds_read_b128 a[140:143], v1 offset:17600
v_mfma_f32_16x16x32_bf16 v[176:179], a[192:195], v[92:95], v[176:179]
v_mfma_f32_16x16x32_bf16 v[180:183], a[196:199], v[92:95], 0
ds_read_b128 a[136:139], v1 offset:17536
v_mfma_f32_16x16x32_bf16 v[180:183], a[164:167], v[88:91], v[180:183]
v_mfma_f32_16x16x32_bf16 v[184:187], a[168:171], v[88:91], 0
ds_read_b128 a[132:135], v1 offset:17472
v_mfma_f32_16x16x32_bf16 v[184:187], a[200:203], v[92:95], v[184:187]
v_mfma_f32_16x16x32_bf16 v[188:191], a[204:207], v[92:95], 0
ds_read_b128 a[128:131], v1 offset:17408
v_mfma_f32_16x16x32_bf16 v[188:191], a[172:175], v[88:91], v[188:191]
v_exp_f32 v72, v72
v_exp_f32 v73, v73
v_exp_f32 v74, v74
v_exp_f32 v75, v75
v_cvt_pk_bf16_f32 v84, v72, v73
v_cvt_pk_bf16_f32 v85, v74, v75
v_mfma_f32_16x16x32_bf16 a[216:219], a[228:231], v[88:91], 0
s_waitcnt lgkmcnt(8)
v_mfma_f32_16x16x32_bf16 a[216:219], a[228:231], v[92:95], a[216:219]
v_mfma_f32_16x16x32_bf16 v[56:59], a[80:83], a[64:67], v[52:55]
v_mfma_f32_16x16x32_bf16 v[56:59], a[84:87], a[68:71], v[56:59]
v_mfma_f32_16x16x32_bf16 v[56:59], a[88:91], a[72:75], v[56:59]
v_mfma_f32_16x16x32_bf16 v[56:59], a[92:95], a[76:79], v[56:59]
v_exp_f32 v76, v76
v_exp_f32 v77, v77
v_exp_f32 v78, v78
v_exp_f32 v79, v79
v_cvt_pk_bf16_f32 v86, v76, v77
v_cvt_pk_bf16_f32 v87, v78, v79
v_mfma_f32_16x16x32_bf16 v[60:63], a[108:111], a[76:79], v[52:55]
v_mfma_f32_16x16x32_bf16 v[60:63], a[104:107], a[72:75], v[60:63]
s_waitcnt vmcnt(4) lgkmcnt(0)
v_mfma_f32_16x16x32_bf16 v[60:63], a[100:103], a[68:71], v[60:63]
v_mfma_f32_16x16x32_bf16 v[60:63], a[96:99], a[64:67], v[60:63]
s_barrier
s_add_u32 s16, s16, 16384
s_addc_u32 s17, s17, 0
v_mfma_f32_16x16x32_bf16 v[192:195], a[144:147], v[80:83], 0
ds_read_b64_tr_b16 a[144:145], v2 offset:25344
v_mfma_f32_16x16x32_bf16 v[192:195], a[176:179], v[84:87], v[192:195]
v_mfma_f32_16x16x32_bf16 v[196:199], a[180:183], v[84:87], 0
ds_read_b64_tr_b16 a[146:147], v2 offset:25856
v_mfma_f32_16x16x32_bf16 v[196:199], a[148:151], v[80:83], v[196:199]
ds_read_b64_tr_b16 a[148:149], v2 offset:25376
v_mfma_f32_16x16x32_bf16 v[200:203], a[152:155], v[80:83], 0
v_mfma_f32_16x16x32_bf16 v[200:203], a[184:187], v[84:87], v[200:203]
ds_read_b64_tr_b16 a[150:151], v2 offset:25888
v_mfma_f32_16x16x32_bf16 v[204:207], a[188:191], v[84:87], 0
ds_read_b64_tr_b16 a[152:153], v2 offset:25408
v_mfma_f32_16x16x32_bf16 v[204:207], a[156:159], v[80:83], v[204:207]
v_mfma_f32_16x16x32_bf16 v[208:211], a[160:163], v[80:83], 0
ds_read_b64_tr_b16 a[154:155], v2 offset:25920
v_mfma_f32_16x16x32_bf16 v[208:211], a[192:195], v[84:87], v[208:211]
ds_read_b64_tr_b16 a[156:157], v2 offset:25440
v_exp_f32 v56, v56
v_exp_f32 v57, v57
v_exp_f32 v58, v58
v_exp_f32 v59, v59
v_cvt_pk_bf16_f32 v88, v56, v57
v_cvt_pk_bf16_f32 v89, v58, v59
v_mfma_f32_16x16x32_bf16 v[212:215], a[196:199], v[84:87], 0
v_mfma_f32_16x16x32_bf16 v[212:215], a[164:167], v[80:83], v[212:215]
ds_read_b64_tr_b16 a[158:159], v2 offset:25952
v_mfma_f32_16x16x32_bf16 v[216:219], a[168:171], v[80:83], 0
ds_read_b64_tr_b16 a[160:161], v2 offset:25472
v_mfma_f32_16x16x32_bf16 v[216:219], a[200:203], v[84:87], v[216:219]
v_mfma_f32_16x16x32_bf16 v[220:223], a[204:207], v[84:87], 0
ds_read_b64_tr_b16 a[162:163], v2 offset:25984
v_mfma_f32_16x16x32_bf16 v[220:223], a[172:175], v[80:83], v[220:223]
ds_read_b64_tr_b16 a[164:165], v2 offset:25504
v_mfma_f32_16x16x32_bf16 a[220:223], a[228:231], v[80:83], 0
v_mfma_f32_16x16x32_bf16 a[220:223], a[228:231], v[84:87], a[220:223]
ds_read_b64_tr_b16 a[166:167], v2 offset:26016
v_mfma_f32_16x16x32_bf16 v[64:67], a[80:83], a[0:3], v[36:39]
ds_read_b64_tr_b16 a[168:169], v2 offset:25536
v_mfma_f32_16x16x32_bf16 v[64:67], a[84:87], a[4:7], v[64:67]
v_mfma_f32_16x16x32_bf16 v[64:67], a[88:91], a[8:11], v[64:67]
ds_read_b64_tr_b16 a[170:171], v2 offset:26048
v_mfma_f32_16x16x32_bf16 v[64:67], a[92:95], a[12:15], v[64:67]
ds_read_b64_tr_b16 a[172:173], v2 offset:25568
v_exp_f32 v60, v60
v_exp_f32 v61, v61
v_exp_f32 v62, v62
v_exp_f32 v63, v63
v_cvt_pk_bf16_f32 v90, v60, v61
v_cvt_pk_bf16_f32 v91, v62, v63
v_mfma_f32_16x16x32_bf16 v[68:71], a[108:111], a[12:15], v[36:39]
v_mfma_f32_16x16x32_bf16 v[68:71], a[104:107], a[8:11], v[68:71]
ds_read_b64_tr_b16 a[174:175], v2 offset:26080
v_mfma_f32_16x16x32_bf16 v[68:71], a[100:103], a[4:7], v[68:71]
ds_read_b64_tr_b16 a[176:177], v2 offset:16896
v_mfma_f32_16x16x32_bf16 v[68:71], a[96:99], a[0:3], v[68:71]
ds_read_b64_tr_b16 a[178:179], v2 offset:17408
v_mfma_f32_16x16x32_bf16 v[72:75], a[112:115], a[0:3], v[36:39]
v_mfma_f32_16x16x32_bf16 v[72:75], a[116:119], a[4:7], v[72:75]
ds_read_b64_tr_b16 a[180:181], v2 offset:16928
v_mfma_f32_16x16x32_bf16 v[72:75], a[120:123], a[8:11], v[72:75]
v_mfma_f32_16x16x32_bf16 v[72:75], a[124:127], a[12:15], v[72:75]
ds_read_b64_tr_b16 a[182:183], v2 offset:17440
v_exp_f32 v64, v64
v_exp_f32 v65, v65
v_exp_f32 v66, v66
v_exp_f32 v67, v67
v_cvt_pk_bf16_f32 v80, v64, v65
v_cvt_pk_bf16_f32 v81, v66, v67
v_mfma_f32_16x16x32_bf16 v[76:79], a[140:143], a[12:15], v[36:39]
v_mfma_f32_16x16x32_bf16 v[76:79], a[136:139], a[8:11], v[76:79]
ds_read_b64_tr_b16 a[184:185], v2 offset:16960
v_mfma_f32_16x16x32_bf16 v[76:79], a[132:135], a[4:7], v[76:79]
s_waitcnt lgkmcnt(13)
v_mfma_f32_16x16x32_bf16 v[76:79], a[128:131], a[0:3], v[76:79]
ds_read_b64_tr_b16 a[186:187], v2 offset:17472
v_mfma_f32_16x16x32_bf16 v[224:227], a[144:147], v[88:91], v[224:227]
v_mfma_f32_16x16x32_bf16 v[228:231], a[148:151], v[88:91], v[228:231]
ds_read_b64_tr_b16 a[188:189], v2 offset:16992
v_mfma_f32_16x16x32_bf16 v[232:235], a[152:155], v[88:91], v[232:235]
s_waitcnt lgkmcnt(7)
v_mfma_f32_16x16x32_bf16 v[236:239], a[156:159], v[88:91], v[236:239]
ds_read_b64_tr_b16 a[190:191], v2 offset:17504
v_mfma_f32_16x16x32_bf16 v[240:243], a[160:163], v[88:91], v[240:243]
v_mfma_f32_16x16x32_bf16 v[244:247], a[164:167], v[88:91], v[244:247]
ds_read_b64_tr_b16 a[192:193], v2 offset:17024
v_mfma_f32_16x16x32_bf16 v[248:251], a[168:171], v[88:91], v[248:251]
v_exp_f32 v68, v68
v_exp_f32 v69, v69
v_exp_f32 v70, v70
v_exp_f32 v71, v71
v_cvt_pk_bf16_f32 v82, v68, v69
v_cvt_pk_bf16_f32 v83, v70, v71
v_mfma_f32_16x16x32_bf16 v[252:255], a[172:175], v[88:91], v[252:255]
ds_read_b64_tr_b16 a[194:195], v2 offset:17536
v_mfma_f32_16x16x32_bf16 a[224:227], a[228:231], v[88:91], a[224:227]
v_mfma_f32_16x16x32_bf16 v[56:59], a[80:83], a[16:19], v[40:43]
ds_read_b64_tr_b16 a[196:197], v2 offset:17056
v_mfma_f32_16x16x32_bf16 v[56:59], a[84:87], a[20:23], v[56:59]
v_mfma_f32_16x16x32_bf16 v[56:59], a[88:91], a[24:27], v[56:59]
ds_read_b64_tr_b16 a[198:199], v2 offset:17568
v_mfma_f32_16x16x32_bf16 v[56:59], a[92:95], a[28:31], v[56:59]
s_add_u32 m0, s33, 33792
v_exp_f32 v72, v72
v_exp_f32 v73, v73
v_exp_f32 v74, v74
v_exp_f32 v75, v75
v_cvt_pk_bf16_f32 v84, v72, v73
v_cvt_pk_bf16_f32 v85, v74, v75
v_mfma_f32_16x16x32_bf16 v[60:63], a[108:111], a[28:31], v[40:43]
buffer_load_dwordx4 v3, s[16:19], 0 offen nt lds
v_mfma_f32_16x16x32_bf16 v[60:63], a[104:107], a[24:27], v[60:63]
v_mfma_f32_16x16x32_bf16 v[60:63], a[100:103], a[20:23], v[60:63]
ds_read_b64_tr_b16 a[200:201], v2 offset:17088
v_mfma_f32_16x16x32_bf16 v[60:63], a[96:99], a[16:19], v[60:63]
v_mfma_f32_16x16x32_bf16 v[64:67], a[112:115], a[16:19], v[40:43]
ds_read_b64_tr_b16 a[202:203], v2 offset:17600
v_mfma_f32_16x16x32_bf16 v[64:67], a[116:119], a[20:23], v[64:67]
v_mfma_f32_16x16x32_bf16 v[64:67], a[120:123], a[24:27], v[64:67]
ds_read_b64_tr_b16 a[204:205], v2 offset:17120
v_mfma_f32_16x16x32_bf16 v[64:67], a[124:127], a[28:31], v[64:67]
s_add_u32 m0, s33, 33824
v_exp_f32 v76, v76
v_exp_f32 v77, v77
v_exp_f32 v78, v78
v_exp_f32 v79, v79
v_cvt_pk_bf16_f32 v86, v76, v77
v_cvt_pk_bf16_f32 v87, v78, v79
v_mfma_f32_16x16x32_bf16 v[68:71], a[140:143], a[28:31], v[40:43]
buffer_load_dwordx4 v3, s[16:19], 0 offen offset:1024 nt lds
v_mfma_f32_16x16x32_bf16 v[68:71], a[136:139], a[24:27], v[68:71]
v_mfma_f32_16x16x32_bf16 v[68:71], a[132:135], a[20:23], v[68:71]
ds_read_b64_tr_b16 a[206:207], v2 offset:17632
v_mfma_f32_16x16x32_bf16 v[68:71], a[128:131], a[16:19], v[68:71]
v_mfma_f32_16x16x32_bf16 v[96:99], a[144:147], v[80:83], v[96:99]
s_waitcnt lgkmcnt(8)
v_mfma_f32_16x16x32_bf16 v[96:99], a[176:179], v[84:87], v[96:99]
v_mfma_f32_16x16x32_bf16 v[100:103], a[180:183], v[84:87], v[100:103]
v_mfma_f32_16x16x32_bf16 v[100:103], a[148:151], v[80:83], v[100:103]
s_add_u32 m0, s33, 33856
v_mfma_f32_16x16x32_bf16 v[104:107], a[152:155], v[80:83], v[104:107]
buffer_load_dwordx4 v3, s[16:19], 0 offen offset:2048 nt lds
v_mfma_f32_16x16x32_bf16 v[104:107], a[184:187], v[84:87], v[104:107]
v_exp_f32 v56, v56
v_exp_f32 v57, v57
v_exp_f32 v58, v58
v_exp_f32 v59, v59
v_cvt_pk_bf16_f32 v88, v56, v57
v_cvt_pk_bf16_f32 v89, v58, v59
v_mfma_f32_16x16x32_bf16 v[108:111], a[188:191], v[84:87], v[108:111]
v_mfma_f32_16x16x32_bf16 v[108:111], a[156:159], v[80:83], v[108:111]
s_waitcnt lgkmcnt(0)
v_mfma_f32_16x16x32_bf16 v[112:115], a[160:163], v[80:83], v[112:115]
buffer_load_dwordx4 v[16:19], v3, s[24:27], s35 offen nt
v_mfma_f32_16x16x32_bf16 v[112:115], a[192:195], v[84:87], v[112:115]
v_mfma_f32_16x16x32_bf16 v[116:119], a[196:199], v[84:87], v[116:119]
v_mfma_f32_16x16x32_bf16 v[116:119], a[164:167], v[80:83], v[116:119]
s_add_u32 m0, s33, 33888
v_mfma_f32_16x16x32_bf16 v[120:123], a[168:171], v[80:83], v[120:123]
buffer_load_dwordx4 v3, s[16:19], 0 offen offset:3072 nt lds
v_mfma_f32_16x16x32_bf16 v[120:123], a[200:203], v[84:87], v[120:123]
v_exp_f32 v60, v60
v_exp_f32 v61, v61
v_exp_f32 v62, v62
v_exp_f32 v63, v63
v_cvt_pk_bf16_f32 v90, v60, v61
v_cvt_pk_bf16_f32 v91, v62, v63
v_mfma_f32_16x16x32_bf16 v[124:127], a[204:207], v[84:87], v[124:127]
s_add_u32 s12, s12, 16384
s_addc_u32 s13, s13, 0
v_mfma_f32_16x16x32_bf16 v[124:127], a[172:175], v[80:83], v[124:127]
v_mfma_f32_16x16x32_bf16 a[208:211], a[228:231], v[80:83], a[208:211]
v_mfma_f32_16x16x32_bf16 a[208:211], a[228:231], v[84:87], a[208:211]
s_add_u32 m0, s33, 16896
v_mfma_f32_16x16x32_bf16 v[72:75], a[80:83], a[32:35], v[44:47]
v_mfma_f32_16x16x32_bf16 v[72:75], a[84:87], a[36:39], v[72:75]
v_mfma_f32_16x16x32_bf16 v[72:75], a[88:91], a[40:43], v[72:75]
buffer_load_dwordx4 v3, s[12:15], 0 offen nt lds
v_mfma_f32_16x16x32_bf16 v[72:75], a[92:95], a[44:47], v[72:75]
v_exp_f32 v64, v64
v_exp_f32 v65, v65
v_exp_f32 v66, v66
v_exp_f32 v67, v67
v_cvt_pk_bf16_f32 v92, v64, v65
v_cvt_pk_bf16_f32 v93, v66, v67
v_mfma_f32_16x16x32_bf16 v[76:79], a[108:111], a[44:47], v[44:47]
v_mfma_f32_16x16x32_bf16 v[76:79], a[104:107], a[40:43], v[76:79]
v_mfma_f32_16x16x32_bf16 v[76:79], a[100:103], a[36:39], v[76:79]
v_mfma_f32_16x16x32_bf16 v[76:79], a[96:99], a[32:35], v[76:79]
s_add_u32 m0, s33, 16928
v_mfma_f32_16x16x32_bf16 v[56:59], a[112:115], a[32:35], v[44:47]
v_mfma_f32_16x16x32_bf16 v[56:59], a[116:119], a[36:39], v[56:59]
v_mfma_f32_16x16x32_bf16 v[56:59], a[120:123], a[40:43], v[56:59]
buffer_load_dwordx4 v3, s[12:15], 0 offen offset:1024 nt lds
v_mfma_f32_16x16x32_bf16 v[56:59], a[124:127], a[44:47], v[56:59]
v_exp_f32 v68, v68
v_exp_f32 v69, v69
v_exp_f32 v70, v70
v_exp_f32 v71, v71
v_cvt_pk_bf16_f32 v94, v68, v69
v_cvt_pk_bf16_f32 v95, v70, v71
v_mfma_f32_16x16x32_bf16 v[60:63], a[140:143], a[44:47], v[44:47]
v_mfma_f32_16x16x32_bf16 v[60:63], a[136:139], a[40:43], v[60:63]
v_mfma_f32_16x16x32_bf16 v[60:63], a[132:135], a[36:39], v[60:63]
v_mfma_f32_16x16x32_bf16 v[60:63], a[128:131], a[32:35], v[60:63]
v_mfma_f32_16x16x32_bf16 v[128:131], a[144:147], v[88:91], v[128:131]
s_add_u32 m0, s33, 16960
v_mfma_f32_16x16x32_bf16 v[128:131], a[176:179], v[92:95], v[128:131]
buffer_load_dwordx4 v3, s[12:15], 0 offen offset:2048 nt lds
v_exp_f32 v72, v72
v_exp_f32 v73, v73
v_exp_f32 v74, v74
v_exp_f32 v75, v75
v_cvt_pk_bf16_f32 v80, v72, v73
v_cvt_pk_bf16_f32 v81, v74, v75
v_mfma_f32_16x16x32_bf16 v[132:135], a[180:183], v[92:95], v[132:135]
v_mfma_f32_16x16x32_bf16 v[132:135], a[148:151], v[88:91], v[132:135]
v_mfma_f32_16x16x32_bf16 v[136:139], a[152:155], v[88:91], v[136:139]
v_mfma_f32_16x16x32_bf16 v[136:139], a[184:187], v[92:95], v[136:139]
v_mfma_f32_16x16x32_bf16 v[140:143], a[188:191], v[92:95], v[140:143]
v_mfma_f32_16x16x32_bf16 v[140:143], a[156:159], v[88:91], v[140:143]
v_mfma_f32_16x16x32_bf16 v[144:147], a[160:163], v[88:91], v[144:147]
s_add_u32 m0, s33, 16992
v_mfma_f32_16x16x32_bf16 v[144:147], a[192:195], v[92:95], v[144:147]
buffer_load_dwordx4 v3, s[12:15], 0 offen offset:3072 nt lds
v_exp_f32 v76, v76
v_exp_f32 v77, v77
v_exp_f32 v78, v78
v_exp_f32 v79, v79
v_cvt_pk_bf16_f32 v82, v76, v77
v_cvt_pk_bf16_f32 v83, v78, v79
v_mfma_f32_16x16x32_bf16 v[148:151], a[196:199], v[92:95], v[148:151]
v_mfma_f32_16x16x32_bf16 v[148:151], a[164:167], v[88:91], v[148:151]
v_mfma_f32_16x16x32_bf16 v[152:155], a[168:171], v[88:91], v[152:155]
v_mfma_f32_16x16x32_bf16 v[152:155], a[200:203], v[92:95], v[152:155]
v_mfma_f32_16x16x32_bf16 v[156:159], a[204:207], v[92:95], v[156:159]
s_waitcnt vmcnt(9) lgkmcnt(0)
v_mfma_f32_16x16x32_bf16 v[156:159], a[172:175], v[88:91], v[156:159]
v_mfma_f32_16x16x32_bf16 a[212:215], a[228:231], v[88:91], a[212:215]
s_barrier
v_mfma_f32_16x16x32_bf16 a[212:215], a[228:231], v[92:95], a[212:215]
v_exp_f32 v56, v56
v_exp_f32 v57, v57
v_exp_f32 v58, v58
v_exp_f32 v59, v59
v_cvt_pk_bf16_f32 v84, v56, v57
v_cvt_pk_bf16_f32 v85, v58, v59
v_mfma_f32_16x16x32_bf16 v[64:67], a[80:83], a[48:51], v[48:51]
v_mfma_f32_16x16x32_bf16 v[64:67], a[84:87], a[52:55], v[64:67]
ds_read_b128 a[80:83], v1 offset:8448
v_mfma_f32_16x16x32_bf16 v[64:67], a[88:91], a[56:59], v[64:67]
v_mfma_f32_16x16x32_bf16 v[64:67], a[92:95], a[60:63], v[64:67]
ds_read_b128 a[84:87], v1 offset:8512
ds_read_b128 a[88:91], v1 offset:8576
v_mfma_f32_16x16x32_bf16 v[68:71], a[108:111], a[60:63], v[48:51]
v_mfma_f32_16x16x32_bf16 v[68:71], a[104:107], a[56:59], v[68:71]
ds_read_b128 a[92:95], v1 offset:8640
v_mfma_f32_16x16x32_bf16 v[68:71], a[100:103], a[52:55], v[68:71]
v_mfma_f32_16x16x32_bf16 v[68:71], a[96:99], a[48:51], v[68:71]
ds_read_b128 a[108:111], v1 offset:9152
v_exp_f32 v60, v60
v_exp_f32 v61, v61
v_exp_f32 v62, v62
v_exp_f32 v63, v63
v_cvt_pk_bf16_f32 v86, v60, v61
v_cvt_pk_bf16_f32 v87, v62, v63
v_mfma_f32_16x16x32_bf16 v[72:75], a[112:115], a[48:51], v[48:51]
v_mfma_f32_16x16x32_bf16 v[72:75], a[116:119], a[52:55], v[72:75]
v_mfma_f32_16x16x32_bf16 v[72:75], a[120:123], a[56:59], v[72:75]
ds_read_b128 a[104:107], v1 offset:9088
v_mfma_f32_16x16x32_bf16 v[72:75], a[124:127], a[60:63], v[72:75]
v_mfma_f32_16x16x32_bf16 v[76:79], a[140:143], a[60:63], v[48:51]
ds_read_b128 a[100:103], v1 offset:9024
v_mfma_f32_16x16x32_bf16 v[76:79], a[136:139], a[56:59], v[76:79]
v_mfma_f32_16x16x32_bf16 v[76:79], a[132:135], a[52:55], v[76:79]
ds_read_b128 a[96:99], v1 offset:8960
v_mfma_f32_16x16x32_bf16 v[76:79], a[128:131], a[48:51], v[76:79]
v_exp_f32 v64, v64
v_exp_f32 v65, v65
v_exp_f32 v66, v66
v_exp_f32 v67, v67
v_cvt_pk_bf16_f32 v88, v64, v65
v_cvt_pk_bf16_f32 v89, v66, v67
v_mfma_f32_16x16x32_bf16 v[160:163], a[144:147], v[80:83], v[160:163]
ds_read_b128 a[112:115], v1
v_mfma_f32_16x16x32_bf16 v[160:163], a[176:179], v[84:87], v[160:163]
v_mfma_f32_16x16x32_bf16 v[164:167], a[180:183], v[84:87], v[164:167]
ds_read_b128 a[116:119], v1 offset:64
v_mfma_f32_16x16x32_bf16 v[164:167], a[148:151], v[80:83], v[164:167]
v_mfma_f32_16x16x32_bf16 v[168:171], a[152:155], v[80:83], v[168:171]
ds_read_b128 a[120:123], v1 offset:128
v_mfma_f32_16x16x32_bf16 v[168:171], a[184:187], v[84:87], v[168:171]
v_mfma_f32_16x16x32_bf16 v[172:175], a[188:191], v[84:87], v[172:175]
ds_read_b128 a[124:127], v1 offset:192
v_mfma_f32_16x16x32_bf16 v[172:175], a[156:159], v[80:83], v[172:175]
v_exp_f32 v68, v68
v_exp_f32 v69, v69
v_exp_f32 v70, v70
v_exp_f32 v71, v71
v_cvt_pk_bf16_f32 v90, v68, v69
v_cvt_pk_bf16_f32 v91, v70, v71
v_mfma_f32_16x16x32_bf16 v[176:179], a[160:163], v[80:83], v[176:179]
ds_read_b128 a[140:143], v1 offset:704
v_mfma_f32_16x16x32_bf16 v[176:179], a[192:195], v[84:87], v[176:179]
v_mfma_f32_16x16x32_bf16 v[180:183], a[196:199], v[84:87], v[180:183]
ds_read_b128 a[136:139], v1 offset:640
v_mfma_f32_16x16x32_bf16 v[180:183], a[164:167], v[80:83], v[180:183]
v_mfma_f32_16x16x32_bf16 v[184:187], a[168:171], v[80:83], v[184:187]
ds_read_b128 a[132:135], v1 offset:576
v_mfma_f32_16x16x32_bf16 v[184:187], a[200:203], v[84:87], v[184:187]
s_mov_b32 s34, 6
v_mfma_f32_16x16x32_bf16 v[188:191], a[204:207], v[84:87], v[188:191]
ds_read_b128 a[128:131], v1 offset:512
v_mfma_f32_16x16x32_bf16 v[188:191], a[172:175], v[80:83], v[188:191]
s_bitcmp0_b32 s44, 0
v_exp_f32 v72, v72
v_exp_f32 v73, v73
v_exp_f32 v74, v74
v_exp_f32 v75, v75
v_cvt_pk_bf16_f32 v92, v72, v73
v_cvt_pk_bf16_f32 v93, v74, v75
v_mfma_f32_16x16x32_bf16 a[216:219], a[228:231], v[80:83], a[216:219]
s_waitcnt lgkmcnt(8)
v_mfma_f32_16x16x32_bf16 a[216:219], a[228:231], v[84:87], a[216:219]
s_cbranch_scc1 L_n011
L_m011:
v_exp_f32 v76, v76
v_mfma_f32_16x16x32_bf16 v[56:59], a[80:83], a[64:67], v[52:55]
v_mfma_f32_16x16x32_bf16 v[56:59], a[84:87], a[68:71], v[56:59]
v_exp_f32 v77, v77
v_mfma_f32_16x16x32_bf16 v[56:59], a[88:91], a[72:75], v[56:59]
v_cvt_pk_bf16_f32 v94, v76, v77
v_mfma_f32_16x16x32_bf16 v[56:59], a[92:95], a[76:79], v[56:59]
v_exp_f32 v78, v78
v_mfma_f32_16x16x32_bf16 v[60:63], a[108:111], a[76:79], v[52:55]
buffer_load_dwordx4 v[20:23], v3, s[24:27], s35 offen offset:1024 nt
v_mfma_f32_16x16x32_bf16 v[60:63], a[104:107], a[72:75], v[60:63]
s_waitcnt vmcnt(5) lgkmcnt(0)
v_exp_f32 v79, v79
v_mfma_f32_16x16x32_bf16 v[60:63], a[100:103], a[68:71], v[60:63]
v_cvt_pk_bf16_f32 v95, v78, v79
v_mfma_f32_16x16x32_bf16 v[60:63], a[96:99], a[64:67], v[60:63]
s_barrier
s_add_u32 s16, s16, 16384
s_addc_u32 s17, s17, 0
v_mfma_f32_16x16x32_bf16 v[192:195], a[144:147], v[88:91], v[192:195]
ds_read_b64_tr_b16 a[144:145], v2 offset:8448
v_mfma_f32_16x16x32_bf16 v[192:195], a[176:179], v[92:95], v[192:195]
v_exp_f32 v56, v56
v_mfma_f32_16x16x32_bf16 v[196:199], a[180:183], v[92:95], v[196:199]
ds_read_b64_tr_b16 a[146:147], v2 offset:8960
v_mfma_f32_16x16x32_bf16 v[196:199], a[148:151], v[88:91], v[196:199]
ds_read_b64_tr_b16 a[148:149], v2 offset:8480
v_mfma_f32_16x16x32_bf16 v[200:203], a[152:155], v[88:91], v[200:203]
v_exp_f32 v57, v57
v_mfma_f32_16x16x32_bf16 v[200:203], a[184:187], v[92:95], v[200:203]
ds_read_b64_tr_b16 a[150:151], v2 offset:8992
v_cvt_pk_bf16_f32 v80, v56, v57
v_mfma_f32_16x16x32_bf16 v[204:207], a[188:191], v[92:95], v[204:207]
ds_read_b64_tr_b16 a[152:153], v2 offset:8512
v_mfma_f32_16x16x32_bf16 v[204:207], a[156:159], v[88:91], v[204:207]
v_exp_f32 v58, v58
v_mfma_f32_16x16x32_bf16 v[208:211], a[160:163], v[88:91], v[208:211]
ds_read_b64_tr_b16 a[154:155], v2 offset:9024
v_mfma_f32_16x16x32_bf16 v[208:211], a[192:195], v[92:95], v[208:211]
ds_read_b64_tr_b16 a[156:157], v2 offset:8544
v_mfma_f32_16x16x32_bf16 v[212:215], a[196:199], v[92:95], v[212:215]
v_exp_f32 v59, v59
v_mfma_f32_16x16x32_bf16 v[212:215], a[164:167], v[88:91], v[212:215]
ds_read_b64_tr_b16 a[158:159], v2 offset:9056
v_cvt_pk_bf16_f32 v81, v58, v59
v_mfma_f32_16x16x32_bf16 v[216:219], a[168:171], v[88:91], v[216:219]
ds_read_b64_tr_b16 a[160:161], v2 offset:8576
v_mfma_f32_16x16x32_bf16 v[216:219], a[200:203], v[92:95], v[216:219]
v_exp_f32 v60, v60
v_mfma_f32_16x16x32_bf16 v[220:223], a[204:207], v[92:95], v[220:223]
ds_read_b64_tr_b16 a[162:163], v2 offset:9088
v_mfma_f32_16x16x32_bf16 v[220:223], a[172:175], v[88:91], v[220:223]
ds_read_b64_tr_b16 a[164:165], v2 offset:8608
v_mfma_f32_16x16x32_bf16 a[220:223], a[228:231], v[88:91], a[220:223]
v_exp_f32 v61, v61
v_mfma_f32_16x16x32_bf16 a[220:223], a[228:231], v[92:95], a[220:223]
ds_read_b64_tr_b16 a[166:167], v2 offset:9120
v_cvt_pk_bf16_f32 v82, v60, v61
v_mfma_f32_16x16x32_bf16 v[64:67], a[80:83], a[0:3], v[36:39]
s_waitcnt vmcnt(6)
ds_read_b64_tr_b16 a[168:169], v2 offset:8640
v_mfma_f32_16x16x32_bf16 v[64:67], a[84:87], a[4:7], v[64:67]
v_exp_f32 v62, v62
v_mfma_f32_16x16x32_bf16 v[64:67], a[88:91], a[8:11], v[64:67]
ds_read_b64_tr_b16 a[170:171], v2 offset:9152
v_lshlrev_b32 v32, 16, v16
v_mfma_f32_16x16x32_bf16 v[64:67], a[92:95], a[12:15], v[64:67]
ds_read_b64_tr_b16 a[172:173], v2 offset:8672
v_and_b32 v33, s45, v16
v_mfma_f32_16x16x32_bf16 v[68:71], a[108:111], a[12:15], v[36:39]
v_exp_f32 v63, v63
v_mfma_f32_16x16x32_bf16 v[68:71], a[104:107], a[8:11], v[68:71]
ds_read_b64_tr_b16 a[174:175], v2 offset:9184
v_cvt_pk_bf16_f32 v83, v62, v63
v_mfma_f32_16x16x32_bf16 v[68:71], a[100:103], a[4:7], v[68:71]
ds_read_b64_tr_b16 a[176:177], v2
v_mul_f32 v32, s38, v32
v_mfma_f32_16x16x32_bf16 v[68:71], a[96:99], a[0:3], v[68:71]
ds_read_b64_tr_b16 a[178:179], v2 offset:512
v_mul_f32 v33, s38, v33
v_mfma_f32_16x16x32_bf16 v[72:75], a[112:115], a[0:3], v[36:39]
v_exp_f32 v64, v64
v_mfma_f32_16x16x32_bf16 v[72:75], a[116:119], a[4:7], v[72:75]
ds_read_b64_tr_b16 a[180:181], v2 offset:32
v_cvt_pk_bf16_f32 v16, v32, v33
v_mfma_f32_16x16x32_bf16 v[72:75], a[120:123], a[8:11], v[72:75]
v_exp_f32 v65, v65
v_mfma_f32_16x16x32_bf16 v[72:75], a[124:127], a[12:15], v[72:75]
ds_read_b64_tr_b16 a[182:183], v2 offset:544
v_cvt_pk_bf16_f32 v88, v64, v65
v_mfma_f32_16x16x32_bf16 v[76:79], a[140:143], a[12:15], v[36:39]
v_exp_f32 v66, v66
v_mfma_f32_16x16x32_bf16 v[76:79], a[136:139], a[8:11], v[76:79]
ds_read_b64_tr_b16 a[184:185], v2 offset:64
v_lshlrev_b32 v34, 16, v17
v_mfma_f32_16x16x32_bf16 v[76:79], a[132:135], a[4:7], v[76:79]
s_waitcnt lgkmcnt(13)
v_exp_f32 v67, v67
v_mfma_f32_16x16x32_bf16 v[76:79], a[128:131], a[0:3], v[76:79]
ds_read_b64_tr_b16 a[186:187], v2 offset:576
v_cvt_pk_bf16_f32 v89, v66, v67
v_mfma_f32_16x16x32_bf16 v[224:227], a[144:147], v[80:83], v[224:227]
v_exp_f32 v68, v68
v_mfma_f32_16x16x32_bf16 v[228:231], a[148:151], v[80:83], v[228:231]
ds_read_b64_tr_b16 a[188:189], v2 offset:96
v_and_b32 v35, s45, v17
v_mfma_f32_16x16x32_bf16 v[232:235], a[152:155], v[80:83], v[232:235]
s_waitcnt lgkmcnt(7)
v_exp_f32 v69, v69
v_mfma_f32_16x16x32_bf16 v[236:239], a[156:159], v[80:83], v[236:239]
ds_read_b64_tr_b16 a[190:191], v2 offset:608
v_cvt_pk_bf16_f32 v90, v68, v69
v_mfma_f32_16x16x32_bf16 v[240:243], a[160:163], v[80:83], v[240:243]
v_exp_f32 v70, v70
v_mfma_f32_16x16x32_bf16 v[244:247], a[164:167], v[80:83], v[244:247]
ds_read_b64_tr_b16 a[192:193], v2 offset:128
v_mul_f32 v34, s38, v34
v_mfma_f32_16x16x32_bf16 v[248:251], a[168:171], v[80:83], v[248:251]
v_exp_f32 v71, v71
v_mfma_f32_16x16x32_bf16 v[252:255], a[172:175], v[80:83], v[252:255]
ds_read_b64_tr_b16 a[194:195], v2 offset:640
v_cvt_pk_bf16_f32 v91, v70, v71
v_mfma_f32_16x16x32_bf16 a[224:227], a[228:231], v[80:83], a[224:227]
v_mfma_f32_16x16x32_bf16 v[56:59], a[80:83], a[16:19], v[40:43]
ds_read_b64_tr_b16 a[196:197], v2 offset:160
v_mul_f32 v35, s38, v35
v_mfma_f32_16x16x32_bf16 v[56:59], a[84:87], a[20:23], v[56:59]
v_mfma_f32_16x16x32_bf16 v[56:59], a[88:91], a[24:27], v[56:59]
ds_read_b64_tr_b16 a[198:199], v2 offset:672
v_mfma_f32_16x16x32_bf16 v[56:59], a[92:95], a[28:31], v[56:59]
s_add_u32 m0, s33, 50688
v_exp_f32 v72, v72
v_exp_f32 v73, v73
v_exp_f32 v74, v74
v_exp_f32 v75, v75
v_cvt_pk_bf16_f32 v92, v72, v73
v_cvt_pk_bf16_f32 v93, v74, v75
v_mfma_f32_16x16x32_bf16 v[60:63], a[108:111], a[28:31], v[40:43]
buffer_load_dwordx4 v3, s[16:19], 0 offen nt lds
v_mfma_f32_16x16x32_bf16 v[60:63], a[104:107], a[24:27], v[60:63]
v_mfma_f32_16x16x32_bf16 v[60:63], a[100:103], a[20:23], v[60:63]
ds_read_b64_tr_b16 a[200:201], v2 offset:192
v_mfma_f32_16x16x32_bf16 v[60:63], a[96:99], a[16:19], v[60:63]
v_exp_f32 v76, v76
v_mfma_f32_16x16x32_bf16 v[64:67], a[112:115], a[16:19], v[40:43]
ds_read_b64_tr_b16 a[202:203], v2 offset:704
v_cvt_pk_bf16_f32 v17, v34, v35
v_mfma_f32_16x16x32_bf16 v[64:67], a[116:119], a[20:23], v[64:67]
v_exp_f32 v77, v77
v_mfma_f32_16x16x32_bf16 v[64:67], a[120:123], a[24:27], v[64:67]
ds_read_b64_tr_b16 a[204:205], v2 offset:224
v_cvt_pk_bf16_f32 v94, v76, v77
v_mfma_f32_16x16x32_bf16 v[64:67], a[124:127], a[28:31], v[64:67]
s_add_u32 m0, s33, 50720
v_exp_f32 v78, v78
v_mfma_f32_16x16x32_bf16 v[68:71], a[140:143], a[28:31], v[40:43]
buffer_load_dwordx4 v3, s[16:19], 0 offen offset:1024 nt lds
v_mfma_f32_16x16x32_bf16 v[68:71], a[136:139], a[24:27], v[68:71]
v_exp_f32 v79, v79
v_mfma_f32_16x16x32_bf16 v[68:71], a[132:135], a[20:23], v[68:71]
ds_read_b64_tr_b16 a[206:207], v2 offset:736
v_cvt_pk_bf16_f32 v95, v78, v79
v_mfma_f32_16x16x32_bf16 v[68:71], a[128:131], a[16:19], v[68:71]
v_exp_f32 v56, v56
v_mfma_f32_16x16x32_bf16 v[96:99], a[144:147], v[88:91], v[96:99]
s_waitcnt lgkmcnt(8)
v_lshlrev_b32 v32, 16, v18
v_and_b32 v33, s45, v18
v_mfma_f32_16x16x32_bf16 v[96:99], a[176:179], v[92:95], v[96:99]
v_exp_f32 v57, v57
v_mfma_f32_16x16x32_bf16 v[100:103], a[180:183], v[92:95], v[100:103]
v_cvt_pk_bf16_f32 v80, v56, v57
v_mul_f32 v32, s38, v32
v_mfma_f32_16x16x32_bf16 v[100:103], a[148:151], v[88:91], v[100:103]
s_add_u32 m0, s33, 50752
v_exp_f32 v58, v58
v_mfma_f32_16x16x32_bf16 v[104:107], a[152:155], v[88:91], v[104:107]
buffer_load_dwordx4 v3, s[16:19], 0 offen offset:2048 nt lds
v_mfma_f32_16x16x32_bf16 v[104:107], a[184:187], v[92:95], v[104:107]
v_exp_f32 v59, v59
v_mfma_f32_16x16x32_bf16 v[108:111], a[188:191], v[92:95], v[108:111]
v_cvt_pk_bf16_f32 v81, v58, v59
v_mul_f32 v33, s38, v33
v_mfma_f32_16x16x32_bf16 v[108:111], a[156:159], v[88:91], v[108:111]
s_waitcnt lgkmcnt(0)
v_exp_f32 v60, v60
v_mfma_f32_16x16x32_bf16 v[112:115], a[160:163], v[88:91], v[112:115]
buffer_load_dwordx4 v[24:27], v3, s[24:27], s35 offen offset:2048 nt
v_mfma_f32_16x16x32_bf16 v[112:115], a[192:195], v[92:95], v[112:115]
v_exp_f32 v61, v61
v_mfma_f32_16x16x32_bf16 v[116:119], a[196:199], v[92:95], v[116:119]
v_cvt_pk_bf16_f32 v82, v60, v61
v_cvt_pk_bf16_f32 v18, v32, v33
v_mfma_f32_16x16x32_bf16 v[116:119], a[164:167], v[88:91], v[116:119]
s_add_u32 m0, s33, 50784
v_exp_f32 v62, v62
v_mfma_f32_16x16x32_bf16 v[120:123], a[168:171], v[88:91], v[120:123]
buffer_load_dwordx4 v3, s[16:19], 0 offen offset:3072 nt lds
v_mfma_f32_16x16x32_bf16 v[120:123], a[200:203], v[92:95], v[120:123]
v_exp_f32 v63, v63
v_mfma_f32_16x16x32_bf16 v[124:127], a[204:207], v[92:95], v[124:127]
s_add_u32 s12, s12, 16384
s_addc_u32 s13, s13, 0
v_cvt_pk_bf16_f32 v83, v62, v63
v_mfma_f32_16x16x32_bf16 v[124:127], a[172:175], v[88:91], v[124:127]
v_mfma_f32_16x16x32_bf16 a[208:211], a[228:231], v[88:91], a[208:211]
v_lshlrev_b32 v34, 16, v19
v_and_b32 v35, s45, v19
v_mfma_f32_16x16x32_bf16 a[208:211], a[228:231], v[92:95], a[208:211]
s_add_u32 m0, s33, 0
v_mfma_f32_16x16x32_bf16 v[72:75], a[80:83], a[32:35], v[44:47]
v_mul_f32 v34, s38, v34
v_mfma_f32_16x16x32_bf16 v[72:75], a[84:87], a[36:39], v[72:75]
v_mfma_f32_16x16x32_bf16 v[72:75], a[88:91], a[40:43], v[72:75]
buffer_load_dwordx4 v3, s[12:15], 0 offen nt lds
v_mfma_f32_16x16x32_bf16 v[72:75], a[92:95], a[44:47], v[72:75]
v_exp_f32 v64, v64
v_exp_f32 v65, v65
v_exp_f32 v66, v66
v_exp_f32 v67, v67
v_cvt_pk_bf16_f32 v84, v64, v65
v_cvt_pk_bf16_f32 v85, v66, v67
v_mfma_f32_16x16x32_bf16 v[76:79], a[108:111], a[44:47], v[44:47]
v_mul_f32 v35, s38, v35
v_mfma_f32_16x16x32_bf16 v[76:79], a[104:107], a[40:43], v[76:79]
v_exp_f32 v68, v68
v_mfma_f32_16x16x32_bf16 v[76:79], a[100:103], a[36:39], v[76:79]
v_cvt_pk_bf16_f32 v19, v34, v35
v_mfma_f32_16x16x32_bf16 v[76:79], a[96:99], a[32:35], v[76:79]
s_add_u32 m0, s33, 32
v_exp_f32 v69, v69
v_mfma_f32_16x16x32_bf16 v[56:59], a[112:115], a[32:35], v[44:47]
v_cvt_pk_bf16_f32 v86, v68, v69
v_mfma_f32_16x16x32_bf16 v[56:59], a[116:119], a[36:39], v[56:59]
v_exp_f32 v70, v70
v_mfma_f32_16x16x32_bf16 v[56:59], a[120:123], a[40:43], v[56:59]
buffer_load_dwordx4 v3, s[12:15], 0 offen offset:1024 nt lds
v_mfma_f32_16x16x32_bf16 v[56:59], a[124:127], a[44:47], v[56:59]
v_exp_f32 v71, v71
v_mfma_f32_16x16x32_bf16 v[60:63], a[140:143], a[44:47], v[44:47]
v_exp_f32 v72, v72
v_mfma_f32_16x16x32_bf16 v[60:63], a[136:139], a[40:43], v[60:63]
v_cvt_pk_bf16_f32 v87, v70, v71
v_mfma_f32_16x16x32_bf16 v[60:63], a[132:135], a[36:39], v[60:63]
v_exp_f32 v73, v73
v_mfma_f32_16x16x32_bf16 v[60:63], a[128:131], a[32:35], v[60:63]
v_cvt_pk_bf16_f32 v88, v72, v73
v_mfma_f32_16x16x32_bf16 v[128:131], a[144:147], v[80:83], v[128:131]
s_add_u32 m0, s33, 64
v_exp_f32 v74, v74
v_mfma_f32_16x16x32_bf16 v[128:131], a[176:179], v[84:87], v[128:131]
buffer_load_dwordx4 v3, s[12:15], 0 offen offset:2048 nt lds
v_mfma_f32_16x16x32_bf16 v[132:135], a[180:183], v[84:87], v[132:135]
v_exp_f32 v75, v75
v_mfma_f32_16x16x32_bf16 v[132:135], a[148:151], v[80:83], v[132:135]
v_cvt_pk_bf16_f32 v89, v74, v75
v_mfma_f32_16x16x32_bf16 v[136:139], a[152:155], v[80:83], v[136:139]
v_exp_f32 v76, v76
v_mfma_f32_16x16x32_bf16 v[136:139], a[184:187], v[84:87], v[136:139]
v_mfma_f32_16x16x32_bf16 v[140:143], a[188:191], v[84:87], v[140:143]
v_exp_f32 v77, v77
v_mfma_f32_16x16x32_bf16 v[140:143], a[156:159], v[80:83], v[140:143]
v_cvt_pk_bf16_f32 v90, v76, v77
v_mfma_f32_16x16x32_bf16 v[144:147], a[160:163], v[80:83], v[144:147]
s_add_u32 m0, s33, 96
v_exp_f32 v78, v78
v_mfma_f32_16x16x32_bf16 v[144:147], a[192:195], v[84:87], v[144:147]
buffer_load_dwordx4 v3, s[12:15], 0 offen offset:3072 nt lds
v_mfma_f32_16x16x32_bf16 v[148:151], a[196:199], v[84:87], v[148:151]
v_exp_f32 v79, v79
v_mfma_f32_16x16x32_bf16 v[148:151], a[164:167], v[80:83], v[148:151]
v_cvt_pk_bf16_f32 v91, v78, v79
v_mfma_f32_16x16x32_bf16 v[152:155], a[168:171], v[80:83], v[152:155]
v_exp_f32 v56, v56
v_mfma_f32_16x16x32_bf16 v[152:155], a[200:203], v[84:87], v[152:155]
ds_write_b128 v4, v[16:19]
v_mfma_f32_16x16x32_bf16 v[156:159], a[204:207], v[84:87], v[156:159]
s_waitcnt vmcnt(10) lgkmcnt(1)
v_exp_f32 v57, v57
v_mfma_f32_16x16x32_bf16 v[156:159], a[172:175], v[80:83], v[156:159]
v_cvt_pk_bf16_f32 v92, v56, v57
v_mfma_f32_16x16x32_bf16 a[212:215], a[228:231], v[80:83], a[212:215]
s_barrier
v_exp_f32 v58, v58
v_mfma_f32_16x16x32_bf16 a[212:215], a[228:231], v[84:87], a[212:215]
v_mfma_f32_16x16x32_bf16 v[64:67], a[80:83], a[48:51], v[48:51]
v_exp_f32 v59, v59
v_mfma_f32_16x16x32_bf16 v[64:67], a[84:87], a[52:55], v[64:67]
ds_read_b128 a[80:83], v1 offset:25344
v_cvt_pk_bf16_f32 v93, v58, v59
v_mfma_f32_16x16x32_bf16 v[64:67], a[88:91], a[56:59], v[64:67]
v_mfma_f32_16x16x32_bf16 v[64:67], a[92:95], a[60:63], v[64:67]
ds_read_b128 a[84:87], v1 offset:25408
ds_read_b128 a[88:91], v1 offset:25472
v_mfma_f32_16x16x32_bf16 v[68:71], a[108:111], a[60:63], v[48:51]
v_mfma_f32_16x16x32_bf16 v[68:71], a[104:107], a[56:59], v[68:71]
ds_read_b128 a[92:95], v1 offset:25536
v_mfma_f32_16x16x32_bf16 v[68:71], a[100:103], a[52:55], v[68:71]
v_mfma_f32_16x16x32_bf16 v[68:71], a[96:99], a[48:51], v[68:71]
ds_read_b128 a[108:111], v1 offset:26048
v_exp_f32 v60, v60
v_exp_f32 v61, v61
v_exp_f32 v62, v62
v_exp_f32 v63, v63
v_cvt_pk_bf16_f32 v94, v60, v61
v_cvt_pk_bf16_f32 v95, v62, v63
v_mfma_f32_16x16x32_bf16 v[72:75], a[112:115], a[48:51], v[48:51]
v_mfma_f32_16x16x32_bf16 v[72:75], a[116:119], a[52:55], v[72:75]
v_exp_f32 v64, v64
v_mfma_f32_16x16x32_bf16 v[72:75], a[120:123], a[56:59], v[72:75]
ds_read_b128 a[104:107], v1 offset:25984
v_mfma_f32_16x16x32_bf16 v[72:75], a[124:127], a[60:63], v[72:75]
v_exp_f32 v65, v65
v_mfma_f32_16x16x32_bf16 v[76:79], a[140:143], a[60:63], v[48:51]
ds_read_b128 a[100:103], v1 offset:25920
v_cvt_pk_bf16_f32 v80, v64, v65
v_mfma_f32_16x16x32_bf16 v[76:79], a[136:139], a[56:59], v[76:79]
v_exp_f32 v66, v66
v_mfma_f32_16x16x32_bf16 v[76:79], a[132:135], a[52:55], v[76:79]
ds_read_b128 a[96:99], v1 offset:25856
v_mfma_f32_16x16x32_bf16 v[76:79], a[128:131], a[48:51], v[76:79]
v_exp_f32 v67, v67
v_mfma_f32_16x16x32_bf16 v[160:163], a[144:147], v[88:91], v[160:163]
ds_read_b128 a[112:115], v1 offset:16896
v_cvt_pk_bf16_f32 v81, v66, v67
v_mfma_f32_16x16x32_bf16 v[160:163], a[176:179], v[92:95], v[160:163]
v_exp_f32 v68, v68
v_mfma_f32_16x16x32_bf16 v[164:167], a[180:183], v[92:95], v[164:167]
ds_read_b128 a[116:119], v1 offset:16960
v_mfma_f32_16x16x32_bf16 v[164:167], a[148:151], v[88:91], v[164:167]
v_exp_f32 v69, v69
v_mfma_f32_16x16x32_bf16 v[168:171], a[152:155], v[88:91], v[168:171]
ds_read_b128 a[120:123], v1 offset:17024
v_cvt_pk_bf16_f32 v82, v68, v69
v_mfma_f32_16x16x32_bf16 v[168:171], a[184:187], v[92:95], v[168:171]
v_exp_f32 v70, v70
v_mfma_f32_16x16x32_bf16 v[172:175], a[188:191], v[92:95], v[172:175]
ds_read_b128 a[124:127], v1 offset:17088
v_mfma_f32_16x16x32_bf16 v[172:175], a[156:159], v[88:91], v[172:175]
v_exp_f32 v71, v71
v_mfma_f32_16x16x32_bf16 v[176:179], a[160:163], v[88:91], v[176:179]
ds_read_b128 a[140:143], v1 offset:17600
v_cvt_pk_bf16_f32 v83, v70, v71
v_mfma_f32_16x16x32_bf16 v[176:179], a[192:195], v[92:95], v[176:179]
v_exp_f32 v72, v72
v_mfma_f32_16x16x32_bf16 v[180:183], a[196:199], v[92:95], v[180:183]
ds_read_b128 a[136:139], v1 offset:17536
v_mfma_f32_16x16x32_bf16 v[180:183], a[164:167], v[88:91], v[180:183]
v_exp_f32 v73, v73
v_mfma_f32_16x16x32_bf16 v[184:187], a[168:171], v[88:91], v[184:187]
ds_read_b128 a[132:135], v1 offset:17472
v_cvt_pk_bf16_f32 v84, v72, v73
v_mfma_f32_16x16x32_bf16 v[184:187], a[200:203], v[92:95], v[184:187]
v_exp_f32 v74, v74
v_mfma_f32_16x16x32_bf16 v[188:191], a[204:207], v[92:95], v[188:191]
ds_read_b128 a[128:131], v1 offset:17408
v_mfma_f32_16x16x32_bf16 v[188:191], a[172:175], v[88:91], v[188:191]
v_exp_f32 v75, v75
v_mfma_f32_16x16x32_bf16 a[216:219], a[228:231], v[88:91], a[216:219]
s_waitcnt lgkmcnt(8)
v_cvt_pk_bf16_f32 v85, v74, v75
v_mfma_f32_16x16x32_bf16 a[216:219], a[228:231], v[92:95], a[216:219]
v_mfma_f32_16x16x32_bf16 v[56:59], a[80:83], a[64:67], v[52:55]
v_mfma_f32_16x16x32_bf16 v[56:59], a[84:87], a[68:71], v[56:59]
v_mfma_f32_16x16x32_bf16 v[56:59], a[88:91], a[72:75], v[56:59]
v_mfma_f32_16x16x32_bf16 v[56:59], a[92:95], a[76:79], v[56:59]
v_exp_f32 v76, v76
v_exp_f32 v77, v77
v_exp_f32 v78, v78
v_exp_f32 v79, v79
v_cvt_pk_bf16_f32 v86, v76, v77
v_cvt_pk_bf16_f32 v87, v78, v79
v_mfma_f32_16x16x32_bf16 v[60:63], a[108:111], a[76:79], v[52:55]
buffer_load_dwordx4 v[16:19], v3, s[24:27], s35 offen offset:3072 nt
v_mfma_f32_16x16x32_bf16 v[60:63], a[104:107], a[72:75], v[60:63]
s_waitcnt vmcnt(5) lgkmcnt(0)
v_mfma_f32_16x16x32_bf16 v[60:63], a[100:103], a[68:71], v[60:63]
s_waitcnt vmcnt(10)
v_lshlrev_b32 v32, 16, v20
v_mfma_f32_16x16x32_bf16 v[60:63], a[96:99], a[64:67], v[60:63]
s_barrier
s_add_u32 s16, s16, 16384
s_addc_u32 s17, s17, 0
v_mfma_f32_16x16x32_bf16 v[192:195], a[144:147], v[80:83], v[192:195]
ds_read_b64_tr_b16 a[144:145], v2 offset:25344
v_and_b32 v33, s45, v20
v_mfma_f32_16x16x32_bf16 v[192:195], a[176:179], v[84:87], v[192:195]
s_add_u32 s35, s35, 3072
v_exp_f32 v56, v56
v_mfma_f32_16x16x32_bf16 v[196:199], a[180:183], v[84:87], v[196:199]
ds_read_b64_tr_b16 a[146:147], v2 offset:25856
v_mul_f32 v32, s38, v32
v_mfma_f32_16x16x32_bf16 v[196:199], a[148:151], v[80:83], v[196:199]
ds_read_b64_tr_b16 a[148:149], v2 offset:25376
v_mul_f32 v33, s38, v33
v_mfma_f32_16x16x32_bf16 v[200:203], a[152:155], v[80:83], v[200:203]
v_exp_f32 v57, v57
v_mfma_f32_16x16x32_bf16 v[200:203], a[184:187], v[84:87], v[200:203]
ds_read_b64_tr_b16 a[150:151], v2 offset:25888
v_cvt_pk_bf16_f32 v88, v56, v57
v_mfma_f32_16x16x32_bf16 v[204:207], a[188:191], v[84:87], v[204:207]
ds_read_b64_tr_b16 a[152:153], v2 offset:25408
v_cvt_pk_bf16_f32 v20, v32, v33
v_mfma_f32_16x16x32_bf16 v[204:207], a[156:159], v[80:83], v[204:207]
v_exp_f32 v58, v58
v_mfma_f32_16x16x32_bf16 v[208:211], a[160:163], v[80:83], v[208:211]
ds_read_b64_tr_b16 a[154:155], v2 offset:25920
v_lshlrev_b32 v34, 16, v21
v_mfma_f32_16x16x32_bf16 v[208:211], a[192:195], v[84:87], v[208:211]
ds_read_b64_tr_b16 a[156:157], v2 offset:25440
v_and_b32 v35, s45, v21
v_mfma_f32_16x16x32_bf16 v[212:215], a[196:199], v[84:87], v[212:215]
v_exp_f32 v59, v59
v_mfma_f32_16x16x32_bf16 v[212:215], a[164:167], v[80:83], v[212:215]
ds_read_b64_tr_b16 a[158:159], v2 offset:25952
v_cvt_pk_bf16_f32 v89, v58, v59
v_mfma_f32_16x16x32_bf16 v[216:219], a[168:171], v[80:83], v[216:219]
ds_read_b64_tr_b16 a[160:161], v2 offset:25472
v_mul_f32 v34, s38, v34
v_mfma_f32_16x16x32_bf16 v[216:219], a[200:203], v[84:87], v[216:219]
v_exp_f32 v60, v60
v_mfma_f32_16x16x32_bf16 v[220:223], a[204:207], v[84:87], v[220:223]
ds_read_b64_tr_b16 a[162:163], v2 offset:25984
v_mul_f32 v35, s38, v35
v_mfma_f32_16x16x32_bf16 v[220:223], a[172:175], v[80:83], v[220:223]
ds_read_b64_tr_b16 a[164:165], v2 offset:25504
v_cvt_pk_bf16_f32 v21, v34, v35
v_mfma_f32_16x16x32_bf16 a[220:223], a[228:231], v[80:83], a[220:223]
v_exp_f32 v61, v61
v_mfma_f32_16x16x32_bf16 a[220:223], a[228:231], v[84:87], a[220:223]
ds_read_b64_tr_b16 a[166:167], v2 offset:26016
v_cvt_pk_bf16_f32 v90, v60, v61
v_mfma_f32_16x16x32_bf16 v[64:67], a[80:83], a[0:3], v[36:39]
ds_read_b64_tr_b16 a[168:169], v2 offset:25536
v_lshlrev_b32 v32, 16, v22
v_mfma_f32_16x16x32_bf16 v[64:67], a[84:87], a[4:7], v[64:67]
v_exp_f32 v62, v62
v_mfma_f32_16x16x32_bf16 v[64:67], a[88:91], a[8:11], v[64:67]
ds_read_b64_tr_b16 a[170:171], v2 offset:26048
v_and_b32 v33, s45, v22
v_mfma_f32_16x16x32_bf16 v[64:67], a[92:95], a[12:15], v[64:67]
ds_read_b64_tr_b16 a[172:173], v2 offset:25568
v_mul_f32 v32, s38, v32
v_mfma_f32_16x16x32_bf16 v[68:71], a[108:111], a[12:15], v[36:39]
v_exp_f32 v63, v63
v_mfma_f32_16x16x32_bf16 v[68:71], a[104:107], a[8:11], v[68:71]
ds_read_b64_tr_b16 a[174:175], v2 offset:26080
v_cvt_pk_bf16_f32 v91, v62, v63
v_mfma_f32_16x16x32_bf16 v[68:71], a[100:103], a[4:7], v[68:71]
ds_read_b64_tr_b16 a[176:177], v2 offset:16896
v_mul_f32 v33, s38, v33
v_mfma_f32_16x16x32_bf16 v[68:71], a[96:99], a[0:3], v[68:71]
ds_read_b64_tr_b16 a[178:179], v2 offset:17408
v_cvt_pk_bf16_f32 v22, v32, v33
v_mfma_f32_16x16x32_bf16 v[72:75], a[112:115], a[0:3], v[36:39]
v_exp_f32 v64, v64
v_mfma_f32_16x16x32_bf16 v[72:75], a[116:119], a[4:7], v[72:75]
ds_read_b64_tr_b16 a[180:181], v2 offset:16928
v_lshlrev_b32 v34, 16, v23
v_mfma_f32_16x16x32_bf16 v[72:75], a[120:123], a[8:11], v[72:75]
v_exp_f32 v65, v65
v_mfma_f32_16x16x32_bf16 v[72:75], a[124:127], a[12:15], v[72:75]
ds_read_b64_tr_b16 a[182:183], v2 offset:17440
v_cvt_pk_bf16_f32 v80, v64, v65
v_mfma_f32_16x16x32_bf16 v[76:79], a[140:143], a[12:15], v[36:39]
v_exp_f32 v66, v66
v_mfma_f32_16x16x32_bf16 v[76:79], a[136:139], a[8:11], v[76:79]
ds_read_b64_tr_b16 a[184:185], v2 offset:16960
v_and_b32 v35, s45, v23
v_mfma_f32_16x16x32_bf16 v[76:79], a[132:135], a[4:7], v[76:79]
s_waitcnt lgkmcnt(13)
v_exp_f32 v67, v67
v_mfma_f32_16x16x32_bf16 v[76:79], a[128:131], a[0:3], v[76:79]
ds_read_b64_tr_b16 a[186:187], v2 offset:17472
v_cvt_pk_bf16_f32 v81, v66, v67
v_mfma_f32_16x16x32_bf16 v[224:227], a[144:147], v[88:91], v[224:227]
v_exp_f32 v68, v68
v_mfma_f32_16x16x32_bf16 v[228:231], a[148:151], v[88:91], v[228:231]
ds_read_b64_tr_b16 a[188:189], v2 offset:16992
v_mul_f32 v34, s38, v34
v_mfma_f32_16x16x32_bf16 v[232:235], a[152:155], v[88:91], v[232:235]
s_waitcnt lgkmcnt(7)
v_exp_f32 v69, v69
v_mfma_f32_16x16x32_bf16 v[236:239], a[156:159], v[88:91], v[236:239]
ds_read_b64_tr_b16 a[190:191], v2 offset:17504
v_cvt_pk_bf16_f32 v82, v68, v69
v_mfma_f32_16x16x32_bf16 v[240:243], a[160:163], v[88:91], v[240:243]
v_exp_f32 v70, v70
v_mfma_f32_16x16x32_bf16 v[244:247], a[164:167], v[88:91], v[244:247]
ds_read_b64_tr_b16 a[192:193], v2 offset:17024
v_mul_f32 v35, s38, v35
v_mfma_f32_16x16x32_bf16 v[248:251], a[168:171], v[88:91], v[248:251]
v_exp_f32 v71, v71
v_mfma_f32_16x16x32_bf16 v[252:255], a[172:175], v[88:91], v[252:255]
ds_read_b64_tr_b16 a[194:195], v2 offset:17536
v_cvt_pk_bf16_f32 v83, v70, v71
v_mfma_f32_16x16x32_bf16 a[224:227], a[228:231], v[88:91], a[224:227]
v_mfma_f32_16x16x32_bf16 v[56:59], a[80:83], a[16:19], v[40:43]
ds_read_b64_tr_b16 a[196:197], v2 offset:17056
v_cvt_pk_bf16_f32 v23, v34, v35
v_mfma_f32_16x16x32_bf16 v[56:59], a[84:87], a[20:23], v[56:59]
v_mfma_f32_16x16x32_bf16 v[56:59], a[88:91], a[24:27], v[56:59]
ds_read_b64_tr_b16 a[198:199], v2 offset:17568
v_mfma_f32_16x16x32_bf16 v[56:59], a[92:95], a[28:31], v[56:59]
s_add_u32 m0, s33, 33792
v_exp_f32 v72, v72
v_exp_f32 v73, v73
v_exp_f32 v74, v74
v_exp_f32 v75, v75
v_cvt_pk_bf16_f32 v84, v72, v73
v_cvt_pk_bf16_f32 v85, v74, v75
v_mfma_f32_16x16x32_bf16 v[60:63], a[108:111], a[28:31], v[40:43]
buffer_load_dwordx4 v3, s[16:19], 0 offen nt lds
v_mfma_f32_16x16x32_bf16 v[60:63], a[104:107], a[24:27], v[60:63]
v_mfma_f32_16x16x32_bf16 v[60:63], a[100:103], a[20:23], v[60:63]
ds_read_b64_tr_b16 a[200:201], v2 offset:17088
v_mfma_f32_16x16x32_bf16 v[60:63], a[96:99], a[16:19], v[60:63]
v_exp_f32 v76, v76
v_mfma_f32_16x16x32_bf16 v[64:67], a[112:115], a[16:19], v[40:43]
ds_read_b64_tr_b16 a[202:203], v2 offset:17600
v_mfma_f32_16x16x32_bf16 v[64:67], a[116:119], a[20:23], v[64:67]
v_exp_f32 v77, v77
v_mfma_f32_16x16x32_bf16 v[64:67], a[120:123], a[24:27], v[64:67]
ds_read_b64_tr_b16 a[204:205], v2 offset:17120
v_cvt_pk_bf16_f32 v86, v76, v77
v_mfma_f32_16x16x32_bf16 v[64:67], a[124:127], a[28:31], v[64:67]
s_add_u32 m0, s33, 33824
v_exp_f32 v78, v78
v_mfma_f32_16x16x32_bf16 v[68:71], a[140:143], a[28:31], v[40:43]
buffer_load_dwordx4 v3, s[16:19], 0 offen offset:1024 nt lds
v_mfma_f32_16x16x32_bf16 v[68:71], a[136:139], a[24:27], v[68:71]
s_waitcnt vmcnt(8)
v_exp_f32 v79, v79
v_mfma_f32_16x16x32_bf16 v[68:71], a[132:135], a[20:23], v[68:71]
ds_read_b64_tr_b16 a[206:207], v2 offset:17632
v_cvt_pk_bf16_f32 v87, v78, v79
v_mfma_f32_16x16x32_bf16 v[68:71], a[128:131], a[16:19], v[68:71]
v_exp_f32 v56, v56
v_mfma_f32_16x16x32_bf16 v[96:99], a[144:147], v[80:83], v[96:99]
s_waitcnt lgkmcnt(8)
v_lshlrev_b32 v32, 16, v24
v_and_b32 v33, s45, v24
v_mfma_f32_16x16x32_bf16 v[96:99], a[176:179], v[84:87], v[96:99]
v_exp_f32 v57, v57
v_mfma_f32_16x16x32_bf16 v[100:103], a[180:183], v[84:87], v[100:103]
v_cvt_pk_bf16_f32 v88, v56, v57
v_mul_f32 v32, s38, v32
v_mfma_f32_16x16x32_bf16 v[100:103], a[148:151], v[80:83], v[100:103]
s_add_u32 m0, s33, 33856
v_exp_f32 v58, v58
v_mfma_f32_16x16x32_bf16 v[104:107], a[152:155], v[80:83], v[104:107]
buffer_load_dwordx4 v3, s[16:19], 0 offen offset:2048 nt lds
v_mfma_f32_16x16x32_bf16 v[104:107], a[184:187], v[84:87], v[104:107]
v_exp_f32 v59, v59
v_mfma_f32_16x16x32_bf16 v[108:111], a[188:191], v[84:87], v[108:111]
v_cvt_pk_bf16_f32 v89, v58, v59
v_mul_f32 v33, s38, v33
v_mfma_f32_16x16x32_bf16 v[108:111], a[156:159], v[80:83], v[108:111]
s_waitcnt lgkmcnt(0)
v_exp_f32 v60, v60
v_mfma_f32_16x16x32_bf16 v[112:115], a[160:163], v[80:83], v[112:115]
ds_write_b128 v4, v[20:23] offset:1056
v_mfma_f32_16x16x32_bf16 v[112:115], a[192:195], v[84:87], v[112:115]
v_exp_f32 v61, v61
v_mfma_f32_16x16x32_bf16 v[116:119], a[196:199], v[84:87], v[116:119]
v_cvt_pk_bf16_f32 v90, v60, v61
v_cvt_pk_bf16_f32 v24, v32, v33
v_mfma_f32_16x16x32_bf16 v[116:119], a[164:167], v[80:83], v[116:119]
s_add_u32 m0, s33, 33888
v_exp_f32 v62, v62
v_mfma_f32_16x16x32_bf16 v[120:123], a[168:171], v[80:83], v[120:123]
buffer_load_dwordx4 v3, s[16:19], 0 offen offset:3072 nt lds
v_mfma_f32_16x16x32_bf16 v[120:123], a[200:203], v[84:87], v[120:123]
v_exp_f32 v63, v63
v_mfma_f32_16x16x32_bf16 v[124:127], a[204:207], v[84:87], v[124:127]
s_add_u32 s12, s12, 16384
s_addc_u32 s13, s13, 0
v_cvt_pk_bf16_f32 v91, v62, v63
v_mfma_f32_16x16x32_bf16 v[124:127], a[172:175], v[80:83], v[124:127]
v_mfma_f32_16x16x32_bf16 a[208:211], a[228:231], v[80:83], a[208:211]
v_lshlrev_b32 v34, 16, v25
v_and_b32 v35, s45, v25
v_mfma_f32_16x16x32_bf16 a[208:211], a[228:231], v[84:87], a[208:211]
s_add_u32 m0, s33, 16896
v_mfma_f32_16x16x32_bf16 v[72:75], a[80:83], a[32:35], v[44:47]
v_mul_f32 v34, s38, v34
v_mfma_f32_16x16x32_bf16 v[72:75], a[84:87], a[36:39], v[72:75]
v_mfma_f32_16x16x32_bf16 v[72:75], a[88:91], a[40:43], v[72:75]
buffer_load_dwordx4 v3, s[12:15], 0 offen nt lds
v_mfma_f32_16x16x32_bf16 v[72:75], a[92:95], a[44:47], v[72:75]
v_exp_f32 v64, v64
v_exp_f32 v65, v65
v_exp_f32 v66, v66
v_exp_f32 v67, v67
v_cvt_pk_bf16_f32 v92, v64, v65
v_cvt_pk_bf16_f32 v93, v66, v67
v_mfma_f32_16x16x32_bf16 v[76:79], a[108:111], a[44:47], v[44:47]
v_mul_f32 v35, s38, v35
v_mfma_f32_16x16x32_bf16 v[76:79], a[104:107], a[40:43], v[76:79]
v_exp_f32 v68, v68
v_mfma_f32_16x16x32_bf16 v[76:79], a[100:103], a[36:39], v[76:79]
v_cvt_pk_bf16_f32 v25, v34, v35
v_lshlrev_b32 v32, 16, v26
v_mfma_f32_16x16x32_bf16 v[76:79], a[96:99], a[32:35], v[76:79]
s_add_u32 m0, s33, 16928
v_exp_f32 v69, v69
v_mfma_f32_16x16x32_bf16 v[56:59], a[112:115], a[32:35], v[44:47]
v_cvt_pk_bf16_f32 v94, v68, v69
v_and_b32 v33, s45, v26
v_mfma_f32_16x16x32_bf16 v[56:59], a[116:119], a[36:39], v[56:59]
v_exp_f32 v70, v70
v_mfma_f32_16x16x32_bf16 v[56:59], a[120:123], a[40:43], v[56:59]
buffer_load_dwordx4 v3, s[12:15], 0 offen offset:1024 nt lds
v_mfma_f32_16x16x32_bf16 v[56:59], a[124:127], a[44:47], v[56:59]
v_exp_f32 v71, v71
v_mfma_f32_16x16x32_bf16 v[60:63], a[140:143], a[44:47], v[44:47]
v_exp_f32 v72, v72
v_mfma_f32_16x16x32_bf16 v[60:63], a[136:139], a[40:43], v[60:63]
v_cvt_pk_bf16_f32 v95, v70, v71
v_mul_f32 v32, s38, v32
v_mfma_f32_16x16x32_bf16 v[60:63], a[132:135], a[36:39], v[60:63]
v_exp_f32 v73, v73
v_mfma_f32_16x16x32_bf16 v[60:63], a[128:131], a[32:35], v[60:63]
v_cvt_pk_bf16_f32 v80, v72, v73
v_mul_f32 v33, s38, v33
v_mfma_f32_16x16x32_bf16 v[128:131], a[144:147], v[88:91], v[128:131]
s_add_u32 m0, s33, 16960
v_exp_f32 v74, v74
v_mfma_f32_16x16x32_bf16 v[128:131], a[176:179], v[92:95], v[128:131]
buffer_load_dwordx4 v3, s[12:15], 0 offen offset:2048 nt lds
v_mfma_f32_16x16x32_bf16 v[132:135], a[180:183], v[92:95], v[132:135]
v_exp_f32 v75, v75
v_mfma_f32_16x16x32_bf16 v[132:135], a[148:151], v[88:91], v[132:135]
v_cvt_pk_bf16_f32 v81, v74, v75
v_cvt_pk_bf16_f32 v26, v32, v33
v_mfma_f32_16x16x32_bf16 v[136:139], a[152:155], v[88:91], v[136:139]
v_exp_f32 v76, v76
v_mfma_f32_16x16x32_bf16 v[136:139], a[184:187], v[92:95], v[136:139]
v_lshlrev_b32 v34, 16, v27
v_and_b32 v35, s45, v27
v_mfma_f32_16x16x32_bf16 v[140:143], a[188:191], v[92:95], v[140:143]
v_exp_f32 v77, v77
v_mfma_f32_16x16x32_bf16 v[140:143], a[156:159], v[88:91], v[140:143]
v_cvt_pk_bf16_f32 v82, v76, v77
v_mul_f32 v34, s38, v34
v_mfma_f32_16x16x32_bf16 v[144:147], a[160:163], v[88:91], v[144:147]
s_add_u32 m0, s33, 16992
v_exp_f32 v78, v78
v_mfma_f32_16x16x32_bf16 v[144:147], a[192:195], v[92:95], v[144:147]
buffer_load_dwordx4 v3, s[12:15], 0 offen offset:3072 nt lds
v_mfma_f32_16x16x32_bf16 v[148:151], a[196:199], v[92:95], v[148:151]
v_exp_f32 v79, v79
v_mfma_f32_16x16x32_bf16 v[148:151], a[164:167], v[88:91], v[148:151]
v_cvt_pk_bf16_f32 v83, v78, v79
v_mul_f32 v35, s38, v35
v_mfma_f32_16x16x32_bf16 v[152:155], a[168:171], v[88:91], v[152:155]
v_exp_f32 v56, v56
v_cvt_pk_bf16_f32 v27, v34, v35
v_mfma_f32_16x16x32_bf16 v[152:155], a[200:203], v[92:95], v[152:155]
ds_write_b128 v4, v[24:27] offset:2112
v_mfma_f32_16x16x32_bf16 v[156:159], a[204:207], v[92:95], v[156:159]
s_waitcnt vmcnt(9) lgkmcnt(2)
v_exp_f32 v57, v57
v_mfma_f32_16x16x32_bf16 v[156:159], a[172:175], v[88:91], v[156:159]
v_cvt_pk_bf16_f32 v84, v56, v57
v_add_u32 v4, 3168, v4
v_mfma_f32_16x16x32_bf16 a[212:215], a[228:231], v[88:91], a[212:215]
s_barrier
v_exp_f32 v58, v58
v_mfma_f32_16x16x32_bf16 a[212:215], a[228:231], v[92:95], a[212:215]
v_mfma_f32_16x16x32_bf16 v[64:67], a[80:83], a[48:51], v[48:51]
v_exp_f32 v59, v59
v_mfma_f32_16x16x32_bf16 v[64:67], a[84:87], a[52:55], v[64:67]
ds_read_b128 a[80:83], v1 offset:8448
v_cvt_pk_bf16_f32 v85, v58, v59
v_mfma_f32_16x16x32_bf16 v[64:67], a[88:91], a[56:59], v[64:67]
v_mfma_f32_16x16x32_bf16 v[64:67], a[92:95], a[60:63], v[64:67]
ds_read_b128 a[84:87], v1 offset:8512
ds_read_b128 a[88:91], v1 offset:8576
v_mfma_f32_16x16x32_bf16 v[68:71], a[108:111], a[60:63], v[48:51]
v_mfma_f32_16x16x32_bf16 v[68:71], a[104:107], a[56:59], v[68:71]
ds_read_b128 a[92:95], v1 offset:8640
v_mfma_f32_16x16x32_bf16 v[68:71], a[100:103], a[52:55], v[68:71]
v_mfma_f32_16x16x32_bf16 v[68:71], a[96:99], a[48:51], v[68:71]
ds_read_b128 a[108:111], v1 offset:9152
v_exp_f32 v60, v60
v_exp_f32 v61, v61
v_exp_f32 v62, v62
v_exp_f32 v63, v63
v_cvt_pk_bf16_f32 v86, v60, v61
v_cvt_pk_bf16_f32 v87, v62, v63
v_mfma_f32_16x16x32_bf16 v[72:75], a[112:115], a[48:51], v[48:51]
v_mfma_f32_16x16x32_bf16 v[72:75], a[116:119], a[52:55], v[72:75]
v_exp_f32 v64, v64
v_mfma_f32_16x16x32_bf16 v[72:75], a[120:123], a[56:59], v[72:75]
ds_read_b128 a[104:107], v1 offset:9088
v_mfma_f32_16x16x32_bf16 v[72:75], a[124:127], a[60:63], v[72:75]
v_exp_f32 v65, v65
v_mfma_f32_16x16x32_bf16 v[76:79], a[140:143], a[60:63], v[48:51]
ds_read_b128 a[100:103], v1 offset:9024
v_cvt_pk_bf16_f32 v88, v64, v65
v_mfma_f32_16x16x32_bf16 v[76:79], a[136:139], a[56:59], v[76:79]
v_exp_f32 v66, v66
v_mfma_f32_16x16x32_bf16 v[76:79], a[132:135], a[52:55], v[76:79]
ds_read_b128 a[96:99], v1 offset:8960
v_mfma_f32_16x16x32_bf16 v[76:79], a[128:131], a[48:51], v[76:79]
v_exp_f32 v67, v67
v_mfma_f32_16x16x32_bf16 v[160:163], a[144:147], v[80:83], v[160:163]
ds_read_b128 a[112:115], v1
v_cvt_pk_bf16_f32 v89, v66, v67
v_mfma_f32_16x16x32_bf16 v[160:163], a[176:179], v[84:87], v[160:163]
v_exp_f32 v68, v68
v_mfma_f32_16x16x32_bf16 v[164:167], a[180:183], v[84:87], v[164:167]
ds_read_b128 a[116:119], v1 offset:64
v_mfma_f32_16x16x32_bf16 v[164:167], a[148:151], v[80:83], v[164:167]
v_exp_f32 v69, v69
v_mfma_f32_16x16x32_bf16 v[168:171], a[152:155], v[80:83], v[168:171]
ds_read_b128 a[120:123], v1 offset:128
v_cvt_pk_bf16_f32 v90, v68, v69
v_mfma_f32_16x16x32_bf16 v[168:171], a[184:187], v[84:87], v[168:171]
v_exp_f32 v70, v70
v_mfma_f32_16x16x32_bf16 v[172:175], a[188:191], v[84:87], v[172:175]
ds_read_b128 a[124:127], v1 offset:192
v_mfma_f32_16x16x32_bf16 v[172:175], a[156:159], v[80:83], v[172:175]
v_exp_f32 v71, v71
v_mfma_f32_16x16x32_bf16 v[176:179], a[160:163], v[80:83], v[176:179]
ds_read_b128 a[140:143], v1 offset:704
v_cvt_pk_bf16_f32 v91, v70, v71
v_mfma_f32_16x16x32_bf16 v[176:179], a[192:195], v[84:87], v[176:179]
v_exp_f32 v72, v72
v_mfma_f32_16x16x32_bf16 v[180:183], a[196:199], v[84:87], v[180:183]
ds_read_b128 a[136:139], v1 offset:640
v_mfma_f32_16x16x32_bf16 v[180:183], a[164:167], v[80:83], v[180:183]
v_exp_f32 v73, v73
v_mfma_f32_16x16x32_bf16 v[184:187], a[168:171], v[80:83], v[184:187]
ds_read_b128 a[132:135], v1 offset:576
v_cvt_pk_bf16_f32 v92, v72, v73
v_mfma_f32_16x16x32_bf16 v[184:187], a[200:203], v[84:87], v[184:187]
s_sub_u32 s34, s34, 1
v_exp_f32 v74, v74
v_mfma_f32_16x16x32_bf16 v[188:191], a[204:207], v[84:87], v[188:191]
ds_read_b128 a[128:131], v1 offset:512
v_mfma_f32_16x16x32_bf16 v[188:191], a[172:175], v[80:83], v[188:191]
s_cmp_lg_u32 s34, 0
v_exp_f32 v75, v75
v_mfma_f32_16x16x32_bf16 a[216:219], a[228:231], v[80:83], a[216:219]
s_waitcnt lgkmcnt(8)
v_cvt_pk_bf16_f32 v93, v74, v75
v_mfma_f32_16x16x32_bf16 a[216:219], a[228:231], v[84:87], a[216:219]
s_cbranch_scc1 L_m011
L_x01:
v_exp_f32 v76, v76
v_mfma_f32_16x16x32_bf16 v[56:59], a[80:83], a[64:67], v[52:55]
v_mfma_f32_16x16x32_bf16 v[56:59], a[84:87], a[68:71], v[56:59]
v_exp_f32 v77, v77
v_mfma_f32_16x16x32_bf16 v[56:59], a[88:91], a[72:75], v[56:59]
v_cvt_pk_bf16_f32 v94, v76, v77
v_mfma_f32_16x16x32_bf16 v[56:59], a[92:95], a[76:79], v[56:59]
v_exp_f32 v78, v78
v_mfma_f32_16x16x32_bf16 v[60:63], a[108:111], a[76:79], v[52:55]
v_mfma_f32_16x16x32_bf16 v[60:63], a[104:107], a[72:75], v[60:63]
s_waitcnt vmcnt(4) lgkmcnt(0)
v_exp_f32 v79, v79
v_mfma_f32_16x16x32_bf16 v[60:63], a[100:103], a[68:71], v[60:63]
s_add_u32 s12, s12, 66863104
s_addc_u32 s13, s13, 0
v_cvt_pk_bf16_f32 v95, v78, v79
v_mfma_f32_16x16x32_bf16 v[60:63], a[96:99], a[64:67], v[60:63]
s_barrier
s_add_u32 s16, s16, 16384
s_addc_u32 s17, s17, 0
v_mfma_f32_16x16x32_bf16 v[192:195], a[144:147], v[88:91], v[192:195]
ds_read_b64_tr_b16 a[144:145], v2 offset:8448
ds_read_b64_tr_b16 a[146:147], v2 offset:8960
v_mfma_f32_16x16x32_bf16 v[192:195], a[176:179], v[92:95], v[192:195]
v_exp_f32 v56, v56
v_mfma_f32_16x16x32_bf16 v[196:199], a[180:183], v[92:95], v[196:199]
v_mfma_f32_16x16x32_bf16 v[196:199], a[148:151], v[88:91], v[196:199]
ds_read_b64_tr_b16 a[148:149], v2 offset:8480
ds_read_b64_tr_b16 a[150:151], v2 offset:8992
v_mfma_f32_16x16x32_bf16 v[200:203], a[152:155], v[88:91], v[200:203]
v_exp_f32 v57, v57
v_mfma_f32_16x16x32_bf16 v[200:203], a[184:187], v[92:95], v[200:203]
ds_read_b64_tr_b16 a[152:153], v2 offset:8512
v_cvt_pk_bf16_f32 v80, v56, v57
v_mfma_f32_16x16x32_bf16 v[204:207], a[188:191], v[92:95], v[204:207]
ds_read_b64_tr_b16 a[154:155], v2 offset:9024
v_mfma_f32_16x16x32_bf16 v[204:207], a[156:159], v[88:91], v[204:207]
v_exp_f32 v58, v58
v_mfma_f32_16x16x32_bf16 v[208:211], a[160:163], v[88:91], v[208:211]
ds_read_b64_tr_b16 a[156:157], v2 offset:8544
ds_read_b64_tr_b16 a[158:159], v2 offset:9056
v_mfma_f32_16x16x32_bf16 v[208:211], a[192:195], v[92:95], v[208:211]
ds_read_b64_tr_b16 a[160:161], v2 offset:8576
v_mfma_f32_16x16x32_bf16 v[212:215], a[196:199], v[92:95], v[212:215]
v_exp_f32 v59, v59
v_mfma_f32_16x16x32_bf16 v[212:215], a[164:167], v[88:91], v[212:215]
ds_read_b64_tr_b16 a[162:163], v2 offset:9088
v_cvt_pk_bf16_f32 v81, v58, v59
v_mfma_f32_16x16x32_bf16 v[216:219], a[168:171], v[88:91], v[216:219]
ds_read_b64_tr_b16 a[164:165], v2 offset:8608
v_mfma_f32_16x16x32_bf16 v[216:219], a[200:203], v[92:95], v[216:219]
v_exp_f32 v60, v60
v_mfma_f32_16x16x32_bf16 v[220:223], a[204:207], v[92:95], v[220:223]
ds_read_b64_tr_b16 a[166:167], v2 offset:9120
v_mfma_f32_16x16x32_bf16 v[220:223], a[172:175], v[88:91], v[220:223]
ds_read_b64_tr_b16 a[168:169], v2 offset:8640
v_mfma_f32_16x16x32_bf16 a[220:223], a[228:231], v[88:91], a[220:223]
v_exp_f32 v61, v61
v_mfma_f32_16x16x32_bf16 a[220:223], a[228:231], v[92:95], a[220:223]
ds_read_b64_tr_b16 a[170:171], v2 offset:9152
v_cvt_pk_bf16_f32 v82, v60, v61
v_mfma_f32_16x16x32_bf16 v[64:67], a[80:83], a[0:3], v[36:39]
ds_read_b64_tr_b16 a[172:173], v2 offset:8672
v_mfma_f32_16x16x32_bf16 v[64:67], a[84:87], a[4:7], v[64:67]
v_exp_f32 v62, v62
v_mfma_f32_16x16x32_bf16 v[64:67], a[88:91], a[8:11], v[64:67]
ds_read_b64_tr_b16 a[174:175], v2 offset:9184
v_mfma_f32_16x16x32_bf16 v[64:67], a[92:95], a[12:15], v[64:67]
ds_read_b64_tr_b16 a[176:177], v2
v_mfma_f32_16x16x32_bf16 v[68:71], a[108:111], a[12:15], v[36:39]
v_exp_f32 v63, v63
v_mfma_f32_16x16x32_bf16 v[68:71], a[104:107], a[8:11], v[68:71]
ds_read_b64_tr_b16 a[178:179], v2 offset:512
v_cvt_pk_bf16_f32 v83, v62, v63
v_mfma_f32_16x16x32_bf16 v[68:71], a[100:103], a[4:7], v[68:71]
ds_read_b64_tr_b16 a[180:181], v2 offset:32
v_mfma_f32_16x16x32_bf16 v[68:71], a[96:99], a[0:3], v[68:71]
ds_read_b64_tr_b16 a[182:183], v2 offset:544
v_mfma_f32_16x16x32_bf16 v[72:75], a[112:115], a[0:3], v[36:39]
v_exp_f32 v64, v64
v_mfma_f32_16x16x32_bf16 v[72:75], a[116:119], a[4:7], v[72:75]
ds_read_b64_tr_b16 a[184:185], v2 offset:64
v_mfma_f32_16x16x32_bf16 v[72:75], a[120:123], a[8:11], v[72:75]
v_exp_f32 v65, v65
v_mfma_f32_16x16x32_bf16 v[72:75], a[124:127], a[12:15], v[72:75]
ds_read_b64_tr_b16 a[186:187], v2 offset:576
v_cvt_pk_bf16_f32 v88, v64, v65
v_mfma_f32_16x16x32_bf16 v[76:79], a[140:143], a[12:15], v[36:39]
v_exp_f32 v66, v66
v_mfma_f32_16x16x32_bf16 v[76:79], a[136:139], a[8:11], v[76:79]
ds_read_b64_tr_b16 a[188:189], v2 offset:96
v_mfma_f32_16x16x32_bf16 v[76:79], a[132:135], a[4:7], v[76:79]
s_waitcnt lgkmcnt(14)
v_exp_f32 v67, v67
v_mfma_f32_16x16x32_bf16 v[76:79], a[128:131], a[0:3], v[76:79]
ds_read_b64_tr_b16 a[190:191], v2 offset:608
v_cvt_pk_bf16_f32 v89, v66, v67
v_mfma_f32_16x16x32_bf16 v[224:227], a[144:147], v[80:83], v[224:227]
v_exp_f32 v68, v68
v_mfma_f32_16x16x32_bf16 v[228:231], a[148:151], v[80:83], v[228:231]
ds_read_b64_tr_b16 a[192:193], v2 offset:128
v_mfma_f32_16x16x32_bf16 v[232:235], a[152:155], v[80:83], v[232:235]
s_waitcnt lgkmcnt(9)
v_exp_f32 v69, v69
v_mfma_f32_16x16x32_bf16 v[236:239], a[156:159], v[80:83], v[236:239]
ds_read_b64_tr_b16 a[194:195], v2 offset:640
v_cvt_pk_bf16_f32 v90, v68, v69
v_mfma_f32_16x16x32_bf16 v[240:243], a[160:163], v[80:83], v[240:243]
s_add_u32 m0, s33, 50688
v_exp_f32 v70, v70
v_mfma_f32_16x16x32_bf16 v[244:247], a[164:167], v[80:83], v[244:247]
buffer_load_dwordx4 v3, s[16:19], 0 offen nt lds
v_mfma_f32_16x16x32_bf16 v[248:251], a[168:171], v[80:83], v[248:251]
v_exp_f32 v71, v71
v_mfma_f32_16x16x32_bf16 v[252:255], a[172:175], v[80:83], v[252:255]
ds_read_b64_tr_b16 a[196:197], v2 offset:160
v_cvt_pk_bf16_f32 v91, v70, v71
v_mfma_f32_16x16x32_bf16 a[224:227], a[228:231], v[80:83], a[224:227]
v_mfma_f32_16x16x32_bf16 v[56:59], a[80:83], a[16:19], v[40:43]
ds_read_b64_tr_b16 a[198:199], v2 offset:672
v_mfma_f32_16x16x32_bf16 v[56:59], a[84:87], a[20:23], v[56:59]
s_add_u32 m0, s33, 50720
v_mfma_f32_16x16x32_bf16 v[56:59], a[88:91], a[24:27], v[56:59]
ds_read_b64_tr_b16 a[200:201], v2 offset:192
v_mfma_f32_16x16x32_bf16 v[56:59], a[92:95], a[28:31], v[56:59]
v_exp_f32 v72, v72
v_exp_f32 v73, v73
v_exp_f32 v74, v74
v_exp_f32 v75, v75
v_cvt_pk_bf16_f32 v92, v72, v73
v_cvt_pk_bf16_f32 v93, v74, v75
v_mfma_f32_16x16x32_bf16 v[60:63], a[108:111], a[28:31], v[40:43]
buffer_load_dwordx4 v3, s[16:19], 0 offen offset:1024 nt lds
v_mfma_f32_16x16x32_bf16 v[60:63], a[104:107], a[24:27], v[60:63]
s_add_u32 m0, s33, 50752
v_mfma_f32_16x16x32_bf16 v[60:63], a[100:103], a[20:23], v[60:63]
ds_read_b64_tr_b16 a[202:203], v2 offset:704
v_mfma_f32_16x16x32_bf16 v[60:63], a[96:99], a[16:19], v[60:63]
v_exp_f32 v76, v76
v_mfma_f32_16x16x32_bf16 v[64:67], a[112:115], a[16:19], v[40:43]
buffer_load_dwordx4 v3, s[16:19], 0 offen offset:2048 nt lds
v_mfma_f32_16x16x32_bf16 v[64:67], a[116:119], a[20:23], v[64:67]
v_exp_f32 v77, v77
v_mfma_f32_16x16x32_bf16 v[64:67], a[120:123], a[24:27], v[64:67]
ds_read_b64_tr_b16 a[204:205], v2 offset:224
v_cvt_pk_bf16_f32 v94, v76, v77
v_mfma_f32_16x16x32_bf16 v[64:67], a[124:127], a[28:31], v[64:67]
s_add_u32 m0, s33, 50784
v_exp_f32 v78, v78
v_mfma_f32_16x16x32_bf16 v[68:71], a[140:143], a[28:31], v[40:43]
buffer_load_dwordx4 v3, s[16:19], 0 offen offset:3072 nt lds
v_mfma_f32_16x16x32_bf16 v[68:71], a[136:139], a[24:27], v[68:71]
s_waitcnt lgkmcnt(7)
v_exp_f32 v79, v79
v_mfma_f32_16x16x32_bf16 v[68:71], a[132:135], a[20:23], v[68:71]
ds_read_b64_tr_b16 a[206:207], v2 offset:736
v_cvt_pk_bf16_f32 v95, v78, v79
v_mfma_f32_16x16x32_bf16 v[68:71], a[128:131], a[16:19], v[68:71]
s_add_u32 m0, s33, 0
v_exp_f32 v56, v56
v_mfma_f32_16x16x32_bf16 v[96:99], a[144:147], v[88:91], v[96:99]
buffer_load_dwordx4 v3, s[12:15], 0 offen nt lds
v_mfma_f32_16x16x32_bf16 v[96:99], a[176:179], v[92:95], v[96:99]
v_exp_f32 v57, v57
v_mfma_f32_16x16x32_bf16 v[100:103], a[180:183], v[92:95], v[100:103]
v_cvt_pk_bf16_f32 v80, v56, v57
v_accvgpr_read_b32 v4, a253
v_mfma_f32_16x16x32_bf16 v[100:103], a[148:151], v[88:91], v[100:103]
v_exp_f32 v58, v58
v_mfma_f32_16x16x32_bf16 v[104:107], a[152:155], v[88:91], v[104:107]
v_mfma_f32_16x16x32_bf16 v[104:107], a[184:187], v[92:95], v[104:107]
s_add_u32 m0, s33, 32
v_exp_f32 v59, v59
v_mfma_f32_16x16x32_bf16 v[108:111], a[188:191], v[92:95], v[108:111]
s_waitcnt lgkmcnt(0)
v_cvt_pk_bf16_f32 v81, v58, v59
v_mfma_f32_16x16x32_bf16 v[108:111], a[156:159], v[88:91], v[108:111]
s_waitcnt lgkmcnt(0)
v_exp_f32 v60, v60
v_mfma_f32_16x16x32_bf16 v[112:115], a[160:163], v[88:91], v[112:115]
buffer_load_dwordx4 v3, s[12:15], 0 offen offset:1024 nt lds
v_mfma_f32_16x16x32_bf16 v[112:115], a[192:195], v[92:95], v[112:115]
s_barrier
v_exp_f32 v61, v61
v_mfma_f32_16x16x32_bf16 v[116:119], a[196:199], v[92:95], v[116:119]
v_cvt_pk_bf16_f32 v82, v60, v61
v_mfma_f32_16x16x32_bf16 v[116:119], a[164:167], v[88:91], v[116:119]
s_add_u32 m0, s33, 64
v_exp_f32 v62, v62
v_mfma_f32_16x16x32_bf16 v[120:123], a[168:171], v[88:91], v[120:123]
buffer_load_dwordx4 v3, s[12:15], 0 offen offset:2048 nt lds
v_mfma_f32_16x16x32_bf16 v[120:123], a[200:203], v[92:95], v[120:123]
v_exp_f32 v63, v63
v_mfma_f32_16x16x32_bf16 v[124:127], a[204:207], v[92:95], v[124:127]
v_cvt_pk_bf16_f32 v83, v62, v63
v_mfma_f32_16x16x32_bf16 v[124:127], a[172:175], v[88:91], v[124:127]
v_mfma_f32_16x16x32_bf16 a[208:211], a[228:231], v[88:91], a[208:211]
v_mfma_f32_16x16x32_bf16 a[208:211], a[228:231], v[92:95], a[208:211]
s_add_u32 m0, s33, 96
v_mfma_f32_16x16x32_bf16 v[72:75], a[80:83], a[32:35], v[44:47]
v_mfma_f32_16x16x32_bf16 v[72:75], a[84:87], a[36:39], v[72:75]
v_mfma_f32_16x16x32_bf16 v[72:75], a[88:91], a[40:43], v[72:75]
buffer_load_dwordx4 v3, s[12:15], 0 offen offset:3072 nt lds
v_mfma_f32_16x16x32_bf16 v[72:75], a[92:95], a[44:47], v[72:75]
v_exp_f32 v64, v64
v_exp_f32 v65, v65
v_exp_f32 v66, v66
v_exp_f32 v67, v67
v_cvt_pk_bf16_f32 v84, v64, v65
v_cvt_pk_bf16_f32 v85, v66, v67
v_mfma_f32_16x16x32_bf16 v[76:79], a[108:111], a[44:47], v[44:47]
s_add_u32 s16, s16, 66863104
s_addc_u32 s17, s17, 0
v_mfma_f32_16x16x32_bf16 v[76:79], a[104:107], a[40:43], v[76:79]
s_add_u32 m0, s33, 33792
v_exp_f32 v68, v68
v_mfma_f32_16x16x32_bf16 v[76:79], a[100:103], a[36:39], v[76:79]
buffer_load_dwordx4 v3, s[16:19], 0 offen nt lds
v_mfma_f32_16x16x32_bf16 v[76:79], a[96:99], a[32:35], v[76:79]
v_exp_f32 v69, v69
v_mfma_f32_16x16x32_bf16 v[56:59], a[112:115], a[32:35], v[44:47]
v_cvt_pk_bf16_f32 v86, v68, v69
v_mfma_f32_16x16x32_bf16 v[56:59], a[116:119], a[36:39], v[56:59]
v_exp_f32 v70, v70
v_mfma_f32_16x16x32_bf16 v[56:59], a[120:123], a[40:43], v[56:59]
v_mfma_f32_16x16x32_bf16 v[56:59], a[124:127], a[44:47], v[56:59]
s_add_u32 m0, s33, 33824
v_exp_f32 v71, v71
v_mfma_f32_16x16x32_bf16 v[60:63], a[140:143], a[44:47], v[44:47]
v_exp_f32 v72, v72
v_mfma_f32_16x16x32_bf16 v[60:63], a[136:139], a[40:43], v[60:63]
v_cvt_pk_bf16_f32 v87, v70, v71
v_mfma_f32_16x16x32_bf16 v[60:63], a[132:135], a[36:39], v[60:63]
v_exp_f32 v73, v73
v_mfma_f32_16x16x32_bf16 v[60:63], a[128:131], a[32:35], v[60:63]
v_cvt_pk_bf16_f32 v88, v72, v73
v_mfma_f32_16x16x32_bf16 v[128:131], a[144:147], v[80:83], v[128:131]
v_exp_f32 v74, v74
v_mfma_f32_16x16x32_bf16 v[128:131], a[176:179], v[84:87], v[128:131]
buffer_load_dwordx4 v3, s[16:19], 0 offen offset:1024 nt lds
v_mfma_f32_16x16x32_bf16 v[132:135], a[180:183], v[84:87], v[132:135]
s_add_u32 m0, s33, 33856
v_exp_f32 v75, v75
v_mfma_f32_16x16x32_bf16 v[132:135], a[148:151], v[80:83], v[132:135]
v_cvt_pk_bf16_f32 v89, v74, v75
v_mfma_f32_16x16x32_bf16 v[136:139], a[152:155], v[80:83], v[136:139]
v_exp_f32 v76, v76
v_mfma_f32_16x16x32_bf16 v[136:139], a[184:187], v[84:87], v[136:139]
buffer_load_dwordx4 v3, s[16:19], 0 offen offset:2048 nt lds
v_mfma_f32_16x16x32_bf16 v[140:143], a[188:191], v[84:87], v[140:143]
v_exp_f32 v77, v77
v_mfma_f32_16x16x32_bf16 v[140:143], a[156:159], v[80:83], v[140:143]
v_cvt_pk_bf16_f32 v90, v76, v77
v_mfma_f32_16x16x32_bf16 v[144:147], a[160:163], v[80:83], v[144:147]
s_add_u32 m0, s33, 33888
v_exp_f32 v78, v78
v_mfma_f32_16x16x32_bf16 v[144:147], a[192:195], v[84:87], v[144:147]
buffer_load_dwordx4 v3, s[16:19], 0 offen offset:3072 nt lds
v_mfma_f32_16x16x32_bf16 v[148:151], a[196:199], v[84:87], v[148:151]
v_exp_f32 v79, v79
v_mfma_f32_16x16x32_bf16 v[148:151], a[164:167], v[80:83], v[148:151]
v_cvt_pk_bf16_f32 v91, v78, v79
v_mfma_f32_16x16x32_bf16 v[152:155], a[168:171], v[80:83], v[152:155]
v_exp_f32 v56, v56
v_mfma_f32_16x16x32_bf16 v[152:155], a[200:203], v[84:87], v[152:155]
v_mfma_f32_16x16x32_bf16 v[156:159], a[204:207], v[84:87], v[156:159]
s_waitcnt vmcnt(12) lgkmcnt(0)
v_exp_f32 v57, v57
v_mfma_f32_16x16x32_bf16 v[156:159], a[172:175], v[80:83], v[156:159]
v_cvt_pk_bf16_f32 v92, v56, v57
v_mfma_f32_16x16x32_bf16 a[212:215], a[228:231], v[80:83], a[212:215]
s_barrier
v_exp_f32 v58, v58
v_mfma_f32_16x16x32_bf16 a[212:215], a[228:231], v[84:87], a[212:215]
v_mfma_f32_16x16x32_bf16 v[64:67], a[80:83], a[48:51], v[48:51]
v_exp_f32 v59, v59
v_mfma_f32_16x16x32_bf16 v[64:67], a[84:87], a[52:55], v[64:67]
ds_read_b128 a[80:83], v1 offset:25344
v_cvt_pk_bf16_f32 v93, v58, v59
v_mfma_f32_16x16x32_bf16 v[64:67], a[88:91], a[56:59], v[64:67]
v_mfma_f32_16x16x32_bf16 v[64:67], a[92:95], a[60:63], v[64:67]
ds_read_b128 a[84:87], v1 offset:25408
ds_read_b128 a[88:91], v1 offset:25472
v_mfma_f32_16x16x32_bf16 v[68:71], a[108:111], a[60:63], v[48:51]
v_mfma_f32_16x16x32_bf16 v[68:71], a[104:107], a[56:59], v[68:71]
ds_read_b128 a[92:95], v1 offset:25536
v_mfma_f32_16x16x32_bf16 v[68:71], a[100:103], a[52:55], v[68:71]
v_mfma_f32_16x16x32_bf16 v[68:71], a[96:99], a[48:51], v[68:71]
ds_read_b128 a[108:111], v1 offset:26048
v_exp_f32 v60, v60
v_exp_f32 v61, v61
v_exp_f32 v62, v62
v_exp_f32 v63, v63
v_cvt_pk_bf16_f32 v94, v60, v61
v_cvt_pk_bf16_f32 v95, v62, v63
v_mfma_f32_16x16x32_bf16 v[72:75], a[112:115], a[48:51], v[48:51]
v_mfma_f32_16x16x32_bf16 v[72:75], a[116:119], a[52:55], v[72:75]
v_exp_f32 v64, v64
v_mfma_f32_16x16x32_bf16 v[72:75], a[120:123], a[56:59], v[72:75]
ds_read_b128 a[104:107], v1 offset:25984
v_mfma_f32_16x16x32_bf16 v[72:75], a[124:127], a[60:63], v[72:75]
v_exp_f32 v65, v65
v_mfma_f32_16x16x32_bf16 v[76:79], a[140:143], a[60:63], v[48:51]
ds_read_b128 a[100:103], v1 offset:25920
v_cvt_pk_bf16_f32 v80, v64, v65
v_mfma_f32_16x16x32_bf16 v[76:79], a[136:139], a[56:59], v[76:79]
v_exp_f32 v66, v66
v_mfma_f32_16x16x32_bf16 v[76:79], a[132:135], a[52:55], v[76:79]
ds_read_b128 a[96:99], v1 offset:25856
v_mfma_f32_16x16x32_bf16 v[76:79], a[128:131], a[48:51], v[76:79]
v_exp_f32 v67, v67
v_mfma_f32_16x16x32_bf16 v[160:163], a[144:147], v[88:91], v[160:163]
ds_read_b128 a[112:115], v1 offset:16896
v_cvt_pk_bf16_f32 v81, v66, v67
v_mfma_f32_16x16x32_bf16 v[160:163], a[176:179], v[92:95], v[160:163]
v_exp_f32 v68, v68
v_mfma_f32_16x16x32_bf16 v[164:167], a[180:183], v[92:95], v[164:167]
ds_read_b128 a[116:119], v1 offset:16960
v_mfma_f32_16x16x32_bf16 v[164:167], a[148:151], v[88:91], v[164:167]
v_exp_f32 v69, v69
v_mfma_f32_16x16x32_bf16 v[168:171], a[152:155], v[88:91], v[168:171]
ds_read_b128 a[120:123], v1 offset:17024
v_cvt_pk_bf16_f32 v82, v68, v69
v_mfma_f32_16x16x32_bf16 v[168:171], a[184:187], v[92:95], v[168:171]
v_exp_f32 v70, v70
v_mfma_f32_16x16x32_bf16 v[172:175], a[188:191], v[92:95], v[172:175]
ds_read_b128 a[124:127], v1 offset:17088
v_mfma_f32_16x16x32_bf16 v[172:175], a[156:159], v[88:91], v[172:175]
v_exp_f32 v71, v71
v_mfma_f32_16x16x32_bf16 v[176:179], a[160:163], v[88:91], v[176:179]
ds_read_b128 a[140:143], v1 offset:17600
v_cvt_pk_bf16_f32 v83, v70, v71
v_mfma_f32_16x16x32_bf16 v[176:179], a[192:195], v[92:95], v[176:179]
v_exp_f32 v72, v72
v_mfma_f32_16x16x32_bf16 v[180:183], a[196:199], v[92:95], v[180:183]
ds_read_b128 a[136:139], v1 offset:17536
v_mfma_f32_16x16x32_bf16 v[180:183], a[164:167], v[88:91], v[180:183]
v_exp_f32 v73, v73
v_mfma_f32_16x16x32_bf16 v[184:187], a[168:171], v[88:91], v[184:187]
ds_read_b128 a[132:135], v1 offset:17472
v_cvt_pk_bf16_f32 v84, v72, v73
v_mfma_f32_16x16x32_bf16 v[184:187], a[200:203], v[92:95], v[184:187]
v_exp_f32 v74, v74
v_mfma_f32_16x16x32_bf16 v[188:191], a[204:207], v[92:95], v[188:191]
ds_read_b128 a[128:131], v1 offset:17408
v_mfma_f32_16x16x32_bf16 v[188:191], a[172:175], v[88:91], v[188:191]
v_exp_f32 v75, v75
v_mfma_f32_16x16x32_bf16 a[216:219], a[228:231], v[88:91], a[216:219]
s_waitcnt lgkmcnt(8)
v_cvt_pk_bf16_f32 v85, v74, v75
v_mfma_f32_16x16x32_bf16 a[216:219], a[228:231], v[92:95], a[216:219]
v_mfma_f32_16x16x32_bf16 v[56:59], a[80:83], a[64:67], v[52:55]
v_mfma_f32_16x16x32_bf16 v[56:59], a[84:87], a[68:71], v[56:59]
v_mfma_f32_16x16x32_bf16 v[56:59], a[88:91], a[72:75], v[56:59]
v_mfma_f32_16x16x32_bf16 v[56:59], a[92:95], a[76:79], v[56:59]
v_exp_f32 v76, v76
v_exp_f32 v77, v77
v_exp_f32 v78, v78
v_exp_f32 v79, v79
v_cvt_pk_bf16_f32 v86, v76, v77
v_cvt_pk_bf16_f32 v87, v78, v79
v_mfma_f32_16x16x32_bf16 v[60:63], a[108:111], a[76:79], v[52:55]
v_mfma_f32_16x16x32_bf16 v[60:63], a[104:107], a[72:75], v[60:63]
s_waitcnt vmcnt(8) lgkmcnt(0)
v_mfma_f32_16x16x32_bf16 v[60:63], a[100:103], a[68:71], v[60:63]
v_mfma_f32_16x16x32_bf16 v[60:63], a[96:99], a[64:67], v[60:63]
s_barrier
s_add_u32 s12, s12, 16384
s_addc_u32 s13, s13, 0
v_mfma_f32_16x16x32_bf16 v[192:195], a[144:147], v[80:83], v[192:195]
ds_read_b64_tr_b16 a[144:145], v2 offset:25344
ds_read_b64_tr_b16 a[146:147], v2 offset:25856
v_mfma_f32_16x16x32_bf16 v[192:195], a[176:179], v[84:87], v[192:195]
v_exp_f32 v56, v56
v_mfma_f32_16x16x32_bf16 v[196:199], a[180:183], v[84:87], v[196:199]
v_mfma_f32_16x16x32_bf16 v[196:199], a[148:151], v[80:83], v[196:199]
ds_read_b64_tr_b16 a[148:149], v2 offset:25376
ds_read_b64_tr_b16 a[150:151], v2 offset:25888
v_mfma_f32_16x16x32_bf16 v[200:203], a[152:155], v[80:83], v[200:203]
v_exp_f32 v57, v57
v_mfma_f32_16x16x32_bf16 v[200:203], a[184:187], v[84:87], v[200:203]
ds_read_b64_tr_b16 a[152:153], v2 offset:25408
v_cvt_pk_bf16_f32 v88, v56, v57
v_mfma_f32_16x16x32_bf16 v[204:207], a[188:191], v[84:87], v[204:207]
ds_read_b64_tr_b16 a[154:155], v2 offset:25920
v_accvgpr_read_b32 v32, a242
v_mfma_f32_16x16x32_bf16 v[204:207], a[156:159], v[80:83], v[204:207]
s_add_u32 m0, s33, 16896
v_exp_f32 v58, v58
v_mfma_f32_16x16x32_bf16 v[208:211], a[160:163], v[80:83], v[208:211]
buffer_load_dwordx4 v3, s[12:15], 0 offen nt lds
v_mfma_f32_16x16x32_bf16 v[208:211], a[192:195], v[84:87], v[208:211]
ds_read_b64_tr_b16 a[156:157], v2 offset:25440
ds_read_b64_tr_b16 a[158:159], v2 offset:25952
v_mfma_f32_16x16x32_bf16 v[212:215], a[196:199], v[84:87], v[212:215]
v_exp_f32 v59, v59
v_mfma_f32_16x16x32_bf16 v[212:215], a[164:167], v[80:83], v[212:215]
ds_read_b64_tr_b16 a[160:161], v2 offset:25472
v_cvt_pk_bf16_f32 v89, v58, v59
v_mfma_f32_16x16x32_bf16 v[216:219], a[168:171], v[80:83], v[216:219]
ds_read_b64_tr_b16 a[162:163], v2 offset:25984
ds_read_b128 a[64:67], v32
v_mfma_f32_16x16x32_bf16 v[216:219], a[200:203], v[84:87], v[216:219]
v_exp_f32 v60, v60
v_mfma_f32_16x16x32_bf16 v[220:223], a[204:207], v[84:87], v[220:223]
ds_read_b64_tr_b16 a[164:165], v2 offset:25504
ds_read_b128 a[68:71], v32 offset:64
v_mfma_f32_16x16x32_bf16 v[220:223], a[172:175], v[80:83], v[220:223]
ds_read_b64_tr_b16 a[166:167], v2 offset:26016
ds_read_b128 a[72:75], v32 offset:128
v_mfma_f32_16x16x32_bf16 a[220:223], a[228:231], v[80:83], a[220:223]
s_add_u32 m0, s33, 16928
v_exp_f32 v61, v61
v_mfma_f32_16x16x32_bf16 a[220:223], a[228:231], v[84:87], a[220:223]
ds_read_b64_tr_b16 a[168:169], v2 offset:25536
v_cvt_pk_bf16_f32 v90, v60, v61
v_mfma_f32_16x16x32_bf16 v[64:67], a[80:83], a[0:3], v[36:39]
buffer_load_dwordx4 v3, s[12:15], 0 offen offset:1024 nt lds
v_mfma_f32_16x16x32_bf16 v[64:67], a[84:87], a[4:7], v[64:67]
v_exp_f32 v62, v62
v_mfma_f32_16x16x32_bf16 v[64:67], a[88:91], a[8:11], v[64:67]
ds_read_b64_tr_b16 a[170:171], v2 offset:26048
ds_read_b128 a[76:79], v32 offset:192
v_mfma_f32_16x16x32_bf16 v[64:67], a[92:95], a[12:15], v[64:67]
ds_read_b64_tr_b16 a[172:173], v2 offset:25568
v_accvgpr_read_b32 v52, a241
v_mfma_f32_16x16x32_bf16 v[68:71], a[108:111], a[12:15], v[36:39]
v_exp_f32 v63, v63
v_mfma_f32_16x16x32_bf16 v[68:71], a[104:107], a[8:11], v[68:71]
ds_read_b64_tr_b16 a[174:175], v2 offset:26080
v_cvt_pk_bf16_f32 v91, v62, v63
v_mfma_f32_16x16x32_bf16 v[68:71], a[100:103], a[4:7], v[68:71]
ds_read_b64_tr_b16 a[176:177], v2 offset:16896
v_accvgpr_read_b32 v53, a241
v_mfma_f32_16x16x32_bf16 v[68:71], a[96:99], a[0:3], v[68:71]
ds_read_b64_tr_b16 a[178:179], v2 offset:17408
v_accvgpr_read_b32 v54, a241
v_mfma_f32_16x16x32_bf16 v[72:75], a[112:115], a[0:3], v[36:39]
s_add_u32 m0, s33, 16960
v_exp_f32 v64, v64
v_mfma_f32_16x16x32_bf16 v[72:75], a[116:119], a[4:7], v[72:75]
buffer_load_dwordx4 v3, s[12:15], 0 offen offset:2048 nt lds
v_mfma_f32_16x16x32_bf16 v[72:75], a[120:123], a[8:11], v[72:75]
v_exp_f32 v65, v65
v_mfma_f32_16x16x32_bf16 v[72:75], a[124:127], a[12:15], v[72:75]
ds_read_b64_tr_b16 a[180:181], v2 offset:16928
v_cvt_pk_bf16_f32 v80, v64, v65
v_mfma_f32_16x16x32_bf16 v[76:79], a[140:143], a[12:15], v[36:39]
v_exp_f32 v66, v66
v_mfma_f32_16x16x32_bf16 v[76:79], a[136:139], a[8:11], v[76:79]
ds_read_b64_tr_b16 a[182:183], v2 offset:17440
v_accvgpr_read_b32 v55, a241
v_mfma_f32_16x16x32_bf16 v[76:79], a[132:135], a[4:7], v[76:79]
s_waitcnt lgkmcnt(14)
v_exp_f32 v67, v67
v_mfma_f32_16x16x32_bf16 v[76:79], a[128:131], a[0:3], v[76:79]
ds_read_b64_tr_b16 a[184:185], v2 offset:16960
v_cvt_pk_bf16_f32 v81, v66, v67
v_mfma_f32_16x16x32_bf16 v[224:227], a[144:147], v[88:91], v[224:227]
v_exp_f32 v68, v68
v_mfma_f32_16x16x32_bf16 v[228:231], a[148:151], v[88:91], v[228:231]
s_waitcnt lgkmcnt(5)
ds_read_b64_tr_b16 a[186:187], v2 offset:17472
v_mfma_f32_16x16x32_bf16 v[232:235], a[152:155], v[88:91], v[232:235]
s_add_u32 m0, s33, 16992
v_exp_f32 v69, v69
v_mfma_f32_16x16x32_bf16 v[236:239], a[156:159], v[88:91], v[236:239]
ds_read_b64_tr_b16 a[188:189], v2 offset:16992
v_cvt_pk_bf16_f32 v82, v68, v69
v_mfma_f32_16x16x32_bf16 v[240:243], a[160:163], v[88:91], v[240:243]
v_exp_f32 v70, v70
v_mfma_f32_16x16x32_bf16 v[244:247], a[164:167], v[88:91], v[244:247]
buffer_load_dwordx4 v3, s[12:15], 0 offen offset:3072 nt lds
v_mfma_f32_16x16x32_bf16 v[248:251], a[168:171], v[88:91], v[248:251]
v_exp_f32 v71, v71
v_mfma_f32_16x16x32_bf16 v[252:255], a[172:175], v[88:91], v[252:255]
ds_read_b64_tr_b16 a[190:191], v2 offset:17504
v_cvt_pk_bf16_f32 v83, v70, v71
v_mfma_f32_16x16x32_bf16 a[224:227], a[228:231], v[88:91], a[224:227]
v_exp_f32 v72, v72
v_mfma_f32_16x16x32_bf16 v[56:59], a[80:83], a[16:19], v[40:43]
ds_read_b64_tr_b16 a[192:193], v2 offset:17024
ds_read_b128 a[0:3], v6
v_mfma_f32_16x16x32_bf16 v[56:59], a[84:87], a[20:23], v[56:59]
v_exp_f32 v73, v73
v_mfma_f32_16x16x32_bf16 v[56:59], a[88:91], a[24:27], v[56:59]
ds_read_b64_tr_b16 a[194:195], v2 offset:17536
v_cvt_pk_bf16_f32 v84, v72, v73
v_mfma_f32_16x16x32_bf16 v[56:59], a[92:95], a[28:31], v[56:59]
v_exp_f32 v74, v74
v_mfma_f32_16x16x32_bf16 v[60:63], a[108:111], a[28:31], v[40:43]
ds_read_b64_tr_b16 a[196:197], v2 offset:17056
ds_read_b128 a[4:7], v6 offset:64
v_accvgpr_read_b32 v32, a245
v_accvgpr_read_b32 v33, a247
v_accvgpr_read_b32 v11, a224
v_mfma_f32_16x16x32_bf16 v[60:63], a[104:107], a[24:27], v[60:63]
v_exp_f32 v75, v75
v_mfma_f32_16x16x32_bf16 v[60:63], a[100:103], a[20:23], v[60:63]
ds_read_b64_tr_b16 a[198:199], v2 offset:17568
v_cvt_pk_bf16_f32 v85, v74, v75
v_mfma_f32_16x16x32_bf16 v[60:63], a[96:99], a[16:19], v[60:63]
ds_write_b128 v32, v[224:227]
v_exp_f32 v76, v76
v_mfma_f32_16x16x32_bf16 v[64:67], a[112:115], a[16:19], v[40:43]
ds_read_b64_tr_b16 a[200:201], v2 offset:17088
ds_read_b128 a[8:11], v6 offset:128
v_mfma_f32_16x16x32_bf16 v[64:67], a[116:119], a[20:23], v[64:67]
v_exp_f32 v77, v77
v_mfma_f32_16x16x32_bf16 v[64:67], a[120:123], a[24:27], v[64:67]
ds_read_b64_tr_b16 a[202:203], v2 offset:17600
v_cvt_pk_bf16_f32 v86, v76, v77
v_mfma_f32_16x16x32_bf16 v[64:67], a[124:127], a[28:31], v[64:67]
ds_write_b128 v32, v[228:231] offset:1024
v_exp_f32 v78, v78
v_mfma_f32_16x16x32_bf16 v[68:71], a[140:143], a[28:31], v[40:43]
ds_read_b64_tr_b16 a[204:205], v2 offset:17120
ds_read_b128 a[12:15], v6 offset:192
v_mfma_f32_16x16x32_bf16 v[68:71], a[136:139], a[24:27], v[68:71]
v_exp_f32 v79, v79
v_mfma_f32_16x16x32_bf16 v[68:71], a[132:135], a[20:23], v[68:71]
ds_read_b64_tr_b16 a[206:207], v2 offset:17632
v_cvt_pk_bf16_f32 v87, v78, v79
v_mfma_f32_16x16x32_bf16 v[68:71], a[128:131], a[16:19], v[68:71]
ds_write_b128 v32, v[232:235] offset:2048
v_exp_f32 v56, v56
v_mfma_f32_16x16x32_bf16 v[96:99], a[144:147], v[80:83], v[96:99]
s_waitcnt lgkmcnt(14)
ds_read_b128 a[16:19], v6 offset:512
v_mfma_f32_16x16x32_bf16 v[96:99], a[176:179], v[84:87], v[96:99]
ds_write_b128 v32, v[236:239] offset:3072
v_exp_f32 v57, v57
v_accvgpr_read_b32 v40, a238
v_accvgpr_read_b32 v41, a238
v_accvgpr_read_b32 v42, a238
v_accvgpr_read_b32 v43, a238
v_mfma_f32_16x16x32_bf16 v[100:103], a[180:183], v[84:87], v[100:103]
ds_read_b128 a[20:23], v6 offset:576
v_cvt_pk_bf16_f32 v88, v56, v57
v_mfma_f32_16x16x32_bf16 v[100:103], a[148:151], v[80:83], v[100:103]
ds_write_b32 v33, v11
v_exp_f32 v58, v58
v_accvgpr_read_b32 v32, a246
v_accvgpr_read_b32 v33, a248
v_mfma_f32_16x16x32_bf16 v[104:107], a[152:155], v[80:83], v[104:107]
ds_read_b128 a[24:27], v6 offset:640
ds_read_b128 a[28:31], v6 offset:704
v_mfma_f32_16x16x32_bf16 v[104:107], a[184:187], v[84:87], v[104:107]
v_exp_f32 v59, v59
v_mfma_f32_16x16x32_bf16 v[108:111], a[188:191], v[84:87], v[108:111]
v_cvt_pk_bf16_f32 v89, v58, v59
v_accvgpr_read_b32 v36, a237
v_mfma_f32_16x16x32_bf16 v[108:111], a[156:159], v[80:83], v[108:111]
s_waitcnt lgkmcnt(2)
v_exp_f32 v60, v60
v_mfma_f32_16x16x32_bf16 v[112:115], a[160:163], v[80:83], v[112:115]
s_waitcnt lgkmcnt(7)
v_accvgpr_read_b32 v37, a237
v_accvgpr_read_b32 v38, a237
v_mfma_f32_16x16x32_bf16 v[112:115], a[192:195], v[84:87], v[112:115]
s_barrier
v_exp_f32 v61, v61
v_mfma_f32_16x16x32_bf16 v[116:119], a[196:199], v[84:87], v[116:119]
s_add_u32 s16, s16, 16384
s_addc_u32 s17, s17, 0
v_cvt_pk_bf16_f32 v90, v60, v61
v_mfma_f32_16x16x32_bf16 v[116:119], a[164:167], v[80:83], v[116:119]
ds_read_b32 v12, v33
ds_read_b128 v[224:227], v32
ds_read_b128 v[228:231], v32 offset:1024
ds_read_b128 v[232:235], v32 offset:2048
v_exp_f32 v62, v62
v_mfma_f32_16x16x32_bf16 v[120:123], a[168:171], v[80:83], v[120:123]
ds_read_b128 v[236:239], v32 offset:3072
v_accvgpr_read_b32 v32, a249
v_mfma_f32_16x16x32_bf16 v[120:123], a[200:203], v[84:87], v[120:123]
s_add_u32 m0, s33, 50688
v_exp_f32 v63, v63
v_mfma_f32_16x16x32_bf16 v[124:127], a[204:207], v[84:87], v[124:127]
v_cvt_pk_bf16_f32 v91, v62, v63
v_accvgpr_read_b32 v34, a243
v_mfma_f32_16x16x32_bf16 v[124:127], a[172:175], v[80:83], v[124:127]
s_waitcnt vmcnt(24)
v_exp_f32 v64, v64
v_mfma_f32_16x16x32_bf16 a[208:211], a[228:231], v[80:83], a[208:211]
buffer_load_dwordx4 v3, s[16:19], 0 offen nt lds
v_mfma_f32_16x16x32_bf16 a[208:211], a[228:231], v[84:87], a[208:211]
v_exp_f32 v65, v65
v_mfma_f32_16x16x32_bf16 v[72:75], a[80:83], a[32:35], v[44:47]
v_cvt_pk_bf16_f32 v92, v64, v65
v_accvgpr_read_b32 v35, a244
v_mfma_f32_16x16x32_bf16 v[72:75], a[84:87], a[36:39], v[72:75]
s_add_u32 m0, s33, 50720
v_exp_f32 v66, v66
v_mfma_f32_16x16x32_bf16 v[72:75], a[88:91], a[40:43], v[72:75]
buffer_load_dwordx4 v3, s[16:19], 0 offen offset:1024 nt lds
v_mfma_f32_16x16x32_bf16 v[72:75], a[92:95], a[44:47], v[72:75]
v_exp_f32 v67, v67
v_mfma_f32_16x16x32_bf16 v[76:79], a[108:111], a[44:47], v[44:47]
v_cvt_pk_bf16_f32 v93, v66, v67
v_accvgpr_read_b32 v39, a237
v_mfma_f32_16x16x32_bf16 v[76:79], a[104:107], a[40:43], v[76:79]
s_add_u32 m0, s33, 50752
v_exp_f32 v68, v68
v_mfma_f32_16x16x32_bf16 v[76:79], a[100:103], a[36:39], v[76:79]
buffer_load_dwordx4 v3, s[16:19], 0 offen offset:2048 nt lds
v_mfma_f32_16x16x32_bf16 v[76:79], a[96:99], a[32:35], v[76:79]
s_waitcnt lgkmcnt(0)
v_exp_f32 v69, v69
v_add_f32 v11, v11, v12
v_rcp_f32 v14, v11
v_add_f32 v5, v5, v11
v_add_f32 v5, v5, v14
v_pk_add_f32 v[240:241], v[240:241], v[224:225]
v_pk_add_f32 v[242:243], v[242:243], v[226:227]
v_pk_add_f32 v[244:245], v[244:245], v[228:229]
v_pk_add_f32 v[246:247], v[246:247], v[230:231]
v_pk_add_f32 v[248:249], v[248:249], v[232:233]
v_pk_add_f32 v[250:251], v[250:251], v[234:235]
v_pk_add_f32 v[252:253], v[252:253], v[236:237]
v_pk_add_f32 v[254:255], v[254:255], v[238:239]
v_pk_mul_f32 v[240:241], v[240:241], v[14:15] op_sel_hi:[1,0]
v_pk_mul_f32 v[242:243], v[242:243], v[14:15] op_sel_hi:[1,0]
v_pk_mul_f32 v[244:245], v[244:245], v[14:15] op_sel_hi:[1,0]
v_pk_mul_f32 v[246:247], v[246:247], v[14:15] op_sel_hi:[1,0]
v_pk_mul_f32 v[248:249], v[248:249], v[14:15] op_sel_hi:[1,0]
v_pk_mul_f32 v[250:251], v[250:251], v[14:15] op_sel_hi:[1,0]
v_pk_mul_f32 v[252:253], v[252:253], v[14:15] op_sel_hi:[1,0]
v_pk_mul_f32 v[254:255], v[254:255], v[14:15] op_sel_hi:[1,0]
v_cvt_pk_bf16_f32 v240, v240, v241
v_mfma_f32_16x16x32_bf16 v[56:59], a[112:115], a[32:35], v[44:47]
v_cvt_pk_bf16_f32 v94, v68, v69
v_cvt_pk_bf16_f32 v241, v242, v243
v_mfma_f32_16x16x32_bf16 v[56:59], a[116:119], a[36:39], v[56:59]
v_exp_f32 v70, v70
v_mfma_f32_16x16x32_bf16 v[56:59], a[120:123], a[40:43], v[56:59]
v_cvt_pk_bf16_f32 v244, v244, v245
v_cvt_pk_bf16_f32 v245, v246, v247
v_mfma_f32_16x16x32_bf16 v[56:59], a[124:127], a[44:47], v[56:59]
s_add_u32 m0, s33, 50784
v_exp_f32 v71, v71
v_mfma_f32_16x16x32_bf16 v[60:63], a[140:143], a[44:47], v[44:47]
v_exp_f32 v72, v72
v_mfma_f32_16x16x32_bf16 v[60:63], a[136:139], a[40:43], v[60:63]
v_cvt_pk_bf16_f32 v95, v70, v71
v_cvt_pk_bf16_f32 v248, v248, v249
v_mfma_f32_16x16x32_bf16 v[60:63], a[132:135], a[36:39], v[60:63]
v_exp_f32 v73, v73
v_mfma_f32_16x16x32_bf16 v[60:63], a[128:131], a[32:35], v[60:63]
ds_read_b128 a[32:35], v6 offset:8448
ds_write_b64 v32, v[240:241]
v_cvt_pk_bf16_f32 v80, v72, v73
v_mfma_f32_16x16x32_bf16 v[128:131], a[144:147], v[88:91], v[128:131]
v_exp_f32 v74, v74
v_mfma_f32_16x16x32_bf16 v[128:131], a[176:179], v[92:95], v[128:131]
buffer_load_dwordx4 v3, s[16:19], 0 offen offset:3072 nt lds
ds_write_b64 v32, v[244:245] offset:32
v_accvgpr_read_b32 v44, a239
v_accvgpr_read_b32 v45, a239
v_accvgpr_read_b32 v46, a239
v_accvgpr_read_b32 v47, a239
v_mfma_f32_16x16x32_bf16 v[132:135], a[180:183], v[92:95], v[132:135]
v_exp_f32 v75, v75
v_mfma_f32_16x16x32_bf16 v[132:135], a[148:151], v[88:91], v[132:135]
ds_read_b128 a[36:39], v6 offset:8512
v_cvt_pk_bf16_f32 v81, v74, v75
v_mfma_f32_16x16x32_bf16 v[136:139], a[152:155], v[88:91], v[136:139]
v_exp_f32 v76, v76
v_mfma_f32_16x16x32_bf16 v[136:139], a[184:187], v[92:95], v[136:139]
ds_read_b128 a[40:43], v6 offset:8576
ds_read_b128 a[44:47], v6 offset:8640
v_mfma_f32_16x16x32_bf16 v[140:143], a[188:191], v[92:95], v[140:143]
v_exp_f32 v77, v77
v_mfma_f32_16x16x32_bf16 v[140:143], a[156:159], v[88:91], v[140:143]
v_cvt_pk_bf16_f32 v82, v76, v77
v_cvt_pk_bf16_f32 v249, v250, v251
v_mfma_f32_16x16x32_bf16 v[144:147], a[160:163], v[88:91], v[144:147]
v_exp_f32 v78, v78
v_mfma_f32_16x16x32_bf16 v[144:147], a[192:195], v[92:95], v[144:147]
ds_write_b64 v32, v[248:249] offset:64
v_cvt_pk_bf16_f32 v252, v252, v253
v_cvt_pk_bf16_f32 v253, v254, v255
v_mfma_f32_16x16x32_bf16 v[148:151], a[196:199], v[92:95], v[148:151]
v_exp_f32 v79, v79
v_mfma_f32_16x16x32_bf16 v[148:151], a[164:167], v[88:91], v[148:151]
ds_write_b64 v32, v[252:253] offset:96
v_cvt_pk_bf16_f32 v83, v78, v79
v_accvgpr_read_b32 v10, a208
v_mfma_f32_16x16x32_bf16 v[152:155], a[168:171], v[88:91], v[152:155]
v_exp_f32 v56, v56
v_mfma_f32_16x16x32_bf16 v[152:155], a[200:203], v[92:95], v[152:155]
v_rcp_f32 v14, v10
v_add_f32 v5, v5, v10
v_accvgpr_read_b32 v32, a250
v_accvgpr_read_b32 v33, a251
v_mfma_f32_16x16x32_bf16 v[156:159], a[204:207], v[92:95], v[156:159]
s_waitcnt vmcnt(12) lgkmcnt(14)
v_exp_f32 v57, v57
v_mfma_f32_16x16x32_bf16 v[156:159], a[172:175], v[88:91], v[156:159]
ds_read_b128 v[224:227], v32
ds_read_b128 v[228:231], v32 offset:4224
v_cvt_pk_bf16_f32 v84, v56, v57
v_add_f32 v5, v5, v14
v_mfma_f32_16x16x32_bf16 a[212:215], a[228:231], v[88:91], a[212:215]
s_barrier
v_exp_f32 v58, v58
v_mfma_f32_16x16x32_bf16 a[212:215], a[228:231], v[92:95], a[212:215]
ds_read_b128 v[16:19], v34
ds_read_b128 v[20:23], v34 offset:64
v_mfma_f32_16x16x32_bf16 v[64:67], a[80:83], a[48:51], v[48:51]
v_exp_f32 v59, v59
v_mfma_f32_16x16x32_bf16 v[64:67], a[84:87], a[52:55], v[64:67]
ds_read_b128 a[80:83], v1 offset:8448
v_cvt_pk_bf16_f32 v85, v58, v59
v_mfma_f32_16x16x32_bf16 v[64:67], a[88:91], a[56:59], v[64:67]
v_exp_f32 v60, v60
v_mfma_f32_16x16x32_bf16 v[64:67], a[92:95], a[60:63], v[64:67]
ds_read_b128 a[84:87], v1 offset:8512
ds_read_b128 a[88:91], v1 offset:8576
v_mfma_f32_16x16x32_bf16 v[68:71], a[108:111], a[60:63], v[48:51]
s_waitcnt lgkmcnt(6)
v_exp_f32 v61, v61
v_mfma_f32_16x16x32_bf16 v[68:71], a[104:107], a[56:59], v[68:71]
ds_read_b128 a[92:95], v1 offset:8640
v_cvt_pk_bf16_f32 v86, v60, v61
v_mfma_f32_16x16x32_bf16 v[68:71], a[100:103], a[52:55], v[68:71]
v_exp_f32 v62, v62
v_mfma_f32_16x16x32_bf16 v[68:71], a[96:99], a[48:51], v[68:71]
ds_read_b128 a[108:111], v1 offset:9152
ds_read_b128 v[24:27], v34 offset:128
v_mfma_f32_16x16x32_bf16 v[72:75], a[112:115], a[48:51], v[48:51]
v_exp_f32 v63, v63
v_mfma_f32_16x16x32_bf16 v[72:75], a[116:119], a[52:55], v[72:75]
v_exp_f32 v64, v64
v_mfma_f32_16x16x32_bf16 v[72:75], a[120:123], a[56:59], v[72:75]
ds_read_b128 a[104:107], v1 offset:9088
v_cvt_pk_bf16_f32 v87, v62, v63
v_mfma_f32_16x16x32_bf16 v[72:75], a[124:127], a[60:63], v[72:75]
v_exp_f32 v65, v65
v_mfma_f32_16x16x32_bf16 v[76:79], a[140:143], a[60:63], v[48:51]
ds_read_b128 a[100:103], v1 offset:9024
v_cvt_pk_bf16_f32 v88, v64, v65
v_mfma_f32_16x16x32_bf16 v[76:79], a[136:139], a[56:59], v[76:79]
v_exp_f32 v66, v66
v_mfma_f32_16x16x32_bf16 v[76:79], a[132:135], a[52:55], v[76:79]
ds_read_b128 a[96:99], v1 offset:8960
ds_read_b128 v[28:31], v34 offset:192
v_mfma_f32_16x16x32_bf16 v[76:79], a[128:131], a[48:51], v[76:79]
v_exp_f32 v67, v67
v_mfma_f32_16x16x32_bf16 v[160:163], a[144:147], v[80:83], v[160:163]
ds_read_b128 a[112:115], v1
v_cvt_pk_bf16_f32 v89, v66, v67
v_mfma_f32_16x16x32_bf16 v[160:163], a[176:179], v[84:87], v[160:163]
buffer_store_dwordx4 v[224:227], v33, s[28:31], s43 offen sc0 sc1
v_exp_f32 v68, v68
v_accvgpr_read_b32 v48, a240
v_accvgpr_read_b32 v49, a240
v_accvgpr_read_b32 v50, a240
v_accvgpr_read_b32 v51, a240
v_mfma_f32_16x16x32_bf16 v[164:167], a[180:183], v[84:87], v[164:167]
ds_read_b128 a[116:119], v1 offset:64
ds_read_b128 a[48:51], v6 offset:8960
v_mfma_f32_16x16x32_bf16 v[164:167], a[148:151], v[80:83], v[164:167]
s_add_u32 s43, s43, 4096
v_exp_f32 v69, v69
v_mfma_f32_16x16x32_bf16 v[168:171], a[152:155], v[80:83], v[168:171]
ds_read_b128 a[120:123], v1 offset:128
v_cvt_pk_bf16_f32 v90, v68, v69
v_mfma_f32_16x16x32_bf16 v[168:171], a[184:187], v[84:87], v[168:171]
s_waitcnt lgkmcnt(14)
v_exp_f32 v70, v70
v_mfma_f32_16x16x32_bf16 v[172:175], a[188:191], v[84:87], v[172:175]
ds_read_b128 a[124:127], v1 offset:192
ds_read_b128 a[52:55], v6 offset:9024
v_mfma_f32_16x16x32_bf16 v[172:175], a[156:159], v[80:83], v[172:175]
s_waitcnt lgkmcnt(6)
buffer_store_dwordx4 v[228:231], v33, s[28:31], s43 offen sc0 sc1
v_exp_f32 v71, v71
v_bitop3_b32 v16, v16, v35, s41 bitop3:0x28
v_bitop3_b32 v17, v17, v35, s41 bitop3:0x28
v_bitop3_b32 v18, v18, v35, s41 bitop3:0x28
v_bitop3_b32 v19, v19, v35, s41 bitop3:0x28
v_bitop3_b32 v20, v20, v35, s41 bitop3:0x28
v_bitop3_b32 v21, v21, v35, s41 bitop3:0x28
v_bitop3_b32 v22, v22, v35, s41 bitop3:0x28
v_bitop3_b32 v23, v23, v35, s41 bitop3:0x28
v_bitop3_b32 v24, v24, v35, s41 bitop3:0x28
v_bitop3_b32 v25, v25, v35, s41 bitop3:0x28
v_bitop3_b32 v26, v26, v35, s41 bitop3:0x28
v_bitop3_b32 v27, v27, v35, s41 bitop3:0x28
v_bitop3_b32 v28, v28, v35, s41 bitop3:0x28
v_bitop3_b32 v29, v29, v35, s41 bitop3:0x28
v_bitop3_b32 v30, v30, v35, s41 bitop3:0x28
v_bitop3_b32 v31, v31, v35, s41 bitop3:0x28
v_pk_mul_f32 v[96:97], v[96:97], v[14:15] op_sel_hi:[1,0]
v_pk_mul_f32 v[98:99], v[98:99], v[14:15] op_sel_hi:[1,0]
v_pk_mul_f32 v[100:101], v[100:101], v[14:15] op_sel_hi:[1,0]
v_pk_mul_f32 v[102:103], v[102:103], v[14:15] op_sel_hi:[1,0]
v_pk_mul_f32 v[104:105], v[104:105], v[14:15] op_sel_hi:[1,0]
v_pk_mul_f32 v[106:107], v[106:107], v[14:15] op_sel_hi:[1,0]
v_pk_mul_f32 v[108:109], v[108:109], v[14:15] op_sel_hi:[1,0]
v_pk_mul_f32 v[110:111], v[110:111], v[14:15] op_sel_hi:[1,0]
v_pk_mul_f32 v[112:113], v[112:113], v[14:15] op_sel_hi:[1,0]
v_pk_mul_f32 v[114:115], v[114:115], v[14:15] op_sel_hi:[1,0]
v_pk_mul_f32 v[116:117], v[116:117], v[14:15] op_sel_hi:[1,0]
v_pk_mul_f32 v[118:119], v[118:119], v[14:15] op_sel_hi:[1,0]
v_pk_mul_f32 v[120:121], v[120:121], v[14:15] op_sel_hi:[1,0]
v_pk_mul_f32 v[122:123], v[122:123], v[14:15] op_sel_hi:[1,0]
v_pk_mul_f32 v[124:125], v[124:125], v[14:15] op_sel_hi:[1,0]
v_pk_mul_f32 v[126:127], v[126:127], v[14:15] op_sel_hi:[1,0]
v_mfma_f32_16x16x32_bf16 v[176:179], a[160:163], v[80:83], v[176:179]
ds_read_b128 a[140:143], v1 offset:704
v_cvt_pk_bf16_f32 v91, v70, v71
v_mfma_f32_16x16x32_bf16 v[176:179], a[192:195], v[84:87], v[176:179]
s_add_u32 s43, s43, 18870272
v_exp_f32 v72, v72
v_mfma_f32_16x16x32_bf16 v[180:183], a[196:199], v[84:87], v[180:183]
ds_read_b128 a[136:139], v1 offset:640
ds_read_b128 a[56:59], v6 offset:9088
v_mfma_f32_16x16x32_bf16 v[180:183], a[164:167], v[80:83], v[180:183]
v_exp_f32 v73, v73
v_mfma_f32_16x16x32_bf16 v[184:187], a[168:171], v[80:83], v[184:187]
ds_read_b128 a[132:135], v1 offset:576
v_cvt_pk_bf16_f32 v92, v72, v73
v_mfma_f32_16x16x32_bf16 v[184:187], a[200:203], v[84:87], v[184:187]
v_exp_f32 v74, v74
v_mfma_f32_16x16x32_bf16 v[188:191], a[204:207], v[84:87], v[188:191]
ds_read_b128 a[128:131], v1 offset:512
ds_read_b128 a[60:63], v6 offset:9152
v_mfma_f32_16x16x32_bf16 v[188:191], a[172:175], v[80:83], v[188:191]
v_exp_f32 v75, v75
v_mfma_f32_16x16x32_bf16 a[216:219], a[228:231], v[80:83], a[216:219]
s_waitcnt lgkmcnt(13)
v_cvt_pk_bf16_f32 v93, v74, v75
v_cvt_pk_bf16_f32 v96, v96, v97
v_mfma_f32_16x16x32_bf16 a[216:219], a[228:231], v[84:87], a[216:219]
s_waitcnt lgkmcnt(14)
v_exp_f32 v76, v76
v_mfma_f32_16x16x32_bf16 v[52:55], v[16:19], a[64:67], v[52:55]
v_cvt_pk_bf16_f32 v97, v98, v99
v_cvt_pk_bf16_f32 v100, v100, v101
v_mfma_f32_16x16x32_bf16 v[52:55], v[20:23], a[68:71], v[52:55]
v_cvt_pk_bf16_f32 v101, v102, v103
v_cvt_pk_bf16_f32 v104, v104, v105
v_mfma_f32_16x16x32_bf16 v[52:55], v[24:27], a[72:75], v[52:55]
v_cvt_pk_bf16_f32 v105, v106, v107
v_cvt_pk_bf16_f32 v108, v108, v109
v_mfma_f32_16x16x32_bf16 v[52:55], v[28:31], a[76:79], v[52:55]
v_cvt_pk_bf16_f32 v109, v110, v111
v_cvt_pk_bf16_f32 v112, v112, v113
v_mfma_f32_16x16x32_bf16 v[56:59], a[80:83], a[64:67], v[52:55]
v_cvt_pk_bf16_f32 v113, v114, v115
v_cvt_pk_bf16_f32 v116, v116, v117
v_mfma_f32_16x16x32_bf16 v[56:59], a[84:87], a[68:71], v[56:59]
v_exp_f32 v77, v77
v_mfma_f32_16x16x32_bf16 v[56:59], a[88:91], a[72:75], v[56:59]
v_cvt_pk_bf16_f32 v94, v76, v77
v_cvt_pk_bf16_f32 v117, v118, v119
v_mfma_f32_16x16x32_bf16 v[56:59], a[92:95], a[76:79], v[56:59]
ds_write_b64 v7, v[96:97]
v_exp_f32 v78, v78
v_mfma_f32_16x16x32_bf16 v[60:63], a[108:111], a[76:79], v[52:55]
ds_write_b64 v7, v[100:101] offset:32
v_mfma_f32_16x16x32_bf16 v[60:63], a[104:107], a[72:75], v[60:63]
s_waitcnt vmcnt(10) lgkmcnt(3)
v_exp_f32 v79, v79
v_mfma_f32_16x16x32_bf16 v[60:63], a[100:103], a[68:71], v[60:63]
v_cvt_pk_bf16_f32 v95, v78, v79
v_cvt_pk_bf16_f32 v120, v120, v121
v_mfma_f32_16x16x32_bf16 v[60:63], a[96:99], a[64:67], v[60:63]
s_barrier
s_add_u32 s12, s12, 16384
s_addc_u32 s13, s13, 0
v_mfma_f32_16x16x32_bf16 v[192:195], a[144:147], v[88:91], v[192:195]
ds_read_b64_tr_b16 a[144:145], v2 offset:8448
v_cvt_pk_bf16_f32 v121, v122, v123
v_mfma_f32_16x16x32_bf16 v[192:195], a[176:179], v[92:95], v[192:195]
ds_write_b64 v7, v[104:105] offset:64
v_exp_f32 v56, v56
v_mfma_f32_16x16x32_bf16 v[196:199], a[180:183], v[92:95], v[196:199]
ds_read_b64_tr_b16 a[146:147], v2 offset:8960
v_cvt_pk_bf16_f32 v124, v124, v125
v_mfma_f32_16x16x32_bf16 v[196:199], a[148:151], v[88:91], v[196:199]
ds_read_b64_tr_b16 a[148:149], v2 offset:8480
ds_write_b64 v7, v[108:109] offset:96
v_cvt_pk_bf16_f32 v125, v126, v127
v_mfma_f32_16x16x32_bf16 v[200:203], a[152:155], v[88:91], v[200:203]
v_exp_f32 v57, v57
v_mfma_f32_16x16x32_bf16 v[200:203], a[184:187], v[92:95], v[200:203]
ds_read_b64_tr_b16 a[150:151], v2 offset:8992
ds_write_b64 v7, v[112:113] offset:128
v_cvt_pk_bf16_f32 v80, v56, v57
v_mfma_f32_16x16x32_bf16 v[204:207], a[188:191], v[92:95], v[204:207]
ds_read_b64_tr_b16 a[152:153], v2 offset:8512
v_accvgpr_read_b32 v10, a212
v_mfma_f32_16x16x32_bf16 v[204:207], a[156:159], v[88:91], v[204:207]
s_add_u32 m0, s33, 0
v_exp_f32 v58, v58
v_mfma_f32_16x16x32_bf16 v[208:211], a[160:163], v[88:91], v[208:211]
buffer_load_dwordx4 v3, s[12:15], 0 offen nt lds
ds_write_b64 v7, v[116:117] offset:160
v_mfma_f32_16x16x32_bf16 v[208:211], a[192:195], v[92:95], v[208:211]
ds_read_b64_tr_b16 a[154:155], v2 offset:9024
ds_write_b64 v7, v[120:121] offset:192
v_rcp_f32 v14, v10
v_add_f32 v5, v5, v10
v_add_f32 v5, v5, v14
v_pk_mul_f32 v[128:129], v[128:129], v[14:15] op_sel_hi:[1,0]
v_pk_mul_f32 v[130:131], v[130:131], v[14:15] op_sel_hi:[1,0]
v_pk_mul_f32 v[132:133], v[132:133], v[14:15] op_sel_hi:[1,0]
v_pk_mul_f32 v[134:135], v[134:135], v[14:15] op_sel_hi:[1,0]
v_pk_mul_f32 v[136:137], v[136:137], v[14:15] op_sel_hi:[1,0]
v_pk_mul_f32 v[138:139], v[138:139], v[14:15] op_sel_hi:[1,0]
v_pk_mul_f32 v[140:141], v[140:141], v[14:15] op_sel_hi:[1,0]
v_pk_mul_f32 v[142:143], v[142:143], v[14:15] op_sel_hi:[1,0]
v_pk_mul_f32 v[144:145], v[144:145], v[14:15] op_sel_hi:[1,0]
v_pk_mul_f32 v[146:147], v[146:147], v[14:15] op_sel_hi:[1,0]
v_pk_mul_f32 v[148:149], v[148:149], v[14:15] op_sel_hi:[1,0]
v_pk_mul_f32 v[150:151], v[150:151], v[14:15] op_sel_hi:[1,0]
v_pk_mul_f32 v[152:153], v[152:153], v[14:15] op_sel_hi:[1,0]
v_pk_mul_f32 v[154:155], v[154:155], v[14:15] op_sel_hi:[1,0]
v_pk_mul_f32 v[156:157], v[156:157], v[14:15] op_sel_hi:[1,0]
v_pk_mul_f32 v[158:159], v[158:159], v[14:15] op_sel_hi:[1,0]
v_mfma_f32_16x16x32_bf16 v[212:215], a[196:199], v[92:95], v[212:215]
v_exp_f32 v59, v59
v_mfma_f32_16x16x32_bf16 v[212:215], a[164:167], v[88:91], v[212:215]
ds_read_b64_tr_b16 a[156:157], v2 offset:8544
v_cvt_pk_bf16_f32 v81, v58, v59
v_mfma_f32_16x16x32_bf16 v[216:219], a[168:171], v[88:91], v[216:219]
ds_read_b64_tr_b16 a[158:159], v2 offset:9056
v_cvt_pk_bf16_f32 v128, v128, v129
v_mfma_f32_16x16x32_bf16 v[216:219], a[200:203], v[92:95], v[216:219]
v_exp_f32 v60, v60
v_mfma_f32_16x16x32_bf16 v[220:223], a[204:207], v[92:95], v[220:223]
ds_read_b64_tr_b16 a[160:161], v2 offset:8576
v_cvt_pk_bf16_f32 v129, v130, v131
v_mfma_f32_16x16x32_bf16 v[220:223], a[172:175], v[88:91], v[220:223]
s_waitcnt lgkmcnt(14)
ds_read_b64_tr_b16 a[162:163], v2 offset:9088
v_mfma_f32_16x16x32_bf16 a[220:223], a[228:231], v[88:91], a[220:223]
s_add_u32 m0, s33, 32
v_exp_f32 v61, v61
v_mfma_f32_16x16x32_bf16 a[220:223], a[228:231], v[92:95], a[220:223]
ds_read_b64_tr_b16 a[164:165], v2 offset:8608
v_cvt_pk_bf16_f32 v82, v60, v61
v_mfma_f32_16x16x32_bf16 v[36:39], v[16:19], a[0:3], v[36:39]
buffer_load_dwordx4 v3, s[12:15], 0 offen offset:1024 nt lds
v_mfma_f32_16x16x32_bf16 v[36:39], v[20:23], a[4:7], v[36:39]
ds_read_b64_tr_b16 a[166:167], v2 offset:9120
v_cvt_pk_bf16_f32 v132, v132, v133
v_mfma_f32_16x16x32_bf16 v[36:39], v[24:27], a[8:11], v[36:39]
ds_read_b64_tr_b16 a[168:169], v2 offset:8640
v_cvt_pk_bf16_f32 v133, v134, v135
v_mfma_f32_16x16x32_bf16 v[36:39], v[28:31], a[12:15], v[36:39]
ds_read_b64_tr_b16 a[170:171], v2 offset:9152
v_cvt_pk_bf16_f32 v136, v136, v137
v_mfma_f32_16x16x32_bf16 v[64:67], a[80:83], a[0:3], v[36:39]
ds_read_b64_tr_b16 a[172:173], v2 offset:8672
v_cvt_pk_bf16_f32 v137, v138, v139
v_mfma_f32_16x16x32_bf16 v[64:67], a[84:87], a[4:7], v[64:67]
v_exp_f32 v62, v62
v_mfma_f32_16x16x32_bf16 v[64:67], a[88:91], a[8:11], v[64:67]
ds_read_b64_tr_b16 a[174:175], v2 offset:9184
v_cvt_pk_bf16_f32 v140, v140, v141
v_mfma_f32_16x16x32_bf16 v[64:67], a[92:95], a[12:15], v[64:67]
ds_read_b64_tr_b16 a[176:177], v2
v_cvt_pk_bf16_f32 v141, v142, v143
v_mfma_f32_16x16x32_bf16 v[68:71], a[108:111], a[12:15], v[36:39]
v_exp_f32 v63, v63
v_mfma_f32_16x16x32_bf16 v[68:71], a[104:107], a[8:11], v[68:71]
ds_read_b64_tr_b16 a[178:179], v2 offset:512
v_cvt_pk_bf16_f32 v83, v62, v63
v_mfma_f32_16x16x32_bf16 v[68:71], a[100:103], a[4:7], v[68:71]
ds_read_b64_tr_b16 a[180:181], v2 offset:32
v_cvt_pk_bf16_f32 v144, v144, v145
v_mfma_f32_16x16x32_bf16 v[68:71], a[96:99], a[0:3], v[68:71]
ds_read_b64_tr_b16 a[182:183], v2 offset:544
v_cvt_pk_bf16_f32 v145, v146, v147
v_mfma_f32_16x16x32_bf16 v[72:75], a[112:115], a[0:3], v[36:39]
s_add_u32 m0, s33, 64
v_exp_f32 v64, v64
v_mfma_f32_16x16x32_bf16 v[72:75], a[116:119], a[4:7], v[72:75]
buffer_load_dwordx4 v3, s[12:15], 0 offen offset:2048 nt lds
v_mfma_f32_16x16x32_bf16 v[72:75], a[120:123], a[8:11], v[72:75]
v_exp_f32 v65, v65
v_mfma_f32_16x16x32_bf16 v[72:75], a[124:127], a[12:15], v[72:75]
ds_read_b64_tr_b16 a[184:185], v2 offset:64
v_cvt_pk_bf16_f32 v88, v64, v65
v_mfma_f32_16x16x32_bf16 v[76:79], a[140:143], a[12:15], v[36:39]
v_exp_f32 v66, v66
v_mfma_f32_16x16x32_bf16 v[76:79], a[136:139], a[8:11], v[76:79]
ds_read_b64_tr_b16 a[186:187], v2 offset:576
v_cvt_pk_bf16_f32 v148, v148, v149
v_mfma_f32_16x16x32_bf16 v[76:79], a[132:135], a[4:7], v[76:79]
s_waitcnt lgkmcnt(14)
v_exp_f32 v67, v67
v_mfma_f32_16x16x32_bf16 v[76:79], a[128:131], a[0:3], v[76:79]
ds_read_b64_tr_b16 a[188:189], v2 offset:96
v_cvt_pk_bf16_f32 v89, v66, v67
v_mfma_f32_16x16x32_bf16 v[224:227], a[144:147], v[80:83], 0
v_exp_f32 v68, v68
v_mfma_f32_16x16x32_bf16 v[228:231], a[148:151], v[80:83], 0
s_waitcnt lgkmcnt(7)
ds_read_b64_tr_b16 a[190:191], v2 offset:608
v_mfma_f32_16x16x32_bf16 v[232:235], a[152:155], v[80:83], 0
s_add_u32 m0, s33, 96
v_exp_f32 v69, v69
v_mfma_f32_16x16x32_bf16 v[236:239], a[156:159], v[80:83], 0
ds_read_b64_tr_b16 a[192:193], v2 offset:128
v_cvt_pk_bf16_f32 v90, v68, v69
v_mfma_f32_16x16x32_bf16 v[240:243], a[160:163], v[80:83], 0
v_exp_f32 v70, v70
v_mfma_f32_16x16x32_bf16 v[244:247], a[164:167], v[80:83], 0
buffer_load_dwordx4 v3, s[12:15], 0 offen offset:3072 nt lds
v_mfma_f32_16x16x32_bf16 v[248:251], a[168:171], v[80:83], 0
v_exp_f32 v71, v71
v_mfma_f32_16x16x32_bf16 v[252:255], a[172:175], v[80:83], 0
ds_read_b64_tr_b16 a[194:195], v2 offset:640
v_cvt_pk_bf16_f32 v91, v70, v71
v_mfma_f32_16x16x32_bf16 a[224:227], a[228:231], v[80:83], 0
s_waitcnt lgkmcnt(14)
v_exp_f32 v72, v72
v_mfma_f32_16x16x32_bf16 v[40:43], v[16:19], a[16:19], v[40:43]
ds_read_b64_tr_b16 a[196:197], v2 offset:160
v_cvt_pk_bf16_f32 v149, v150, v151
v_mfma_f32_16x16x32_bf16 v[40:43], v[20:23], a[20:23], v[40:43]
ds_read_b64_tr_b16 a[198:199], v2 offset:672
v_cvt_pk_bf16_f32 v152, v152, v153
v_mfma_f32_16x16x32_bf16 v[40:43], v[24:27], a[24:27], v[40:43]
ds_write_b64 v7, v[124:125] offset:224
v_mfma_f32_16x16x32_bf16 v[40:43], v[28:31], a[28:31], v[40:43]
ds_write_b64 v7, v[128:129] offset:512
v_mfma_f32_16x16x32_bf16 v[56:59], a[80:83], a[16:19], v[40:43]
ds_write_b64 v7, v[132:133] offset:544
v_mfma_f32_16x16x32_bf16 v[56:59], a[84:87], a[20:23], v[56:59]
v_exp_f32 v73, v73
v_mfma_f32_16x16x32_bf16 v[56:59], a[88:91], a[24:27], v[56:59]
ds_read_b64_tr_b16 a[200:201], v2 offset:192
v_cvt_pk_bf16_f32 v92, v72, v73
v_mfma_f32_16x16x32_bf16 v[56:59], a[92:95], a[28:31], v[56:59]
v_exp_f32 v74, v74
v_mfma_f32_16x16x32_bf16 v[60:63], a[108:111], a[28:31], v[40:43]
ds_write_b64 v7, v[136:137] offset:576
v_mfma_f32_16x16x32_bf16 v[60:63], a[104:107], a[24:27], v[60:63]
v_exp_f32 v75, v75
v_mfma_f32_16x16x32_bf16 v[60:63], a[100:103], a[20:23], v[60:63]
ds_read_b64_tr_b16 a[202:203], v2 offset:704
v_cvt_pk_bf16_f32 v93, v74, v75
v_mfma_f32_16x16x32_bf16 v[60:63], a[96:99], a[16:19], v[60:63]
v_exp_f32 v76, v76
v_mfma_f32_16x16x32_bf16 v[64:67], a[112:115], a[16:19], v[40:43]
ds_write_b64 v7, v[140:141] offset:608
v_mfma_f32_16x16x32_bf16 v[64:67], a[116:119], a[20:23], v[64:67]
v_exp_f32 v77, v77
v_mfma_f32_16x16x32_bf16 v[64:67], a[120:123], a[24:27], v[64:67]
ds_read_b64_tr_b16 a[204:205], v2 offset:224
v_cvt_pk_bf16_f32 v94, v76, v77
v_mfma_f32_16x16x32_bf16 v[64:67], a[124:127], a[28:31], v[64:67]
v_exp_f32 v78, v78
v_mfma_f32_16x16x32_bf16 v[68:71], a[140:143], a[28:31], v[40:43]
ds_write_b64 v7, v[144:145] offset:640
v_mfma_f32_16x16x32_bf16 v[68:71], a[136:139], a[24:27], v[68:71]
v_exp_f32 v79, v79
v_mfma_f32_16x16x32_bf16 v[68:71], a[132:135], a[20:23], v[68:71]
ds_read_b64_tr_b16 a[206:207], v2 offset:736
v_cvt_pk_bf16_f32 v95, v78, v79
v_mfma_f32_16x16x32_bf16 v[68:71], a[128:131], a[16:19], v[68:71]
v_exp_f32 v56, v56
v_mfma_f32_16x16x32_bf16 v[96:99], a[144:147], v[88:91], 0
s_waitcnt lgkmcnt(14)
v_cvt_pk_bf16_f32 v153, v154, v155
v_cvt_pk_bf16_f32 v156, v156, v157
v_mfma_f32_16x16x32_bf16 v[96:99], a[176:179], v[92:95], v[96:99]
v_exp_f32 v57, v57
v_mfma_f32_16x16x32_bf16 v[100:103], a[180:183], v[92:95], 0
v_cvt_pk_bf16_f32 v80, v56, v57
v_cvt_pk_bf16_f32 v157, v158, v159
v_mfma_f32_16x16x32_bf16 v[100:103], a[148:151], v[88:91], v[100:103]
v_exp_f32 v58, v58
v_mfma_f32_16x16x32_bf16 v[104:107], a[152:155], v[88:91], 0
ds_write_b64 v7, v[148:149] offset:672
v_mfma_f32_16x16x32_bf16 v[104:107], a[184:187], v[92:95], v[104:107]
v_exp_f32 v59, v59
v_mfma_f32_16x16x32_bf16 v[108:111], a[188:191], v[92:95], 0
v_cvt_pk_bf16_f32 v81, v58, v59
v_accvgpr_read_b32 v10, a216
v_mfma_f32_16x16x32_bf16 v[108:111], a[156:159], v[88:91], v[108:111]
s_waitcnt lgkmcnt(1)
v_exp_f32 v60, v60
v_mfma_f32_16x16x32_bf16 v[112:115], a[160:163], v[88:91], 0
s_waitcnt lgkmcnt(1)
v_rcp_f32 v14, v10
v_mfma_f32_16x16x32_bf16 v[112:115], a[192:195], v[92:95], v[112:115]
s_barrier
v_exp_f32 v61, v61
v_mfma_f32_16x16x32_bf16 v[116:119], a[196:199], v[92:95], 0
s_add_u32 s16, s16, 16384
s_addc_u32 s17, s17, 0
v_cvt_pk_bf16_f32 v82, v60, v61
v_mfma_f32_16x16x32_bf16 v[116:119], a[164:167], v[88:91], v[116:119]
v_exp_f32 v62, v62
v_mfma_f32_16x16x32_bf16 v[120:123], a[168:171], v[88:91], 0
ds_write_b64 v7, v[152:153] offset:704
v_mfma_f32_16x16x32_bf16 v[120:123], a[200:203], v[92:95], v[120:123]
s_add_u32 m0, s33, 33792
v_exp_f32 v63, v63
v_mfma_f32_16x16x32_bf16 v[124:127], a[204:207], v[92:95], 0
v_cvt_pk_bf16_f32 v83, v62, v63
v_add_f32 v5, v5, v10
v_mfma_f32_16x16x32_bf16 v[124:127], a[172:175], v[88:91], v[124:127]
v_exp_f32 v64, v64
v_mfma_f32_16x16x32_bf16 a[208:211], a[228:231], v[88:91], 0
buffer_load_dwordx4 v3, s[16:19], 0 offen nt lds
ds_write_b64 v7, v[156:157] offset:736
v_add_f32 v5, v5, v14
v_pk_mul_f32 v[160:161], v[160:161], v[14:15] op_sel_hi:[1,0]
v_pk_mul_f32 v[162:163], v[162:163], v[14:15] op_sel_hi:[1,0]
v_pk_mul_f32 v[164:165], v[164:165], v[14:15] op_sel_hi:[1,0]
v_pk_mul_f32 v[166:167], v[166:167], v[14:15] op_sel_hi:[1,0]
v_pk_mul_f32 v[168:169], v[168:169], v[14:15] op_sel_hi:[1,0]
v_pk_mul_f32 v[170:171], v[170:171], v[14:15] op_sel_hi:[1,0]
v_pk_mul_f32 v[172:173], v[172:173], v[14:15] op_sel_hi:[1,0]
v_pk_mul_f32 v[174:175], v[174:175], v[14:15] op_sel_hi:[1,0]
v_pk_mul_f32 v[176:177], v[176:177], v[14:15] op_sel_hi:[1,0]
v_pk_mul_f32 v[178:179], v[178:179], v[14:15] op_sel_hi:[1,0]
v_pk_mul_f32 v[180:181], v[180:181], v[14:15] op_sel_hi:[1,0]
v_pk_mul_f32 v[182:183], v[182:183], v[14:15] op_sel_hi:[1,0]
v_pk_mul_f32 v[184:185], v[184:185], v[14:15] op_sel_hi:[1,0]
v_pk_mul_f32 v[186:187], v[186:187], v[14:15] op_sel_hi:[1,0]
v_pk_mul_f32 v[188:189], v[188:189], v[14:15] op_sel_hi:[1,0]
v_pk_mul_f32 v[190:191], v[190:191], v[14:15] op_sel_hi:[1,0]
v_mfma_f32_16x16x32_bf16 a[208:211], a[228:231], v[92:95], a[208:211]
s_waitcnt lgkmcnt(14)
v_exp_f32 v65, v65
v_mfma_f32_16x16x32_bf16 v[44:47], v[16:19], a[32:35], v[44:47]
v_cvt_pk_bf16_f32 v160, v160, v161
v_cvt_pk_bf16_f32 v161, v162, v163
v_mfma_f32_16x16x32_bf16 v[44:47], v[20:23], a[36:39], v[44:47]
v_cvt_pk_bf16_f32 v164, v164, v165
v_cvt_pk_bf16_f32 v165, v166, v167
v_mfma_f32_16x16x32_bf16 v[44:47], v[24:27], a[40:43], v[44:47]
v_cvt_pk_bf16_f32 v168, v168, v169
v_cvt_pk_bf16_f32 v169, v170, v171
v_mfma_f32_16x16x32_bf16 v[44:47], v[28:31], a[44:47], v[44:47]
v_cvt_pk_bf16_f32 v172, v172, v173
v_cvt_pk_bf16_f32 v173, v174, v175
v_mfma_f32_16x16x32_bf16 v[72:75], a[80:83], a[32:35], v[44:47]
v_cvt_pk_bf16_f32 v84, v64, v65
v_cvt_pk_bf16_f32 v176, v176, v177
v_mfma_f32_16x16x32_bf16 v[72:75], a[84:87], a[36:39], v[72:75]
s_add_u32 m0, s33, 33824
v_exp_f32 v66, v66
v_mfma_f32_16x16x32_bf16 v[72:75], a[88:91], a[40:43], v[72:75]
buffer_load_dwordx4 v3, s[16:19], 0 offen offset:1024 nt lds
ds_write_b64 v7, v[160:161] offset:8448
v_mfma_f32_16x16x32_bf16 v[72:75], a[92:95], a[44:47], v[72:75]
ds_write_b64 v7, v[164:165] offset:8480
v_exp_f32 v67, v67
v_mfma_f32_16x16x32_bf16 v[76:79], a[108:111], a[44:47], v[44:47]
v_cvt_pk_bf16_f32 v85, v66, v67
v_cvt_pk_bf16_f32 v177, v178, v179
v_mfma_f32_16x16x32_bf16 v[76:79], a[104:107], a[40:43], v[76:79]
s_add_u32 m0, s33, 33856
v_exp_f32 v68, v68
v_mfma_f32_16x16x32_bf16 v[76:79], a[100:103], a[36:39], v[76:79]
buffer_load_dwordx4 v3, s[16:19], 0 offen offset:2048 nt lds
v_mfma_f32_16x16x32_bf16 v[76:79], a[96:99], a[32:35], v[76:79]
v_exp_f32 v69, v69
v_mfma_f32_16x16x32_bf16 v[56:59], a[112:115], a[32:35], v[44:47]
v_cvt_pk_bf16_f32 v86, v68, v69
v_cvt_pk_bf16_f32 v180, v180, v181
v_mfma_f32_16x16x32_bf16 v[56:59], a[116:119], a[36:39], v[56:59]
v_exp_f32 v70, v70
v_mfma_f32_16x16x32_bf16 v[56:59], a[120:123], a[40:43], v[56:59]
v_cvt_pk_bf16_f32 v181, v182, v183
v_cvt_pk_bf16_f32 v184, v184, v185
v_mfma_f32_16x16x32_bf16 v[56:59], a[124:127], a[44:47], v[56:59]
s_add_u32 m0, s33, 33888
v_exp_f32 v71, v71
v_mfma_f32_16x16x32_bf16 v[60:63], a[140:143], a[44:47], v[44:47]
v_exp_f32 v72, v72
v_mfma_f32_16x16x32_bf16 v[60:63], a[136:139], a[40:43], v[60:63]
v_cvt_pk_bf16_f32 v87, v70, v71
v_cvt_pk_bf16_f32 v185, v186, v187
v_mfma_f32_16x16x32_bf16 v[60:63], a[132:135], a[36:39], v[60:63]
v_exp_f32 v73, v73
v_mfma_f32_16x16x32_bf16 v[60:63], a[128:131], a[32:35], v[60:63]
v_cvt_pk_bf16_f32 v88, v72, v73
v_cvt_pk_bf16_f32 v188, v188, v189
v_mfma_f32_16x16x32_bf16 v[128:131], a[144:147], v[80:83], 0
v_exp_f32 v74, v74
v_mfma_f32_16x16x32_bf16 v[128:131], a[176:179], v[84:87], v[128:131]
buffer_load_dwordx4 v3, s[16:19], 0 offen offset:3072 nt lds
v_mfma_f32_16x16x32_bf16 v[132:135], a[180:183], v[84:87], 0
v_exp_f32 v75, v75
v_mfma_f32_16x16x32_bf16 v[132:135], a[148:151], v[80:83], v[132:135]
v_cvt_pk_bf16_f32 v89, v74, v75
v_cvt_pk_bf16_f32 v189, v190, v191
v_mfma_f32_16x16x32_bf16 v[136:139], a[152:155], v[80:83], 0
v_exp_f32 v76, v76
v_mfma_f32_16x16x32_bf16 v[136:139], a[184:187], v[84:87], v[136:139]
ds_write_b64 v7, v[168:169] offset:8512
v_mfma_f32_16x16x32_bf16 v[140:143], a[188:191], v[84:87], 0
v_exp_f32 v77, v77
v_mfma_f32_16x16x32_bf16 v[140:143], a[156:159], v[80:83], v[140:143]
v_cvt_pk_bf16_f32 v90, v76, v77
v_accvgpr_read_b32 v10, a220
v_mfma_f32_16x16x32_bf16 v[144:147], a[160:163], v[80:83], 0
v_exp_f32 v78, v78
v_mfma_f32_16x16x32_bf16 v[144:147], a[192:195], v[84:87], v[144:147]
ds_write_b64 v7, v[172:173] offset:8544
v_mfma_f32_16x16x32_bf16 v[148:151], a[196:199], v[84:87], 0
v_exp_f32 v79, v79
v_mfma_f32_16x16x32_bf16 v[148:151], a[164:167], v[80:83], v[148:151]
v_cvt_pk_bf16_f32 v91, v78, v79
v_rcp_f32 v14, v10
v_add_f32 v5, v5, v10
v_add_f32 v5, v5, v14
v_pk_mul_f32 v[192:193], v[192:193], v[14:15] op_sel_hi:[1,0]
v_pk_mul_f32 v[194:195], v[194:195], v[14:15] op_sel_hi:[1,0]
v_pk_mul_f32 v[196:197], v[196:197], v[14:15] op_sel_hi:[1,0]
v_pk_mul_f32 v[198:199], v[198:199], v[14:15] op_sel_hi:[1,0]
v_pk_mul_f32 v[200:201], v[200:201], v[14:15] op_sel_hi:[1,0]
v_pk_mul_f32 v[202:203], v[202:203], v[14:15] op_sel_hi:[1,0]
v_pk_mul_f32 v[204:205], v[204:205], v[14:15] op_sel_hi:[1,0]
v_pk_mul_f32 v[206:207], v[206:207], v[14:15] op_sel_hi:[1,0]
v_pk_mul_f32 v[208:209], v[208:209], v[14:15] op_sel_hi:[1,0]
v_pk_mul_f32 v[210:211], v[210:211], v[14:15] op_sel_hi:[1,0]
v_pk_mul_f32 v[212:213], v[212:213], v[14:15] op_sel_hi:[1,0]
v_pk_mul_f32 v[214:215], v[214:215], v[14:15] op_sel_hi:[1,0]
v_pk_mul_f32 v[216:217], v[216:217], v[14:15] op_sel_hi:[1,0]
v_pk_mul_f32 v[218:219], v[218:219], v[14:15] op_sel_hi:[1,0]
v_pk_mul_f32 v[220:221], v[220:221], v[14:15] op_sel_hi:[1,0]
v_pk_mul_f32 v[222:223], v[222:223], v[14:15] op_sel_hi:[1,0]
v_mfma_f32_16x16x32_bf16 v[152:155], a[168:171], v[80:83], 0
v_exp_f32 v56, v56
v_mfma_f32_16x16x32_bf16 v[152:155], a[200:203], v[84:87], v[152:155]
ds_write_b64 v7, v[176:177] offset:8576
v_mfma_f32_16x16x32_bf16 v[156:159], a[204:207], v[84:87], 0
s_waitcnt vmcnt(14) lgkmcnt(8)
v_exp_f32 v57, v57
v_mfma_f32_16x16x32_bf16 v[156:159], a[172:175], v[80:83], v[156:159]
v_cvt_pk_bf16_f32 v92, v56, v57
v_cvt_pk_bf16_f32 v192, v192, v193
v_mfma_f32_16x16x32_bf16 a[212:215], a[228:231], v[80:83], 0
s_barrier
v_exp_f32 v58, v58
v_mfma_f32_16x16x32_bf16 a[212:215], a[228:231], v[84:87], a[212:215]
s_waitcnt lgkmcnt(14)
v_cvt_pk_bf16_f32 v193, v194, v195
v_cvt_pk_bf16_f32 v196, v196, v197
v_mfma_f32_16x16x32_bf16 v[48:51], v[16:19], a[48:51], v[48:51]
ds_write_b64 v7, v[180:181] offset:8608
v_mfma_f32_16x16x32_bf16 v[48:51], v[20:23], a[52:55], v[48:51]
ds_write_b64 v7, v[184:185] offset:8640
v_mfma_f32_16x16x32_bf16 v[48:51], v[24:27], a[56:59], v[48:51]
ds_write_b64 v7, v[188:189] offset:8672
v_mfma_f32_16x16x32_bf16 v[48:51], v[28:31], a[60:63], v[48:51]
ds_write_b64 v7, v[192:193] offset:8960
v_mfma_f32_16x16x32_bf16 v[64:67], a[80:83], a[48:51], v[48:51]
v_exp_f32 v59, v59
v_mfma_f32_16x16x32_bf16 v[64:67], a[84:87], a[52:55], v[64:67]
ds_read_b128 a[80:83], v1 offset:25344
v_cvt_pk_bf16_f32 v93, v58, v59
v_mfma_f32_16x16x32_bf16 v[64:67], a[88:91], a[56:59], v[64:67]
v_exp_f32 v60, v60
v_mfma_f32_16x16x32_bf16 v[64:67], a[92:95], a[60:63], v[64:67]
ds_read_b128 a[84:87], v1 offset:25408
ds_read_b128 a[88:91], v1 offset:25472
v_mfma_f32_16x16x32_bf16 v[68:71], a[108:111], a[60:63], v[48:51]
v_exp_f32 v61, v61
v_mfma_f32_16x16x32_bf16 v[68:71], a[104:107], a[56:59], v[68:71]
ds_read_b128 a[92:95], v1 offset:25536
v_cvt_pk_bf16_f32 v94, v60, v61
v_mfma_f32_16x16x32_bf16 v[68:71], a[100:103], a[52:55], v[68:71]
v_exp_f32 v62, v62
v_mfma_f32_16x16x32_bf16 v[68:71], a[96:99], a[48:51], v[68:71]
ds_read_b128 a[108:111], v1 offset:26048
v_cvt_pk_bf16_f32 v197, v198, v199
v_mfma_f32_16x16x32_bf16 v[72:75], a[112:115], a[48:51], v[48:51]
v_exp_f32 v63, v63
v_mfma_f32_16x16x32_bf16 v[72:75], a[116:119], a[52:55], v[72:75]
v_exp_f32 v64, v64
v_mfma_f32_16x16x32_bf16 v[72:75], a[120:123], a[56:59], v[72:75]
ds_read_b128 a[104:107], v1 offset:25984
v_cvt_pk_bf16_f32 v95, v62, v63
v_mfma_f32_16x16x32_bf16 v[72:75], a[124:127], a[60:63], v[72:75]
ds_write_b64 v7, v[196:197] offset:8992
v_exp_f32 v65, v65
v_mfma_f32_16x16x32_bf16 v[76:79], a[140:143], a[60:63], v[48:51]
ds_read_b128 a[100:103], v1 offset:25920
v_cvt_pk_bf16_f32 v80, v64, v65
v_mfma_f32_16x16x32_bf16 v[76:79], a[136:139], a[56:59], v[76:79]
v_exp_f32 v66, v66
v_mfma_f32_16x16x32_bf16 v[76:79], a[132:135], a[52:55], v[76:79]
ds_read_b128 a[96:99], v1 offset:25856
v_cvt_pk_bf16_f32 v200, v200, v201
v_mfma_f32_16x16x32_bf16 v[76:79], a[128:131], a[48:51], v[76:79]
v_exp_f32 v67, v67
v_mfma_f32_16x16x32_bf16 v[160:163], a[144:147], v[88:91], 0
ds_read_b128 a[112:115], v1 offset:16896
v_cvt_pk_bf16_f32 v81, v66, v67
v_mfma_f32_16x16x32_bf16 v[160:163], a[176:179], v[92:95], v[160:163]
v_exp_f32 v68, v68
v_mfma_f32_16x16x32_bf16 v[164:167], a[180:183], v[92:95], 0
ds_read_b128 a[116:119], v1 offset:16960
v_cvt_pk_bf16_f32 v201, v202, v203
v_mfma_f32_16x16x32_bf16 v[164:167], a[148:151], v[88:91], v[164:167]
ds_write_b64 v7, v[200:201] offset:9024
v_exp_f32 v69, v69
v_mfma_f32_16x16x32_bf16 v[168:171], a[152:155], v[88:91], 0
ds_read_b128 a[120:123], v1 offset:17024
v_cvt_pk_bf16_f32 v82, v68, v69
v_mfma_f32_16x16x32_bf16 v[168:171], a[184:187], v[92:95], v[168:171]
v_exp_f32 v70, v70
v_mfma_f32_16x16x32_bf16 v[172:175], a[188:191], v[92:95], 0
ds_read_b128 a[124:127], v1 offset:17088
v_cvt_pk_bf16_f32 v204, v204, v205
v_mfma_f32_16x16x32_bf16 v[172:175], a[156:159], v[88:91], v[172:175]
v_exp_f32 v71, v71
v_mfma_f32_16x16x32_bf16 v[176:179], a[160:163], v[88:91], 0
ds_read_b128 a[140:143], v1 offset:17600
v_cvt_pk_bf16_f32 v83, v70, v71
v_mfma_f32_16x16x32_bf16 v[176:179], a[192:195], v[92:95], v[176:179]
v_exp_f32 v72, v72
v_mfma_f32_16x16x32_bf16 v[180:183], a[196:199], v[92:95], 0
ds_read_b128 a[136:139], v1 offset:17536
v_cvt_pk_bf16_f32 v205, v206, v207
v_mfma_f32_16x16x32_bf16 v[180:183], a[164:167], v[88:91], v[180:183]
ds_write_b64 v7, v[204:205] offset:9056
v_exp_f32 v73, v73
v_mfma_f32_16x16x32_bf16 v[184:187], a[168:171], v[88:91], 0
ds_read_b128 a[132:135], v1 offset:17472
ds_read_b128 v[16:19], v4
v_cvt_pk_bf16_f32 v84, v72, v73
v_mfma_f32_16x16x32_bf16 v[184:187], a[200:203], v[92:95], v[184:187]
v_exp_f32 v74, v74
v_mfma_f32_16x16x32_bf16 v[188:191], a[204:207], v[92:95], 0
ds_read_b128 a[128:131], v1 offset:17408
v_cvt_pk_bf16_f32 v208, v208, v209
v_mfma_f32_16x16x32_bf16 v[188:191], a[172:175], v[88:91], v[188:191]
v_exp_f32 v75, v75
v_mfma_f32_16x16x32_bf16 a[216:219], a[228:231], v[88:91], 0
s_waitcnt lgkmcnt(11)
v_cvt_pk_bf16_f32 v85, v74, v75
v_cvt_pk_bf16_f32 v209, v210, v211
v_mfma_f32_16x16x32_bf16 a[216:219], a[228:231], v[92:95], a[216:219]
v_exp_f32 v76, v76
v_mfma_f32_16x16x32_bf16 v[56:59], a[80:83], a[64:67], v[52:55]
ds_write_b64 v7, v[208:209] offset:9088
v_mfma_f32_16x16x32_bf16 v[56:59], a[84:87], a[68:71], v[56:59]
v_exp_f32 v77, v77
v_mfma_f32_16x16x32_bf16 v[56:59], a[88:91], a[72:75], v[56:59]
v_cvt_pk_bf16_f32 v86, v76, v77
v_cvt_pk_bf16_f32 v212, v212, v213
v_mfma_f32_16x16x32_bf16 v[56:59], a[92:95], a[76:79], v[56:59]
s_waitcnt lgkmcnt(2)
v_exp_f32 v78, v78
v_mfma_f32_16x16x32_bf16 v[60:63], a[108:111], a[76:79], v[52:55]
buffer_store_dwordx4 v[16:19], v3, s[28:31], s36 offen sc0 sc1
v_cvt_pk_bf16_f32 v213, v214, v215
v_cvt_pk_bf16_f32 v216, v216, v217
v_cvt_pk_bf16_f32 v217, v218, v219
v_mfma_f32_16x16x32_bf16 v[60:63], a[104:107], a[72:75], v[60:63]
s_waitcnt vmcnt(11) lgkmcnt(1)
v_exp_f32 v79, v79
v_mfma_f32_16x16x32_bf16 v[60:63], a[100:103], a[68:71], v[60:63]
v_cvt_pk_bf16_f32 v87, v78, v79
v_cvt_pk_bf16_f32 v220, v220, v221
v_mfma_f32_16x16x32_bf16 v[60:63], a[96:99], a[64:67], v[60:63]
s_barrier
s_add_u32 s12, s12, 16384
s_addc_u32 s13, s13, 0
v_mfma_f32_16x16x32_bf16 v[192:195], a[144:147], v[80:83], 0
ds_read_b64_tr_b16 a[144:145], v2 offset:25344
ds_read_b64_tr_b16 a[146:147], v2 offset:25856
v_mfma_f32_16x16x32_bf16 v[192:195], a[176:179], v[84:87], v[192:195]
ds_write_b64 v7, v[212:213] offset:9120
v_exp_f32 v56, v56
v_mfma_f32_16x16x32_bf16 v[196:199], a[180:183], v[84:87], 0
ds_write_b64 v7, v[216:217] offset:9152
v_mfma_f32_16x16x32_bf16 v[196:199], a[148:151], v[80:83], v[196:199]
ds_read_b64_tr_b16 a[148:149], v2 offset:25376
ds_read_b64_tr_b16 a[150:151], v2 offset:25888
v_mfma_f32_16x16x32_bf16 v[200:203], a[152:155], v[80:83], 0
v_exp_f32 v57, v57
v_mfma_f32_16x16x32_bf16 v[200:203], a[184:187], v[84:87], v[200:203]
ds_read_b64_tr_b16 a[152:153], v2 offset:25408
v_cvt_pk_bf16_f32 v88, v56, v57
v_mfma_f32_16x16x32_bf16 v[204:207], a[188:191], v[84:87], 0
ds_read_b64_tr_b16 a[154:155], v2 offset:25920
v_cvt_pk_bf16_f32 v221, v222, v223
v_mfma_f32_16x16x32_bf16 v[204:207], a[156:159], v[80:83], v[204:207]
s_add_u32 m0, s33, 16896
v_exp_f32 v58, v58
v_mfma_f32_16x16x32_bf16 v[208:211], a[160:163], v[80:83], 0
buffer_load_dwordx4 v3, s[12:15], 0 offen nt lds
v_mfma_f32_16x16x32_bf16 v[208:211], a[192:195], v[84:87], v[208:211]
ds_read_b64_tr_b16 a[156:157], v2 offset:25440
ds_read_b64_tr_b16 a[158:159], v2 offset:25952
v_mfma_f32_16x16x32_bf16 v[212:215], a[196:199], v[84:87], 0
v_exp_f32 v59, v59
v_mfma_f32_16x16x32_bf16 v[212:215], a[164:167], v[80:83], v[212:215]
ds_read_b64_tr_b16 a[160:161], v2 offset:25472
v_cvt_pk_bf16_f32 v89, v58, v59
v_mfma_f32_16x16x32_bf16 v[216:219], a[168:171], v[80:83], 0
ds_read_b64_tr_b16 a[162:163], v2 offset:25984
ds_write_b64 v7, v[220:221] offset:9184
v_mfma_f32_16x16x32_bf16 v[216:219], a[200:203], v[84:87], v[216:219]
v_exp_f32 v60, v60
v_mfma_f32_16x16x32_bf16 v[220:223], a[204:207], v[84:87], 0
ds_read_b64_tr_b16 a[164:165], v2 offset:25504
v_mfma_f32_16x16x32_bf16 v[220:223], a[172:175], v[80:83], v[220:223]
ds_read_b64_tr_b16 a[166:167], v2 offset:26016
v_mfma_f32_16x16x32_bf16 a[220:223], a[228:231], v[80:83], 0
s_add_u32 m0, s33, 16928
v_exp_f32 v61, v61
v_mfma_f32_16x16x32_bf16 a[220:223], a[228:231], v[84:87], a[220:223]
ds_read_b64_tr_b16 a[168:169], v2 offset:25536
v_cvt_pk_bf16_f32 v90, v60, v61
v_mfma_f32_16x16x32_bf16 v[64:67], a[80:83], a[0:3], v[36:39]
buffer_load_dwordx4 v3, s[12:15], 0 offen offset:1024 nt lds
v_mfma_f32_16x16x32_bf16 v[64:67], a[84:87], a[4:7], v[64:67]
v_exp_f32 v62, v62
v_mfma_f32_16x16x32_bf16 v[64:67], a[88:91], a[8:11], v[64:67]
ds_read_b64_tr_b16 a[170:171], v2 offset:26048
v_mfma_f32_16x16x32_bf16 v[64:67], a[92:95], a[12:15], v[64:67]
ds_read_b64_tr_b16 a[172:173], v2 offset:25568
v_mfma_f32_16x16x32_bf16 v[68:71], a[108:111], a[12:15], v[36:39]
v_exp_f32 v63, v63
v_mfma_f32_16x16x32_bf16 v[68:71], a[104:107], a[8:11], v[68:71]
ds_read_b64_tr_b16 a[174:175], v2 offset:26080
v_cvt_pk_bf16_f32 v91, v62, v63
v_mfma_f32_16x16x32_bf16 v[68:71], a[100:103], a[4:7], v[68:71]
ds_read_b64_tr_b16 a[176:177], v2 offset:16896
v_mfma_f32_16x16x32_bf16 v[68:71], a[96:99], a[0:3], v[68:71]
ds_read_b64_tr_b16 a[178:179], v2 offset:17408
v_mfma_f32_16x16x32_bf16 v[72:75], a[112:115], a[0:3], v[36:39]
s_add_u32 m0, s33, 16960
v_exp_f32 v64, v64
v_mfma_f32_16x16x32_bf16 v[72:75], a[116:119], a[4:7], v[72:75]
buffer_load_dwordx4 v3, s[12:15], 0 offen offset:2048 nt lds
v_mfma_f32_16x16x32_bf16 v[72:75], a[120:123], a[8:11], v[72:75]
v_exp_f32 v65, v65
v_mfma_f32_16x16x32_bf16 v[72:75], a[124:127], a[12:15], v[72:75]
ds_read_b64_tr_b16 a[180:181], v2 offset:16928
v_cvt_pk_bf16_f32 v80, v64, v65
v_mfma_f32_16x16x32_bf16 v[76:79], a[140:143], a[12:15], v[36:39]
v_exp_f32 v66, v66
v_mfma_f32_16x16x32_bf16 v[76:79], a[136:139], a[8:11], v[76:79]
ds_read_b64_tr_b16 a[182:183], v2 offset:17440
v_mfma_f32_16x16x32_bf16 v[76:79], a[132:135], a[4:7], v[76:79]
s_waitcnt lgkmcnt(13)
v_exp_f32 v67, v67
v_mfma_f32_16x16x32_bf16 v[76:79], a[128:131], a[0:3], v[76:79]
ds_read_b64_tr_b16 a[184:185], v2 offset:16960
v_cvt_pk_bf16_f32 v81, v66, v67
v_mfma_f32_16x16x32_bf16 v[224:227], a[144:147], v[88:91], v[224:227]
v_exp_f32 v68, v68
v_mfma_f32_16x16x32_bf16 v[228:231], a[148:151], v[88:91], v[228:231]
s_waitcnt lgkmcnt(5)
ds_read_b64_tr_b16 a[186:187], v2 offset:17472
v_mfma_f32_16x16x32_bf16 v[232:235], a[152:155], v[88:91], v[232:235]
s_add_u32 m0, s33, 16992
v_exp_f32 v69, v69
v_mfma_f32_16x16x32_bf16 v[236:239], a[156:159], v[88:91], v[236:239]
ds_read_b64_tr_b16 a[188:189], v2 offset:16992
v_cvt_pk_bf16_f32 v82, v68, v69
v_mfma_f32_16x16x32_bf16 v[240:243], a[160:163], v[88:91], v[240:243]
v_exp_f32 v70, v70
v_mfma_f32_16x16x32_bf16 v[244:247], a[164:167], v[88:91], v[244:247]
buffer_load_dwordx4 v3, s[12:15], 0 offen offset:3072 nt lds
v_mfma_f32_16x16x32_bf16 v[248:251], a[168:171], v[88:91], v[248:251]
v_exp_f32 v71, v71
v_mfma_f32_16x16x32_bf16 v[252:255], a[172:175], v[88:91], v[252:255]
ds_read_b64_tr_b16 a[190:191], v2 offset:17504
v_cvt_pk_bf16_f32 v83, v70, v71
v_mfma_f32_16x16x32_bf16 a[224:227], a[228:231], v[88:91], a[224:227]
v_exp_f32 v72, v72
v_mfma_f32_16x16x32_bf16 v[56:59], a[80:83], a[16:19], v[40:43]
ds_read_b64_tr_b16 a[192:193], v2 offset:17024
v_mfma_f32_16x16x32_bf16 v[56:59], a[84:87], a[20:23], v[56:59]
v_exp_f32 v73, v73
v_mfma_f32_16x16x32_bf16 v[56:59], a[88:91], a[24:27], v[56:59]
ds_read_b64_tr_b16 a[194:195], v2 offset:17536
v_cvt_pk_bf16_f32 v84, v72, v73
v_mfma_f32_16x16x32_bf16 v[56:59], a[92:95], a[28:31], v[56:59]
v_exp_f32 v74, v74
v_mfma_f32_16x16x32_bf16 v[60:63], a[108:111], a[28:31], v[40:43]
ds_read_b64_tr_b16 a[196:197], v2 offset:17056
v_mfma_f32_16x16x32_bf16 v[60:63], a[104:107], a[24:27], v[60:63]
v_exp_f32 v75, v75
v_mfma_f32_16x16x32_bf16 v[60:63], a[100:103], a[20:23], v[60:63]
ds_read_b64_tr_b16 a[198:199], v2 offset:17568
v_cvt_pk_bf16_f32 v85, v74, v75
v_mfma_f32_16x16x32_bf16 v[60:63], a[96:99], a[16:19], v[60:63]
v_exp_f32 v76, v76
v_mfma_f32_16x16x32_bf16 v[64:67], a[112:115], a[16:19], v[40:43]
ds_read_b64_tr_b16 a[200:201], v2 offset:17088
v_mfma_f32_16x16x32_bf16 v[64:67], a[116:119], a[20:23], v[64:67]
v_exp_f32 v77, v77
v_mfma_f32_16x16x32_bf16 v[64:67], a[120:123], a[24:27], v[64:67]
ds_read_b64_tr_b16 a[202:203], v2 offset:17600
v_cvt_pk_bf16_f32 v86, v76, v77
v_mfma_f32_16x16x32_bf16 v[64:67], a[124:127], a[28:31], v[64:67]
v_exp_f32 v78, v78
v_mfma_f32_16x16x32_bf16 v[68:71], a[140:143], a[28:31], v[40:43]
ds_read_b64_tr_b16 a[204:205], v2 offset:17120
v_mfma_f32_16x16x32_bf16 v[68:71], a[136:139], a[24:27], v[68:71]
v_exp_f32 v79, v79
v_mfma_f32_16x16x32_bf16 v[68:71], a[132:135], a[20:23], v[68:71]
ds_read_b64_tr_b16 a[206:207], v2 offset:17632
v_cvt_pk_bf16_f32 v87, v78, v79
v_mfma_f32_16x16x32_bf16 v[68:71], a[128:131], a[16:19], v[68:71]
v_exp_f32 v56, v56
v_mfma_f32_16x16x32_bf16 v[96:99], a[144:147], v[80:83], v[96:99]
s_waitcnt lgkmcnt(8)
v_mfma_f32_16x16x32_bf16 v[96:99], a[176:179], v[84:87], v[96:99]
v_exp_f32 v57, v57
v_mfma_f32_16x16x32_bf16 v[100:103], a[180:183], v[84:87], v[100:103]
v_cvt_pk_bf16_f32 v88, v56, v57
v_mfma_f32_16x16x32_bf16 v[100:103], a[148:151], v[80:83], v[100:103]
v_exp_f32 v58, v58
v_mfma_f32_16x16x32_bf16 v[104:107], a[152:155], v[80:83], v[104:107]
v_mfma_f32_16x16x32_bf16 v[104:107], a[184:187], v[84:87], v[104:107]
v_exp_f32 v59, v59
v_mfma_f32_16x16x32_bf16 v[108:111], a[188:191], v[84:87], v[108:111]
v_cvt_pk_bf16_f32 v89, v58, v59
v_mfma_f32_16x16x32_bf16 v[108:111], a[156:159], v[80:83], v[108:111]
s_waitcnt lgkmcnt(0)
v_exp_f32 v60, v60
v_mfma_f32_16x16x32_bf16 v[112:115], a[160:163], v[80:83], v[112:115]
s_waitcnt lgkmcnt(0)
v_mfma_f32_16x16x32_bf16 v[112:115], a[192:195], v[84:87], v[112:115]
s_barrier
v_exp_f32 v61, v61
v_mfma_f32_16x16x32_bf16 v[116:119], a[196:199], v[84:87], v[116:119]
s_add_u32 s16, s16, 16384
s_addc_u32 s17, s17, 0
v_cvt_pk_bf16_f32 v90, v60, v61
v_mfma_f32_16x16x32_bf16 v[116:119], a[164:167], v[80:83], v[116:119]
v_exp_f32 v62, v62
v_mfma_f32_16x16x32_bf16 v[120:123], a[168:171], v[80:83], v[120:123]
v_mfma_f32_16x16x32_bf16 v[120:123], a[200:203], v[84:87], v[120:123]
s_add_u32 m0, s33, 50688
v_exp_f32 v63, v63
v_mfma_f32_16x16x32_bf16 v[124:127], a[204:207], v[84:87], v[124:127]
v_cvt_pk_bf16_f32 v91, v62, v63
v_mfma_f32_16x16x32_bf16 v[124:127], a[172:175], v[80:83], v[124:127]
v_exp_f32 v64, v64
v_mfma_f32_16x16x32_bf16 a[208:211], a[228:231], v[80:83], a[208:211]
buffer_load_dwordx4 v3, s[16:19], 0 offen nt lds
v_mfma_f32_16x16x32_bf16 a[208:211], a[228:231], v[84:87], a[208:211]
v_exp_f32 v65, v65
v_mfma_f32_16x16x32_bf16 v[72:75], a[80:83], a[32:35], v[44:47]
ds_read_b128 v[20:23], v4 offset:1056
v_cvt_pk_bf16_f32 v92, v64, v65
v_mfma_f32_16x16x32_bf16 v[72:75], a[84:87], a[36:39], v[72:75]
s_add_u32 m0, s33, 50720
v_exp_f32 v66, v66
v_mfma_f32_16x16x32_bf16 v[72:75], a[88:91], a[40:43], v[72:75]
buffer_load_dwordx4 v3, s[16:19], 0 offen offset:1024 nt lds
v_mfma_f32_16x16x32_bf16 v[72:75], a[92:95], a[44:47], v[72:75]
v_exp_f32 v67, v67
v_mfma_f32_16x16x32_bf16 v[76:79], a[108:111], a[44:47], v[44:47]
v_cvt_pk_bf16_f32 v93, v66, v67
v_add_u32 v4, 2112, v4
v_mfma_f32_16x16x32_bf16 v[76:79], a[104:107], a[40:43], v[76:79]
s_add_u32 m0, s33, 50752
v_exp_f32 v68, v68
v_mfma_f32_16x16x32_bf16 v[76:79], a[100:103], a[36:39], v[76:79]
buffer_load_dwordx4 v3, s[16:19], 0 offen offset:2048 nt lds
v_mfma_f32_16x16x32_bf16 v[76:79], a[96:99], a[32:35], v[76:79]
v_exp_f32 v69, v69
v_mfma_f32_16x16x32_bf16 v[56:59], a[112:115], a[32:35], v[44:47]
v_cvt_pk_bf16_f32 v94, v68, v69
v_mfma_f32_16x16x32_bf16 v[56:59], a[116:119], a[36:39], v[56:59]
v_exp_f32 v70, v70
v_mfma_f32_16x16x32_bf16 v[56:59], a[120:123], a[40:43], v[56:59]
v_mfma_f32_16x16x32_bf16 v[56:59], a[124:127], a[44:47], v[56:59]
s_add_u32 m0, s33, 50784
v_exp_f32 v71, v71
v_mfma_f32_16x16x32_bf16 v[60:63], a[140:143], a[44:47], v[44:47]
v_exp_f32 v72, v72
v_mfma_f32_16x16x32_bf16 v[60:63], a[136:139], a[40:43], v[60:63]
v_cvt_pk_bf16_f32 v95, v70, v71
v_mfma_f32_16x16x32_bf16 v[60:63], a[132:135], a[36:39], v[60:63]
v_exp_f32 v73, v73
v_mfma_f32_16x16x32_bf16 v[60:63], a[128:131], a[32:35], v[60:63]
v_cvt_pk_bf16_f32 v80, v72, v73
v_mfma_f32_16x16x32_bf16 v[128:131], a[144:147], v[88:91], v[128:131]
v_exp_f32 v74, v74
v_mfma_f32_16x16x32_bf16 v[128:131], a[176:179], v[92:95], v[128:131]
buffer_load_dwordx4 v3, s[16:19], 0 offen offset:3072 nt lds
v_mfma_f32_16x16x32_bf16 v[132:135], a[180:183], v[92:95], v[132:135]
v_exp_f32 v75, v75
v_mfma_f32_16x16x32_bf16 v[132:135], a[148:151], v[88:91], v[132:135]
v_cvt_pk_bf16_f32 v81, v74, v75
v_mfma_f32_16x16x32_bf16 v[136:139], a[152:155], v[88:91], v[136:139]
v_exp_f32 v76, v76
v_mfma_f32_16x16x32_bf16 v[136:139], a[184:187], v[92:95], v[136:139]
v_mfma_f32_16x16x32_bf16 v[140:143], a[188:191], v[92:95], v[140:143]
v_exp_f32 v77, v77
v_mfma_f32_16x16x32_bf16 v[140:143], a[156:159], v[88:91], v[140:143]
v_cvt_pk_bf16_f32 v82, v76, v77
v_mfma_f32_16x16x32_bf16 v[144:147], a[160:163], v[88:91], v[144:147]
v_exp_f32 v78, v78
v_mfma_f32_16x16x32_bf16 v[144:147], a[192:195], v[92:95], v[144:147]
v_mfma_f32_16x16x32_bf16 v[148:151], a[196:199], v[92:95], v[148:151]
v_exp_f32 v79, v79
v_mfma_f32_16x16x32_bf16 v[148:151], a[164:167], v[88:91], v[148:151]
v_cvt_pk_bf16_f32 v83, v78, v79
v_mfma_f32_16x16x32_bf16 v[152:155], a[168:171], v[88:91], v[152:155]
s_waitcnt lgkmcnt(0)
v_exp_f32 v56, v56
v_mfma_f32_16x16x32_bf16 v[152:155], a[200:203], v[92:95], v[152:155]
buffer_store_dwordx4 v[20:23], v3, s[28:31], s36 offen offset:1024 sc0 sc1
v_mfma_f32_16x16x32_bf16 v[156:159], a[204:207], v[92:95], v[156:159]
s_waitcnt vmcnt(14) lgkmcnt(1)
v_exp_f32 v57, v57
v_mfma_f32_16x16x32_bf16 v[156:159], a[172:175], v[88:91], v[156:159]
v_cvt_pk_bf16_f32 v84, v56, v57
v_mfma_f32_16x16x32_bf16 a[212:215], a[228:231], v[88:91], a[212:215]
s_barrier
v_exp_f32 v58, v58
v_mfma_f32_16x16x32_bf16 a[212:215], a[228:231], v[92:95], a[212:215]
v_mfma_f32_16x16x32_bf16 v[64:67], a[80:83], a[48:51], v[48:51]
s_add_u32 s36, s36, 2048
v_exp_f32 v59, v59
v_mfma_f32_16x16x32_bf16 v[64:67], a[84:87], a[52:55], v[64:67]
ds_read_b128 a[80:83], v1 offset:8448
v_cvt_pk_bf16_f32 v85, v58, v59
v_mfma_f32_16x16x32_bf16 v[64:67], a[88:91], a[56:59], v[64:67]
v_exp_f32 v60, v60
v_mfma_f32_16x16x32_bf16 v[64:67], a[92:95], a[60:63], v[64:67]
ds_read_b128 a[84:87], v1 offset:8512
ds_read_b128 a[88:91], v1 offset:8576
v_mfma_f32_16x16x32_bf16 v[68:71], a[108:111], a[60:63], v[48:51]
v_exp_f32 v61, v61
v_mfma_f32_16x16x32_bf16 v[68:71], a[104:107], a[56:59], v[68:71]
ds_read_b128 a[92:95], v1 offset:8640
v_cvt_pk_bf16_f32 v86, v60, v61
v_mfma_f32_16x16x32_bf16 v[68:71], a[100:103], a[52:55], v[68:71]
v_exp_f32 v62, v62
v_mfma_f32_16x16x32_bf16 v[68:71], a[96:99], a[48:51], v[68:71]
ds_read_b128 a[108:111], v1 offset:9152
v_mfma_f32_16x16x32_bf16 v[72:75], a[112:115], a[48:51], v[48:51]
v_exp_f32 v63, v63
v_mfma_f32_16x16x32_bf16 v[72:75], a[116:119], a[52:55], v[72:75]
v_exp_f32 v64, v64
v_mfma_f32_16x16x32_bf16 v[72:75], a[120:123], a[56:59], v[72:75]
ds_read_b128 a[104:107], v1 offset:9088
v_cvt_pk_bf16_f32 v87, v62, v63
v_mfma_f32_16x16x32_bf16 v[72:75], a[124:127], a[60:63], v[72:75]
v_exp_f32 v65, v65
v_mfma_f32_16x16x32_bf16 v[76:79], a[140:143], a[60:63], v[48:51]
ds_read_b128 a[100:103], v1 offset:9024
v_cvt_pk_bf16_f32 v88, v64, v65
v_mfma_f32_16x16x32_bf16 v[76:79], a[136:139], a[56:59], v[76:79]
v_exp_f32 v66, v66
v_mfma_f32_16x16x32_bf16 v[76:79], a[132:135], a[52:55], v[76:79]
ds_read_b128 a[96:99], v1 offset:8960
v_mfma_f32_16x16x32_bf16 v[76:79], a[128:131], a[48:51], v[76:79]
v_exp_f32 v67, v67
v_mfma_f32_16x16x32_bf16 v[160:163], a[144:147], v[80:83], v[160:163]
ds_read_b128 a[112:115], v1
v_cvt_pk_bf16_f32 v89, v66, v67
v_mfma_f32_16x16x32_bf16 v[160:163], a[176:179], v[84:87], v[160:163]
v_exp_f32 v68, v68
v_mfma_f32_16x16x32_bf16 v[164:167], a[180:183], v[84:87], v[164:167]
ds_read_b128 a[116:119], v1 offset:64
v_mfma_f32_16x16x32_bf16 v[164:167], a[148:151], v[80:83], v[164:167]
v_exp_f32 v69, v69
v_mfma_f32_16x16x32_bf16 v[168:171], a[152:155], v[80:83], v[168:171]
ds_read_b128 a[120:123], v1 offset:128
v_cvt_pk_bf16_f32 v90, v68, v69
v_mfma_f32_16x16x32_bf16 v[168:171], a[184:187], v[84:87], v[168:171]
v_exp_f32 v70, v70
v_mfma_f32_16x16x32_bf16 v[172:175], a[188:191], v[84:87], v[172:175]
ds_read_b128 a[124:127], v1 offset:192
v_mfma_f32_16x16x32_bf16 v[172:175], a[156:159], v[80:83], v[172:175]
v_exp_f32 v71, v71
v_mfma_f32_16x16x32_bf16 v[176:179], a[160:163], v[80:83], v[176:179]
ds_read_b128 a[140:143], v1 offset:704
v_cvt_pk_bf16_f32 v91, v70, v71
v_mfma_f32_16x16x32_bf16 v[176:179], a[192:195], v[84:87], v[176:179]
v_exp_f32 v72, v72
v_mfma_f32_16x16x32_bf16 v[180:183], a[196:199], v[84:87], v[180:183]
ds_read_b128 a[136:139], v1 offset:640
v_mfma_f32_16x16x32_bf16 v[180:183], a[164:167], v[80:83], v[180:183]
v_exp_f32 v73, v73
v_mfma_f32_16x16x32_bf16 v[184:187], a[168:171], v[80:83], v[184:187]
ds_read_b128 a[132:135], v1 offset:576
v_cvt_pk_bf16_f32 v92, v72, v73
v_mfma_f32_16x16x32_bf16 v[184:187], a[200:203], v[84:87], v[184:187]
s_mov_b32 s34, 6
v_exp_f32 v74, v74
v_mfma_f32_16x16x32_bf16 v[188:191], a[204:207], v[84:87], v[188:191]
ds_read_b128 a[128:131], v1 offset:512
v_mfma_f32_16x16x32_bf16 v[188:191], a[172:175], v[80:83], v[188:191]
s_bitcmp0_b32 s44, 0
v_exp_f32 v75, v75
v_mfma_f32_16x16x32_bf16 a[216:219], a[228:231], v[80:83], a[216:219]
s_waitcnt lgkmcnt(8)
v_cvt_pk_bf16_f32 v93, v74, v75
v_mfma_f32_16x16x32_bf16 a[216:219], a[228:231], v[84:87], a[216:219]
s_cbranch_scc1 L_n111
L_m111:
v_exp_f32 v76, v76
v_mfma_f32_16x16x32_bf16 v[56:59], a[80:83], a[64:67], v[52:55]
v_mfma_f32_16x16x32_bf16 v[56:59], a[84:87], a[68:71], v[56:59]
v_exp_f32 v77, v77
v_mfma_f32_16x16x32_bf16 v[56:59], a[88:91], a[72:75], v[56:59]
v_cvt_pk_bf16_f32 v94, v76, v77
v_mfma_f32_16x16x32_bf16 v[56:59], a[92:95], a[76:79], v[56:59]
v_exp_f32 v78, v78
v_mfma_f32_16x16x32_bf16 v[60:63], a[108:111], a[76:79], v[52:55]
v_mfma_f32_16x16x32_bf16 v[60:63], a[104:107], a[72:75], v[60:63]
s_waitcnt vmcnt(10) lgkmcnt(0)
v_exp_f32 v79, v79
v_mfma_f32_16x16x32_bf16 v[60:63], a[100:103], a[68:71], v[60:63]
v_cvt_pk_bf16_f32 v95, v78, v79
v_mfma_f32_16x16x32_bf16 v[60:63], a[96:99], a[64:67], v[60:63]
s_barrier
s_add_u32 s12, s12, 16384
s_addc_u32 s13, s13, 0
v_mfma_f32_16x16x32_bf16 v[192:195], a[144:147], v[88:91], v[192:195]
ds_read_b64_tr_b16 a[144:145], v2 offset:8448
ds_read_b64_tr_b16 a[146:147], v2 offset:8960
v_mfma_f32_16x16x32_bf16 v[192:195], a[176:179], v[92:95], v[192:195]
v_exp_f32 v56, v56
v_mfma_f32_16x16x32_bf16 v[196:199], a[180:183], v[92:95], v[196:199]
v_mfma_f32_16x16x32_bf16 v[196:199], a[148:151], v[88:91], v[196:199]
ds_read_b64_tr_b16 a[148:149], v2 offset:8480
ds_read_b64_tr_b16 a[150:151], v2 offset:8992
v_mfma_f32_16x16x32_bf16 v[200:203], a[152:155], v[88:91], v[200:203]
v_exp_f32 v57, v57
v_mfma_f32_16x16x32_bf16 v[200:203], a[184:187], v[92:95], v[200:203]
ds_read_b64_tr_b16 a[152:153], v2 offset:8512
v_cvt_pk_bf16_f32 v80, v56, v57
v_mfma_f32_16x16x32_bf16 v[204:207], a[188:191], v[92:95], v[204:207]
ds_read_b64_tr_b16 a[154:155], v2 offset:9024
v_mfma_f32_16x16x32_bf16 v[204:207], a[156:159], v[88:91], v[204:207]
s_add_u32 m0, s33, 0
v_exp_f32 v58, v58
v_mfma_f32_16x16x32_bf16 v[208:211], a[160:163], v[88:91], v[208:211]
buffer_load_dwordx4 v3, s[12:15], 0 offen nt lds
v_mfma_f32_16x16x32_bf16 v[208:211], a[192:195], v[92:95], v[208:211]
ds_read_b64_tr_b16 a[156:157], v2 offset:8544
ds_read_b64_tr_b16 a[158:159], v2 offset:9056
v_mfma_f32_16x16x32_bf16 v[212:215], a[196:199], v[92:95], v[212:215]
v_exp_f32 v59, v59
v_mfma_f32_16x16x32_bf16 v[212:215], a[164:167], v[88:91], v[212:215]
ds_read_b64_tr_b16 a[160:161], v2 offset:8576
v_cvt_pk_bf16_f32 v81, v58, v59
v_mfma_f32_16x16x32_bf16 v[216:219], a[168:171], v[88:91], v[216:219]
ds_read_b64_tr_b16 a[162:163], v2 offset:9088
v_mfma_f32_16x16x32_bf16 v[216:219], a[200:203], v[92:95], v[216:219]
v_exp_f32 v60, v60
v_mfma_f32_16x16x32_bf16 v[220:223], a[204:207], v[92:95], v[220:223]
ds_read_b64_tr_b16 a[164:165], v2 offset:8608
v_mfma_f32_16x16x32_bf16 v[220:223], a[172:175], v[88:91], v[220:223]
ds_read_b64_tr_b16 a[166:167], v2 offset:9120
v_mfma_f32_16x16x32_bf16 a[220:223], a[228:231], v[88:91], a[220:223]
s_add_u32 m0, s33, 32
v_exp_f32 v61, v61
v_mfma_f32_16x16x32_bf16 a[220:223], a[228:231], v[92:95], a[220:223]
ds_read_b64_tr_b16 a[168:169], v2 offset:8640
v_cvt_pk_bf16_f32 v82, v60, v61
v_mfma_f32_16x16x32_bf16 v[64:67], a[80:83], a[0:3], v[36:39]
buffer_load_dwordx4 v3, s[12:15], 0 offen offset:1024 nt lds
v_mfma_f32_16x16x32_bf16 v[64:67], a[84:87], a[4:7], v[64:67]
v_exp_f32 v62, v62
v_mfma_f32_16x16x32_bf16 v[64:67], a[88:91], a[8:11], v[64:67]
ds_read_b64_tr_b16 a[170:171], v2 offset:9152
v_mfma_f32_16x16x32_bf16 v[64:67], a[92:95], a[12:15], v[64:67]
ds_read_b64_tr_b16 a[172:173], v2 offset:8672
v_mfma_f32_16x16x32_bf16 v[68:71], a[108:111], a[12:15], v[36:39]
v_exp_f32 v63, v63
v_mfma_f32_16x16x32_bf16 v[68:71], a[104:107], a[8:11], v[68:71]
ds_read_b64_tr_b16 a[174:175], v2 offset:9184
v_cvt_pk_bf16_f32 v83, v62, v63
v_mfma_f32_16x16x32_bf16 v[68:71], a[100:103], a[4:7], v[68:71]
ds_read_b64_tr_b16 a[176:177], v2
v_mfma_f32_16x16x32_bf16 v[68:71], a[96:99], a[0:3], v[68:71]
ds_read_b64_tr_b16 a[178:179], v2 offset:512
v_mfma_f32_16x16x32_bf16 v[72:75], a[112:115], a[0:3], v[36:39]
s_add_u32 m0, s33, 64
v_exp_f32 v64, v64
v_mfma_f32_16x16x32_bf16 v[72:75], a[116:119], a[4:7], v[72:75]
buffer_load_dwordx4 v3, s[12:15], 0 offen offset:2048 nt lds
v_mfma_f32_16x16x32_bf16 v[72:75], a[120:123], a[8:11], v[72:75]
v_exp_f32 v65, v65
v_mfma_f32_16x16x32_bf16 v[72:75], a[124:127], a[12:15], v[72:75]
ds_read_b64_tr_b16 a[180:181], v2 offset:32
v_cvt_pk_bf16_f32 v88, v64, v65
v_mfma_f32_16x16x32_bf16 v[76:79], a[140:143], a[12:15], v[36:39]
v_exp_f32 v66, v66
v_mfma_f32_16x16x32_bf16 v[76:79], a[136:139], a[8:11], v[76:79]
ds_read_b64_tr_b16 a[182:183], v2 offset:544
v_mfma_f32_16x16x32_bf16 v[76:79], a[132:135], a[4:7], v[76:79]
s_waitcnt lgkmcnt(12)
v_exp_f32 v67, v67
v_mfma_f32_16x16x32_bf16 v[76:79], a[128:131], a[0:3], v[76:79]
ds_read_b64_tr_b16 a[184:185], v2 offset:64
v_cvt_pk_bf16_f32 v89, v66, v67
v_mfma_f32_16x16x32_bf16 v[224:227], a[144:147], v[80:83], v[224:227]
v_exp_f32 v68, v68
v_mfma_f32_16x16x32_bf16 v[228:231], a[148:151], v[80:83], v[228:231]
s_waitcnt lgkmcnt(5)
ds_read_b64_tr_b16 a[186:187], v2 offset:576
v_mfma_f32_16x16x32_bf16 v[232:235], a[152:155], v[80:83], v[232:235]
s_add_u32 m0, s33, 96
v_exp_f32 v69, v69
v_mfma_f32_16x16x32_bf16 v[236:239], a[156:159], v[80:83], v[236:239]
ds_read_b64_tr_b16 a[188:189], v2 offset:96
v_cvt_pk_bf16_f32 v90, v68, v69
v_mfma_f32_16x16x32_bf16 v[240:243], a[160:163], v[80:83], v[240:243]
v_exp_f32 v70, v70
v_mfma_f32_16x16x32_bf16 v[244:247], a[164:167], v[80:83], v[244:247]
buffer_load_dwordx4 v3, s[12:15], 0 offen offset:3072 nt lds
v_mfma_f32_16x16x32_bf16 v[248:251], a[168:171], v[80:83], v[248:251]
v_exp_f32 v71, v71
v_mfma_f32_16x16x32_bf16 v[252:255], a[172:175], v[80:83], v[252:255]
ds_read_b64_tr_b16 a[190:191], v2 offset:608
v_cvt_pk_bf16_f32 v91, v70, v71
v_mfma_f32_16x16x32_bf16 a[224:227], a[228:231], v[80:83], a[224:227]
v_exp_f32 v72, v72
v_mfma_f32_16x16x32_bf16 v[56:59], a[80:83], a[16:19], v[40:43]
ds_read_b64_tr_b16 a[192:193], v2 offset:128
v_mfma_f32_16x16x32_bf16 v[56:59], a[84:87], a[20:23], v[56:59]
v_exp_f32 v73, v73
v_mfma_f32_16x16x32_bf16 v[56:59], a[88:91], a[24:27], v[56:59]
ds_read_b64_tr_b16 a[194:195], v2 offset:640
v_cvt_pk_bf16_f32 v92, v72, v73
v_mfma_f32_16x16x32_bf16 v[56:59], a[92:95], a[28:31], v[56:59]
v_exp_f32 v74, v74
v_mfma_f32_16x16x32_bf16 v[60:63], a[108:111], a[28:31], v[40:43]
ds_read_b64_tr_b16 a[196:197], v2 offset:160
v_mfma_f32_16x16x32_bf16 v[60:63], a[104:107], a[24:27], v[60:63]
v_exp_f32 v75, v75
v_mfma_f32_16x16x32_bf16 v[60:63], a[100:103], a[20:23], v[60:63]
ds_read_b64_tr_b16 a[198:199], v2 offset:672
v_cvt_pk_bf16_f32 v93, v74, v75
v_mfma_f32_16x16x32_bf16 v[60:63], a[96:99], a[16:19], v[60:63]
v_exp_f32 v76, v76
v_mfma_f32_16x16x32_bf16 v[64:67], a[112:115], a[16:19], v[40:43]
ds_read_b64_tr_b16 a[200:201], v2 offset:192
v_mfma_f32_16x16x32_bf16 v[64:67], a[116:119], a[20:23], v[64:67]
v_exp_f32 v77, v77
v_mfma_f32_16x16x32_bf16 v[64:67], a[120:123], a[24:27], v[64:67]
ds_read_b64_tr_b16 a[202:203], v2 offset:704
v_cvt_pk_bf16_f32 v94, v76, v77
v_mfma_f32_16x16x32_bf16 v[64:67], a[124:127], a[28:31], v[64:67]
v_exp_f32 v78, v78
v_mfma_f32_16x16x32_bf16 v[68:71], a[140:143], a[28:31], v[40:43]
ds_read_b64_tr_b16 a[204:205], v2 offset:224
v_mfma_f32_16x16x32_bf16 v[68:71], a[136:139], a[24:27], v[68:71]
v_exp_f32 v79, v79
v_mfma_f32_16x16x32_bf16 v[68:71], a[132:135], a[20:23], v[68:71]
ds_read_b64_tr_b16 a[206:207], v2 offset:736
v_cvt_pk_bf16_f32 v95, v78, v79
v_mfma_f32_16x16x32_bf16 v[68:71], a[128:131], a[16:19], v[68:71]
v_exp_f32 v56, v56
v_mfma_f32_16x16x32_bf16 v[96:99], a[144:147], v[88:91], v[96:99]
s_waitcnt lgkmcnt(8)
v_mfma_f32_16x16x32_bf16 v[96:99], a[176:179], v[92:95], v[96:99]
v_exp_f32 v57, v57
v_mfma_f32_16x16x32_bf16 v[100:103], a[180:183], v[92:95], v[100:103]
v_cvt_pk_bf16_f32 v80, v56, v57
v_mfma_f32_16x16x32_bf16 v[100:103], a[148:151], v[88:91], v[100:103]
v_exp_f32 v58, v58
v_mfma_f32_16x16x32_bf16 v[104:107], a[152:155], v[88:91], v[104:107]
v_mfma_f32_16x16x32_bf16 v[104:107], a[184:187], v[92:95], v[104:107]
v_exp_f32 v59, v59
v_mfma_f32_16x16x32_bf16 v[108:111], a[188:191], v[92:95], v[108:111]
v_cvt_pk_bf16_f32 v81, v58, v59
v_mfma_f32_16x16x32_bf16 v[108:111], a[156:159], v[88:91], v[108:111]
s_waitcnt lgkmcnt(0)
v_exp_f32 v60, v60
v_mfma_f32_16x16x32_bf16 v[112:115], a[160:163], v[88:91], v[112:115]
s_waitcnt lgkmcnt(0)
v_mfma_f32_16x16x32_bf16 v[112:115], a[192:195], v[92:95], v[112:115]
s_barrier
v_exp_f32 v61, v61
v_mfma_f32_16x16x32_bf16 v[116:119], a[196:199], v[92:95], v[116:119]
s_add_u32 s16, s16, 16384
s_addc_u32 s17, s17, 0
v_cvt_pk_bf16_f32 v82, v60, v61
v_mfma_f32_16x16x32_bf16 v[116:119], a[164:167], v[88:91], v[116:119]
v_exp_f32 v62, v62
v_mfma_f32_16x16x32_bf16 v[120:123], a[168:171], v[88:91], v[120:123]
v_mfma_f32_16x16x32_bf16 v[120:123], a[200:203], v[92:95], v[120:123]
s_add_u32 m0, s33, 33792
v_exp_f32 v63, v63
v_mfma_f32_16x16x32_bf16 v[124:127], a[204:207], v[92:95], v[124:127]
v_cvt_pk_bf16_f32 v83, v62, v63
v_mfma_f32_16x16x32_bf16 v[124:127], a[172:175], v[88:91], v[124:127]
v_mfma_f32_16x16x32_bf16 a[208:211], a[228:231], v[88:91], a[208:211]
buffer_load_dwordx4 v3, s[16:19], 0 offen nt lds
v_mfma_f32_16x16x32_bf16 a[208:211], a[228:231], v[92:95], a[208:211]
v_mfma_f32_16x16x32_bf16 v[72:75], a[80:83], a[32:35], v[44:47]
ds_read_b128 v[16:19], v4
v_mfma_f32_16x16x32_bf16 v[72:75], a[84:87], a[36:39], v[72:75]
s_add_u32 m0, s33, 33824
v_mfma_f32_16x16x32_bf16 v[72:75], a[88:91], a[40:43], v[72:75]
buffer_load_dwordx4 v3, s[16:19], 0 offen offset:1024 nt lds
v_mfma_f32_16x16x32_bf16 v[72:75], a[92:95], a[44:47], v[72:75]
v_exp_f32 v64, v64
v_exp_f32 v65, v65
v_exp_f32 v66, v66
v_exp_f32 v67, v67
v_cvt_pk_bf16_f32 v84, v64, v65
v_cvt_pk_bf16_f32 v85, v66, v67
v_mfma_f32_16x16x32_bf16 v[76:79], a[108:111], a[44:47], v[44:47]
v_mfma_f32_16x16x32_bf16 v[76:79], a[104:107], a[40:43], v[76:79]
s_add_u32 m0, s33, 33856
v_exp_f32 v68, v68
v_mfma_f32_16x16x32_bf16 v[76:79], a[100:103], a[36:39], v[76:79]
buffer_load_dwordx4 v3, s[16:19], 0 offen offset:2048 nt lds
v_mfma_f32_16x16x32_bf16 v[76:79], a[96:99], a[32:35], v[76:79]
v_exp_f32 v69, v69
v_mfma_f32_16x16x32_bf16 v[56:59], a[112:115], a[32:35], v[44:47]
v_cvt_pk_bf16_f32 v86, v68, v69
v_mfma_f32_16x16x32_bf16 v[56:59], a[116:119], a[36:39], v[56:59]
v_exp_f32 v70, v70
v_mfma_f32_16x16x32_bf16 v[56:59], a[120:123], a[40:43], v[56:59]
v_mfma_f32_16x16x32_bf16 v[56:59], a[124:127], a[44:47], v[56:59]
s_add_u32 m0, s33, 33888
v_exp_f32 v71, v71
v_mfma_f32_16x16x32_bf16 v[60:63], a[140:143], a[44:47], v[44:47]
v_exp_f32 v72, v72
v_mfma_f32_16x16x32_bf16 v[60:63], a[136:139], a[40:43], v[60:63]
v_cvt_pk_bf16_f32 v87, v70, v71
v_mfma_f32_16x16x32_bf16 v[60:63], a[132:135], a[36:39], v[60:63]
v_exp_f32 v73, v73
v_mfma_f32_16x16x32_bf16 v[60:63], a[128:131], a[32:35], v[60:63]
v_cvt_pk_bf16_f32 v88, v72, v73
v_mfma_f32_16x16x32_bf16 v[128:131], a[144:147], v[80:83], v[128:131]
v_exp_f32 v74, v74
v_mfma_f32_16x16x32_bf16 v[128:131], a[176:179], v[84:87], v[128:131]
buffer_load_dwordx4 v3, s[16:19], 0 offen offset:3072 nt lds
v_mfma_f32_16x16x32_bf16 v[132:135], a[180:183], v[84:87], v[132:135]
v_exp_f32 v75, v75
v_mfma_f32_16x16x32_bf16 v[132:135], a[148:151], v[80:83], v[132:135]
v_cvt_pk_bf16_f32 v89, v74, v75
v_mfma_f32_16x16x32_bf16 v[136:139], a[152:155], v[80:83], v[136:139]
v_exp_f32 v76, v76
v_mfma_f32_16x16x32_bf16 v[136:139], a[184:187], v[84:87], v[136:139]
v_mfma_f32_16x16x32_bf16 v[140:143], a[188:191], v[84:87], v[140:143]
v_exp_f32 v77, v77
v_mfma_f32_16x16x32_bf16 v[140:143], a[156:159], v[80:83], v[140:143]
v_cvt_pk_bf16_f32 v90, v76, v77
v_mfma_f32_16x16x32_bf16 v[144:147], a[160:163], v[80:83], v[144:147]
v_exp_f32 v78, v78
v_mfma_f32_16x16x32_bf16 v[144:147], a[192:195], v[84:87], v[144:147]
v_mfma_f32_16x16x32_bf16 v[148:151], a[196:199], v[84:87], v[148:151]
v_exp_f32 v79, v79
v_mfma_f32_16x16x32_bf16 v[148:151], a[164:167], v[80:83], v[148:151]
v_cvt_pk_bf16_f32 v91, v78, v79
v_mfma_f32_16x16x32_bf16 v[152:155], a[168:171], v[80:83], v[152:155]
s_waitcnt lgkmcnt(0)
v_exp_f32 v56, v56
v_mfma_f32_16x16x32_bf16 v[152:155], a[200:203], v[84:87], v[152:155]
buffer_store_dwordx4 v[16:19], v3, s[28:31], s36 offen sc0 sc1
v_mfma_f32_16x16x32_bf16 v[156:159], a[204:207], v[84:87], v[156:159]
s_waitcnt vmcnt(14) lgkmcnt(1)
v_exp_f32 v57, v57
v_mfma_f32_16x16x32_bf16 v[156:159], a[172:175], v[80:83], v[156:159]
v_cvt_pk_bf16_f32 v92, v56, v57
v_mfma_f32_16x16x32_bf16 a[212:215], a[228:231], v[80:83], a[212:215]
s_barrier
v_exp_f32 v58, v58
v_mfma_f32_16x16x32_bf16 a[212:215], a[228:231], v[84:87], a[212:215]
v_mfma_f32_16x16x32_bf16 v[64:67], a[80:83], a[48:51], v[48:51]
v_exp_f32 v59, v59
v_mfma_f32_16x16x32_bf16 v[64:67], a[84:87], a[52:55], v[64:67]
ds_read_b128 a[80:83], v1 offset:25344
v_cvt_pk_bf16_f32 v93, v58, v59
v_mfma_f32_16x16x32_bf16 v[64:67], a[88:91], a[56:59], v[64:67]
v_exp_f32 v60, v60
v_mfma_f32_16x16x32_bf16 v[64:67], a[92:95], a[60:63], v[64:67]
ds_read_b128 a[84:87], v1 offset:25408
ds_read_b128 a[88:91], v1 offset:25472
v_mfma_f32_16x16x32_bf16 v[68:71], a[108:111], a[60:63], v[48:51]
v_exp_f32 v61, v61
v_mfma_f32_16x16x32_bf16 v[68:71], a[104:107], a[56:59], v[68:71]
ds_read_b128 a[92:95], v1 offset:25536
v_cvt_pk_bf16_f32 v94, v60, v61
v_mfma_f32_16x16x32_bf16 v[68:71], a[100:103], a[52:55], v[68:71]
v_exp_f32 v62, v62
v_mfma_f32_16x16x32_bf16 v[68:71], a[96:99], a[48:51], v[68:71]
ds_read_b128 a[108:111], v1 offset:26048
v_mfma_f32_16x16x32_bf16 v[72:75], a[112:115], a[48:51], v[48:51]
v_exp_f32 v63, v63
v_mfma_f32_16x16x32_bf16 v[72:75], a[116:119], a[52:55], v[72:75]
v_exp_f32 v64, v64
v_mfma_f32_16x16x32_bf16 v[72:75], a[120:123], a[56:59], v[72:75]
ds_read_b128 a[104:107], v1 offset:25984
v_cvt_pk_bf16_f32 v95, v62, v63
v_mfma_f32_16x16x32_bf16 v[72:75], a[124:127], a[60:63], v[72:75]
v_exp_f32 v65, v65
v_mfma_f32_16x16x32_bf16 v[76:79], a[140:143], a[60:63], v[48:51]
ds_read_b128 a[100:103], v1 offset:25920
v_cvt_pk_bf16_f32 v80, v64, v65
v_mfma_f32_16x16x32_bf16 v[76:79], a[136:139], a[56:59], v[76:79]
v_exp_f32 v66, v66
v_mfma_f32_16x16x32_bf16 v[76:79], a[132:135], a[52:55], v[76:79]
ds_read_b128 a[96:99], v1 offset:25856
v_mfma_f32_16x16x32_bf16 v[76:79], a[128:131], a[48:51], v[76:79]
v_exp_f32 v67, v67
v_mfma_f32_16x16x32_bf16 v[160:163], a[144:147], v[88:91], v[160:163]
ds_read_b128 a[112:115], v1 offset:16896
v_cvt_pk_bf16_f32 v81, v66, v67
v_mfma_f32_16x16x32_bf16 v[160:163], a[176:179], v[92:95], v[160:163]
v_exp_f32 v68, v68
v_mfma_f32_16x16x32_bf16 v[164:167], a[180:183], v[92:95], v[164:167]
ds_read_b128 a[116:119], v1 offset:16960
v_mfma_f32_16x16x32_bf16 v[164:167], a[148:151], v[88:91], v[164:167]
v_exp_f32 v69, v69
v_mfma_f32_16x16x32_bf16 v[168:171], a[152:155], v[88:91], v[168:171]
ds_read_b128 a[120:123], v1 offset:17024
v_cvt_pk_bf16_f32 v82, v68, v69
v_mfma_f32_16x16x32_bf16 v[168:171], a[184:187], v[92:95], v[168:171]
v_exp_f32 v70, v70
v_mfma_f32_16x16x32_bf16 v[172:175], a[188:191], v[92:95], v[172:175]
ds_read_b128 a[124:127], v1 offset:17088
v_mfma_f32_16x16x32_bf16 v[172:175], a[156:159], v[88:91], v[172:175]
v_exp_f32 v71, v71
v_mfma_f32_16x16x32_bf16 v[176:179], a[160:163], v[88:91], v[176:179]
ds_read_b128 a[140:143], v1 offset:17600
v_cvt_pk_bf16_f32 v83, v70, v71
v_mfma_f32_16x16x32_bf16 v[176:179], a[192:195], v[92:95], v[176:179]
v_exp_f32 v72, v72
v_mfma_f32_16x16x32_bf16 v[180:183], a[196:199], v[92:95], v[180:183]
ds_read_b128 a[136:139], v1 offset:17536
v_mfma_f32_16x16x32_bf16 v[180:183], a[164:167], v[88:91], v[180:183]
v_exp_f32 v73, v73
v_mfma_f32_16x16x32_bf16 v[184:187], a[168:171], v[88:91], v[184:187]
ds_read_b128 a[132:135], v1 offset:17472
v_cvt_pk_bf16_f32 v84, v72, v73
v_mfma_f32_16x16x32_bf16 v[184:187], a[200:203], v[92:95], v[184:187]
v_exp_f32 v74, v74
v_mfma_f32_16x16x32_bf16 v[188:191], a[204:207], v[92:95], v[188:191]
ds_read_b128 a[128:131], v1 offset:17408
v_mfma_f32_16x16x32_bf16 v[188:191], a[172:175], v[88:91], v[188:191]
v_exp_f32 v75, v75
v_mfma_f32_16x16x32_bf16 a[216:219], a[228:231], v[88:91], a[216:219]
s_waitcnt lgkmcnt(8)
v_cvt_pk_bf16_f32 v85, v74, v75
v_mfma_f32_16x16x32_bf16 a[216:219], a[228:231], v[92:95], a[216:219]
v_mfma_f32_16x16x32_bf16 v[56:59], a[80:83], a[64:67], v[52:55]
v_mfma_f32_16x16x32_bf16 v[56:59], a[84:87], a[68:71], v[56:59]
v_mfma_f32_16x16x32_bf16 v[56:59], a[88:91], a[72:75], v[56:59]
v_mfma_f32_16x16x32_bf16 v[56:59], a[92:95], a[76:79], v[56:59]
v_exp_f32 v76, v76
v_exp_f32 v77, v77
v_exp_f32 v78, v78
v_exp_f32 v79, v79
v_cvt_pk_bf16_f32 v86, v76, v77
v_cvt_pk_bf16_f32 v87, v78, v79
v_mfma_f32_16x16x32_bf16 v[60:63], a[108:111], a[76:79], v[52:55]
v_mfma_f32_16x16x32_bf16 v[60:63], a[104:107], a[72:75], v[60:63]
s_waitcnt vmcnt(10) lgkmcnt(0)
v_mfma_f32_16x16x32_bf16 v[60:63], a[100:103], a[68:71], v[60:63]
v_mfma_f32_16x16x32_bf16 v[60:63], a[96:99], a[64:67], v[60:63]
s_barrier
s_add_u32 s12, s12, 16384
s_addc_u32 s13, s13, 0
v_mfma_f32_16x16x32_bf16 v[192:195], a[144:147], v[80:83], v[192:195]
ds_read_b64_tr_b16 a[144:145], v2 offset:25344
ds_read_b64_tr_b16 a[146:147], v2 offset:25856
v_mfma_f32_16x16x32_bf16 v[192:195], a[176:179], v[84:87], v[192:195]
v_exp_f32 v56, v56
v_mfma_f32_16x16x32_bf16 v[196:199], a[180:183], v[84:87], v[196:199]
v_mfma_f32_16x16x32_bf16 v[196:199], a[148:151], v[80:83], v[196:199]
ds_read_b64_tr_b16 a[148:149], v2 offset:25376
ds_read_b64_tr_b16 a[150:151], v2 offset:25888
v_mfma_f32_16x16x32_bf16 v[200:203], a[152:155], v[80:83], v[200:203]
v_exp_f32 v57, v57
v_mfma_f32_16x16x32_bf16 v[200:203], a[184:187], v[84:87], v[200:203]
ds_read_b64_tr_b16 a[152:153], v2 offset:25408
v_cvt_pk_bf16_f32 v88, v56, v57
v_mfma_f32_16x16x32_bf16 v[204:207], a[188:191], v[84:87], v[204:207]
ds_read_b64_tr_b16 a[154:155], v2 offset:25920
v_mfma_f32_16x16x32_bf16 v[204:207], a[156:159], v[80:83], v[204:207]
s_add_u32 m0, s33, 16896
v_exp_f32 v58, v58
v_mfma_f32_16x16x32_bf16 v[208:211], a[160:163], v[80:83], v[208:211]
buffer_load_dwordx4 v3, s[12:15], 0 offen nt lds
v_mfma_f32_16x16x32_bf16 v[208:211], a[192:195], v[84:87], v[208:211]
ds_read_b64_tr_b16 a[156:157], v2 offset:25440
ds_read_b64_tr_b16 a[158:159], v2 offset:25952
v_mfma_f32_16x16x32_bf16 v[212:215], a[196:199], v[84:87], v[212:215]
v_exp_f32 v59, v59
v_mfma_f32_16x16x32_bf16 v[212:215], a[164:167], v[80:83], v[212:215]
ds_read_b64_tr_b16 a[160:161], v2 offset:25472
v_cvt_pk_bf16_f32 v89, v58, v59
v_mfma_f32_16x16x32_bf16 v[216:219], a[168:171], v[80:83], v[216:219]
ds_read_b64_tr_b16 a[162:163], v2 offset:25984
v_mfma_f32_16x16x32_bf16 v[216:219], a[200:203], v[84:87], v[216:219]
v_exp_f32 v60, v60
v_mfma_f32_16x16x32_bf16 v[220:223], a[204:207], v[84:87], v[220:223]
ds_read_b64_tr_b16 a[164:165], v2 offset:25504
v_mfma_f32_16x16x32_bf16 v[220:223], a[172:175], v[80:83], v[220:223]
ds_read_b64_tr_b16 a[166:167], v2 offset:26016
v_mfma_f32_16x16x32_bf16 a[220:223], a[228:231], v[80:83], a[220:223]
s_add_u32 m0, s33, 16928
v_exp_f32 v61, v61
v_mfma_f32_16x16x32_bf16 a[220:223], a[228:231], v[84:87], a[220:223]
ds_read_b64_tr_b16 a[168:169], v2 offset:25536
v_cvt_pk_bf16_f32 v90, v60, v61
v_mfma_f32_16x16x32_bf16 v[64:67], a[80:83], a[0:3], v[36:39]
buffer_load_dwordx4 v3, s[12:15], 0 offen offset:1024 nt lds
v_mfma_f32_16x16x32_bf16 v[64:67], a[84:87], a[4:7], v[64:67]
v_exp_f32 v62, v62
v_mfma_f32_16x16x32_bf16 v[64:67], a[88:91], a[8:11], v[64:67]
ds_read_b64_tr_b16 a[170:171], v2 offset:26048
v_mfma_f32_16x16x32_bf16 v[64:67], a[92:95], a[12:15], v[64:67]
ds_read_b64_tr_b16 a[172:173], v2 offset:25568
v_mfma_f32_16x16x32_bf16 v[68:71], a[108:111], a[12:15], v[36:39]
v_exp_f32 v63, v63
v_mfma_f32_16x16x32_bf16 v[68:71], a[104:107], a[8:11], v[68:71]
ds_read_b64_tr_b16 a[174:175], v2 offset:26080
v_cvt_pk_bf16_f32 v91, v62, v63
v_mfma_f32_16x16x32_bf16 v[68:71], a[100:103], a[4:7], v[68:71]
ds_read_b64_tr_b16 a[176:177], v2 offset:16896
v_mfma_f32_16x16x32_bf16 v[68:71], a[96:99], a[0:3], v[68:71]
ds_read_b64_tr_b16 a[178:179], v2 offset:17408
v_mfma_f32_16x16x32_bf16 v[72:75], a[112:115], a[0:3], v[36:39]
s_add_u32 m0, s33, 16960
v_exp_f32 v64, v64
v_mfma_f32_16x16x32_bf16 v[72:75], a[116:119], a[4:7], v[72:75]
buffer_load_dwordx4 v3, s[12:15], 0 offen offset:2048 nt lds
v_mfma_f32_16x16x32_bf16 v[72:75], a[120:123], a[8:11], v[72:75]
v_exp_f32 v65, v65
v_mfma_f32_16x16x32_bf16 v[72:75], a[124:127], a[12:15], v[72:75]
ds_read_b64_tr_b16 a[180:181], v2 offset:16928
v_cvt_pk_bf16_f32 v80, v64, v65
v_mfma_f32_16x16x32_bf16 v[76:79], a[140:143], a[12:15], v[36:39]
v_exp_f32 v66, v66
v_mfma_f32_16x16x32_bf16 v[76:79], a[136:139], a[8:11], v[76:79]
ds_read_b64_tr_b16 a[182:183], v2 offset:17440
v_mfma_f32_16x16x32_bf16 v[76:79], a[132:135], a[4:7], v[76:79]
s_waitcnt lgkmcnt(12)
v_exp_f32 v67, v67
v_mfma_f32_16x16x32_bf16 v[76:79], a[128:131], a[0:3], v[76:79]
ds_read_b64_tr_b16 a[184:185], v2 offset:16960
v_cvt_pk_bf16_f32 v81, v66, v67
v_mfma_f32_16x16x32_bf16 v[224:227], a[144:147], v[88:91], v[224:227]
v_exp_f32 v68, v68
v_mfma_f32_16x16x32_bf16 v[228:231], a[148:151], v[88:91], v[228:231]
s_waitcnt lgkmcnt(5)
ds_read_b64_tr_b16 a[186:187], v2 offset:17472
v_mfma_f32_16x16x32_bf16 v[232:235], a[152:155], v[88:91], v[232:235]
s_add_u32 m0, s33, 16992
v_exp_f32 v69, v69
v_mfma_f32_16x16x32_bf16 v[236:239], a[156:159], v[88:91], v[236:239]
ds_read_b64_tr_b16 a[188:189], v2 offset:16992
v_cvt_pk_bf16_f32 v82, v68, v69
v_mfma_f32_16x16x32_bf16 v[240:243], a[160:163], v[88:91], v[240:243]
v_exp_f32 v70, v70
v_mfma_f32_16x16x32_bf16 v[244:247], a[164:167], v[88:91], v[244:247]
buffer_load_dwordx4 v3, s[12:15], 0 offen offset:3072 nt lds
v_mfma_f32_16x16x32_bf16 v[248:251], a[168:171], v[88:91], v[248:251]
v_exp_f32 v71, v71
v_mfma_f32_16x16x32_bf16 v[252:255], a[172:175], v[88:91], v[252:255]
ds_read_b64_tr_b16 a[190:191], v2 offset:17504
v_cvt_pk_bf16_f32 v83, v70, v71
v_mfma_f32_16x16x32_bf16 a[224:227], a[228:231], v[88:91], a[224:227]
v_exp_f32 v72, v72
v_mfma_f32_16x16x32_bf16 v[56:59], a[80:83], a[16:19], v[40:43]
ds_read_b64_tr_b16 a[192:193], v2 offset:17024
v_mfma_f32_16x16x32_bf16 v[56:59], a[84:87], a[20:23], v[56:59]
v_exp_f32 v73, v73
v_mfma_f32_16x16x32_bf16 v[56:59], a[88:91], a[24:27], v[56:59]
ds_read_b64_tr_b16 a[194:195], v2 offset:17536
v_cvt_pk_bf16_f32 v84, v72, v73
v_mfma_f32_16x16x32_bf16 v[56:59], a[92:95], a[28:31], v[56:59]
v_exp_f32 v74, v74
v_mfma_f32_16x16x32_bf16 v[60:63], a[108:111], a[28:31], v[40:43]
ds_read_b64_tr_b16 a[196:197], v2 offset:17056
v_mfma_f32_16x16x32_bf16 v[60:63], a[104:107], a[24:27], v[60:63]
v_exp_f32 v75, v75
v_mfma_f32_16x16x32_bf16 v[60:63], a[100:103], a[20:23], v[60:63]
ds_read_b64_tr_b16 a[198:199], v2 offset:17568
v_cvt_pk_bf16_f32 v85, v74, v75
v_mfma_f32_16x16x32_bf16 v[60:63], a[96:99], a[16:19], v[60:63]
v_exp_f32 v76, v76
v_mfma_f32_16x16x32_bf16 v[64:67], a[112:115], a[16:19], v[40:43]
ds_read_b64_tr_b16 a[200:201], v2 offset:17088
v_mfma_f32_16x16x32_bf16 v[64:67], a[116:119], a[20:23], v[64:67]
v_exp_f32 v77, v77
v_mfma_f32_16x16x32_bf16 v[64:67], a[120:123], a[24:27], v[64:67]
ds_read_b64_tr_b16 a[202:203], v2 offset:17600
v_cvt_pk_bf16_f32 v86, v76, v77
v_mfma_f32_16x16x32_bf16 v[64:67], a[124:127], a[28:31], v[64:67]
v_exp_f32 v78, v78
v_mfma_f32_16x16x32_bf16 v[68:71], a[140:143], a[28:31], v[40:43]
ds_read_b64_tr_b16 a[204:205], v2 offset:17120
v_mfma_f32_16x16x32_bf16 v[68:71], a[136:139], a[24:27], v[68:71]
v_exp_f32 v79, v79
v_mfma_f32_16x16x32_bf16 v[68:71], a[132:135], a[20:23], v[68:71]
ds_read_b64_tr_b16 a[206:207], v2 offset:17632
v_cvt_pk_bf16_f32 v87, v78, v79
v_mfma_f32_16x16x32_bf16 v[68:71], a[128:131], a[16:19], v[68:71]
v_exp_f32 v56, v56
v_mfma_f32_16x16x32_bf16 v[96:99], a[144:147], v[80:83], v[96:99]
s_waitcnt lgkmcnt(8)
v_mfma_f32_16x16x32_bf16 v[96:99], a[176:179], v[84:87], v[96:99]
v_exp_f32 v57, v57
v_mfma_f32_16x16x32_bf16 v[100:103], a[180:183], v[84:87], v[100:103]
v_cvt_pk_bf16_f32 v88, v56, v57
v_mfma_f32_16x16x32_bf16 v[100:103], a[148:151], v[80:83], v[100:103]
v_exp_f32 v58, v58
v_mfma_f32_16x16x32_bf16 v[104:107], a[152:155], v[80:83], v[104:107]
v_mfma_f32_16x16x32_bf16 v[104:107], a[184:187], v[84:87], v[104:107]
v_exp_f32 v59, v59
v_mfma_f32_16x16x32_bf16 v[108:111], a[188:191], v[84:87], v[108:111]
v_cvt_pk_bf16_f32 v89, v58, v59
v_mfma_f32_16x16x32_bf16 v[108:111], a[156:159], v[80:83], v[108:111]
s_waitcnt lgkmcnt(0)
v_exp_f32 v60, v60
v_mfma_f32_16x16x32_bf16 v[112:115], a[160:163], v[80:83], v[112:115]
s_waitcnt lgkmcnt(0)
v_mfma_f32_16x16x32_bf16 v[112:115], a[192:195], v[84:87], v[112:115]
s_barrier
v_exp_f32 v61, v61
v_mfma_f32_16x16x32_bf16 v[116:119], a[196:199], v[84:87], v[116:119]
s_add_u32 s16, s16, 16384
s_addc_u32 s17, s17, 0
v_cvt_pk_bf16_f32 v90, v60, v61
v_mfma_f32_16x16x32_bf16 v[116:119], a[164:167], v[80:83], v[116:119]
v_exp_f32 v62, v62
v_mfma_f32_16x16x32_bf16 v[120:123], a[168:171], v[80:83], v[120:123]
v_mfma_f32_16x16x32_bf16 v[120:123], a[200:203], v[84:87], v[120:123]
s_add_u32 m0, s33, 50688
v_exp_f32 v63, v63
v_mfma_f32_16x16x32_bf16 v[124:127], a[204:207], v[84:87], v[124:127]
v_cvt_pk_bf16_f32 v91, v62, v63
v_mfma_f32_16x16x32_bf16 v[124:127], a[172:175], v[80:83], v[124:127]
v_mfma_f32_16x16x32_bf16 a[208:211], a[228:231], v[80:83], a[208:211]
buffer_load_dwordx4 v3, s[16:19], 0 offen nt lds
v_mfma_f32_16x16x32_bf16 a[208:211], a[228:231], v[84:87], a[208:211]
v_mfma_f32_16x16x32_bf16 v[72:75], a[80:83], a[32:35], v[44:47]
ds_read_b128 v[20:23], v4 offset:1056
v_mfma_f32_16x16x32_bf16 v[72:75], a[84:87], a[36:39], v[72:75]
s_add_u32 m0, s33, 50720
v_mfma_f32_16x16x32_bf16 v[72:75], a[88:91], a[40:43], v[72:75]
buffer_load_dwordx4 v3, s[16:19], 0 offen offset:1024 nt lds
v_mfma_f32_16x16x32_bf16 v[72:75], a[92:95], a[44:47], v[72:75]
v_exp_f32 v64, v64
v_exp_f32 v65, v65
v_exp_f32 v66, v66
v_exp_f32 v67, v67
v_cvt_pk_bf16_f32 v92, v64, v65
v_cvt_pk_bf16_f32 v93, v66, v67
v_mfma_f32_16x16x32_bf16 v[76:79], a[108:111], a[44:47], v[44:47]
v_add_u32 v4, 2112, v4
v_mfma_f32_16x16x32_bf16 v[76:79], a[104:107], a[40:43], v[76:79]
s_add_u32 m0, s33, 50752
v_exp_f32 v68, v68
v_mfma_f32_16x16x32_bf16 v[76:79], a[100:103], a[36:39], v[76:79]
buffer_load_dwordx4 v3, s[16:19], 0 offen offset:2048 nt lds
v_mfma_f32_16x16x32_bf16 v[76:79], a[96:99], a[32:35], v[76:79]
v_exp_f32 v69, v69
v_mfma_f32_16x16x32_bf16 v[56:59], a[112:115], a[32:35], v[44:47]
v_cvt_pk_bf16_f32 v94, v68, v69
v_mfma_f32_16x16x32_bf16 v[56:59], a[116:119], a[36:39], v[56:59]
v_exp_f32 v70, v70
v_mfma_f32_16x16x32_bf16 v[56:59], a[120:123], a[40:43], v[56:59]
v_mfma_f32_16x16x32_bf16 v[56:59], a[124:127], a[44:47], v[56:59]
s_add_u32 m0, s33, 50784
v_exp_f32 v71, v71
v_mfma_f32_16x16x32_bf16 v[60:63], a[140:143], a[44:47], v[44:47]
v_exp_f32 v72, v72
v_mfma_f32_16x16x32_bf16 v[60:63], a[136:139], a[40:43], v[60:63]
v_cvt_pk_bf16_f32 v95, v70, v71
v_mfma_f32_16x16x32_bf16 v[60:63], a[132:135], a[36:39], v[60:63]
v_exp_f32 v73, v73
v_mfma_f32_16x16x32_bf16 v[60:63], a[128:131], a[32:35], v[60:63]
v_cvt_pk_bf16_f32 v80, v72, v73
v_mfma_f32_16x16x32_bf16 v[128:131], a[144:147], v[88:91], v[128:131]
v_exp_f32 v74, v74
v_mfma_f32_16x16x32_bf16 v[128:131], a[176:179], v[92:95], v[128:131]
buffer_load_dwordx4 v3, s[16:19], 0 offen offset:3072 nt lds
v_mfma_f32_16x16x32_bf16 v[132:135], a[180:183], v[92:95], v[132:135]
v_exp_f32 v75, v75
v_mfma_f32_16x16x32_bf16 v[132:135], a[148:151], v[88:91], v[132:135]
v_cvt_pk_bf16_f32 v81, v74, v75
v_mfma_f32_16x16x32_bf16 v[136:139], a[152:155], v[88:91], v[136:139]
v_exp_f32 v76, v76
v_mfma_f32_16x16x32_bf16 v[136:139], a[184:187], v[92:95], v[136:139]
v_mfma_f32_16x16x32_bf16 v[140:143], a[188:191], v[92:95], v[140:143]
v_exp_f32 v77, v77
v_mfma_f32_16x16x32_bf16 v[140:143], a[156:159], v[88:91], v[140:143]
v_cvt_pk_bf16_f32 v82, v76, v77
v_mfma_f32_16x16x32_bf16 v[144:147], a[160:163], v[88:91], v[144:147]
v_exp_f32 v78, v78
v_mfma_f32_16x16x32_bf16 v[144:147], a[192:195], v[92:95], v[144:147]
v_mfma_f32_16x16x32_bf16 v[148:151], a[196:199], v[92:95], v[148:151]
v_exp_f32 v79, v79
v_mfma_f32_16x16x32_bf16 v[148:151], a[164:167], v[88:91], v[148:151]
v_cvt_pk_bf16_f32 v83, v78, v79
v_mfma_f32_16x16x32_bf16 v[152:155], a[168:171], v[88:91], v[152:155]
s_waitcnt lgkmcnt(0)
v_exp_f32 v56, v56
v_mfma_f32_16x16x32_bf16 v[152:155], a[200:203], v[92:95], v[152:155]
buffer_store_dwordx4 v[20:23], v3, s[28:31], s36 offen offset:1024 sc0 sc1
v_mfma_f32_16x16x32_bf16 v[156:159], a[204:207], v[92:95], v[156:159]
s_waitcnt vmcnt(14) lgkmcnt(1)
v_exp_f32 v57, v57
v_mfma_f32_16x16x32_bf16 v[156:159], a[172:175], v[88:91], v[156:159]
v_cvt_pk_bf16_f32 v84, v56, v57
v_mfma_f32_16x16x32_bf16 a[212:215], a[228:231], v[88:91], a[212:215]
s_barrier
v_exp_f32 v58, v58
v_mfma_f32_16x16x32_bf16 a[212:215], a[228:231], v[92:95], a[212:215]
v_mfma_f32_16x16x32_bf16 v[64:67], a[80:83], a[48:51], v[48:51]
s_add_u32 s36, s36, 2048
v_exp_f32 v59, v59
v_mfma_f32_16x16x32_bf16 v[64:67], a[84:87], a[52:55], v[64:67]
ds_read_b128 a[80:83], v1 offset:8448
v_cvt_pk_bf16_f32 v85, v58, v59
v_mfma_f32_16x16x32_bf16 v[64:67], a[88:91], a[56:59], v[64:67]
v_exp_f32 v60, v60
v_mfma_f32_16x16x32_bf16 v[64:67], a[92:95], a[60:63], v[64:67]
ds_read_b128 a[84:87], v1 offset:8512
ds_read_b128 a[88:91], v1 offset:8576
v_mfma_f32_16x16x32_bf16 v[68:71], a[108:111], a[60:63], v[48:51]
v_exp_f32 v61, v61
v_mfma_f32_16x16x32_bf16 v[68:71], a[104:107], a[56:59], v[68:71]
ds_read_b128 a[92:95], v1 offset:8640
v_cvt_pk_bf16_f32 v86, v60, v61
v_mfma_f32_16x16x32_bf16 v[68:71], a[100:103], a[52:55], v[68:71]
v_exp_f32 v62, v62
v_mfma_f32_16x16x32_bf16 v[68:71], a[96:99], a[48:51], v[68:71]
ds_read_b128 a[108:111], v1 offset:9152
v_mfma_f32_16x16x32_bf16 v[72:75], a[112:115], a[48:51], v[48:51]
v_exp_f32 v63, v63
v_mfma_f32_16x16x32_bf16 v[72:75], a[116:119], a[52:55], v[72:75]
v_exp_f32 v64, v64
v_mfma_f32_16x16x32_bf16 v[72:75], a[120:123], a[56:59], v[72:75]
ds_read_b128 a[104:107], v1 offset:9088
v_cvt_pk_bf16_f32 v87, v62, v63
v_mfma_f32_16x16x32_bf16 v[72:75], a[124:127], a[60:63], v[72:75]
v_exp_f32 v65, v65
v_mfma_f32_16x16x32_bf16 v[76:79], a[140:143], a[60:63], v[48:51]
ds_read_b128 a[100:103], v1 offset:9024
v_cvt_pk_bf16_f32 v88, v64, v65
v_mfma_f32_16x16x32_bf16 v[76:79], a[136:139], a[56:59], v[76:79]
v_exp_f32 v66, v66
v_mfma_f32_16x16x32_bf16 v[76:79], a[132:135], a[52:55], v[76:79]
ds_read_b128 a[96:99], v1 offset:8960
v_mfma_f32_16x16x32_bf16 v[76:79], a[128:131], a[48:51], v[76:79]
v_exp_f32 v67, v67
v_mfma_f32_16x16x32_bf16 v[160:163], a[144:147], v[80:83], v[160:163]
ds_read_b128 a[112:115], v1
v_cvt_pk_bf16_f32 v89, v66, v67
v_mfma_f32_16x16x32_bf16 v[160:163], a[176:179], v[84:87], v[160:163]
v_exp_f32 v68, v68
v_mfma_f32_16x16x32_bf16 v[164:167], a[180:183], v[84:87], v[164:167]
ds_read_b128 a[116:119], v1 offset:64
v_mfma_f32_16x16x32_bf16 v[164:167], a[148:151], v[80:83], v[164:167]
v_exp_f32 v69, v69
v_mfma_f32_16x16x32_bf16 v[168:171], a[152:155], v[80:83], v[168:171]
ds_read_b128 a[120:123], v1 offset:128
v_cvt_pk_bf16_f32 v90, v68, v69
v_mfma_f32_16x16x32_bf16 v[168:171], a[184:187], v[84:87], v[168:171]
v_exp_f32 v70, v70
v_mfma_f32_16x16x32_bf16 v[172:175], a[188:191], v[84:87], v[172:175]
ds_read_b128 a[124:127], v1 offset:192
v_mfma_f32_16x16x32_bf16 v[172:175], a[156:159], v[80:83], v[172:175]
v_exp_f32 v71, v71
v_mfma_f32_16x16x32_bf16 v[176:179], a[160:163], v[80:83], v[176:179]
ds_read_b128 a[140:143], v1 offset:704
v_cvt_pk_bf16_f32 v91, v70, v71
v_mfma_f32_16x16x32_bf16 v[176:179], a[192:195], v[84:87], v[176:179]
v_exp_f32 v72, v72
v_mfma_f32_16x16x32_bf16 v[180:183], a[196:199], v[84:87], v[180:183]
ds_read_b128 a[136:139], v1 offset:640
v_mfma_f32_16x16x32_bf16 v[180:183], a[164:167], v[80:83], v[180:183]
v_exp_f32 v73, v73
v_mfma_f32_16x16x32_bf16 v[184:187], a[168:171], v[80:83], v[184:187]
ds_read_b128 a[132:135], v1 offset:576
v_cvt_pk_bf16_f32 v92, v72, v73
v_mfma_f32_16x16x32_bf16 v[184:187], a[200:203], v[84:87], v[184:187]
s_sub_u32 s34, s34, 1
v_exp_f32 v74, v74
v_mfma_f32_16x16x32_bf16 v[188:191], a[204:207], v[84:87], v[188:191]
ds_read_b128 a[128:131], v1 offset:512
v_mfma_f32_16x16x32_bf16 v[188:191], a[172:175], v[80:83], v[188:191]
s_cmp_lg_u32 s34, 0
v_exp_f32 v75, v75
v_mfma_f32_16x16x32_bf16 a[216:219], a[228:231], v[80:83], a[216:219]
s_waitcnt lgkmcnt(8)
v_cvt_pk_bf16_f32 v93, v74, v75
v_mfma_f32_16x16x32_bf16 a[216:219], a[228:231], v[84:87], a[216:219]
s_cbranch_scc1 L_m111
L_x11:
v_exp_f32 v76, v76
v_mfma_f32_16x16x32_bf16 v[56:59], a[80:83], a[64:67], v[52:55]
v_mfma_f32_16x16x32_bf16 v[56:59], a[84:87], a[68:71], v[56:59]
v_exp_f32 v77, v77
v_mfma_f32_16x16x32_bf16 v[56:59], a[88:91], a[72:75], v[56:59]
v_cvt_pk_bf16_f32 v94, v76, v77
v_mfma_f32_16x16x32_bf16 v[56:59], a[92:95], a[76:79], v[56:59]
v_exp_f32 v78, v78
v_mfma_f32_16x16x32_bf16 v[60:63], a[108:111], a[76:79], v[52:55]
v_mfma_f32_16x16x32_bf16 v[60:63], a[104:107], a[72:75], v[60:63]
s_waitcnt vmcnt(10) lgkmcnt(0)
v_exp_f32 v79, v79
v_mfma_f32_16x16x32_bf16 v[60:63], a[100:103], a[68:71], v[60:63]
v_cvt_pk_bf16_f32 v95, v78, v79
v_mfma_f32_16x16x32_bf16 v[60:63], a[96:99], a[64:67], v[60:63]
s_barrier
v_mfma_f32_16x16x32_bf16 v[192:195], a[144:147], v[88:91], v[192:195]
ds_read_b64_tr_b16 a[144:145], v2 offset:8448
v_mfma_f32_16x16x32_bf16 v[192:195], a[176:179], v[92:95], v[192:195]
v_exp_f32 v56, v56
v_mfma_f32_16x16x32_bf16 v[196:199], a[180:183], v[92:95], v[196:199]
ds_read_b64_tr_b16 a[146:147], v2 offset:8960
v_mfma_f32_16x16x32_bf16 v[196:199], a[148:151], v[88:91], v[196:199]
ds_read_b64_tr_b16 a[148:149], v2 offset:8480
v_mfma_f32_16x16x32_bf16 v[200:203], a[152:155], v[88:91], v[200:203]
v_exp_f32 v57, v57
v_mfma_f32_16x16x32_bf16 v[200:203], a[184:187], v[92:95], v[200:203]
ds_read_b64_tr_b16 a[150:151], v2 offset:8992
v_cvt_pk_bf16_f32 v80, v56, v57
v_mfma_f32_16x16x32_bf16 v[204:207], a[188:191], v[92:95], v[204:207]
ds_read_b64_tr_b16 a[152:153], v2 offset:8512
v_mfma_f32_16x16x32_bf16 v[204:207], a[156:159], v[88:91], v[204:207]
v_exp_f32 v58, v58
v_mfma_f32_16x16x32_bf16 v[208:211], a[160:163], v[88:91], v[208:211]
ds_read_b64_tr_b16 a[154:155], v2 offset:9024
v_mfma_f32_16x16x32_bf16 v[208:211], a[192:195], v[92:95], v[208:211]
ds_read_b64_tr_b16 a[156:157], v2 offset:8544
v_mfma_f32_16x16x32_bf16 v[212:215], a[196:199], v[92:95], v[212:215]
v_exp_f32 v59, v59
v_mfma_f32_16x16x32_bf16 v[212:215], a[164:167], v[88:91], v[212:215]
ds_read_b64_tr_b16 a[158:159], v2 offset:9056
v_cvt_pk_bf16_f32 v81, v58, v59
v_mfma_f32_16x16x32_bf16 v[216:219], a[168:171], v[88:91], v[216:219]
ds_read_b64_tr_b16 a[160:161], v2 offset:8576
v_mfma_f32_16x16x32_bf16 v[216:219], a[200:203], v[92:95], v[216:219]
v_exp_f32 v60, v60
v_mfma_f32_16x16x32_bf16 v[220:223], a[204:207], v[92:95], v[220:223]
ds_read_b64_tr_b16 a[162:163], v2 offset:9088
v_mfma_f32_16x16x32_bf16 v[220:223], a[172:175], v[88:91], v[220:223]
ds_read_b64_tr_b16 a[164:165], v2 offset:8608
v_mfma_f32_16x16x32_bf16 a[220:223], a[228:231], v[88:91], a[220:223]
v_exp_f32 v61, v61
v_mfma_f32_16x16x32_bf16 a[220:223], a[228:231], v[92:95], a[220:223]
ds_read_b64_tr_b16 a[166:167], v2 offset:9120
v_cvt_pk_bf16_f32 v82, v60, v61
v_mfma_f32_16x16x32_bf16 v[64:67], a[80:83], a[0:3], v[36:39]
ds_read_b64_tr_b16 a[168:169], v2 offset:8640
v_mfma_f32_16x16x32_bf16 v[64:67], a[84:87], a[4:7], v[64:67]
v_exp_f32 v62, v62
v_mfma_f32_16x16x32_bf16 v[64:67], a[88:91], a[8:11], v[64:67]
ds_read_b64_tr_b16 a[170:171], v2 offset:9152
v_mfma_f32_16x16x32_bf16 v[64:67], a[92:95], a[12:15], v[64:67]
ds_read_b64_tr_b16 a[172:173], v2 offset:8672
v_mfma_f32_16x16x32_bf16 v[68:71], a[108:111], a[12:15], v[36:39]
v_exp_f32 v63, v63
v_mfma_f32_16x16x32_bf16 v[68:71], a[104:107], a[8:11], v[68:71]
ds_read_b64_tr_b16 a[174:175], v2 offset:9184
v_cvt_pk_bf16_f32 v83, v62, v63
v_mfma_f32_16x16x32_bf16 v[68:71], a[100:103], a[4:7], v[68:71]
ds_read_b64_tr_b16 a[176:177], v2
v_mfma_f32_16x16x32_bf16 v[68:71], a[96:99], a[0:3], v[68:71]
ds_read_b64_tr_b16 a[178:179], v2 offset:512
v_mfma_f32_16x16x32_bf16 v[72:75], a[112:115], a[0:3], v[36:39]
v_exp_f32 v64, v64
v_mfma_f32_16x16x32_bf16 v[72:75], a[116:119], a[4:7], v[72:75]
ds_read_b64_tr_b16 a[180:181], v2 offset:32
v_mfma_f32_16x16x32_bf16 v[72:75], a[120:123], a[8:11], v[72:75]
v_exp_f32 v65, v65
v_mfma_f32_16x16x32_bf16 v[72:75], a[124:127], a[12:15], v[72:75]
ds_read_b64_tr_b16 a[182:183], v2 offset:544
v_cvt_pk_bf16_f32 v88, v64, v65
v_mfma_f32_16x16x32_bf16 v[76:79], a[140:143], a[12:15], v[36:39]
v_exp_f32 v66, v66
v_mfma_f32_16x16x32_bf16 v[76:79], a[136:139], a[8:11], v[76:79]
ds_read_b64_tr_b16 a[184:185], v2 offset:64
v_mfma_f32_16x16x32_bf16 v[76:79], a[132:135], a[4:7], v[76:79]
s_waitcnt lgkmcnt(13)
v_exp_f32 v67, v67
v_mfma_f32_16x16x32_bf16 v[76:79], a[128:131], a[0:3], v[76:79]
ds_read_b64_tr_b16 a[186:187], v2 offset:576
v_cvt_pk_bf16_f32 v89, v66, v67
v_mfma_f32_16x16x32_bf16 v[224:227], a[144:147], v[80:83], v[224:227]
v_exp_f32 v68, v68
v_mfma_f32_16x16x32_bf16 v[228:231], a[148:151], v[80:83], v[228:231]
ds_read_b64_tr_b16 a[188:189], v2 offset:96
v_mfma_f32_16x16x32_bf16 v[232:235], a[152:155], v[80:83], v[232:235]
s_waitcnt lgkmcnt(7)
v_exp_f32 v69, v69
v_mfma_f32_16x16x32_bf16 v[236:239], a[156:159], v[80:83], v[236:239]
ds_read_b64_tr_b16 a[190:191], v2 offset:608
v_cvt_pk_bf16_f32 v90, v68, v69
v_mfma_f32_16x16x32_bf16 v[240:243], a[160:163], v[80:83], v[240:243]
v_exp_f32 v70, v70
v_mfma_f32_16x16x32_bf16 v[244:247], a[164:167], v[80:83], v[244:247]
ds_read_b64_tr_b16 a[192:193], v2 offset:128
v_mfma_f32_16x16x32_bf16 v[248:251], a[168:171], v[80:83], v[248:251]
v_exp_f32 v71, v71
v_mfma_f32_16x16x32_bf16 v[252:255], a[172:175], v[80:83], v[252:255]
ds_read_b64_tr_b16 a[194:195], v2 offset:640
v_cvt_pk_bf16_f32 v91, v70, v71
v_mfma_f32_16x16x32_bf16 a[224:227], a[228:231], v[80:83], a[224:227]
v_exp_f32 v72, v72
v_mfma_f32_16x16x32_bf16 v[56:59], a[80:83], a[16:19], v[40:43]
ds_read_b64_tr_b16 a[196:197], v2 offset:160
v_mfma_f32_16x16x32_bf16 v[56:59], a[84:87], a[20:23], v[56:59]
v_exp_f32 v73, v73
v_mfma_f32_16x16x32_bf16 v[56:59], a[88:91], a[24:27], v[56:59]
ds_read_b64_tr_b16 a[198:199], v2 offset:672
v_cvt_pk_bf16_f32 v92, v72, v73
v_mfma_f32_16x16x32_bf16 v[56:59], a[92:95], a[28:31], v[56:59]
v_exp_f32 v74, v74
v_mfma_f32_16x16x32_bf16 v[60:63], a[108:111], a[28:31], v[40:43]
ds_read_b64_tr_b16 a[200:201], v2 offset:192
v_mfma_f32_16x16x32_bf16 v[60:63], a[104:107], a[24:27], v[60:63]
v_exp_f32 v75, v75
v_mfma_f32_16x16x32_bf16 v[60:63], a[100:103], a[20:23], v[60:63]
ds_read_b64_tr_b16 a[202:203], v2 offset:704
ds_read_b128 v[16:19], v4
v_cvt_pk_bf16_f32 v93, v74, v75
v_mfma_f32_16x16x32_bf16 v[60:63], a[96:99], a[16:19], v[60:63]
v_exp_f32 v76, v76
v_mfma_f32_16x16x32_bf16 v[64:67], a[112:115], a[16:19], v[40:43]
v_mfma_f32_16x16x32_bf16 v[64:67], a[116:119], a[20:23], v[64:67]
v_exp_f32 v77, v77
v_mfma_f32_16x16x32_bf16 v[64:67], a[120:123], a[24:27], v[64:67]
ds_read_b64_tr_b16 a[204:205], v2 offset:224
v_cvt_pk_bf16_f32 v94, v76, v77
v_mfma_f32_16x16x32_bf16 v[64:67], a[124:127], a[28:31], v[64:67]
v_exp_f32 v78, v78
v_mfma_f32_16x16x32_bf16 v[68:71], a[140:143], a[28:31], v[40:43]
v_mfma_f32_16x16x32_bf16 v[68:71], a[136:139], a[24:27], v[68:71]
s_waitcnt lgkmcnt(1)
v_exp_f32 v79, v79
v_mfma_f32_16x16x32_bf16 v[68:71], a[132:135], a[20:23], v[68:71]
ds_read_b64_tr_b16 a[206:207], v2 offset:736
v_cvt_pk_bf16_f32 v95, v78, v79
v_mfma_f32_16x16x32_bf16 v[68:71], a[128:131], a[16:19], v[68:71]
s_waitcnt lgkmcnt(9)
v_exp_f32 v56, v56
v_mfma_f32_16x16x32_bf16 v[96:99], a[144:147], v[88:91], v[96:99]
buffer_store_dwordx4 v[16:19], v3, s[28:31], s36 offen sc0 sc1
v_mfma_f32_16x16x32_bf16 v[96:99], a[176:179], v[92:95], v[96:99]
v_exp_f32 v57, v57
v_mfma_f32_16x16x32_bf16 v[100:103], a[180:183], v[92:95], v[100:103]
v_cvt_pk_bf16_f32 v80, v56, v57
v_mfma_f32_16x16x32_bf16 v[100:103], a[148:151], v[88:91], v[100:103]
v_exp_f32 v58, v58
v_mfma_f32_16x16x32_bf16 v[104:107], a[152:155], v[88:91], v[104:107]
v_mfma_f32_16x16x32_bf16 v[104:107], a[184:187], v[92:95], v[104:107]
v_exp_f32 v59, v59
v_mfma_f32_16x16x32_bf16 v[108:111], a[188:191], v[92:95], v[108:111]
v_cvt_pk_bf16_f32 v81, v58, v59
v_mfma_f32_16x16x32_bf16 v[108:111], a[156:159], v[88:91], v[108:111]
v_exp_f32 v60, v60
v_mfma_f32_16x16x32_bf16 v[112:115], a[160:163], v[88:91], v[112:115]
s_waitcnt lgkmcnt(0)
v_mfma_f32_16x16x32_bf16 v[112:115], a[192:195], v[92:95], v[112:115]
v_exp_f32 v61, v61
v_mfma_f32_16x16x32_bf16 v[116:119], a[196:199], v[92:95], v[116:119]
v_cvt_pk_bf16_f32 v82, v60, v61
v_mfma_f32_16x16x32_bf16 v[116:119], a[164:167], v[88:91], v[116:119]
v_exp_f32 v62, v62
v_mfma_f32_16x16x32_bf16 v[120:123], a[168:171], v[88:91], v[120:123]
v_mfma_f32_16x16x32_bf16 v[120:123], a[200:203], v[92:95], v[120:123]
v_exp_f32 v63, v63
v_mfma_f32_16x16x32_bf16 v[124:127], a[204:207], v[92:95], v[124:127]
v_cvt_pk_bf16_f32 v83, v62, v63
v_mfma_f32_16x16x32_bf16 v[124:127], a[172:175], v[88:91], v[124:127]
v_exp_f32 v64, v64
v_mfma_f32_16x16x32_bf16 a[208:211], a[228:231], v[88:91], a[208:211]
v_mfma_f32_16x16x32_bf16 a[208:211], a[228:231], v[92:95], a[208:211]
v_exp_f32 v65, v65
v_mfma_f32_16x16x32_bf16 v[72:75], a[80:83], a[32:35], v[44:47]
v_cvt_pk_bf16_f32 v84, v64, v65
v_mfma_f32_16x16x32_bf16 v[72:75], a[84:87], a[36:39], v[72:75]
v_exp_f32 v66, v66
v_mfma_f32_16x16x32_bf16 v[72:75], a[88:91], a[40:43], v[72:75]
v_mfma_f32_16x16x32_bf16 v[72:75], a[92:95], a[44:47], v[72:75]
v_exp_f32 v67, v67
v_mfma_f32_16x16x32_bf16 v[76:79], a[108:111], a[44:47], v[44:47]
v_cvt_pk_bf16_f32 v85, v66, v67
v_mfma_f32_16x16x32_bf16 v[76:79], a[104:107], a[40:43], v[76:79]
v_exp_f32 v68, v68
v_mfma_f32_16x16x32_bf16 v[76:79], a[100:103], a[36:39], v[76:79]
v_mfma_f32_16x16x32_bf16 v[76:79], a[96:99], a[32:35], v[76:79]
v_exp_f32 v69, v69
v_mfma_f32_16x16x32_bf16 v[56:59], a[112:115], a[32:35], v[44:47]
v_cvt_pk_bf16_f32 v86, v68, v69
v_mfma_f32_16x16x32_bf16 v[56:59], a[116:119], a[36:39], v[56:59]
v_exp_f32 v70, v70
v_mfma_f32_16x16x32_bf16 v[56:59], a[120:123], a[40:43], v[56:59]
ds_read_b128 v[20:23], v4 offset:1056
v_mfma_f32_16x16x32_bf16 v[56:59], a[124:127], a[44:47], v[56:59]
v_exp_f32 v71, v71
v_mfma_f32_16x16x32_bf16 v[60:63], a[140:143], a[44:47], v[44:47]
v_exp_f32 v72, v72
v_mfma_f32_16x16x32_bf16 v[60:63], a[136:139], a[40:43], v[60:63]
v_cvt_pk_bf16_f32 v87, v70, v71
v_mfma_f32_16x16x32_bf16 v[60:63], a[132:135], a[36:39], v[60:63]
v_exp_f32 v73, v73
v_mfma_f32_16x16x32_bf16 v[60:63], a[128:131], a[32:35], v[60:63]
v_cvt_pk_bf16_f32 v88, v72, v73
v_mfma_f32_16x16x32_bf16 v[128:131], a[144:147], v[80:83], v[128:131]
v_exp_f32 v74, v74
v_mfma_f32_16x16x32_bf16 v[128:131], a[176:179], v[84:87], v[128:131]
v_mfma_f32_16x16x32_bf16 v[132:135], a[180:183], v[84:87], v[132:135]
v_exp_f32 v75, v75
v_mfma_f32_16x16x32_bf16 v[132:135], a[148:151], v[80:83], v[132:135]
v_cvt_pk_bf16_f32 v89, v74, v75
v_mfma_f32_16x16x32_bf16 v[136:139], a[152:155], v[80:83], v[136:139]
v_exp_f32 v76, v76
v_mfma_f32_16x16x32_bf16 v[136:139], a[184:187], v[84:87], v[136:139]
v_mfma_f32_16x16x32_bf16 v[140:143], a[188:191], v[84:87], v[140:143]
v_exp_f32 v77, v77
v_mfma_f32_16x16x32_bf16 v[140:143], a[156:159], v[80:83], v[140:143]
v_cvt_pk_bf16_f32 v90, v76, v77
v_mfma_f32_16x16x32_bf16 v[144:147], a[160:163], v[80:83], v[144:147]
v_exp_f32 v78, v78
v_mfma_f32_16x16x32_bf16 v[144:147], a[192:195], v[84:87], v[144:147]
v_mfma_f32_16x16x32_bf16 v[148:151], a[196:199], v[84:87], v[148:151]
v_exp_f32 v79, v79
v_mfma_f32_16x16x32_bf16 v[148:151], a[164:167], v[80:83], v[148:151]
v_cvt_pk_bf16_f32 v91, v78, v79
v_mfma_f32_16x16x32_bf16 v[152:155], a[168:171], v[80:83], v[152:155]
v_exp_f32 v56, v56
v_mfma_f32_16x16x32_bf16 v[152:155], a[200:203], v[84:87], v[152:155]
v_mfma_f32_16x16x32_bf16 v[156:159], a[204:207], v[84:87], v[156:159]
s_waitcnt vmcnt(6) lgkmcnt(1)
v_exp_f32 v57, v57
v_mfma_f32_16x16x32_bf16 v[156:159], a[172:175], v[80:83], v[156:159]
v_cvt_pk_bf16_f32 v92, v56, v57
v_mfma_f32_16x16x32_bf16 a[212:215], a[228:231], v[80:83], a[212:215]
s_barrier
v_exp_f32 v58, v58
v_mfma_f32_16x16x32_bf16 a[212:215], a[228:231], v[84:87], a[212:215]
v_mfma_f32_16x16x32_bf16 v[64:67], a[80:83], a[48:51], v[48:51]
v_exp_f32 v59, v59
v_mfma_f32_16x16x32_bf16 v[64:67], a[84:87], a[52:55], v[64:67]
ds_read_b128 a[80:83], v1 offset:25344
v_cvt_pk_bf16_f32 v93, v58, v59
v_mfma_f32_16x16x32_bf16 v[64:67], a[88:91], a[56:59], v[64:67]
v_exp_f32 v60, v60
v_mfma_f32_16x16x32_bf16 v[64:67], a[92:95], a[60:63], v[64:67]
ds_read_b128 a[84:87], v1 offset:25408
ds_read_b128 a[88:91], v1 offset:25472
v_mfma_f32_16x16x32_bf16 v[68:71], a[108:111], a[60:63], v[48:51]
s_waitcnt lgkmcnt(3)
v_exp_f32 v61, v61
v_mfma_f32_16x16x32_bf16 v[68:71], a[104:107], a[56:59], v[68:71]
ds_read_b128 a[92:95], v1 offset:25536
v_cvt_pk_bf16_f32 v94, v60, v61
v_mfma_f32_16x16x32_bf16 v[68:71], a[100:103], a[52:55], v[68:71]
buffer_store_dwordx4 v[20:23], v3, s[28:31], s36 offen offset:1024 sc0 sc1
v_exp_f32 v62, v62
v_mfma_f32_16x16x32_bf16 v[68:71], a[96:99], a[48:51], v[68:71]
ds_read_b128 a[108:111], v1 offset:26048
v_mfma_f32_16x16x32_bf16 v[72:75], a[112:115], a[48:51], v[48:51]
s_add_u32 s36, s36, 2048
v_exp_f32 v63, v63
v_mfma_f32_16x16x32_bf16 v[72:75], a[116:119], a[52:55], v[72:75]
v_exp_f32 v64, v64
v_mfma_f32_16x16x32_bf16 v[72:75], a[120:123], a[56:59], v[72:75]
ds_read_b128 a[104:107], v1 offset:25984
v_cvt_pk_bf16_f32 v95, v62, v63
v_mfma_f32_16x16x32_bf16 v[72:75], a[124:127], a[60:63], v[72:75]
v_exp_f32 v65, v65
v_mfma_f32_16x16x32_bf16 v[76:79], a[140:143], a[60:63], v[48:51]
ds_read_b128 a[100:103], v1 offset:25920
v_cvt_pk_bf16_f32 v80, v64, v65
v_mfma_f32_16x16x32_bf16 v[76:79], a[136:139], a[56:59], v[76:79]
v_exp_f32 v66, v66
v_mfma_f32_16x16x32_bf16 v[76:79], a[132:135], a[52:55], v[76:79]
ds_read_b128 a[96:99], v1 offset:25856
v_mfma_f32_16x16x32_bf16 v[76:79], a[128:131], a[48:51], v[76:79]
v_exp_f32 v67, v67
v_mfma_f32_16x16x32_bf16 v[160:163], a[144:147], v[88:91], v[160:163]
ds_read_b128 a[112:115], v1 offset:16896
v_cvt_pk_bf16_f32 v81, v66, v67
v_mfma_f32_16x16x32_bf16 v[160:163], a[176:179], v[92:95], v[160:163]
v_exp_f32 v68, v68
v_mfma_f32_16x16x32_bf16 v[164:167], a[180:183], v[92:95], v[164:167]
ds_read_b128 a[116:119], v1 offset:16960
v_mfma_f32_16x16x32_bf16 v[164:167], a[148:151], v[88:91], v[164:167]
v_exp_f32 v69, v69
v_mfma_f32_16x16x32_bf16 v[168:171], a[152:155], v[88:91], v[168:171]
ds_read_b128 a[120:123], v1 offset:17024
v_cvt_pk_bf16_f32 v82, v68, v69
v_mfma_f32_16x16x32_bf16 v[168:171], a[184:187], v[92:95], v[168:171]
v_exp_f32 v70, v70
v_mfma_f32_16x16x32_bf16 v[172:175], a[188:191], v[92:95], v[172:175]
ds_read_b128 a[124:127], v1 offset:17088
v_mfma_f32_16x16x32_bf16 v[172:175], a[156:159], v[88:91], v[172:175]
v_exp_f32 v71, v71
v_mfma_f32_16x16x32_bf16 v[176:179], a[160:163], v[88:91], v[176:179]
ds_read_b128 a[140:143], v1 offset:17600
v_cvt_pk_bf16_f32 v83, v70, v71
v_mfma_f32_16x16x32_bf16 v[176:179], a[192:195], v[92:95], v[176:179]
v_exp_f32 v72, v72
v_mfma_f32_16x16x32_bf16 v[180:183], a[196:199], v[92:95], v[180:183]
ds_read_b128 a[136:139], v1 offset:17536
v_mfma_f32_16x16x32_bf16 v[180:183], a[164:167], v[88:91], v[180:183]
v_exp_f32 v73, v73
v_mfma_f32_16x16x32_bf16 v[184:187], a[168:171], v[88:91], v[184:187]
ds_read_b128 a[132:135], v1 offset:17472
v_cvt_pk_bf16_f32 v84, v72, v73
v_mfma_f32_16x16x32_bf16 v[184:187], a[200:203], v[92:95], v[184:187]
v_exp_f32 v74, v74
v_mfma_f32_16x16x32_bf16 v[188:191], a[204:207], v[92:95], v[188:191]
ds_read_b128 a[128:131], v1 offset:17408
v_mfma_f32_16x16x32_bf16 v[188:191], a[172:175], v[88:91], v[188:191]
v_exp_f32 v75, v75
v_mfma_f32_16x16x32_bf16 a[216:219], a[228:231], v[88:91], a[216:219]
s_waitcnt lgkmcnt(8)
v_cvt_pk_bf16_f32 v85, v74, v75
v_mfma_f32_16x16x32_bf16 a[216:219], a[228:231], v[92:95], a[216:219]
v_exp_f32 v76, v76
v_mfma_f32_16x16x32_bf16 v[56:59], a[80:83], a[64:67], v[52:55]
v_mfma_f32_16x16x32_bf16 v[56:59], a[84:87], a[68:71], v[56:59]
v_exp_f32 v77, v77
v_mfma_f32_16x16x32_bf16 v[56:59], a[88:91], a[72:75], v[56:59]
v_cvt_pk_bf16_f32 v86, v76, v77
v_mfma_f32_16x16x32_bf16 v[56:59], a[92:95], a[76:79], v[56:59]
v_exp_f32 v78, v78
v_mfma_f32_16x16x32_bf16 v[60:63], a[108:111], a[76:79], v[52:55]
v_mfma_f32_16x16x32_bf16 v[60:63], a[104:107], a[72:75], v[60:63]
s_waitcnt vmcnt(3) lgkmcnt(0)
v_exp_f32 v79, v79
v_mfma_f32_16x16x32_bf16 v[60:63], a[100:103], a[68:71], v[60:63]
v_cvt_pk_bf16_f32 v87, v78, v79
v_mfma_f32_16x16x32_bf16 v[60:63], a[96:99], a[64:67], v[60:63]
s_barrier
v_mfma_f32_16x16x32_bf16 v[192:195], a[144:147], v[80:83], v[192:195]
ds_read_b64_tr_b16 a[144:145], v2 offset:25344
v_mfma_f32_16x16x32_bf16 v[192:195], a[176:179], v[84:87], v[192:195]
v_exp_f32 v56, v56
v_mfma_f32_16x16x32_bf16 v[196:199], a[180:183], v[84:87], v[196:199]
ds_read_b64_tr_b16 a[146:147], v2 offset:25856
v_mfma_f32_16x16x32_bf16 v[196:199], a[148:151], v[80:83], v[196:199]
ds_read_b64_tr_b16 a[148:149], v2 offset:25376
v_mfma_f32_16x16x32_bf16 v[200:203], a[152:155], v[80:83], v[200:203]
v_exp_f32 v57, v57
v_mfma_f32_16x16x32_bf16 v[200:203], a[184:187], v[84:87], v[200:203]
ds_read_b64_tr_b16 a[150:151], v2 offset:25888
v_cvt_pk_bf16_f32 v88, v56, v57
v_mfma_f32_16x16x32_bf16 v[204:207], a[188:191], v[84:87], v[204:207]
ds_read_b64_tr_b16 a[152:153], v2 offset:25408
v_mfma_f32_16x16x32_bf16 v[204:207], a[156:159], v[80:83], v[204:207]
v_exp_f32 v58, v58
v_mfma_f32_16x16x32_bf16 v[208:211], a[160:163], v[80:83], v[208:211]
ds_read_b64_tr_b16 a[154:155], v2 offset:25920
v_mfma_f32_16x16x32_bf16 v[208:211], a[192:195], v[84:87], v[208:211]
ds_read_b64_tr_b16 a[156:157], v2 offset:25440
v_mfma_f32_16x16x32_bf16 v[212:215], a[196:199], v[84:87], v[212:215]
v_exp_f32 v59, v59
v_mfma_f32_16x16x32_bf16 v[212:215], a[164:167], v[80:83], v[212:215]
ds_read_b64_tr_b16 a[158:159], v2 offset:25952
v_cvt_pk_bf16_f32 v89, v58, v59
v_mfma_f32_16x16x32_bf16 v[216:219], a[168:171], v[80:83], v[216:219]
ds_read_b64_tr_b16 a[160:161], v2 offset:25472
v_mfma_f32_16x16x32_bf16 v[216:219], a[200:203], v[84:87], v[216:219]
v_exp_f32 v60, v60
v_mfma_f32_16x16x32_bf16 v[220:223], a[204:207], v[84:87], v[220:223]
ds_read_b64_tr_b16 a[162:163], v2 offset:25984
v_mfma_f32_16x16x32_bf16 v[220:223], a[172:175], v[80:83], v[220:223]
ds_read_b64_tr_b16 a[164:165], v2 offset:25504
v_mfma_f32_16x16x32_bf16 a[220:223], a[228:231], v[80:83], a[220:223]
v_exp_f32 v61, v61
v_mfma_f32_16x16x32_bf16 a[220:223], a[228:231], v[84:87], a[220:223]
ds_read_b64_tr_b16 a[166:167], v2 offset:26016
v_cvt_pk_bf16_f32 v90, v60, v61
v_mfma_f32_16x16x32_bf16 v[64:67], a[80:83], a[0:3], v[36:39]
ds_read_b64_tr_b16 a[168:169], v2 offset:25536
v_mfma_f32_16x16x32_bf16 v[64:67], a[84:87], a[4:7], v[64:67]
v_exp_f32 v62, v62
v_mfma_f32_16x16x32_bf16 v[64:67], a[88:91], a[8:11], v[64:67]
ds_read_b64_tr_b16 a[170:171], v2 offset:26048
v_mfma_f32_16x16x32_bf16 v[64:67], a[92:95], a[12:15], v[64:67]
ds_read_b64_tr_b16 a[172:173], v2 offset:25568
v_mfma_f32_16x16x32_bf16 v[68:71], a[108:111], a[12:15], v[36:39]
v_exp_f32 v63, v63
v_mfma_f32_16x16x32_bf16 v[68:71], a[104:107], a[8:11], v[68:71]
ds_read_b64_tr_b16 a[174:175], v2 offset:26080
v_cvt_pk_bf16_f32 v91, v62, v63
v_mfma_f32_16x16x32_bf16 v[68:71], a[100:103], a[4:7], v[68:71]
ds_read_b64_tr_b16 a[176:177], v2 offset:16896
v_mfma_f32_16x16x32_bf16 v[68:71], a[96:99], a[0:3], v[68:71]
ds_read_b64_tr_b16 a[178:179], v2 offset:17408
v_mfma_f32_16x16x32_bf16 v[72:75], a[112:115], a[0:3], v[36:39]
v_exp_f32 v64, v64
v_mfma_f32_16x16x32_bf16 v[72:75], a[116:119], a[4:7], v[72:75]
ds_read_b64_tr_b16 a[180:181], v2 offset:16928
v_mfma_f32_16x16x32_bf16 v[72:75], a[120:123], a[8:11], v[72:75]
v_exp_f32 v65, v65
v_mfma_f32_16x16x32_bf16 v[72:75], a[124:127], a[12:15], v[72:75]
ds_read_b64_tr_b16 a[182:183], v2 offset:17440
v_cvt_pk_bf16_f32 v80, v64, v65
v_mfma_f32_16x16x32_bf16 v[76:79], a[140:143], a[12:15], v[36:39]
v_exp_f32 v66, v66
v_mfma_f32_16x16x32_bf16 v[76:79], a[136:139], a[8:11], v[76:79]
ds_read_b64_tr_b16 a[184:185], v2 offset:16960
v_mfma_f32_16x16x32_bf16 v[76:79], a[132:135], a[4:7], v[76:79]
s_waitcnt lgkmcnt(13)
v_exp_f32 v67, v67
v_mfma_f32_16x16x32_bf16 v[76:79], a[128:131], a[0:3], v[76:79]
ds_read_b64_tr_b16 a[186:187], v2 offset:17472
v_cvt_pk_bf16_f32 v81, v66, v67
v_mfma_f32_16x16x32_bf16 v[224:227], a[144:147], v[88:91], v[224:227]
v_exp_f32 v68, v68
v_mfma_f32_16x16x32_bf16 v[228:231], a[148:151], v[88:91], v[228:231]
ds_read_b64_tr_b16 a[188:189], v2 offset:16992
v_mfma_f32_16x16x32_bf16 v[232:235], a[152:155], v[88:91], v[232:235]
s_waitcnt lgkmcnt(7)
v_exp_f32 v69, v69
v_mfma_f32_16x16x32_bf16 v[236:239], a[156:159], v[88:91], v[236:239]
ds_read_b64_tr_b16 a[190:191], v2 offset:17504
v_cvt_pk_bf16_f32 v82, v68, v69
v_mfma_f32_16x16x32_bf16 v[240:243], a[160:163], v[88:91], v[240:243]
v_exp_f32 v70, v70
v_mfma_f32_16x16x32_bf16 v[244:247], a[164:167], v[88:91], v[244:247]
ds_read_b64_tr_b16 a[192:193], v2 offset:17024
v_mfma_f32_16x16x32_bf16 v[248:251], a[168:171], v[88:91], v[248:251]
v_exp_f32 v71, v71
v_mfma_f32_16x16x32_bf16 v[252:255], a[172:175], v[88:91], v[252:255]
ds_read_b64_tr_b16 a[194:195], v2 offset:17536
v_cvt_pk_bf16_f32 v83, v70, v71
v_mfma_f32_16x16x32_bf16 a[224:227], a[228:231], v[88:91], a[224:227]
v_exp_f32 v72, v72
v_mfma_f32_16x16x32_bf16 v[56:59], a[80:83], a[16:19], v[40:43]
ds_read_b64_tr_b16 a[196:197], v2 offset:17056
v_mfma_f32_16x16x32_bf16 v[56:59], a[84:87], a[20:23], v[56:59]
v_exp_f32 v73, v73
v_mfma_f32_16x16x32_bf16 v[56:59], a[88:91], a[24:27], v[56:59]
ds_read_b64_tr_b16 a[198:199], v2 offset:17568
v_cvt_pk_bf16_f32 v84, v72, v73
v_mfma_f32_16x16x32_bf16 v[56:59], a[92:95], a[28:31], v[56:59]
v_exp_f32 v74, v74
v_mfma_f32_16x16x32_bf16 v[60:63], a[108:111], a[28:31], v[40:43]
ds_read_b64_tr_b16 a[200:201], v2 offset:17088
v_accvgpr_read_b32 v32, a245
v_mfma_f32_16x16x32_bf16 v[60:63], a[104:107], a[24:27], v[60:63]
v_exp_f32 v75, v75
v_mfma_f32_16x16x32_bf16 v[60:63], a[100:103], a[20:23], v[60:63]
ds_read_b64_tr_b16 a[202:203], v2 offset:17600
v_cvt_pk_bf16_f32 v85, v74, v75
v_mfma_f32_16x16x32_bf16 v[60:63], a[96:99], a[16:19], v[60:63]
v_exp_f32 v76, v76
v_mfma_f32_16x16x32_bf16 v[64:67], a[112:115], a[16:19], v[40:43]
v_accvgpr_read_b32 v33, a247
v_accvgpr_read_b32 v11, a224
v_mfma_f32_16x16x32_bf16 v[64:67], a[116:119], a[20:23], v[64:67]
v_exp_f32 v77, v77
v_mfma_f32_16x16x32_bf16 v[64:67], a[120:123], a[24:27], v[64:67]
ds_read_b64_tr_b16 a[204:205], v2 offset:17120
v_cvt_pk_bf16_f32 v86, v76, v77
v_mfma_f32_16x16x32_bf16 v[64:67], a[124:127], a[28:31], v[64:67]
ds_write_b128 v32, v[224:227]
v_exp_f32 v78, v78
v_mfma_f32_16x16x32_bf16 v[68:71], a[140:143], a[28:31], v[40:43]
ds_write_b128 v32, v[228:231] offset:1024
v_mfma_f32_16x16x32_bf16 v[68:71], a[136:139], a[24:27], v[68:71]
v_exp_f32 v79, v79
v_mfma_f32_16x16x32_bf16 v[68:71], a[132:135], a[20:23], v[68:71]
ds_read_b64_tr_b16 a[206:207], v2 offset:17632
v_cvt_pk_bf16_f32 v87, v78, v79
v_mfma_f32_16x16x32_bf16 v[68:71], a[128:131], a[16:19], v[68:71]
ds_write_b128 v32, v[232:235] offset:2048
v_exp_f32 v56, v56
v_mfma_f32_16x16x32_bf16 a[208:211], a[228:231], v[80:83], a[208:211]
s_waitcnt lgkmcnt(11)
ds_write_b128 v32, v[236:239] offset:3072
v_mfma_f32_16x16x32_bf16 a[208:211], a[228:231], v[84:87], a[208:211]
ds_write_b32 v33, v11
v_exp_f32 v57, v57
v_accvgpr_read_b32 v32, a246
v_mfma_f32_16x16x32_bf16 v[96:99], a[144:147], v[80:83], v[96:99]
v_cvt_pk_bf16_f32 v88, v56, v57
v_accvgpr_read_b32 v33, a248
v_mfma_f32_16x16x32_bf16 v[96:99], a[176:179], v[84:87], v[96:99]
v_exp_f32 v58, v58
v_mfma_f32_16x16x32_bf16 v[100:103], a[180:183], v[84:87], v[100:103]
v_mfma_f32_16x16x32_bf16 v[100:103], a[148:151], v[80:83], v[100:103]
v_exp_f32 v59, v59
v_mfma_f32_16x16x32_bf16 v[104:107], a[152:155], v[80:83], v[104:107]
v_cvt_pk_bf16_f32 v89, v58, v59
v_accvgpr_read_b32 v10, a208
v_mfma_f32_16x16x32_bf16 v[104:107], a[184:187], v[84:87], v[104:107]
s_waitcnt lgkmcnt(0)
v_exp_f32 v60, v60
v_mfma_f32_16x16x32_bf16 v[108:111], a[188:191], v[84:87], v[108:111]
s_waitcnt lgkmcnt(3)
v_rcp_f32 v14, v10
v_mfma_f32_16x16x32_bf16 v[108:111], a[156:159], v[80:83], v[108:111]
s_barrier
v_exp_f32 v61, v61
v_mfma_f32_16x16x32_bf16 v[112:115], a[160:163], v[80:83], v[112:115]
ds_read_b32 v12, v33
v_cvt_pk_bf16_f32 v90, v60, v61
v_mfma_f32_16x16x32_bf16 v[112:115], a[192:195], v[84:87], v[112:115]
ds_read_b128 v[224:227], v32
ds_read_b128 v[228:231], v32 offset:1024
v_exp_f32 v62, v62
v_mfma_f32_16x16x32_bf16 v[116:119], a[196:199], v[84:87], v[116:119]
ds_read_b128 v[232:235], v32 offset:2048
ds_read_b128 v[236:239], v32 offset:3072
v_mfma_f32_16x16x32_bf16 v[116:119], a[164:167], v[80:83], v[116:119]
v_exp_f32 v63, v63
v_mfma_f32_16x16x32_bf16 v[120:123], a[168:171], v[80:83], v[120:123]
v_cvt_pk_bf16_f32 v91, v62, v63
v_accvgpr_read_b32 v32, a249
v_mfma_f32_16x16x32_bf16 v[120:123], a[200:203], v[84:87], v[120:123]
v_exp_f32 v64, v64
v_mfma_f32_16x16x32_bf16 v[124:127], a[204:207], v[84:87], v[124:127]
v_mfma_f32_16x16x32_bf16 v[124:127], a[172:175], v[80:83], v[124:127]
v_exp_f32 v65, v65
v_mfma_f32_16x16x32_bf16 v[72:75], a[80:83], a[32:35], v[44:47]
v_cvt_pk_bf16_f32 v92, v64, v65
v_add_f32 v5, v5, v10
v_mfma_f32_16x16x32_bf16 v[72:75], a[84:87], a[36:39], v[72:75]
v_exp_f32 v66, v66
v_mfma_f32_16x16x32_bf16 v[72:75], a[88:91], a[40:43], v[72:75]
v_mfma_f32_16x16x32_bf16 v[72:75], a[92:95], a[44:47], v[72:75]
v_exp_f32 v67, v67
v_add_f32 v5, v5, v14
v_pk_mul_f32 v[96:97], v[96:97], v[14:15] op_sel_hi:[1,0]
v_pk_mul_f32 v[98:99], v[98:99], v[14:15] op_sel_hi:[1,0]
v_pk_mul_f32 v[100:101], v[100:101], v[14:15] op_sel_hi:[1,0]
v_pk_mul_f32 v[102:103], v[102:103], v[14:15] op_sel_hi:[1,0]
v_pk_mul_f32 v[104:105], v[104:105], v[14:15] op_sel_hi:[1,0]
v_pk_mul_f32 v[106:107], v[106:107], v[14:15] op_sel_hi:[1,0]
v_pk_mul_f32 v[108:109], v[108:109], v[14:15] op_sel_hi:[1,0]
v_pk_mul_f32 v[110:111], v[110:111], v[14:15] op_sel_hi:[1,0]
v_pk_mul_f32 v[112:113], v[112:113], v[14:15] op_sel_hi:[1,0]
v_pk_mul_f32 v[114:115], v[114:115], v[14:15] op_sel_hi:[1,0]
v_pk_mul_f32 v[116:117], v[116:117], v[14:15] op_sel_hi:[1,0]
v_pk_mul_f32 v[118:119], v[118:119], v[14:15] op_sel_hi:[1,0]
v_pk_mul_f32 v[120:121], v[120:121], v[14:15] op_sel_hi:[1,0]
v_pk_mul_f32 v[122:123], v[122:123], v[14:15] op_sel_hi:[1,0]
v_pk_mul_f32 v[124:125], v[124:125], v[14:15] op_sel_hi:[1,0]
v_pk_mul_f32 v[126:127], v[126:127], v[14:15] op_sel_hi:[1,0]
v_cvt_pk_bf16_f32 v96, v96, v97
v_cvt_pk_bf16_f32 v97, v98, v99
v_cvt_pk_bf16_f32 v100, v100, v101
v_cvt_pk_bf16_f32 v101, v102, v103
v_cvt_pk_bf16_f32 v104, v104, v105
v_cvt_pk_bf16_f32 v105, v106, v107
v_cvt_pk_bf16_f32 v108, v108, v109
v_mfma_f32_16x16x32_bf16 v[76:79], a[108:111], a[44:47], v[44:47]
ds_write_b64 v7, v[96:97]
v_cvt_pk_bf16_f32 v93, v66, v67
v_cvt_pk_bf16_f32 v109, v110, v111
v_mfma_f32_16x16x32_bf16 v[76:79], a[104:107], a[40:43], v[76:79]
ds_write_b64 v7, v[100:101] offset:32
v_exp_f32 v68, v68
v_mfma_f32_16x16x32_bf16 v[76:79], a[100:103], a[36:39], v[76:79]
ds_write_b64 v7, v[104:105] offset:64
v_cvt_pk_bf16_f32 v112, v112, v113
v_cvt_pk_bf16_f32 v113, v114, v115
v_mfma_f32_16x16x32_bf16 v[76:79], a[96:99], a[32:35], v[76:79]
ds_write_b64 v7, v[108:109] offset:96
v_exp_f32 v69, v69
v_cvt_pk_bf16_f32 v116, v116, v117
v_cvt_pk_bf16_f32 v117, v118, v119
v_cvt_pk_bf16_f32 v120, v120, v121
v_mfma_f32_16x16x32_bf16 v[56:59], a[112:115], a[32:35], v[44:47]
ds_write_b64 v7, v[112:113] offset:128
v_cvt_pk_bf16_f32 v94, v68, v69
v_cvt_pk_bf16_f32 v121, v122, v123
v_mfma_f32_16x16x32_bf16 v[56:59], a[116:119], a[36:39], v[56:59]
ds_write_b64 v7, v[116:117] offset:160
v_exp_f32 v70, v70
v_mfma_f32_16x16x32_bf16 v[56:59], a[120:123], a[40:43], v[56:59]
ds_write_b64 v7, v[120:121] offset:192
v_cvt_pk_bf16_f32 v124, v124, v125
v_cvt_pk_bf16_f32 v125, v126, v127
v_mfma_f32_16x16x32_bf16 v[56:59], a[124:127], a[44:47], v[56:59]
s_waitcnt lgkmcnt(7)
v_exp_f32 v71, v71
v_mfma_f32_16x16x32_bf16 v[60:63], a[140:143], a[44:47], v[44:47]
v_exp_f32 v72, v72
v_mfma_f32_16x16x32_bf16 v[60:63], a[136:139], a[40:43], v[60:63]
v_cvt_pk_bf16_f32 v95, v70, v71
v_add_f32 v11, v11, v12
v_mfma_f32_16x16x32_bf16 v[60:63], a[132:135], a[36:39], v[60:63]
v_exp_f32 v73, v73
v_mfma_f32_16x16x32_bf16 v[60:63], a[128:131], a[32:35], v[60:63]
ds_write_b64 v7, v[124:125] offset:224
v_cvt_pk_bf16_f32 v80, v72, v73
v_rcp_f32 v14, v11
v_add_f32 v5, v5, v11
v_add_f32 v5, v5, v14
v_pk_add_f32 v[240:241], v[240:241], v[224:225]
v_pk_add_f32 v[242:243], v[242:243], v[226:227]
v_pk_add_f32 v[244:245], v[244:245], v[228:229]
v_pk_add_f32 v[246:247], v[246:247], v[230:231]
v_pk_add_f32 v[248:249], v[248:249], v[232:233]
v_pk_add_f32 v[250:251], v[250:251], v[234:235]
v_pk_add_f32 v[252:253], v[252:253], v[236:237]
v_pk_add_f32 v[254:255], v[254:255], v[238:239]
v_pk_mul_f32 v[240:241], v[240:241], v[14:15] op_sel_hi:[1,0]
v_pk_mul_f32 v[242:243], v[242:243], v[14:15] op_sel_hi:[1,0]
v_pk_mul_f32 v[244:245], v[244:245], v[14:15] op_sel_hi:[1,0]
v_pk_mul_f32 v[246:247], v[246:247], v[14:15] op_sel_hi:[1,0]
v_pk_mul_f32 v[248:249], v[248:249], v[14:15] op_sel_hi:[1,0]
v_pk_mul_f32 v[250:251], v[250:251], v[14:15] op_sel_hi:[1,0]
v_pk_mul_f32 v[252:253], v[252:253], v[14:15] op_sel_hi:[1,0]
v_pk_mul_f32 v[254:255], v[254:255], v[14:15] op_sel_hi:[1,0]
v_mfma_f32_16x16x32_bf16 a[212:215], a[228:231], v[88:91], a[212:215]
v_exp_f32 v74, v74
v_mfma_f32_16x16x32_bf16 a[212:215], a[228:231], v[92:95], a[212:215]
ds_read_b128 v[96:99], v8
ds_read_b128 v[100:103], v8 offset:1056
ds_read_b128 v[104:107], v8 offset:2112
ds_read_b128 v[108:111], v8 offset:3168
v_cvt_pk_bf16_f32 v240, v240, v241
v_cvt_pk_bf16_f32 v241, v242, v243
v_mfma_f32_16x16x32_bf16 v[128:131], a[144:147], v[88:91], v[128:131]
v_exp_f32 v75, v75
v_mfma_f32_16x16x32_bf16 v[128:131], a[176:179], v[92:95], v[128:131]
ds_write_b64 v32, v[240:241]
v_cvt_pk_bf16_f32 v81, v74, v75
v_cvt_pk_bf16_f32 v244, v244, v245
v_mfma_f32_16x16x32_bf16 v[132:135], a[180:183], v[92:95], v[132:135]
v_exp_f32 v76, v76
v_mfma_f32_16x16x32_bf16 v[132:135], a[148:151], v[88:91], v[132:135]
v_cvt_pk_bf16_f32 v245, v246, v247
v_cvt_pk_bf16_f32 v248, v248, v249
v_mfma_f32_16x16x32_bf16 v[136:139], a[152:155], v[88:91], v[136:139]
v_exp_f32 v77, v77
v_mfma_f32_16x16x32_bf16 v[136:139], a[184:187], v[92:95], v[136:139]
ds_write_b64 v32, v[244:245] offset:32
v_cvt_pk_bf16_f32 v82, v76, v77
v_cvt_pk_bf16_f32 v249, v250, v251
v_mfma_f32_16x16x32_bf16 v[140:143], a[188:191], v[92:95], v[140:143]
s_waitcnt lgkmcnt(5)
v_exp_f32 v78, v78
v_mfma_f32_16x16x32_bf16 v[140:143], a[156:159], v[88:91], v[140:143]
buffer_store_dwordx4 v[96:99], v9, s[28:31], s42 offen sc0 sc1
ds_write_b64 v32, v[248:249] offset:64
v_cvt_pk_bf16_f32 v252, v252, v253
v_cvt_pk_bf16_f32 v253, v254, v255
v_mfma_f32_16x16x32_bf16 v[144:147], a[160:163], v[88:91], v[144:147]
s_waitcnt lgkmcnt(5)
v_exp_f32 v79, v79
v_mfma_f32_16x16x32_bf16 v[144:147], a[192:195], v[92:95], v[144:147]
buffer_store_dwordx4 v[100:103], v9, s[28:31], s42 offen offset:1024 sc0 sc1
v_cvt_pk_bf16_f32 v83, v78, v79
v_accvgpr_read_b32 v10, a212
v_mfma_f32_16x16x32_bf16 v[148:151], a[196:199], v[92:95], v[148:151]
s_waitcnt lgkmcnt(4)
v_exp_f32 v56, v56
v_mfma_f32_16x16x32_bf16 v[148:151], a[164:167], v[88:91], v[148:151]
buffer_store_dwordx4 v[104:107], v9, s[28:31], s42 offen offset:2048 sc0 sc1
ds_write_b64 v32, v[252:253] offset:96
v_mfma_f32_16x16x32_bf16 v[152:155], a[168:171], v[88:91], v[152:155]
s_waitcnt lgkmcnt(4)
v_exp_f32 v57, v57
v_mfma_f32_16x16x32_bf16 v[152:155], a[200:203], v[92:95], v[152:155]
buffer_store_dwordx4 v[108:111], v9, s[28:31], s42 offen offset:3072 sc0 sc1
v_cvt_pk_bf16_f32 v84, v56, v57
v_accvgpr_read_b32 v32, a250
v_accvgpr_read_b32 v33, a251
v_mfma_f32_16x16x32_bf16 v[156:159], a[204:207], v[92:95], v[156:159]
v_exp_f32 v58, v58
v_mfma_f32_16x16x32_bf16 v[156:159], a[172:175], v[88:91], v[156:159]
ds_read_b128 v[224:227], v32
ds_read_b128 v[228:231], v32 offset:4224
v_mfma_f32_16x16x32_bf16 v[64:67], a[80:83], a[48:51], v[48:51]
v_exp_f32 v59, v59
v_mfma_f32_16x16x32_bf16 v[64:67], a[84:87], a[52:55], v[64:67]
v_cvt_pk_bf16_f32 v85, v58, v59
v_mfma_f32_16x16x32_bf16 v[64:67], a[88:91], a[56:59], v[64:67]
v_exp_f32 v60, v60
v_mfma_f32_16x16x32_bf16 v[64:67], a[92:95], a[60:63], v[64:67]
v_rcp_f32 v14, v10
v_add_f32 v5, v5, v10
v_add_f32 v5, v5, v14
v_pk_mul_f32 v[128:129], v[128:129], v[14:15] op_sel_hi:[1,0]
v_pk_mul_f32 v[130:131], v[130:131], v[14:15] op_sel_hi:[1,0]
v_pk_mul_f32 v[132:133], v[132:133], v[14:15] op_sel_hi:[1,0]
v_pk_mul_f32 v[134:135], v[134:135], v[14:15] op_sel_hi:[1,0]
v_pk_mul_f32 v[136:137], v[136:137], v[14:15] op_sel_hi:[1,0]
v_pk_mul_f32 v[138:139], v[138:139], v[14:15] op_sel_hi:[1,0]
v_pk_mul_f32 v[140:141], v[140:141], v[14:15] op_sel_hi:[1,0]
v_pk_mul_f32 v[142:143], v[142:143], v[14:15] op_sel_hi:[1,0]
v_pk_mul_f32 v[144:145], v[144:145], v[14:15] op_sel_hi:[1,0]
v_pk_mul_f32 v[146:147], v[146:147], v[14:15] op_sel_hi:[1,0]
v_pk_mul_f32 v[148:149], v[148:149], v[14:15] op_sel_hi:[1,0]
v_pk_mul_f32 v[150:151], v[150:151], v[14:15] op_sel_hi:[1,0]
v_pk_mul_f32 v[152:153], v[152:153], v[14:15] op_sel_hi:[1,0]
v_pk_mul_f32 v[154:155], v[154:155], v[14:15] op_sel_hi:[1,0]
v_pk_mul_f32 v[156:157], v[156:157], v[14:15] op_sel_hi:[1,0]
v_pk_mul_f32 v[158:159], v[158:159], v[14:15] op_sel_hi:[1,0]
v_cvt_pk_bf16_f32 v128, v128, v129
v_cvt_pk_bf16_f32 v129, v130, v131
v_cvt_pk_bf16_f32 v132, v132, v133
v_cvt_pk_bf16_f32 v133, v134, v135
v_cvt_pk_bf16_f32 v136, v136, v137
v_mfma_f32_16x16x32_bf16 v[68:71], a[108:111], a[60:63], v[48:51]
ds_write_b64 v7, v[128:129] offset:512
v_exp_f32 v61, v61
v_mfma_f32_16x16x32_bf16 v[68:71], a[104:107], a[56:59], v[68:71]
ds_write_b64 v7, v[132:133] offset:544
v_cvt_pk_bf16_f32 v86, v60, v61
v_cvt_pk_bf16_f32 v137, v138, v139
v_mfma_f32_16x16x32_bf16 v[68:71], a[100:103], a[52:55], v[68:71]
s_waitcnt lgkmcnt(3)
v_exp_f32 v62, v62
v_mfma_f32_16x16x32_bf16 v[68:71], a[96:99], a[48:51], v[68:71]
buffer_store_dwordx4 v[224:227], v33, s[28:31], s43 offen sc0 sc1
ds_write_b64 v7, v[136:137] offset:576
v_cvt_pk_bf16_f32 v140, v140, v141
v_cvt_pk_bf16_f32 v141, v142, v143
v_cvt_pk_bf16_f32 v144, v144, v145
v_cvt_pk_bf16_f32 v145, v146, v147
v_cvt_pk_bf16_f32 v148, v148, v149
v_cvt_pk_bf16_f32 v149, v150, v151
v_cvt_pk_bf16_f32 v152, v152, v153
v_mfma_f32_16x16x32_bf16 v[72:75], a[112:115], a[48:51], v[48:51]
ds_write_b64 v7, v[140:141] offset:608
v_exp_f32 v63, v63
v_mfma_f32_16x16x32_bf16 v[72:75], a[116:119], a[52:55], v[72:75]
s_add_u32 s43, s43, 4096
v_exp_f32 v64, v64
v_mfma_f32_16x16x32_bf16 v[72:75], a[120:123], a[56:59], v[72:75]
s_waitcnt lgkmcnt(4)
v_cvt_pk_bf16_f32 v87, v62, v63
v_cvt_pk_bf16_f32 v153, v154, v155
v_mfma_f32_16x16x32_bf16 v[72:75], a[124:127], a[60:63], v[72:75]
buffer_store_dwordx4 v[228:231], v33, s[28:31], s43 offen sc0 sc1
ds_write_b64 v7, v[144:145] offset:640
v_exp_f32 v65, v65
v_mfma_f32_16x16x32_bf16 v[76:79], a[140:143], a[60:63], v[48:51]
v_exp_f32 v66, v66
v_mfma_f32_16x16x32_bf16 v[76:79], a[136:139], a[56:59], v[76:79]
v_exp_f32 v67, v67
v_mfma_f32_16x16x32_bf16 v[76:79], a[132:135], a[52:55], v[76:79]
v_cvt_pk_bf16_f32 v88, v64, v65
v_cvt_pk_bf16_f32 v89, v66, v67
v_mfma_f32_16x16x32_bf16 v[76:79], a[128:131], a[48:51], v[76:79]
ds_write_b64 v7, v[148:149] offset:672
v_exp_f32 v68, v68
v_mfma_f32_16x16x32_bf16 a[216:219], a[228:231], v[80:83], a[216:219]
v_exp_f32 v69, v69
v_mfma_f32_16x16x32_bf16 a[216:219], a[228:231], v[84:87], a[216:219]
ds_write_b64 v7, v[152:153] offset:704
v_cvt_pk_bf16_f32 v156, v156, v157
v_cvt_pk_bf16_f32 v157, v158, v159
v_mfma_f32_16x16x32_bf16 v[160:163], a[144:147], v[80:83], v[160:163]
v_exp_f32 v70, v70
v_mfma_f32_16x16x32_bf16 v[160:163], a[176:179], v[84:87], v[160:163]
ds_write_b64 v7, v[156:157] offset:736
v_exp_f32 v71, v71
v_mfma_f32_16x16x32_bf16 v[164:167], a[180:183], v[84:87], v[164:167]
v_cvt_pk_bf16_f32 v90, v68, v69
v_cvt_pk_bf16_f32 v91, v70, v71
v_mfma_f32_16x16x32_bf16 v[164:167], a[148:151], v[80:83], v[164:167]
ds_read_b128 v[128:131], v8 offset:512
ds_read_b128 v[132:135], v8 offset:1568
v_exp_f32 v72, v72
v_mfma_f32_16x16x32_bf16 v[168:171], a[152:155], v[80:83], v[168:171]
v_exp_f32 v73, v73
v_mfma_f32_16x16x32_bf16 v[168:171], a[184:187], v[84:87], v[168:171]
ds_read_b128 v[136:139], v8 offset:2624
ds_read_b128 v[140:143], v8 offset:3680
v_mfma_f32_16x16x32_bf16 v[172:175], a[188:191], v[84:87], v[172:175]
v_exp_f32 v74, v74
v_mfma_f32_16x16x32_bf16 v[172:175], a[156:159], v[80:83], v[172:175]
v_exp_f32 v75, v75
v_mfma_f32_16x16x32_bf16 v[176:179], a[160:163], v[80:83], v[176:179]
v_cvt_pk_bf16_f32 v92, v72, v73
v_cvt_pk_bf16_f32 v93, v74, v75
v_mfma_f32_16x16x32_bf16 v[176:179], a[192:195], v[84:87], v[176:179]
v_exp_f32 v76, v76
v_mfma_f32_16x16x32_bf16 v[180:183], a[196:199], v[84:87], v[180:183]
v_exp_f32 v77, v77
v_mfma_f32_16x16x32_bf16 v[180:183], a[164:167], v[80:83], v[180:183]
v_exp_f32 v78, v78
v_mfma_f32_16x16x32_bf16 v[184:187], a[168:171], v[80:83], v[184:187]
s_waitcnt lgkmcnt(3)
v_exp_f32 v79, v79
v_mfma_f32_16x16x32_bf16 v[184:187], a[200:203], v[84:87], v[184:187]
buffer_store_dwordx4 v[128:131], v9, s[28:31], s42 offen offset:512 sc0 sc1
v_cvt_pk_bf16_f32 v94, v76, v77
v_cvt_pk_bf16_f32 v95, v78, v79
v_mfma_f32_16x16x32_bf16 v[188:191], a[204:207], v[84:87], v[188:191]
s_waitcnt lgkmcnt(2)
v_mfma_f32_16x16x32_bf16 v[188:191], a[172:175], v[80:83], v[188:191]
buffer_store_dwordx4 v[132:135], v9, s[28:31], s42 offen offset:1536 sc0 sc1
v_mfma_f32_16x16x32_bf16 a[220:223], a[228:231], v[88:91], a[220:223]
s_waitcnt lgkmcnt(1)
v_mfma_f32_16x16x32_bf16 a[220:223], a[228:231], v[92:95], a[220:223]
v_mfma_f32_16x16x32_bf16 v[192:195], a[144:147], v[88:91], v[192:195]
v_mfma_f32_16x16x32_bf16 v[192:195], a[176:179], v[92:95], v[192:195]
buffer_store_dwordx4 v[136:139], v9, s[28:31], s42 offen offset:2560 sc0 sc1
v_accvgpr_read_b32 v10, a216
v_rcp_f32 v14, v10
v_add_f32 v5, v5, v10
v_add_f32 v5, v5, v14
v_pk_mul_f32 v[160:161], v[160:161], v[14:15] op_sel_hi:[1,0]
v_pk_mul_f32 v[162:163], v[162:163], v[14:15] op_sel_hi:[1,0]
v_pk_mul_f32 v[164:165], v[164:165], v[14:15] op_sel_hi:[1,0]
v_pk_mul_f32 v[166:167], v[166:167], v[14:15] op_sel_hi:[1,0]
v_pk_mul_f32 v[168:169], v[168:169], v[14:15] op_sel_hi:[1,0]
v_pk_mul_f32 v[170:171], v[170:171], v[14:15] op_sel_hi:[1,0]
v_pk_mul_f32 v[172:173], v[172:173], v[14:15] op_sel_hi:[1,0]
v_pk_mul_f32 v[174:175], v[174:175], v[14:15] op_sel_hi:[1,0]
v_pk_mul_f32 v[176:177], v[176:177], v[14:15] op_sel_hi:[1,0]
v_pk_mul_f32 v[178:179], v[178:179], v[14:15] op_sel_hi:[1,0]
v_pk_mul_f32 v[180:181], v[180:181], v[14:15] op_sel_hi:[1,0]
v_pk_mul_f32 v[182:183], v[182:183], v[14:15] op_sel_hi:[1,0]
v_pk_mul_f32 v[184:185], v[184:185], v[14:15] op_sel_hi:[1,0]
v_pk_mul_f32 v[186:187], v[186:187], v[14:15] op_sel_hi:[1,0]
v_pk_mul_f32 v[188:189], v[188:189], v[14:15] op_sel_hi:[1,0]
v_pk_mul_f32 v[190:191], v[190:191], v[14:15] op_sel_hi:[1,0]
v_cvt_pk_bf16_f32 v160, v160, v161
v_cvt_pk_bf16_f32 v161, v162, v163
v_cvt_pk_bf16_f32 v164, v164, v165
v_cvt_pk_bf16_f32 v165, v166, v167
v_mfma_f32_16x16x32_bf16 v[196:199], a[180:183], v[92:95], v[196:199]
ds_write_b64 v7, v[160:161] offset:8448
ds_write_b64 v7, v[164:165] offset:8480
v_cvt_pk_bf16_f32 v168, v168, v169
v_cvt_pk_bf16_f32 v169, v170, v171
v_mfma_f32_16x16x32_bf16 v[196:199], a[148:151], v[88:91], v[196:199]
ds_write_b64 v7, v[168:169] offset:8512
v_cvt_pk_bf16_f32 v172, v172, v173
v_cvt_pk_bf16_f32 v173, v174, v175
v_cvt_pk_bf16_f32 v176, v176, v177
v_cvt_pk_bf16_f32 v177, v178, v179
v_cvt_pk_bf16_f32 v180, v180, v181
v_cvt_pk_bf16_f32 v181, v182, v183
v_cvt_pk_bf16_f32 v184, v184, v185
v_cvt_pk_bf16_f32 v185, v186, v187
v_cvt_pk_bf16_f32 v188, v188, v189
v_cvt_pk_bf16_f32 v189, v190, v191
v_accvgpr_read_b32 v10, a220
v_mfma_f32_16x16x32_bf16 v[200:203], a[152:155], v[88:91], v[200:203]
ds_write_b64 v7, v[172:173] offset:8544
ds_write_b64 v7, v[176:177] offset:8576
v_rcp_f32 v14, v10
v_mfma_f32_16x16x32_bf16 v[200:203], a[184:187], v[92:95], v[200:203]
ds_write_b64 v7, v[180:181] offset:8608
v_add_f32 v5, v5, v10
v_add_f32 v5, v5, v14
v_mfma_f32_16x16x32_bf16 v[204:207], a[188:191], v[92:95], v[204:207]
ds_write_b64 v7, v[184:185] offset:8640
v_mul_f32 v192, v14, v192
v_mul_f32 v193, v14, v193
v_mfma_f32_16x16x32_bf16 v[204:207], a[156:159], v[88:91], v[204:207]
ds_write_b64 v7, v[188:189] offset:8672
v_mul_f32 v194, v14, v194
v_mul_f32 v195, v14, v195
v_mfma_f32_16x16x32_bf16 v[208:211], a[160:163], v[88:91], v[208:211]
s_waitcnt lgkmcnt(8)
v_cvt_pk_bf16_f32 v192, v192, v193
v_cvt_pk_bf16_f32 v193, v194, v195
v_mfma_f32_16x16x32_bf16 v[208:211], a[192:195], v[92:95], v[208:211]
buffer_store_dwordx4 v[140:143], v9, s[28:31], s42 offen offset:3584 sc0 sc1
ds_read_b128 v[160:163], v8 offset:8448
ds_read_b128 v[164:167], v8 offset:9504
ds_read_b128 v[168:171], v8 offset:10560
ds_read_b128 v[172:175], v8 offset:11616
ds_write_b64 v7, v[192:193] offset:8960
v_mul_f32 v196, v14, v196
v_mul_f32 v197, v14, v197
v_mfma_f32_16x16x32_bf16 v[212:215], a[196:199], v[92:95], v[212:215]
s_add_u32 s42, s42, 8192
v_mul_f32 v198, v14, v198
v_mul_f32 v199, v14, v199
v_mfma_f32_16x16x32_bf16 v[212:215], a[164:167], v[88:91], v[212:215]
v_cvt_pk_bf16_f32 v196, v196, v197
v_cvt_pk_bf16_f32 v197, v198, v199
v_mfma_f32_16x16x32_bf16 v[216:219], a[168:171], v[88:91], v[216:219]
v_mul_f32 v200, v14, v200
v_mul_f32 v201, v14, v201
v_mfma_f32_16x16x32_bf16 v[216:219], a[200:203], v[92:95], v[216:219]
ds_write_b64 v7, v[196:197] offset:8992
v_mul_f32 v202, v14, v202
v_mul_f32 v203, v14, v203
v_mfma_f32_16x16x32_bf16 v[220:223], a[204:207], v[92:95], v[220:223]
v_cvt_pk_bf16_f32 v200, v200, v201
v_cvt_pk_bf16_f32 v201, v202, v203
v_mfma_f32_16x16x32_bf16 v[220:223], a[172:175], v[88:91], v[220:223]
s_waitcnt lgkmcnt(5)
buffer_store_dwordx4 v[160:163], v9, s[28:31], s42 offen sc0 sc1
ds_write_b64 v7, v[200:201] offset:9024
L_tail:
v_accvgpr_read_b32 v34, a252
v_cmp_nge_f32 vcc, s40, v5
s_waitcnt lgkmcnt(5)
buffer_store_dwordx4 v[164:167], v9, s[28:31], s42 offen offset:1024 sc0 sc1
v_pk_mul_f32 v[204:205], v[204:205], v[14:15] op_sel_hi:[1,0]
v_pk_mul_f32 v[206:207], v[206:207], v[14:15] op_sel_hi:[1,0]
v_cvt_pk_bf16_f32 v204, v204, v205
v_cvt_pk_bf16_f32 v205, v206, v207
ds_write_b64 v7, v[204:205] offset:9056
v_pk_mul_f32 v[208:209], v[208:209], v[14:15] op_sel_hi:[1,0]
v_pk_mul_f32 v[210:211], v[210:211], v[14:15] op_sel_hi:[1,0]
v_cvt_pk_bf16_f32 v208, v208, v209
v_cvt_pk_bf16_f32 v209, v210, v211
ds_write_b64 v7, v[208:209] offset:9088
v_pk_mul_f32 v[212:213], v[212:213], v[14:15] op_sel_hi:[1,0]
v_pk_mul_f32 v[214:215], v[214:215], v[14:15] op_sel_hi:[1,0]
v_cvt_pk_bf16_f32 v212, v212, v213
v_cvt_pk_bf16_f32 v213, v214, v215
ds_write_b64 v7, v[212:213] offset:9120
v_pk_mul_f32 v[216:217], v[216:217], v[14:15] op_sel_hi:[1,0]
v_pk_mul_f32 v[218:219], v[218:219], v[14:15] op_sel_hi:[1,0]
v_cvt_pk_bf16_f32 v216, v216, v217
v_cvt_pk_bf16_f32 v217, v218, v219
ds_write_b64 v7, v[216:217] offset:9152
v_pk_mul_f32 v[220:221], v[220:221], v[14:15] op_sel_hi:[1,0]
v_pk_mul_f32 v[222:223], v[222:223], v[14:15] op_sel_hi:[1,0]
v_cvt_pk_bf16_f32 v220, v220, v221
v_cvt_pk_bf16_f32 v221, v222, v223
ds_write_b64 v7, v[220:221] offset:9184
ds_read_b128 v[192:195], v8 offset:8960
ds_read_b128 v[196:199], v8 offset:10016
ds_read_b128 v[200:203], v8 offset:11072
ds_read_b128 v[204:207], v8 offset:12128
s_waitcnt lgkmcnt(13)
buffer_store_dwordx4 v[168:171], v9, s[28:31], s42 offen offset:2048 sc0 sc1
s_waitcnt lgkmcnt(12)
buffer_store_dwordx4 v[172:175], v9, s[28:31], s42 offen offset:3072 sc0 sc1
s_or_b32 s48, vcc_lo, vcc_hi
v_mov_b32 v10, s48
ds_write_b32 v34, v10
s_waitcnt lgkmcnt(4)
buffer_store_dwordx4 v[192:195], v9, s[28:31], s42 offen offset:512 sc0 sc1
s_waitcnt lgkmcnt(3)
buffer_store_dwordx4 v[196:199], v9, s[28:31], s42 offen offset:1536 sc0 sc1
s_waitcnt lgkmcnt(2)
buffer_store_dwordx4 v[200:203], v9, s[28:31], s42 offen offset:2560 sc0 sc1
s_waitcnt lgkmcnt(1)
buffer_store_dwordx4 v[204:207], v9, s[28:31], s42 offen offset:3584 sc0 sc1
v_mov_b32 v10, 161792
s_waitcnt lgkmcnt(0)
s_barrier
ds_read_b128 v[80:83], v10
s_waitcnt lgkmcnt(0)
v_or3_b32 v80, v80, v81, v82
v_or_b32 v80, v80, v83
s_nop 0
v_readfirstlane_b32 s48, v80
s_nop 3
s_and_b32 s48, s48, s41
s_cbranch_scc1 L_fallback
L_end:
s_endpgm
L_fallback:
s_waitcnt vmcnt(0) lgkmcnt(0)
s_barrier
s_mov_b32 s41, 0
v_and_b32 v16, 63, v0
v_lshrrev_b32 v17, 4, v16
v_and_b32 v18, 7, v16
v_bfe_u32 v19, v16, 3, 1
v_lshl_add_u32 v18, v18, 2, v19
v_lshlrev_b32 v18, 8, v18
v_lshl_add_u32 v18, v17, 4, v18
v_and_b32 v19, 15, v16
v_lshlrev_b32 v19, 8, v19
v_lshl_add_u32 v19, v17, 4, v19
s_mov_b32 s52, s4
s_mov_b32 s53, s5
s_mov_b32 s54, 37748736
s_mov_b32 s55, 0x20000
s_mov_b64 s[12:13], s[6:7]
s_mov_b32 s14, 134217728
s_lshl_b32 s48, s3, 14
s_add_u32 s48, s48, 0
s_add_u32 s48, s48, s56
buffer_load_dwordx4 v[96:99], v18, s[52:55], s48 offen
buffer_load_dwordx4 v[100:103], v18, s[52:55], s48 offen offset:64
buffer_load_dwordx4 v[104:107], v18, s[52:55], s48 offen offset:128
buffer_load_dwordx4 v[108:111], v18, s[52:55], s48 offen offset:192
s_lshl_b32 s48, s3, 14
s_add_u32 s48, s48, 512
s_add_u32 s48, s48, s56
buffer_load_dwordx4 v[112:115], v18, s[52:55], s48 offen
buffer_load_dwordx4 v[116:119], v18, s[52:55], s48 offen offset:64
buffer_load_dwordx4 v[120:123], v18, s[52:55], s48 offen offset:128
buffer_load_dwordx4 v[124:127], v18, s[52:55], s48 offen offset:192
s_lshl_b32 s48, s3, 14
s_add_u32 s48, s48, 8192
s_add_u32 s48, s48, s56
buffer_load_dwordx4 v[128:131], v18, s[52:55], s48 offen
buffer_load_dwordx4 v[132:135], v18, s[52:55], s48 offen offset:64
buffer_load_dwordx4 v[136:139], v18, s[52:55], s48 offen offset:128
buffer_load_dwordx4 v[140:143], v18, s[52:55], s48 offen offset:192
s_lshl_b32 s48, s3, 14
s_add_u32 s48, s48, 8704
s_add_u32 s48, s48, s56
buffer_load_dwordx4 v[144:147], v18, s[52:55], s48 offen
buffer_load_dwordx4 v[148:151], v18, s[52:55], s48 offen offset:64
buffer_load_dwordx4 v[152:155], v18, s[52:55], s48 offen offset:128
buffer_load_dwordx4 v[156:159], v18, s[52:55], s48 offen offset:192
s_bfe_u32 s48, s3, 0x10000
s_lshl_b32 s48, s48, 9
s_add_u32 s48, s48, 65536
s_add_u32 s48, s48, s56
buffer_load_dwordx4 v[160:163], v18, s[52:55], s48 offen
buffer_load_dwordx4 v[164:167], v18, s[52:55], s48 offen offset:64
buffer_load_dwordx4 v[168:171], v18, s[52:55], s48 offen offset:128
buffer_load_dwordx4 v[172:175], v18, s[52:55], s48 offen offset:192
s_waitcnt vmcnt(0)
v_lshlrev_b32 v32, 16, v96
v_and_b32 v33, s45, v96
v_pk_mul_f32 v[32:33], v[32:33], s[38:39]
v_cvt_pk_bf16_f32 v96, v32, v33
v_lshlrev_b32 v34, 16, v97
v_and_b32 v35, s45, v97
v_pk_mul_f32 v[34:35], v[34:35], s[38:39]
v_cvt_pk_bf16_f32 v97, v34, v35
v_lshlrev_b32 v32, 16, v98
v_and_b32 v33, s45, v98
v_pk_mul_f32 v[32:33], v[32:33], s[38:39]
v_cvt_pk_bf16_f32 v98, v32, v33
v_lshlrev_b32 v34, 16, v99
v_and_b32 v35, s45, v99
v_pk_mul_f32 v[34:35], v[34:35], s[38:39]
v_cvt_pk_bf16_f32 v99, v34, v35
v_lshlrev_b32 v32, 16, v100
v_and_b32 v33, s45, v100
v_pk_mul_f32 v[32:33], v[32:33], s[38:39]
v_cvt_pk_bf16_f32 v100, v32, v33
v_lshlrev_b32 v34, 16, v101
v_and_b32 v35, s45, v101
v_pk_mul_f32 v[34:35], v[34:35], s[38:39]
v_cvt_pk_bf16_f32 v101, v34, v35
v_lshlrev_b32 v32, 16, v102
v_and_b32 v33, s45, v102
v_pk_mul_f32 v[32:33], v[32:33], s[38:39]
v_cvt_pk_bf16_f32 v102, v32, v33
v_lshlrev_b32 v34, 16, v103
v_and_b32 v35, s45, v103
v_pk_mul_f32 v[34:35], v[34:35], s[38:39]
v_cvt_pk_bf16_f32 v103, v34, v35
v_lshlrev_b32 v32, 16, v104
v_and_b32 v33, s45, v104
v_pk_mul_f32 v[32:33], v[32:33], s[38:39]
v_cvt_pk_bf16_f32 v104, v32, v33
v_lshlrev_b32 v34, 16, v105
v_and_b32 v35, s45, v105
v_pk_mul_f32 v[34:35], v[34:35], s[38:39]
v_cvt_pk_bf16_f32 v105, v34, v35
v_lshlrev_b32 v32, 16, v106
v_and_b32 v33, s45, v106
v_pk_mul_f32 v[32:33], v[32:33], s[38:39]
v_cvt_pk_bf16_f32 v106, v32, v33
v_lshlrev_b32 v34, 16, v107
v_and_b32 v35, s45, v107
v_pk_mul_f32 v[34:35], v[34:35], s[38:39]
v_cvt_pk_bf16_f32 v107, v34, v35
v_lshlrev_b32 v32, 16, v108
v_and_b32 v33, s45, v108
v_pk_mul_f32 v[32:33], v[32:33], s[38:39]
v_cvt_pk_bf16_f32 v108, v32, v33
v_lshlrev_b32 v34, 16, v109
v_and_b32 v35, s45, v109
v_pk_mul_f32 v[34:35], v[34:35], s[38:39]
v_cvt_pk_bf16_f32 v109, v34, v35
v_lshlrev_b32 v32, 16, v110
v_and_b32 v33, s45, v110
v_pk_mul_f32 v[32:33], v[32:33], s[38:39]
v_cvt_pk_bf16_f32 v110, v32, v33
v_lshlrev_b32 v34, 16, v111
v_and_b32 v35, s45, v111
v_pk_mul_f32 v[34:35], v[34:35], s[38:39]
v_cvt_pk_bf16_f32 v111, v34, v35
v_lshlrev_b32 v32, 16, v112
v_and_b32 v33, s45, v112
v_pk_mul_f32 v[32:33], v[32:33], s[38:39]
v_cvt_pk_bf16_f32 v112, v32, v33
v_lshlrev_b32 v34, 16, v113
v_and_b32 v35, s45, v113
v_pk_mul_f32 v[34:35], v[34:35], s[38:39]
v_cvt_pk_bf16_f32 v113, v34, v35
v_lshlrev_b32 v32, 16, v114
v_and_b32 v33, s45, v114
v_pk_mul_f32 v[32:33], v[32:33], s[38:39]
v_cvt_pk_bf16_f32 v114, v32, v33
v_lshlrev_b32 v34, 16, v115
v_and_b32 v35, s45, v115
v_pk_mul_f32 v[34:35], v[34:35], s[38:39]
v_cvt_pk_bf16_f32 v115, v34, v35
v_lshlrev_b32 v32, 16, v116
v_and_b32 v33, s45, v116
v_pk_mul_f32 v[32:33], v[32:33], s[38:39]
v_cvt_pk_bf16_f32 v116, v32, v33
v_lshlrev_b32 v34, 16, v117
v_and_b32 v35, s45, v117
v_pk_mul_f32 v[34:35], v[34:35], s[38:39]
v_cvt_pk_bf16_f32 v117, v34, v35
v_lshlrev_b32 v32, 16, v118
v_and_b32 v33, s45, v118
v_pk_mul_f32 v[32:33], v[32:33], s[38:39]
v_cvt_pk_bf16_f32 v118, v32, v33
v_lshlrev_b32 v34, 16, v119
v_and_b32 v35, s45, v119
v_pk_mul_f32 v[34:35], v[34:35], s[38:39]
v_cvt_pk_bf16_f32 v119, v34, v35
v_lshlrev_b32 v32, 16, v120
v_and_b32 v33, s45, v120
v_pk_mul_f32 v[32:33], v[32:33], s[38:39]
v_cvt_pk_bf16_f32 v120, v32, v33
v_lshlrev_b32 v34, 16, v121
v_and_b32 v35, s45, v121
v_pk_mul_f32 v[34:35], v[34:35], s[38:39]
v_cvt_pk_bf16_f32 v121, v34, v35
v_lshlrev_b32 v32, 16, v122
v_and_b32 v33, s45, v122
v_pk_mul_f32 v[32:33], v[32:33], s[38:39]
v_cvt_pk_bf16_f32 v122, v32, v33
v_lshlrev_b32 v34, 16, v123
v_and_b32 v35, s45, v123
v_pk_mul_f32 v[34:35], v[34:35], s[38:39]
v_cvt_pk_bf16_f32 v123, v34, v35
v_lshlrev_b32 v32, 16, v124
v_and_b32 v33, s45, v124
v_pk_mul_f32 v[32:33], v[32:33], s[38:39]
v_cvt_pk_bf16_f32 v124, v32, v33
v_lshlrev_b32 v34, 16, v125
v_and_b32 v35, s45, v125
v_pk_mul_f32 v[34:35], v[34:35], s[38:39]
v_cvt_pk_bf16_f32 v125, v34, v35
v_lshlrev_b32 v32, 16, v126
v_and_b32 v33, s45, v126
v_pk_mul_f32 v[32:33], v[32:33], s[38:39]
v_cvt_pk_bf16_f32 v126, v32, v33
v_lshlrev_b32 v34, 16, v127
v_and_b32 v35, s45, v127
v_pk_mul_f32 v[34:35], v[34:35], s[38:39]
v_cvt_pk_bf16_f32 v127, v34, v35
v_lshlrev_b32 v32, 16, v128
v_and_b32 v33, s45, v128
v_pk_mul_f32 v[32:33], v[32:33], s[38:39]
v_cvt_pk_bf16_f32 v128, v32, v33
v_lshlrev_b32 v34, 16, v129
v_and_b32 v35, s45, v129
v_pk_mul_f32 v[34:35], v[34:35], s[38:39]
v_cvt_pk_bf16_f32 v129, v34, v35
v_lshlrev_b32 v32, 16, v130
v_and_b32 v33, s45, v130
v_pk_mul_f32 v[32:33], v[32:33], s[38:39]
v_cvt_pk_bf16_f32 v130, v32, v33
v_lshlrev_b32 v34, 16, v131
v_and_b32 v35, s45, v131
v_pk_mul_f32 v[34:35], v[34:35], s[38:39]
v_cvt_pk_bf16_f32 v131, v34, v35
v_lshlrev_b32 v32, 16, v132
v_and_b32 v33, s45, v132
v_pk_mul_f32 v[32:33], v[32:33], s[38:39]
v_cvt_pk_bf16_f32 v132, v32, v33
v_lshlrev_b32 v34, 16, v133
v_and_b32 v35, s45, v133
v_pk_mul_f32 v[34:35], v[34:35], s[38:39]
v_cvt_pk_bf16_f32 v133, v34, v35
v_lshlrev_b32 v32, 16, v134
v_and_b32 v33, s45, v134
v_pk_mul_f32 v[32:33], v[32:33], s[38:39]
v_cvt_pk_bf16_f32 v134, v32, v33
v_lshlrev_b32 v34, 16, v135
v_and_b32 v35, s45, v135
v_pk_mul_f32 v[34:35], v[34:35], s[38:39]
v_cvt_pk_bf16_f32 v135, v34, v35
v_lshlrev_b32 v32, 16, v136
v_and_b32 v33, s45, v136
v_pk_mul_f32 v[32:33], v[32:33], s[38:39]
v_cvt_pk_bf16_f32 v136, v32, v33
v_lshlrev_b32 v34, 16, v137
v_and_b32 v35, s45, v137
v_pk_mul_f32 v[34:35], v[34:35], s[38:39]
v_cvt_pk_bf16_f32 v137, v34, v35
v_lshlrev_b32 v32, 16, v138
v_and_b32 v33, s45, v138
v_pk_mul_f32 v[32:33], v[32:33], s[38:39]
v_cvt_pk_bf16_f32 v138, v32, v33
v_lshlrev_b32 v34, 16, v139
v_and_b32 v35, s45, v139
v_pk_mul_f32 v[34:35], v[34:35], s[38:39]
v_cvt_pk_bf16_f32 v139, v34, v35
v_lshlrev_b32 v32, 16, v140
v_and_b32 v33, s45, v140
v_pk_mul_f32 v[32:33], v[32:33], s[38:39]
v_cvt_pk_bf16_f32 v140, v32, v33
v_lshlrev_b32 v34, 16, v141
v_and_b32 v35, s45, v141
v_pk_mul_f32 v[34:35], v[34:35], s[38:39]
v_cvt_pk_bf16_f32 v141, v34, v35
v_lshlrev_b32 v32, 16, v142
v_and_b32 v33, s45, v142
v_pk_mul_f32 v[32:33], v[32:33], s[38:39]
v_cvt_pk_bf16_f32 v142, v32, v33
v_lshlrev_b32 v34, 16, v143
v_and_b32 v35, s45, v143
v_pk_mul_f32 v[34:35], v[34:35], s[38:39]
v_cvt_pk_bf16_f32 v143, v34, v35
v_lshlrev_b32 v32, 16, v144
v_and_b32 v33, s45, v144
v_pk_mul_f32 v[32:33], v[32:33], s[38:39]
v_cvt_pk_bf16_f32 v144, v32, v33
v_lshlrev_b32 v34, 16, v145
v_and_b32 v35, s45, v145
v_pk_mul_f32 v[34:35], v[34:35], s[38:39]
v_cvt_pk_bf16_f32 v145, v34, v35
v_lshlrev_b32 v32, 16, v146
v_and_b32 v33, s45, v146
v_pk_mul_f32 v[32:33], v[32:33], s[38:39]
v_cvt_pk_bf16_f32 v146, v32, v33
v_lshlrev_b32 v34, 16, v147
v_and_b32 v35, s45, v147
v_pk_mul_f32 v[34:35], v[34:35], s[38:39]
v_cvt_pk_bf16_f32 v147, v34, v35
v_lshlrev_b32 v32, 16, v148
v_and_b32 v33, s45, v148
v_pk_mul_f32 v[32:33], v[32:33], s[38:39]
v_cvt_pk_bf16_f32 v148, v32, v33
v_lshlrev_b32 v34, 16, v149
v_and_b32 v35, s45, v149
v_pk_mul_f32 v[34:35], v[34:35], s[38:39]
v_cvt_pk_bf16_f32 v149, v34, v35
v_lshlrev_b32 v32, 16, v150
v_and_b32 v33, s45, v150
v_pk_mul_f32 v[32:33], v[32:33], s[38:39]
v_cvt_pk_bf16_f32 v150, v32, v33
v_lshlrev_b32 v34, 16, v151
v_and_b32 v35, s45, v151
v_pk_mul_f32 v[34:35], v[34:35], s[38:39]
v_cvt_pk_bf16_f32 v151, v34, v35
v_lshlrev_b32 v32, 16, v152
v_and_b32 v33, s45, v152
v_pk_mul_f32 v[32:33], v[32:33], s[38:39]
v_cvt_pk_bf16_f32 v152, v32, v33
v_lshlrev_b32 v34, 16, v153
v_and_b32 v35, s45, v153
v_pk_mul_f32 v[34:35], v[34:35], s[38:39]
v_cvt_pk_bf16_f32 v153, v34, v35
v_lshlrev_b32 v32, 16, v154
v_and_b32 v33, s45, v154
v_pk_mul_f32 v[32:33], v[32:33], s[38:39]
v_cvt_pk_bf16_f32 v154, v32, v33
v_lshlrev_b32 v34, 16, v155
v_and_b32 v35, s45, v155
v_pk_mul_f32 v[34:35], v[34:35], s[38:39]
v_cvt_pk_bf16_f32 v155, v34, v35
v_lshlrev_b32 v32, 16, v156
v_and_b32 v33, s45, v156
v_pk_mul_f32 v[32:33], v[32:33], s[38:39]
v_cvt_pk_bf16_f32 v156, v32, v33
v_lshlrev_b32 v34, 16, v157
v_and_b32 v35, s45, v157
v_pk_mul_f32 v[34:35], v[34:35], s[38:39]
v_cvt_pk_bf16_f32 v157, v34, v35
v_lshlrev_b32 v32, 16, v158
v_and_b32 v33, s45, v158
v_pk_mul_f32 v[32:33], v[32:33], s[38:39]
v_cvt_pk_bf16_f32 v158, v32, v33
v_lshlrev_b32 v34, 16, v159
v_and_b32 v35, s45, v159
v_pk_mul_f32 v[34:35], v[34:35], s[38:39]
v_cvt_pk_bf16_f32 v159, v34, v35
v_lshlrev_b32 v32, 16, v160
v_and_b32 v33, s45, v160
v_pk_mul_f32 v[32:33], v[32:33], s[38:39]
v_cvt_pk_bf16_f32 v160, v32, v33
v_lshlrev_b32 v34, 16, v161
v_and_b32 v35, s45, v161
v_pk_mul_f32 v[34:35], v[34:35], s[38:39]
v_cvt_pk_bf16_f32 v161, v34, v35
v_lshlrev_b32 v32, 16, v162
v_and_b32 v33, s45, v162
v_pk_mul_f32 v[32:33], v[32:33], s[38:39]
v_cvt_pk_bf16_f32 v162, v32, v33
v_lshlrev_b32 v34, 16, v163
v_and_b32 v35, s45, v163
v_pk_mul_f32 v[34:35], v[34:35], s[38:39]
v_cvt_pk_bf16_f32 v163, v34, v35
v_lshlrev_b32 v32, 16, v164
v_and_b32 v33, s45, v164
v_pk_mul_f32 v[32:33], v[32:33], s[38:39]
v_cvt_pk_bf16_f32 v164, v32, v33
v_lshlrev_b32 v34, 16, v165
v_and_b32 v35, s45, v165
v_pk_mul_f32 v[34:35], v[34:35], s[38:39]
v_cvt_pk_bf16_f32 v165, v34, v35
v_lshlrev_b32 v32, 16, v166
v_and_b32 v33, s45, v166
v_pk_mul_f32 v[32:33], v[32:33], s[38:39]
v_cvt_pk_bf16_f32 v166, v32, v33
v_lshlrev_b32 v34, 16, v167
v_and_b32 v35, s45, v167
v_pk_mul_f32 v[34:35], v[34:35], s[38:39]
v_cvt_pk_bf16_f32 v167, v34, v35
v_lshlrev_b32 v32, 16, v168
v_and_b32 v33, s45, v168
v_pk_mul_f32 v[32:33], v[32:33], s[38:39]
v_cvt_pk_bf16_f32 v168, v32, v33
v_lshlrev_b32 v34, 16, v169
v_and_b32 v35, s45, v169
v_pk_mul_f32 v[34:35], v[34:35], s[38:39]
v_cvt_pk_bf16_f32 v169, v34, v35
v_lshlrev_b32 v32, 16, v170
v_and_b32 v33, s45, v170
v_pk_mul_f32 v[32:33], v[32:33], s[38:39]
v_cvt_pk_bf16_f32 v170, v32, v33
v_lshlrev_b32 v34, 16, v171
v_and_b32 v35, s45, v171
v_pk_mul_f32 v[34:35], v[34:35], s[38:39]
v_cvt_pk_bf16_f32 v171, v34, v35
v_lshlrev_b32 v32, 16, v172
v_and_b32 v33, s45, v172
v_pk_mul_f32 v[32:33], v[32:33], s[38:39]
v_cvt_pk_bf16_f32 v172, v32, v33
v_lshlrev_b32 v34, 16, v173
v_and_b32 v35, s45, v173
v_pk_mul_f32 v[34:35], v[34:35], s[38:39]
v_cvt_pk_bf16_f32 v173, v34, v35
v_lshlrev_b32 v32, 16, v174
v_and_b32 v33, s45, v174
v_pk_mul_f32 v[32:33], v[32:33], s[38:39]
v_cvt_pk_bf16_f32 v174, v32, v33
v_lshlrev_b32 v34, 16, v175
v_and_b32 v35, s45, v175
v_pk_mul_f32 v[34:35], v[34:35], s[38:39]
v_cvt_pk_bf16_f32 v175, v34, v35
v_mov_b32 v36, 0xff800000
v_mov_b32 v37, 0xff800000
v_mov_b32 v38, 0xff800000
v_mov_b32 v39, 0xff800000
v_mov_b32 v40, 0xff800000
s_add_u32 s48, s57, 0
s_mov_b32 s49, 64
L_fb0:
buffer_load_dwordx4 v[56:59], v19, s[12:15], s48 offen
buffer_load_dwordx4 v[60:63], v19, s[12:15], s48 offen offset:64
buffer_load_dwordx4 v[64:67], v19, s[12:15], s48 offen offset:128
buffer_load_dwordx4 v[68:71], v19, s[12:15], s48 offen offset:192
s_waitcnt vmcnt(0)
v_mfma_f32_16x16x32_bf16 v[192:195], v[56:59], v[96:99], 0
v_mfma_f32_16x16x32_bf16 v[192:195], v[60:63], v[100:103], v[192:195]
v_mfma_f32_16x16x32_bf16 v[192:195], v[64:67], v[104:107], v[192:195]
v_mfma_f32_16x16x32_bf16 v[192:195], v[68:71], v[108:111], v[192:195]
v_mfma_f32_16x16x32_bf16 v[196:199], v[56:59], v[112:115], 0
v_mfma_f32_16x16x32_bf16 v[196:199], v[60:63], v[116:119], v[196:199]
v_mfma_f32_16x16x32_bf16 v[196:199], v[64:67], v[120:123], v[196:199]
v_mfma_f32_16x16x32_bf16 v[196:199], v[68:71], v[124:127], v[196:199]
v_mfma_f32_16x16x32_bf16 v[200:203], v[56:59], v[128:131], 0
v_mfma_f32_16x16x32_bf16 v[200:203], v[60:63], v[132:135], v[200:203]
v_mfma_f32_16x16x32_bf16 v[200:203], v[64:67], v[136:139], v[200:203]
v_mfma_f32_16x16x32_bf16 v[200:203], v[68:71], v[140:143], v[200:203]
v_mfma_f32_16x16x32_bf16 v[204:207], v[56:59], v[144:147], 0
v_mfma_f32_16x16x32_bf16 v[204:207], v[60:63], v[148:151], v[204:207]
v_mfma_f32_16x16x32_bf16 v[204:207], v[64:67], v[152:155], v[204:207]
v_mfma_f32_16x16x32_bf16 v[204:207], v[68:71], v[156:159], v[204:207]
v_mfma_f32_16x16x32_bf16 v[208:211], v[56:59], v[160:163], 0
v_mfma_f32_16x16x32_bf16 v[208:211], v[60:63], v[164:167], v[208:211]
v_mfma_f32_16x16x32_bf16 v[208:211], v[64:67], v[168:171], v[208:211]
v_mfma_f32_16x16x32_bf16 v[208:211], v[68:71], v[172:175], v[208:211]
s_nop 7
s_nop 1
v_max3_f32 v36, v36, v192, v193
v_max3_f32 v36, v36, v194, v195
v_max3_f32 v37, v37, v196, v197
v_max3_f32 v37, v37, v198, v199
v_max3_f32 v38, v38, v200, v201
v_max3_f32 v38, v38, v202, v203
v_max3_f32 v39, v39, v204, v205
v_max3_f32 v39, v39, v206, v207
v_max3_f32 v40, v40, v208, v209
v_max3_f32 v40, v40, v210, v211
s_add_u32 s48, s48, 4096
s_sub_u32 s49, s49, 1
s_cmp_lg_u32 s49, 0
s_cbranch_scc1 L_fb0
v_xor_b32 v20, 16, v16
v_lshlrev_b32 v20, 2, v20
ds_bpermute_b32 v56, v20, v36
ds_bpermute_b32 v57, v20, v37
ds_bpermute_b32 v58, v20, v38
ds_bpermute_b32 v59, v20, v39
ds_bpermute_b32 v60, v20, v40
s_waitcnt lgkmcnt(0)
v_max_f32 v36, v36, v56
v_max_f32 v37, v37, v57
v_max_f32 v38, v38, v58
v_max_f32 v39, v39, v59
v_max_f32 v40, v40, v60
v_xor_b32 v20, 32, v16
v_lshlrev_b32 v20, 2, v20
ds_bpermute_b32 v56, v20, v36
ds_bpermute_b32 v57, v20, v37
ds_bpermute_b32 v58, v20, v38
ds_bpermute_b32 v59, v20, v39
ds_bpermute_b32 v60, v20, v40
s_waitcnt lgkmcnt(0)
v_max_f32 v36, v36, v56
v_max_f32 v37, v37, v57
v_max_f32 v38, v38, v58
v_max_f32 v39, v39, v59
v_max_f32 v40, v40, v60
v_xor_b32 v36, 0x80000000, v36
v_xor_b32 v37, 0x80000000, v37
v_xor_b32 v38, 0x80000000, v38
v_xor_b32 v39, 0x80000000, v39
v_xor_b32 v40, 0x80000000, v40
v_accvgpr_write_b32 a232, v36
v_accvgpr_write_b32 a233, v37
v_accvgpr_write_b32 a234, v38
v_accvgpr_write_b32 a235, v39
v_accvgpr_write_b32 a236, v40
s_lshl_b32 s48, s3, 14
s_add_u32 s48, s48, 18874368
s_add_u32 s48, s48, s56
buffer_load_dwordx4 v[96:99], v18, s[52:55], s48 offen
buffer_load_dwordx4 v[100:103], v18, s[52:55], s48 offen offset:64
buffer_load_dwordx4 v[104:107], v18, s[52:55], s48 offen offset:128
buffer_load_dwordx4 v[108:111], v18, s[52:55], s48 offen offset:192
s_lshl_b32 s48, s3, 14
s_add_u32 s48, s48, 18874880
s_add_u32 s48, s48, s56
buffer_load_dwordx4 v[112:115], v18, s[52:55], s48 offen
buffer_load_dwordx4 v[116:119], v18, s[52:55], s48 offen offset:64
buffer_load_dwordx4 v[120:123], v18, s[52:55], s48 offen offset:128
buffer_load_dwordx4 v[124:127], v18, s[52:55], s48 offen offset:192
s_lshl_b32 s48, s3, 14
s_add_u32 s48, s48, 18882560
s_add_u32 s48, s48, s56
buffer_load_dwordx4 v[128:131], v18, s[52:55], s48 offen
buffer_load_dwordx4 v[132:135], v18, s[52:55], s48 offen offset:64
buffer_load_dwordx4 v[136:139], v18, s[52:55], s48 offen offset:128
buffer_load_dwordx4 v[140:143], v18, s[52:55], s48 offen offset:192
s_lshl_b32 s48, s3, 14
s_add_u32 s48, s48, 18883072
s_add_u32 s48, s48, s56
buffer_load_dwordx4 v[144:147], v18, s[52:55], s48 offen
buffer_load_dwordx4 v[148:151], v18, s[52:55], s48 offen offset:64
buffer_load_dwordx4 v[152:155], v18, s[52:55], s48 offen offset:128
buffer_load_dwordx4 v[156:159], v18, s[52:55], s48 offen offset:192
s_bfe_u32 s48, s3, 0x10000
s_lshl_b32 s48, s48, 9
s_add_u32 s48, s48, 18939904
s_add_u32 s48, s48, s56
buffer_load_dwordx4 v[160:163], v18, s[52:55], s48 offen
buffer_load_dwordx4 v[164:167], v18, s[52:55], s48 offen offset:64
buffer_load_dwordx4 v[168:171], v18, s[52:55], s48 offen offset:128
buffer_load_dwordx4 v[172:175], v18, s[52:55], s48 offen offset:192
s_waitcnt vmcnt(0)
v_lshlrev_b32 v32, 16, v96
v_and_b32 v33, s45, v96
v_pk_mul_f32 v[32:33], v[32:33], s[38:39]
v_cvt_pk_bf16_f32 v96, v32, v33
v_lshlrev_b32 v34, 16, v97
v_and_b32 v35, s45, v97
v_pk_mul_f32 v[34:35], v[34:35], s[38:39]
v_cvt_pk_bf16_f32 v97, v34, v35
v_lshlrev_b32 v32, 16, v98
v_and_b32 v33, s45, v98
v_pk_mul_f32 v[32:33], v[32:33], s[38:39]
v_cvt_pk_bf16_f32 v98, v32, v33
v_lshlrev_b32 v34, 16, v99
v_and_b32 v35, s45, v99
v_pk_mul_f32 v[34:35], v[34:35], s[38:39]
v_cvt_pk_bf16_f32 v99, v34, v35
v_lshlrev_b32 v32, 16, v100
v_and_b32 v33, s45, v100
v_pk_mul_f32 v[32:33], v[32:33], s[38:39]
v_cvt_pk_bf16_f32 v100, v32, v33
v_lshlrev_b32 v34, 16, v101
v_and_b32 v35, s45, v101
v_pk_mul_f32 v[34:35], v[34:35], s[38:39]
v_cvt_pk_bf16_f32 v101, v34, v35
v_lshlrev_b32 v32, 16, v102
v_and_b32 v33, s45, v102
v_pk_mul_f32 v[32:33], v[32:33], s[38:39]
v_cvt_pk_bf16_f32 v102, v32, v33
v_lshlrev_b32 v34, 16, v103
v_and_b32 v35, s45, v103
v_pk_mul_f32 v[34:35], v[34:35], s[38:39]
v_cvt_pk_bf16_f32 v103, v34, v35
v_lshlrev_b32 v32, 16, v104
v_and_b32 v33, s45, v104
v_pk_mul_f32 v[32:33], v[32:33], s[38:39]
v_cvt_pk_bf16_f32 v104, v32, v33
v_lshlrev_b32 v34, 16, v105
v_and_b32 v35, s45, v105
v_pk_mul_f32 v[34:35], v[34:35], s[38:39]
v_cvt_pk_bf16_f32 v105, v34, v35
v_lshlrev_b32 v32, 16, v106
v_and_b32 v33, s45, v106
v_pk_mul_f32 v[32:33], v[32:33], s[38:39]
v_cvt_pk_bf16_f32 v106, v32, v33
v_lshlrev_b32 v34, 16, v107
v_and_b32 v35, s45, v107
v_pk_mul_f32 v[34:35], v[34:35], s[38:39]
v_cvt_pk_bf16_f32 v107, v34, v35
v_lshlrev_b32 v32, 16, v108
v_and_b32 v33, s45, v108
v_pk_mul_f32 v[32:33], v[32:33], s[38:39]
v_cvt_pk_bf16_f32 v108, v32, v33
v_lshlrev_b32 v34, 16, v109
v_and_b32 v35, s45, v109
v_pk_mul_f32 v[34:35], v[34:35], s[38:39]
v_cvt_pk_bf16_f32 v109, v34, v35
v_lshlrev_b32 v32, 16, v110
v_and_b32 v33, s45, v110
v_pk_mul_f32 v[32:33], v[32:33], s[38:39]
v_cvt_pk_bf16_f32 v110, v32, v33
v_lshlrev_b32 v34, 16, v111
v_and_b32 v35, s45, v111
v_pk_mul_f32 v[34:35], v[34:35], s[38:39]
v_cvt_pk_bf16_f32 v111, v34, v35
v_lshlrev_b32 v32, 16, v112
v_and_b32 v33, s45, v112
v_pk_mul_f32 v[32:33], v[32:33], s[38:39]
v_cvt_pk_bf16_f32 v112, v32, v33
v_lshlrev_b32 v34, 16, v113
v_and_b32 v35, s45, v113
v_pk_mul_f32 v[34:35], v[34:35], s[38:39]
v_cvt_pk_bf16_f32 v113, v34, v35
v_lshlrev_b32 v32, 16, v114
v_and_b32 v33, s45, v114
v_pk_mul_f32 v[32:33], v[32:33], s[38:39]
v_cvt_pk_bf16_f32 v114, v32, v33
v_lshlrev_b32 v34, 16, v115
v_and_b32 v35, s45, v115
v_pk_mul_f32 v[34:35], v[34:35], s[38:39]
v_cvt_pk_bf16_f32 v115, v34, v35
v_lshlrev_b32 v32, 16, v116
v_and_b32 v33, s45, v116
v_pk_mul_f32 v[32:33], v[32:33], s[38:39]
v_cvt_pk_bf16_f32 v116, v32, v33
v_lshlrev_b32 v34, 16, v117
v_and_b32 v35, s45, v117
v_pk_mul_f32 v[34:35], v[34:35], s[38:39]
v_cvt_pk_bf16_f32 v117, v34, v35
v_lshlrev_b32 v32, 16, v118
v_and_b32 v33, s45, v118
v_pk_mul_f32 v[32:33], v[32:33], s[38:39]
v_cvt_pk_bf16_f32 v118, v32, v33
v_lshlrev_b32 v34, 16, v119
v_and_b32 v35, s45, v119
v_pk_mul_f32 v[34:35], v[34:35], s[38:39]
v_cvt_pk_bf16_f32 v119, v34, v35
v_lshlrev_b32 v32, 16, v120
v_and_b32 v33, s45, v120
v_pk_mul_f32 v[32:33], v[32:33], s[38:39]
v_cvt_pk_bf16_f32 v120, v32, v33
v_lshlrev_b32 v34, 16, v121
v_and_b32 v35, s45, v121
v_pk_mul_f32 v[34:35], v[34:35], s[38:39]
v_cvt_pk_bf16_f32 v121, v34, v35
v_lshlrev_b32 v32, 16, v122
v_and_b32 v33, s45, v122
v_pk_mul_f32 v[32:33], v[32:33], s[38:39]
v_cvt_pk_bf16_f32 v122, v32, v33
v_lshlrev_b32 v34, 16, v123
v_and_b32 v35, s45, v123
v_pk_mul_f32 v[34:35], v[34:35], s[38:39]
v_cvt_pk_bf16_f32 v123, v34, v35
v_lshlrev_b32 v32, 16, v124
v_and_b32 v33, s45, v124
v_pk_mul_f32 v[32:33], v[32:33], s[38:39]
v_cvt_pk_bf16_f32 v124, v32, v33
v_lshlrev_b32 v34, 16, v125
v_and_b32 v35, s45, v125
v_pk_mul_f32 v[34:35], v[34:35], s[38:39]
v_cvt_pk_bf16_f32 v125, v34, v35
v_lshlrev_b32 v32, 16, v126
v_and_b32 v33, s45, v126
v_pk_mul_f32 v[32:33], v[32:33], s[38:39]
v_cvt_pk_bf16_f32 v126, v32, v33
v_lshlrev_b32 v34, 16, v127
v_and_b32 v35, s45, v127
v_pk_mul_f32 v[34:35], v[34:35], s[38:39]
v_cvt_pk_bf16_f32 v127, v34, v35
v_lshlrev_b32 v32, 16, v128
v_and_b32 v33, s45, v128
v_pk_mul_f32 v[32:33], v[32:33], s[38:39]
v_cvt_pk_bf16_f32 v128, v32, v33
v_lshlrev_b32 v34, 16, v129
v_and_b32 v35, s45, v129
v_pk_mul_f32 v[34:35], v[34:35], s[38:39]
v_cvt_pk_bf16_f32 v129, v34, v35
v_lshlrev_b32 v32, 16, v130
v_and_b32 v33, s45, v130
v_pk_mul_f32 v[32:33], v[32:33], s[38:39]
v_cvt_pk_bf16_f32 v130, v32, v33
v_lshlrev_b32 v34, 16, v131
v_and_b32 v35, s45, v131
v_pk_mul_f32 v[34:35], v[34:35], s[38:39]
v_cvt_pk_bf16_f32 v131, v34, v35
v_lshlrev_b32 v32, 16, v132
v_and_b32 v33, s45, v132
v_pk_mul_f32 v[32:33], v[32:33], s[38:39]
v_cvt_pk_bf16_f32 v132, v32, v33
v_lshlrev_b32 v34, 16, v133
v_and_b32 v35, s45, v133
v_pk_mul_f32 v[34:35], v[34:35], s[38:39]
v_cvt_pk_bf16_f32 v133, v34, v35
v_lshlrev_b32 v32, 16, v134
v_and_b32 v33, s45, v134
v_pk_mul_f32 v[32:33], v[32:33], s[38:39]
v_cvt_pk_bf16_f32 v134, v32, v33
v_lshlrev_b32 v34, 16, v135
v_and_b32 v35, s45, v135
v_pk_mul_f32 v[34:35], v[34:35], s[38:39]
v_cvt_pk_bf16_f32 v135, v34, v35
v_lshlrev_b32 v32, 16, v136
v_and_b32 v33, s45, v136
v_pk_mul_f32 v[32:33], v[32:33], s[38:39]
v_cvt_pk_bf16_f32 v136, v32, v33
v_lshlrev_b32 v34, 16, v137
v_and_b32 v35, s45, v137
v_pk_mul_f32 v[34:35], v[34:35], s[38:39]
v_cvt_pk_bf16_f32 v137, v34, v35
v_lshlrev_b32 v32, 16, v138
v_and_b32 v33, s45, v138
v_pk_mul_f32 v[32:33], v[32:33], s[38:39]
v_cvt_pk_bf16_f32 v138, v32, v33
v_lshlrev_b32 v34, 16, v139
v_and_b32 v35, s45, v139
v_pk_mul_f32 v[34:35], v[34:35], s[38:39]
v_cvt_pk_bf16_f32 v139, v34, v35
v_lshlrev_b32 v32, 16, v140
v_and_b32 v33, s45, v140
v_pk_mul_f32 v[32:33], v[32:33], s[38:39]
v_cvt_pk_bf16_f32 v140, v32, v33
v_lshlrev_b32 v34, 16, v141
v_and_b32 v35, s45, v141
v_pk_mul_f32 v[34:35], v[34:35], s[38:39]
v_cvt_pk_bf16_f32 v141, v34, v35
v_lshlrev_b32 v32, 16, v142
v_and_b32 v33, s45, v142
v_pk_mul_f32 v[32:33], v[32:33], s[38:39]
v_cvt_pk_bf16_f32 v142, v32, v33
v_lshlrev_b32 v34, 16, v143
v_and_b32 v35, s45, v143
v_pk_mul_f32 v[34:35], v[34:35], s[38:39]
v_cvt_pk_bf16_f32 v143, v34, v35
v_lshlrev_b32 v32, 16, v144
v_and_b32 v33, s45, v144
v_pk_mul_f32 v[32:33], v[32:33], s[38:39]
v_cvt_pk_bf16_f32 v144, v32, v33
v_lshlrev_b32 v34, 16, v145
v_and_b32 v35, s45, v145
v_pk_mul_f32 v[34:35], v[34:35], s[38:39]
v_cvt_pk_bf16_f32 v145, v34, v35
v_lshlrev_b32 v32, 16, v146
v_and_b32 v33, s45, v146
v_pk_mul_f32 v[32:33], v[32:33], s[38:39]
v_cvt_pk_bf16_f32 v146, v32, v33
v_lshlrev_b32 v34, 16, v147
v_and_b32 v35, s45, v147
v_pk_mul_f32 v[34:35], v[34:35], s[38:39]
v_cvt_pk_bf16_f32 v147, v34, v35
v_lshlrev_b32 v32, 16, v148
v_and_b32 v33, s45, v148
v_pk_mul_f32 v[32:33], v[32:33], s[38:39]
v_cvt_pk_bf16_f32 v148, v32, v33
v_lshlrev_b32 v34, 16, v149
v_and_b32 v35, s45, v149
v_pk_mul_f32 v[34:35], v[34:35], s[38:39]
v_cvt_pk_bf16_f32 v149, v34, v35
v_lshlrev_b32 v32, 16, v150
v_and_b32 v33, s45, v150
v_pk_mul_f32 v[32:33], v[32:33], s[38:39]
v_cvt_pk_bf16_f32 v150, v32, v33
v_lshlrev_b32 v34, 16, v151
v_and_b32 v35, s45, v151
v_pk_mul_f32 v[34:35], v[34:35], s[38:39]
v_cvt_pk_bf16_f32 v151, v34, v35
v_lshlrev_b32 v32, 16, v152
v_and_b32 v33, s45, v152
v_pk_mul_f32 v[32:33], v[32:33], s[38:39]
v_cvt_pk_bf16_f32 v152, v32, v33
v_lshlrev_b32 v34, 16, v153
v_and_b32 v35, s45, v153
v_pk_mul_f32 v[34:35], v[34:35], s[38:39]
v_cvt_pk_bf16_f32 v153, v34, v35
v_lshlrev_b32 v32, 16, v154
v_and_b32 v33, s45, v154
v_pk_mul_f32 v[32:33], v[32:33], s[38:39]
v_cvt_pk_bf16_f32 v154, v32, v33
v_lshlrev_b32 v34, 16, v155
v_and_b32 v35, s45, v155
v_pk_mul_f32 v[34:35], v[34:35], s[38:39]
v_cvt_pk_bf16_f32 v155, v34, v35
v_lshlrev_b32 v32, 16, v156
v_and_b32 v33, s45, v156
v_pk_mul_f32 v[32:33], v[32:33], s[38:39]
v_cvt_pk_bf16_f32 v156, v32, v33
v_lshlrev_b32 v34, 16, v157
v_and_b32 v35, s45, v157
v_pk_mul_f32 v[34:35], v[34:35], s[38:39]
v_cvt_pk_bf16_f32 v157, v34, v35
v_lshlrev_b32 v32, 16, v158
v_and_b32 v33, s45, v158
v_pk_mul_f32 v[32:33], v[32:33], s[38:39]
v_cvt_pk_bf16_f32 v158, v32, v33
v_lshlrev_b32 v34, 16, v159
v_and_b32 v35, s45, v159
v_pk_mul_f32 v[34:35], v[34:35], s[38:39]
v_cvt_pk_bf16_f32 v159, v34, v35
v_lshlrev_b32 v32, 16, v160
v_and_b32 v33, s45, v160
v_pk_mul_f32 v[32:33], v[32:33], s[38:39]
v_cvt_pk_bf16_f32 v160, v32, v33
v_lshlrev_b32 v34, 16, v161
v_and_b32 v35, s45, v161
v_pk_mul_f32 v[34:35], v[34:35], s[38:39]
v_cvt_pk_bf16_f32 v161, v34, v35
v_lshlrev_b32 v32, 16, v162
v_and_b32 v33, s45, v162
v_pk_mul_f32 v[32:33], v[32:33], s[38:39]
v_cvt_pk_bf16_f32 v162, v32, v33
v_lshlrev_b32 v34, 16, v163
v_and_b32 v35, s45, v163
v_pk_mul_f32 v[34:35], v[34:35], s[38:39]
v_cvt_pk_bf16_f32 v163, v34, v35
v_lshlrev_b32 v32, 16, v164
v_and_b32 v33, s45, v164
v_pk_mul_f32 v[32:33], v[32:33], s[38:39]
v_cvt_pk_bf16_f32 v164, v32, v33
v_lshlrev_b32 v34, 16, v165
v_and_b32 v35, s45, v165
v_pk_mul_f32 v[34:35], v[34:35], s[38:39]
v_cvt_pk_bf16_f32 v165, v34, v35
v_lshlrev_b32 v32, 16, v166
v_and_b32 v33, s45, v166
v_pk_mul_f32 v[32:33], v[32:33], s[38:39]
v_cvt_pk_bf16_f32 v166, v32, v33
v_lshlrev_b32 v34, 16, v167
v_and_b32 v35, s45, v167
v_pk_mul_f32 v[34:35], v[34:35], s[38:39]
v_cvt_pk_bf16_f32 v167, v34, v35
v_lshlrev_b32 v32, 16, v168
v_and_b32 v33, s45, v168
v_pk_mul_f32 v[32:33], v[32:33], s[38:39]
v_cvt_pk_bf16_f32 v168, v32, v33
v_lshlrev_b32 v34, 16, v169
v_and_b32 v35, s45, v169
v_pk_mul_f32 v[34:35], v[34:35], s[38:39]
v_cvt_pk_bf16_f32 v169, v34, v35
v_lshlrev_b32 v32, 16, v170
v_and_b32 v33, s45, v170
v_pk_mul_f32 v[32:33], v[32:33], s[38:39]
v_cvt_pk_bf16_f32 v170, v32, v33
v_lshlrev_b32 v34, 16, v171
v_and_b32 v35, s45, v171
v_pk_mul_f32 v[34:35], v[34:35], s[38:39]
v_cvt_pk_bf16_f32 v171, v34, v35
v_lshlrev_b32 v32, 16, v172
v_and_b32 v33, s45, v172
v_pk_mul_f32 v[32:33], v[32:33], s[38:39]
v_cvt_pk_bf16_f32 v172, v32, v33
v_lshlrev_b32 v34, 16, v173
v_and_b32 v35, s45, v173
v_pk_mul_f32 v[34:35], v[34:35], s[38:39]
v_cvt_pk_bf16_f32 v173, v34, v35
v_lshlrev_b32 v32, 16, v174
v_and_b32 v33, s45, v174
v_pk_mul_f32 v[32:33], v[32:33], s[38:39]
v_cvt_pk_bf16_f32 v174, v32, v33
v_lshlrev_b32 v34, 16, v175
v_and_b32 v35, s45, v175
v_pk_mul_f32 v[34:35], v[34:35], s[38:39]
v_cvt_pk_bf16_f32 v175, v34, v35
v_mov_b32 v36, 0xff800000
v_mov_b32 v37, 0xff800000
v_mov_b32 v38, 0xff800000
v_mov_b32 v39, 0xff800000
v_mov_b32 v40, 0xff800000
s_add_u32 s48, s57, 67108864
s_mov_b32 s49, 64
L_fb1:
buffer_load_dwordx4 v[56:59], v19, s[12:15], s48 offen
buffer_load_dwordx4 v[60:63], v19, s[12:15], s48 offen offset:64
buffer_load_dwordx4 v[64:67], v19, s[12:15], s48 offen offset:128
buffer_load_dwordx4 v[68:71], v19, s[12:15], s48 offen offset:192
s_waitcnt vmcnt(0)
v_mfma_f32_16x16x32_bf16 v[192:195], v[56:59], v[96:99], 0
v_mfma_f32_16x16x32_bf16 v[192:195], v[60:63], v[100:103], v[192:195]
v_mfma_f32_16x16x32_bf16 v[192:195], v[64:67], v[104:107], v[192:195]
v_mfma_f32_16x16x32_bf16 v[192:195], v[68:71], v[108:111], v[192:195]
v_mfma_f32_16x16x32_bf16 v[196:199], v[56:59], v[112:115], 0
v_mfma_f32_16x16x32_bf16 v[196:199], v[60:63], v[116:119], v[196:199]
v_mfma_f32_16x16x32_bf16 v[196:199], v[64:67], v[120:123], v[196:199]
v_mfma_f32_16x16x32_bf16 v[196:199], v[68:71], v[124:127], v[196:199]
v_mfma_f32_16x16x32_bf16 v[200:203], v[56:59], v[128:131], 0
v_mfma_f32_16x16x32_bf16 v[200:203], v[60:63], v[132:135], v[200:203]
v_mfma_f32_16x16x32_bf16 v[200:203], v[64:67], v[136:139], v[200:203]
v_mfma_f32_16x16x32_bf16 v[200:203], v[68:71], v[140:143], v[200:203]
v_mfma_f32_16x16x32_bf16 v[204:207], v[56:59], v[144:147], 0
v_mfma_f32_16x16x32_bf16 v[204:207], v[60:63], v[148:151], v[204:207]
v_mfma_f32_16x16x32_bf16 v[204:207], v[64:67], v[152:155], v[204:207]
v_mfma_f32_16x16x32_bf16 v[204:207], v[68:71], v[156:159], v[204:207]
v_mfma_f32_16x16x32_bf16 v[208:211], v[56:59], v[160:163], 0
v_mfma_f32_16x16x32_bf16 v[208:211], v[60:63], v[164:167], v[208:211]
v_mfma_f32_16x16x32_bf16 v[208:211], v[64:67], v[168:171], v[208:211]
v_mfma_f32_16x16x32_bf16 v[208:211], v[68:71], v[172:175], v[208:211]
s_nop 7
s_nop 1
v_max3_f32 v36, v36, v192, v193
v_max3_f32 v36, v36, v194, v195
v_max3_f32 v37, v37, v196, v197
v_max3_f32 v37, v37, v198, v199
v_max3_f32 v38, v38, v200, v201
v_max3_f32 v38, v38, v202, v203
v_max3_f32 v39, v39, v204, v205
v_max3_f32 v39, v39, v206, v207
v_max3_f32 v40, v40, v208, v209
v_max3_f32 v40, v40, v210, v211
s_add_u32 s48, s48, 4096
s_sub_u32 s49, s49, 1
s_cmp_lg_u32 s49, 0
s_cbranch_scc1 L_fb1
v_xor_b32 v20, 16, v16
v_lshlrev_b32 v20, 2, v20
ds_bpermute_b32 v56, v20, v36
ds_bpermute_b32 v57, v20, v37
ds_bpermute_b32 v58, v20, v38
ds_bpermute_b32 v59, v20, v39
ds_bpermute_b32 v60, v20, v40
s_waitcnt lgkmcnt(0)
v_max_f32 v36, v36, v56
v_max_f32 v37, v37, v57
v_max_f32 v38, v38, v58
v_max_f32 v39, v39, v59
v_max_f32 v40, v40, v60
v_xor_b32 v20, 32, v16
v_lshlrev_b32 v20, 2, v20
ds_bpermute_b32 v56, v20, v36
ds_bpermute_b32 v57, v20, v37
ds_bpermute_b32 v58, v20, v38
ds_bpermute_b32 v59, v20, v39
ds_bpermute_b32 v60, v20, v40
s_waitcnt lgkmcnt(0)
v_max_f32 v36, v36, v56
v_max_f32 v37, v37, v57
v_max_f32 v38, v38, v58
v_max_f32 v39, v39, v59
v_max_f32 v40, v40, v60
v_xor_b32 v36, 0x80000000, v36
v_xor_b32 v37, 0x80000000, v37
v_xor_b32 v38, 0x80000000, v38
v_xor_b32 v39, 0x80000000, v39
v_xor_b32 v40, 0x80000000, v40
v_accvgpr_write_b32 a237, v36
v_accvgpr_write_b32 a238, v37
v_accvgpr_write_b32 a239, v38
v_accvgpr_write_b32 a240, v39
v_accvgpr_write_b32 a241, v40
s_mov_b32 s14, 4096
s_nop 1
s_branch L_start
.section .rodata,"a"
.p2align 6
.amdhsa_kernel standalone__gqa_softmax__near_ridge_kernel
  .amdhsa_next_free_vgpr 512
  .amdhsa_next_free_sgpr 102
  .amdhsa_accum_offset 256
  .amdhsa_group_segment_fixed_size 0
  .amdhsa_kernarg_size 48
  .amdhsa_user_sgpr_count 2
  .amdhsa_user_sgpr_kernarg_segment_ptr 1
  .amdhsa_system_sgpr_workgroup_id_x 1
.end_amdhsa_kernel
```
